```python
import torch

def _softmax(x, axis=-1):
    return torch.softmax(x, dim=axis)

def _gelu(x):
    return torch.nn.functional.gelu(x, approximate='tanh')

def _silu(x):
    return torch.nn.functional.silu(x)

def _sigmoid(x):
    return torch.sigmoid(x)

def _layernorm(x, axis=-1, eps=1e-05):
    m = x.mean(dim=axis, keepdim=True)
    v = x.var(dim=axis, keepdim=True, unbiased=False)
    return (x - m) / torch.sqrt(v + eps)

def _scatter_add(tgt, idx, src, axis=0):
    return tgt.clone().index_add_(axis, idx, src)

def _segment_sum(src, seg, n):
    out = torch.zeros((n,) + src.shape[1:], dtype=src.dtype)
    return out.index_add_(0, seg, src)

def _pad(x, pw):
    flat = tuple((v for pair in reversed(pw) for v in pair))
    return torch.nn.functional.pad(x, flat)
kernel_name = 'parallel_sum__memory_aug_recurrent_mem_tr__dense_activation_relu__prompt'

def setup_inputs():

    _w = lambda a: (lambda t: t.to(torch.bfloat16) if t.is_floating_point() else t)(torch.as_tensor(a))

    def _A_setup():
        B, S, Dm = (1, 2048, 576)
        H, Dh = (32, 128)
        M, seg = (8, 32)
        seg = min(seg, S)
        S = S // seg * seg
        return {'x': _w((lambda *s: torch.randn(*s, dtype=torch.bfloat16) * 0.05)(B, S, Dm)), 'mem0': _w((lambda *s: torch.randn(*s, dtype=torch.bfloat16) * 1.6)(B, M, Dm)), 'Wq': _w((lambda *s: torch.randn(*s, dtype=torch.bfloat16) * 0.8)(Dm, H, Dh) * Dm ** (-0.5)), 'Wk': _w((lambda *s: torch.randn(*s, dtype=torch.bfloat16) * 0.8)(Dm, H, Dh) * Dm ** (-0.5)), 'Wv': _w((lambda *s: torch.randn(*s, dtype=torch.bfloat16) * 1.6)(Dm, H, Dh) * Dm ** (-0.5)), 'Wo': _w((lambda *s: torch.randn(*s, dtype=torch.bfloat16) * 1.6)(H, Dh, Dm) * (H * Dh) ** (-0.5)), 'seg_len': seg}
    _A_in = _A_setup()

    def _B_setup():
        B, S, D, Dff = (1, 2048, 576, 4608)
        return {'x': _w((lambda *s: torch.randn(*s, dtype=torch.bfloat16) * 0.05)(B, S, D)), 'w1': _w((lambda *s: torch.randn(*s, dtype=torch.bfloat16) * 0.05)(D, Dff)), 'w2': _w((lambda *s: torch.randn(*s, dtype=torch.bfloat16) * 0.05)(Dff, D))}
    _B_in = _B_setup()
    return {'A_x': _A_in['x'], 'A_mem0': _A_in['mem0'], 'A_Wq': _A_in['Wq'], 'A_Wk': _A_in['Wk'], 'A_Wv': _A_in['Wv'], 'A_Wo': _A_in['Wo'], 'A_seg_len': _A_in['seg_len'], 'B_x': _B_in['x'], 'B_w1': _B_in['w1'], 'B_w2': _B_in['w2']}

def reference(A_x, A_mem0, A_Wq, A_Wk, A_Wv, A_Wo, A_seg_len, B_x, B_w1, B_w2):

    def _A_ref(x, mem0, Wq, Wk, Wv, Wo, seg_len):
        B, S, Dm = x.shape
        H, Dh = (Wq.shape[1], Wq.shape[2])
        M = mem0.shape[1]
        scale = Dh ** (-0.5)
        n_seg = S // seg_len
        L = M + seg_len
        idx = torch.arange(L)
        mask = (idx[:, None] < M) | (idx[:, None] >= idx[None, :])
        mem = mem0
        outs = []
        for s in range(n_seg):
            xs = x[:, s * seg_len:(s + 1) * seg_len, :].clone()
            h = torch.concatenate([mem, xs], axis=1)
            q = torch.einsum('btd,dhe->bhte', h, Wq)
            k = torch.einsum('btd,dhe->bhte', h, Wk)
            v = torch.einsum('btd,dhe->bhte', h, Wv)
            scores = torch.einsum('bhqe,bhke->bhqk', q, k) * scale
            scores = torch.where(mask[None, None], scores, -1000000000.0)
            p = _softmax(scores, axis=-1)
            o = torch.einsum('bhqk,bhke->bhqe', p, v)
            o = torch.einsum('bhte,hed->btd', o, Wo)
            mem = o[:, :M, :].clone()
            outs.append(o[:, M:, :])
        return torch.concatenate(outs, axis=1)

    def _B_ref(x, w1, w2):
        h = torch.einsum('bsd,df->bsf', x, w1)
        zero = torch.zeros_like(h)
        h = torch.maximum(h, zero)
        return torch.einsum('bsf,fd->bsd', h, w2)
    x = A_x
    xn = _layernorm(x, axis=-1)
    return x + _A_ref(xn, A_mem0, A_Wq, A_Wk, A_Wv, A_Wo, A_seg_len) + _B_ref(xn, B_w1, B_w2)
```

```asm
; @launch grid=(256,1,1) block=(256,1,1) lds=163840
.amdgcn_target "amdgcn-amd-amdhsa--gfx950"
.text
.globl parallel_sum__memory_aug_recurrent_mem_tr__dense_activation_relu__prompt_kernel
.p2align 8
.type parallel_sum__memory_aug_recurrent_mem_tr__dense_activation_relu__prompt_kernel,@function
parallel_sum__memory_aug_recurrent_mem_tr__dense_activation_relu__prompt_kernel:
    s_cmp_ge_u32 s2, 256
    s_cbranch_scc1 W_X
    s_and_b32 s3, s2, 7
    s_cmp_lg_u32 s3, 0
    s_cbranch_scc1 W_go
    s_lshr_b32 s3, s2, 3
    v_lshrrev_b32 v1, 6, v0
    s_nop 0
    v_readfirstlane_b32 s4, v1
    s_load_dwordx2 s[8:9], s[0:1], 96
    s_mov_b32 s10, 268435456
    s_mov_b32 s11, 0x00020000
    s_load_dwordx2 s[12:13], s[0:1], 8
    s_mov_b32 s14, 9216
    s_mov_b32 s15, 0x00020000
    s_load_dwordx2 s[56:57], s[0:1], 16
    s_mov_b32 s58, 4718592
    s_mov_b32 s59, 0x00020000
    s_load_dwordx2 s[60:61], s[0:1], 24
    s_mov_b32 s62, 4718592
    s_mov_b32 s63, 0x00020000
    s_load_dwordx2 s[64:65], s[0:1], 32
    s_mov_b32 s66, 4718592
    s_mov_b32 s67, 0x00020000
    s_load_dwordx2 s[68:69], s[0:1], 40
    s_mov_b32 s70, 4718592
    s_mov_b32 s71, 0x00020000
    s_load_dwordx2 s[76:77], s[0:1], 88
    s_mov_b32 s78, 256
    s_mov_b32 s79, 0x00020000
    s_memtime s[80:81]
    s_mov_b32 s41, 400000
    v_and_b32 v1, 63, v0
    v_and_b32 v2, 15, v1
    v_lshrrev_b32 v3, 4, v1
    v_lshrrev_b32 v4, 2, v2
    v_and_b32 v5, 1, v2
    v_lshl_add_u32 v4, v4, 1, v5
    v_bfe_u32 v5, v2, 1, 1
    v_and_b32 v6, 1, v3
    v_lshrrev_b32 v7, 1, v3
    s_waitcnt lgkmcnt(0)
    v_lshlrev_b32 v77, 4, v1
    s_mul_i32 s42, s3, 18
    v_add_u32 v8, s42, v0
    v_and_b32 v9, 7, v8
    v_lshrrev_b32 v10, 3, v8
    v_mul_u32_u24 v9, 1152, v9
    v_lshl_add_u32 v9, v10, 4, v9
    v_cmp_gt_u32 vcc, 18, v0
    s_and_saveexec_b64 s[42:43], vcc
    s_cbranch_execz CH_NOM_1
    buffer_load_dwordx4 v[68:71], v9, s[12:15], 0 offen
CH_NOM_1:
    s_mov_b64 exec, s[42:43]
    v_and_b32 v11, 7, v8
    v_lshlrev_b32 v11, 5, v11
    v_lshrrev_b32 v20, 1, v10
    v_lshl_add_u32 v11, v20, 8, v11
    v_and_b32 v20, 1, v10
    v_lshl_add_u32 v72, v20, 4, v11
    v_lshlrev_b32 v73, 4, v8
    v_lshrrev_b32 v8, 4, v1
    v_and_b32 v9, 15, v1
    s_and_b32 s42, s4, 3
    s_lshl_b32 s42, s42, 1
    v_and_b32 v10, 1, v8
    v_or_b32 v10, s42, v10
    v_lshrrev_b32 v11, 1, v9
    v_xor_b32 v11, v11, v10
    v_and_b32 v12, 1, v9
    v_lshlrev_b32 v12, 4, v12
    s_lshl_b32 s43, s4, 2
    v_add_u32 v8, s43, v8
    v_lshl_add_u32 v13, v11, 5, v12
    v_lshl_add_u32 v24, v8, 13, v13
    v_mul_u32_u24 v14, 1152, v8
    v_add_u32 v25, v14, v13
    v_lshrrev_b32 v15, 2, v11
    v_mul_u32_u24 v15, 73728, v15
    v_and_b32 v11, 3, v11
    v_lshl_add_u32 v11, v11, 5, v12
    v_add3_u32 v26, v14, v15, v11
    v_add_u32 v26, 1024, v26
    s_lshl_b32 s44, s3, 8
    s_mul_i32 s45, s3, 147456
    s_lshl_b32 s46, s4, 10
    s_add_u32 s46, s46, 16384
    s_add_u32 m0, s46, 0
    s_add_u32 s47, s44, 0
    buffer_load_dwordx4 v24, s[56:59], s47 offen lds
    s_add_u32 m0, s46, 4096
    s_add_u32 s47, s44, 131072
    buffer_load_dwordx4 v24, s[56:59], s47 offen lds
    s_add_u32 m0, s46, 8192
    s_add_u32 s47, s44, 262144
    buffer_load_dwordx4 v24, s[56:59], s47 offen lds
    s_add_u32 m0, s46, 12288
    s_add_u32 s47, s44, 393216
    buffer_load_dwordx4 v24, s[56:59], s47 offen lds
    s_add_u32 m0, s46, 16384
    s_add_u32 s47, s44, 524288
    buffer_load_dwordx4 v24, s[56:59], s47 offen lds
    s_add_u32 m0, s46, 20480
    s_add_u32 s47, s44, 655360
    buffer_load_dwordx4 v24, s[56:59], s47 offen lds
    s_add_u32 m0, s46, 24576
    s_add_u32 s47, s44, 786432
    buffer_load_dwordx4 v24, s[56:59], s47 offen lds
    s_add_u32 m0, s46, 28672
    s_add_u32 s47, s44, 917504
    buffer_load_dwordx4 v24, s[56:59], s47 offen lds
    s_add_u32 m0, s46, 32768
    s_add_u32 s47, s44, 1048576
    buffer_load_dwordx4 v24, s[56:59], s47 offen lds
    s_add_u32 m0, s46, 36864
    s_add_u32 s47, s44, 1179648
    buffer_load_dwordx4 v24, s[56:59], s47 offen lds
    s_add_u32 m0, s46, 40960
    s_add_u32 s47, s44, 1310720
    buffer_load_dwordx4 v24, s[56:59], s47 offen lds
    s_add_u32 m0, s46, 45056
    s_add_u32 s47, s44, 1441792
    buffer_load_dwordx4 v24, s[56:59], s47 offen lds
    s_add_u32 m0, s46, 49152
    s_add_u32 s47, s44, 1572864
    buffer_load_dwordx4 v24, s[56:59], s47 offen lds
    s_add_u32 m0, s46, 53248
    s_add_u32 s47, s44, 1703936
    buffer_load_dwordx4 v24, s[56:59], s47 offen lds
    s_add_u32 m0, s46, 57344
    s_add_u32 s47, s44, 1835008
    buffer_load_dwordx4 v24, s[56:59], s47 offen lds
    s_add_u32 m0, s46, 61440
    s_add_u32 s47, s44, 1966080
    buffer_load_dwordx4 v24, s[56:59], s47 offen lds
    s_add_u32 m0, s46, 65536
    s_add_u32 s47, s44, 2097152
    buffer_load_dwordx4 v24, s[56:59], s47 offen lds
    s_add_u32 m0, s46, 69632
    s_add_u32 s47, s44, 2228224
    buffer_load_dwordx4 v24, s[56:59], s47 offen lds
    s_add_u32 m0, s46, 73728
    s_add_u32 s47, s44, 2359296
    buffer_load_dwordx4 v24, s[56:59], s47 offen lds
    s_add_u32 m0, s46, 77824
    s_add_u32 s47, s44, 2490368
    buffer_load_dwordx4 v24, s[56:59], s47 offen lds
    s_add_u32 m0, s46, 81920
    s_add_u32 s47, s44, 2621440
    buffer_load_dwordx4 v24, s[56:59], s47 offen lds
    s_add_u32 m0, s46, 86016
    s_add_u32 s47, s44, 2752512
    buffer_load_dwordx4 v24, s[56:59], s47 offen lds
    s_add_u32 m0, s46, 90112
    s_add_u32 s47, s44, 2883584
    buffer_load_dwordx4 v24, s[56:59], s47 offen lds
    s_add_u32 m0, s46, 94208
    s_add_u32 s47, s44, 3014656
    buffer_load_dwordx4 v24, s[56:59], s47 offen lds
    s_add_u32 m0, s46, 98304
    s_add_u32 s47, s44, 3145728
    buffer_load_dwordx4 v24, s[56:59], s47 offen lds
    s_add_u32 m0, s46, 102400
    s_add_u32 s47, s44, 3276800
    buffer_load_dwordx4 v24, s[56:59], s47 offen lds
    s_add_u32 m0, s46, 106496
    s_add_u32 s47, s44, 3407872
    buffer_load_dwordx4 v24, s[56:59], s47 offen lds
    s_add_u32 m0, s46, 110592
    s_add_u32 s47, s44, 3538944
    buffer_load_dwordx4 v24, s[56:59], s47 offen lds
    v_mov_b32 v16, -1
    v_mov_b32 v17, -1
    v_mov_b32 v18, -1
    v_mov_b32 v19, -1
    v_cmp_gt_u32 vcc, 18, v0
    s_and_saveexec_b64 s[42:43], vcc
    s_cbranch_execz CH_NOM_2
    s_mov_b32 s44, 117253120
    buffer_store_dwordx4 v[16:19], v73, s[8:11], s44 offen sc1
CH_NOM_2:
    s_mov_b64 exec, s[42:43]
    v_lshlrev_b32 v8, 4, v0
    s_mul_i32 s44, s3, 9216
    s_add_u32 s44, s44, 116654080
    s_add_u32 s45, s44, 0
    buffer_store_dwordx4 v[16:19], v8, s[8:11], s45 offen sc1
    s_add_u32 s45, s44, 4096
    buffer_store_dwordx4 v[16:19], v8, s[8:11], s45 offen sc1
    s_add_u32 s45, s44, 294912
    buffer_store_dwordx4 v[16:19], v8, s[8:11], s45 offen sc1
    s_add_u32 s45, s44, 299008
    buffer_store_dwordx4 v[16:19], v8, s[8:11], s45 offen sc1
    v_cmp_gt_u32 vcc, 64, v0
    s_and_saveexec_b64 s[42:43], vcc
    s_cbranch_execz CH_NOP_3
    s_add_u32 s45, s44, 8192
    buffer_store_dwordx4 v[16:19], v8, s[8:11], s45 offen sc1
    s_add_u32 s45, s44, 303104
    buffer_store_dwordx4 v[16:19], v8, s[8:11], s45 offen sc1
CH_NOP_3:
    s_mov_b64 exec, s[42:43]
    v_lshlrev_b32 v77, 4, v1
    v_mov_b32 v76, 0x4444
    v_mov_b32 v8, 0xeeee
    v_and_b32 v9, 1, v2
    v_cmp_eq_u32 vcc, 0, v9
    s_nop 1
    v_cndmask_b32 v76, v8, v76, vcc
    v_mov_b32 v9, 0x3f80
    v_mov_b32 v10, 0x3f800000
    v_lshlrev_b32 v8, 2, v3
    v_add_u32 v11, 0, v8
    v_cmp_eq_u32 vcc, v11, v2
    s_nop 1
    v_cndmask_b32 v78, 0, v9, vcc
    v_add_u32 v11, 1, v11
    v_cmp_eq_u32 vcc, v11, v2
    s_nop 1
    v_cndmask_b32 v78, v78, v10, vcc
    v_add_u32 v11, 2, v8
    v_cmp_eq_u32 vcc, v11, v2
    s_nop 1
    v_cndmask_b32 v79, 0, v9, vcc
    v_add_u32 v11, 1, v11
    v_cmp_eq_u32 vcc, v11, v2
    s_nop 1
    v_cndmask_b32 v79, v79, v10, vcc
    v_lshl_add_u32 v12, v5, 1, v7
    v_lshlrev_b32 v12, 7, v12
    v_lshl_add_u32 v12, v4, 4, v12
    v_lshl_add_u32 v12, v6, 3, v12
    v_lshlrev_b32 v13, 10, v7
    v_lshl_add_u32 v13, v2, 4, v13
    v_lshl_add_u32 v13, v6, 3, v13
    v_and_b32 v18, 7, v2
    v_lshlrev_b32 v18, 4, v18
    v_lshl_add_u32 v18, v3, 7, v18
    v_mov_b32 v19, 0x4444
    v_mov_b32 v8, 0xeeee
    v_cmp_gt_u32 vcc, 8, v2
    s_nop 1
    v_cndmask_b32 v19, v8, v19, vcc
    v_lshrrev_b32 v8, 1, v2
    v_and_b32 v9, 1, v2
    v_lshl_add_u32 v9, v3, 1, v9
    v_mul_u32_u24 v9, 576, v9
    v_add_u32 v14, v8, v9
    v_and_b32 v11, 7, v2
    v_lshlrev_b32 v11, 5, v11
    v_lshl_add_u32 v15, v3, 2, v11
    v_lshlrev_b32 v20, 11, v6
    v_lshl_add_u32 v20, v7, 10, v20
    v_lshl_add_u32 v20, v2, 4, v20
    v_lshl_or_b32 v12, v14, 16, v12
    v_lshl_or_b32 v14, v15, 16, v20
    v_mov_b32 v15, v13
    v_lshl_or_b32 v13, v19, 16, v18
    ds_write_b128 v77, v[12:15] offset:15360
    v_bfe_u32 v8, v1, 2, 2
    v_and_b32 v9, 3, v1
    v_and_b32 v10, 1, v8
    v_lshrrev_b32 v11, 1, v8
    v_lshl_add_u32 v12, v11, 3, v10
    v_lshl_add_u32 v12, v6, 2, v12
    v_lshl_add_u32 v12, v7, 4, v12
    v_lshl_add_u32 v13, v6, 1, v10
    v_lshl_add_u32 v13, v11, 2, v13
    v_lshlrev_b32 v12, 8, v12
    v_lshl_add_u32 v12, v9, 3, v12
    v_add_u32 v12, 16384, v12
    s_lshl_b32 s42, s4, 1
    s_add_u32 s42, s42, 0
    v_xor_b32 v14, s42, v13
    v_lshl_add_u32 v27, v14, 5, v12
    s_lshl_b32 s42, s4, 1
    s_add_u32 s42, s42, 1
    v_xor_b32 v14, s42, v13
    v_lshl_add_u32 v28, v14, 5, v12
    v_lshl_add_u32 v12, v6, 2, v10
    v_lshl_add_u32 v12, v7, 3, v12
    v_lshl_add_u32 v13, v6, 1, v10
    v_lshl_add_u32 v13, v7, 2, v13
    v_lshlrev_b32 v14, 2, v11
    v_add_u32 v14, s4, v14
    v_xor_b32 v14, v14, v13
    v_lshlrev_b32 v12, 8, v12
    v_lshl_add_u32 v12, v9, 3, v12
    v_lshl_add_u32 v12, v14, 5, v12
    v_add_u32 v29, 16384, v12
    v_add_u32 v30, 8192, v29
    v_cmp_gt_u32 vcc, 18, v0
    s_and_saveexec_b64 s[42:43], vcc
    s_cbranch_execz CH_NOM_4
    s_mov_b32 s47, 117243904
    s_waitcnt vmcnt(35)
    buffer_store_dwordx4 v[68:71], v72, s[8:11], s47 offen sc1
CH_NOM_4:
    s_mov_b64 exec, s[42:43]
    s_lshl_b32 s44, s3, 8
    s_mul_i32 s45, s3, 147456
    s_waitcnt vmcnt(28) lgkmcnt(0)
    s_barrier
    v_add_u32 v32, 0, v27
    v_add_u32 v33, 0, v28
    ds_read_b64_tr_b16 v[80:81], v32 offset:0
    ds_read_b64_tr_b16 v[82:83], v32 offset:512
    ds_read_b64_tr_b16 v[84:85], v32 offset:8192
    ds_read_b64_tr_b16 v[86:87], v32 offset:8704
    ds_read_b64_tr_b16 v[88:89], v33 offset:0
    ds_read_b64_tr_b16 v[90:91], v33 offset:512
    ds_read_b64_tr_b16 v[92:93], v33 offset:8192
    ds_read_b64_tr_b16 v[94:95], v33 offset:8704
    s_waitcnt vmcnt(24) lgkmcnt(0)
    s_barrier
    s_add_u32 m0, s46, 114688
    s_add_u32 s47, s44, 3670016
    buffer_load_dwordx4 v24, s[56:59], s47 offen lds
    s_add_u32 m0, s46, 118784
    s_add_u32 s47, s44, 3801088
    buffer_load_dwordx4 v24, s[56:59], s47 offen lds
    s_add_u32 m0, s46, 122880
    s_add_u32 s47, s44, 3932160
    buffer_load_dwordx4 v24, s[56:59], s47 offen lds
    s_add_u32 m0, s46, 126976
    s_add_u32 s47, s44, 4063232
    buffer_load_dwordx4 v24, s[56:59], s47 offen lds
    v_add_u32 v32, 16384, v27
    v_add_u32 v33, 16384, v28
    ds_read_b64_tr_b16 v[96:97], v32 offset:0
    ds_read_b64_tr_b16 v[98:99], v32 offset:512
    ds_read_b64_tr_b16 v[100:101], v32 offset:8192
    ds_read_b64_tr_b16 v[102:103], v32 offset:8704
    ds_read_b64_tr_b16 v[104:105], v33 offset:0
    ds_read_b64_tr_b16 v[106:107], v33 offset:512
    ds_read_b64_tr_b16 v[108:109], v33 offset:8192
    ds_read_b64_tr_b16 v[110:111], v33 offset:8704
    s_waitcnt vmcnt(24) lgkmcnt(0)
    s_barrier
    s_add_u32 m0, s46, 131072
    s_add_u32 s47, s44, 0
    buffer_load_dwordx4 v24, s[60:63], s47 offen lds
    s_add_u32 m0, s46, 135168
    s_add_u32 s47, s44, 131072
    buffer_load_dwordx4 v24, s[60:63], s47 offen lds
    s_add_u32 m0, s46, 139264
    s_add_u32 s47, s44, 262144
    buffer_load_dwordx4 v24, s[60:63], s47 offen lds
    s_add_u32 m0, s46, 143360
    s_add_u32 s47, s44, 393216
    buffer_load_dwordx4 v24, s[60:63], s47 offen lds
    v_add_u32 v32, 32768, v27
    v_add_u32 v33, 32768, v28
    ds_read_b64_tr_b16 v[112:113], v32 offset:0
    ds_read_b64_tr_b16 v[114:115], v32 offset:512
    ds_read_b64_tr_b16 v[116:117], v32 offset:8192
    ds_read_b64_tr_b16 v[118:119], v32 offset:8704
    ds_read_b64_tr_b16 v[120:121], v33 offset:0
    ds_read_b64_tr_b16 v[122:123], v33 offset:512
    ds_read_b64_tr_b16 v[124:125], v33 offset:8192
    ds_read_b64_tr_b16 v[126:127], v33 offset:8704
    s_waitcnt vmcnt(24) lgkmcnt(0)
    s_barrier
    s_add_u32 m0, s46, 0
    s_add_u32 s47, s44, 524288
    buffer_load_dwordx4 v24, s[60:63], s47 offen lds
    s_add_u32 m0, s46, 4096
    s_add_u32 s47, s44, 655360
    buffer_load_dwordx4 v24, s[60:63], s47 offen lds
    s_add_u32 m0, s46, 8192
    s_add_u32 s47, s44, 786432
    buffer_load_dwordx4 v24, s[60:63], s47 offen lds
    s_add_u32 m0, s46, 12288
    s_add_u32 s47, s44, 917504
    buffer_load_dwordx4 v24, s[60:63], s47 offen lds
    v_add_u32 v32, 49152, v27
    v_add_u32 v33, 49152, v28
    ds_read_b64_tr_b16 v[128:129], v32 offset:0
    ds_read_b64_tr_b16 v[130:131], v32 offset:512
    ds_read_b64_tr_b16 v[132:133], v32 offset:8192
    ds_read_b64_tr_b16 v[134:135], v32 offset:8704
    ds_read_b64_tr_b16 v[136:137], v33 offset:0
    ds_read_b64_tr_b16 v[138:139], v33 offset:512
    ds_read_b64_tr_b16 v[140:141], v33 offset:8192
    ds_read_b64_tr_b16 v[142:143], v33 offset:8704
    s_waitcnt vmcnt(24) lgkmcnt(0)
    s_barrier
    s_add_u32 m0, s46, 16384
    s_add_u32 s47, s44, 1048576
    buffer_load_dwordx4 v24, s[60:63], s47 offen lds
    s_add_u32 m0, s46, 20480
    s_add_u32 s47, s44, 1179648
    buffer_load_dwordx4 v24, s[60:63], s47 offen lds
    s_add_u32 m0, s46, 24576
    s_add_u32 s47, s44, 1310720
    buffer_load_dwordx4 v24, s[60:63], s47 offen lds
    s_add_u32 m0, s46, 28672
    s_add_u32 s47, s44, 1441792
    buffer_load_dwordx4 v24, s[60:63], s47 offen lds
    v_add_u32 v32, 65536, v27
    v_add_u32 v33, 65536, v28
    ds_read_b64_tr_b16 v[144:145], v32 offset:0
    ds_read_b64_tr_b16 v[146:147], v32 offset:512
    ds_read_b64_tr_b16 v[148:149], v32 offset:8192
    ds_read_b64_tr_b16 v[150:151], v32 offset:8704
    ds_read_b64_tr_b16 v[152:153], v33 offset:0
    ds_read_b64_tr_b16 v[154:155], v33 offset:512
    ds_read_b64_tr_b16 v[156:157], v33 offset:8192
    ds_read_b64_tr_b16 v[158:159], v33 offset:8704
    s_waitcnt vmcnt(24) lgkmcnt(0)
    s_barrier
    s_add_u32 m0, s46, 32768
    s_add_u32 s47, s44, 2097152
    buffer_load_dwordx4 v24, s[60:63], s47 offen lds
    s_add_u32 m0, s46, 36864
    s_add_u32 s47, s44, 2228224
    buffer_load_dwordx4 v24, s[60:63], s47 offen lds
    s_add_u32 m0, s46, 40960
    s_add_u32 s47, s44, 2359296
    buffer_load_dwordx4 v24, s[60:63], s47 offen lds
    s_add_u32 m0, s46, 45056
    s_add_u32 s47, s44, 2490368
    buffer_load_dwordx4 v24, s[60:63], s47 offen lds
    v_add_u32 v32, 81920, v27
    v_add_u32 v33, 81920, v28
    ds_read_b64_tr_b16 v[160:161], v32 offset:0
    ds_read_b64_tr_b16 v[162:163], v32 offset:512
    ds_read_b64_tr_b16 v[164:165], v32 offset:8192
    ds_read_b64_tr_b16 v[166:167], v32 offset:8704
    ds_read_b64_tr_b16 v[168:169], v33 offset:0
    ds_read_b64_tr_b16 v[170:171], v33 offset:512
    ds_read_b64_tr_b16 v[172:173], v33 offset:8192
    ds_read_b64_tr_b16 v[174:175], v33 offset:8704
    s_waitcnt vmcnt(24) lgkmcnt(0)
    s_barrier
    s_add_u32 m0, s46, 49152
    s_add_u32 s47, s44, 2621440
    buffer_load_dwordx4 v24, s[60:63], s47 offen lds
    s_add_u32 m0, s46, 53248
    s_add_u32 s47, s44, 2752512
    buffer_load_dwordx4 v24, s[60:63], s47 offen lds
    s_add_u32 m0, s46, 57344
    s_add_u32 s47, s44, 2883584
    buffer_load_dwordx4 v24, s[60:63], s47 offen lds
    s_add_u32 m0, s46, 61440
    s_add_u32 s47, s44, 3014656
    buffer_load_dwordx4 v24, s[60:63], s47 offen lds
    v_add_u32 v32, 98304, v27
    v_add_u32 v33, 98304, v28
    ds_read_b64_tr_b16 v[176:177], v32 offset:0
    ds_read_b64_tr_b16 v[178:179], v32 offset:512
    ds_read_b64_tr_b16 v[180:181], v32 offset:8192
    ds_read_b64_tr_b16 v[182:183], v32 offset:8704
    ds_read_b64_tr_b16 v[184:185], v33 offset:0
    ds_read_b64_tr_b16 v[186:187], v33 offset:512
    ds_read_b64_tr_b16 v[188:189], v33 offset:8192
    ds_read_b64_tr_b16 v[190:191], v33 offset:8704
    s_waitcnt vmcnt(20) lgkmcnt(0)
    s_barrier
    s_cmp_lg_u32 s4, 0
    s_cbranch_scc1 CH_AR_5
    s_getreg_b32 s42, hwreg(HW_REG_XCC_ID)
    s_and_b32 s42, s42, 15
    s_mul_i32 s43, s42, s42
    s_lshl_b32 s43, s43, 9
    s_add_u32 s42, s42, s43
    s_add_u32 s42, s42, 0x400000
    v_mov_b32 v8, s42
    s_mov_b64 exec, 1
    buffer_atomic_add v8, off, s[76:79], 0 offset:0 sc1
    s_mov_b64 exec, -1
CH_AR_5:
    s_add_u32 m0, s46, 65536
    s_add_u32 s47, s44, 3145728
    buffer_load_dwordx4 v24, s[60:63], s47 offen lds
    s_add_u32 m0, s46, 69632
    s_add_u32 s47, s44, 3276800
    buffer_load_dwordx4 v24, s[60:63], s47 offen lds
    s_add_u32 m0, s46, 73728
    s_add_u32 s47, s44, 3407872
    buffer_load_dwordx4 v24, s[60:63], s47 offen lds
    s_add_u32 m0, s46, 77824
    s_add_u32 s47, s44, 3538944
    buffer_load_dwordx4 v24, s[60:63], s47 offen lds
    v_add_u32 v32, 114688, v27
    v_add_u32 v33, 114688, v28
    ds_read_b64_tr_b16 v[192:193], v32 offset:0
    ds_read_b64_tr_b16 v[194:195], v32 offset:512
    ds_read_b64_tr_b16 v[196:197], v32 offset:8192
    ds_read_b64_tr_b16 v[198:199], v32 offset:8704
    ds_read_b64_tr_b16 v[200:201], v33 offset:0
    ds_read_b64_tr_b16 v[202:203], v33 offset:512
    ds_read_b64_tr_b16 v[204:205], v33 offset:8192
    ds_read_b64_tr_b16 v[206:207], v33 offset:8704
    s_waitcnt vmcnt(20) lgkmcnt(0)
    s_barrier
    s_add_u32 m0, s46, 81920
    s_add_u32 s47, s44, 4194304
    buffer_load_dwordx4 v24, s[60:63], s47 offen lds
    s_add_u32 m0, s46, 86016
    s_add_u32 s47, s44, 4325376
    buffer_load_dwordx4 v24, s[60:63], s47 offen lds
    s_add_u32 m0, s46, 90112
    s_add_u32 s47, s44, 4456448
    buffer_load_dwordx4 v24, s[60:63], s47 offen lds
    s_add_u32 m0, s46, 94208
    s_add_u32 s47, s44, 4587520
    buffer_load_dwordx4 v24, s[60:63], s47 offen lds
    v_add_u32 v32, 131072, v27
    v_add_u32 v33, 131072, v28
    ds_read_b64_tr_b16 v[208:209], v32 offset:0
    ds_read_b64_tr_b16 v[210:211], v32 offset:512
    ds_read_b64_tr_b16 v[212:213], v32 offset:8192
    ds_read_b64_tr_b16 v[214:215], v32 offset:8704
    ds_read_b64_tr_b16 v[216:217], v33 offset:0
    ds_read_b64_tr_b16 v[218:219], v33 offset:512
    ds_read_b64_tr_b16 v[220:221], v33 offset:8192
    ds_read_b64_tr_b16 v[222:223], v33 offset:8704
    s_waitcnt vmcnt(20) lgkmcnt(0)
    s_barrier
    s_add_u32 m0, s46, 98304
    s_add_u32 s47, s44, 0
    buffer_load_dwordx4 v24, s[64:67], s47 offen lds
    s_add_u32 m0, s46, 102400
    s_add_u32 s47, s44, 131072
    buffer_load_dwordx4 v24, s[64:67], s47 offen lds
    s_add_u32 m0, s46, 106496
    s_add_u32 s47, s44, 262144
    buffer_load_dwordx4 v24, s[64:67], s47 offen lds
    s_add_u32 m0, s46, 110592
    s_add_u32 s47, s44, 393216
    buffer_load_dwordx4 v24, s[64:67], s47 offen lds
    v_add_u32 v32, 0, v27
    v_add_u32 v33, 0, v28
    ds_read_b64_tr_b16 v[224:225], v32 offset:0
    ds_read_b64_tr_b16 v[226:227], v32 offset:512
    ds_read_b64_tr_b16 v[228:229], v32 offset:8192
    ds_read_b64_tr_b16 v[230:231], v32 offset:8704
    ds_read_b64_tr_b16 v[232:233], v33 offset:0
    ds_read_b64_tr_b16 v[234:235], v33 offset:512
    ds_read_b64_tr_b16 v[236:237], v33 offset:8192
    ds_read_b64_tr_b16 v[238:239], v33 offset:8704
    s_waitcnt vmcnt(20) lgkmcnt(0)
    s_barrier
    s_add_u32 m0, s46, 114688
    s_add_u32 s47, s44, 1048576
    buffer_load_dwordx4 v24, s[64:67], s47 offen lds
    s_add_u32 m0, s46, 118784
    s_add_u32 s47, s44, 1179648
    buffer_load_dwordx4 v24, s[64:67], s47 offen lds
    s_add_u32 m0, s46, 122880
    s_add_u32 s47, s44, 1310720
    buffer_load_dwordx4 v24, s[64:67], s47 offen lds
    s_add_u32 m0, s46, 126976
    s_add_u32 s47, s44, 1441792
    buffer_load_dwordx4 v24, s[64:67], s47 offen lds
    v_add_u32 v32, 16384, v27
    v_add_u32 v33, 16384, v28
    ds_read_b64_tr_b16 v[240:241], v32 offset:0
    ds_read_b64_tr_b16 v[242:243], v32 offset:512
    ds_read_b64_tr_b16 v[244:245], v32 offset:8192
    ds_read_b64_tr_b16 v[246:247], v32 offset:8704
    ds_read_b64_tr_b16 v[248:249], v33 offset:0
    ds_read_b64_tr_b16 v[250:251], v33 offset:512
    ds_read_b64_tr_b16 v[252:253], v33 offset:8192
    ds_read_b64_tr_b16 v[254:255], v33 offset:8704
    s_waitcnt vmcnt(20) lgkmcnt(0)
    s_barrier
    s_add_u32 m0, s46, 131072
    s_add_u32 s47, s44, 2097152
    buffer_load_dwordx4 v24, s[64:67], s47 offen lds
    s_add_u32 m0, s46, 135168
    s_add_u32 s47, s44, 2228224
    buffer_load_dwordx4 v24, s[64:67], s47 offen lds
    s_add_u32 m0, s46, 139264
    s_add_u32 s47, s44, 2359296
    buffer_load_dwordx4 v24, s[64:67], s47 offen lds
    s_add_u32 m0, s46, 143360
    s_add_u32 s47, s44, 2490368
    buffer_load_dwordx4 v24, s[64:67], s47 offen lds
    v_add_u32 v32, 32768, v27
    v_add_u32 v33, 32768, v28
    ds_read_b64_tr_b16 a[0:1], v32 offset:0
    ds_read_b64_tr_b16 a[2:3], v32 offset:512
    ds_read_b64_tr_b16 a[4:5], v32 offset:8192
    ds_read_b64_tr_b16 a[6:7], v32 offset:8704
    ds_read_b64_tr_b16 a[8:9], v33 offset:0
    ds_read_b64_tr_b16 a[10:11], v33 offset:512
    ds_read_b64_tr_b16 a[12:13], v33 offset:8192
    ds_read_b64_tr_b16 a[14:15], v33 offset:8704
    s_waitcnt vmcnt(20) lgkmcnt(0)
    s_barrier
    s_add_u32 m0, s46, 0
    s_add_u32 s47, s44, 3145728
    buffer_load_dwordx4 v24, s[64:67], s47 offen lds
    s_add_u32 m0, s46, 4096
    s_add_u32 s47, s44, 3276800
    buffer_load_dwordx4 v24, s[64:67], s47 offen lds
    s_add_u32 m0, s46, 8192
    s_add_u32 s47, s44, 3407872
    buffer_load_dwordx4 v24, s[64:67], s47 offen lds
    s_add_u32 m0, s46, 12288
    s_add_u32 s47, s44, 3538944
    buffer_load_dwordx4 v24, s[64:67], s47 offen lds
    v_add_u32 v32, 49152, v27
    v_add_u32 v33, 49152, v28
    ds_read_b64_tr_b16 a[16:17], v32 offset:0
    ds_read_b64_tr_b16 a[18:19], v32 offset:512
    ds_read_b64_tr_b16 a[20:21], v32 offset:8192
    ds_read_b64_tr_b16 a[22:23], v32 offset:8704
    ds_read_b64_tr_b16 a[24:25], v33 offset:0
    ds_read_b64_tr_b16 a[26:27], v33 offset:512
    ds_read_b64_tr_b16 a[28:29], v33 offset:8192
    ds_read_b64_tr_b16 a[30:31], v33 offset:8704
    s_waitcnt vmcnt(20) lgkmcnt(0)
    s_barrier
    s_add_u32 m0, s46, 16384
    s_add_u32 s47, s44, 3670016
    buffer_load_dwordx4 v24, s[64:67], s47 offen lds
    s_add_u32 m0, s46, 20480
    s_add_u32 s47, s44, 3801088
    buffer_load_dwordx4 v24, s[64:67], s47 offen lds
    s_add_u32 m0, s46, 24576
    s_add_u32 s47, s44, 3932160
    buffer_load_dwordx4 v24, s[64:67], s47 offen lds
    s_add_u32 m0, s46, 28672
    s_add_u32 s47, s44, 4063232
    buffer_load_dwordx4 v24, s[64:67], s47 offen lds
    v_add_u32 v32, 65536, v27
    v_add_u32 v33, 65536, v28
    ds_read_b64_tr_b16 a[32:33], v32 offset:0
    ds_read_b64_tr_b16 a[34:35], v32 offset:512
    ds_read_b64_tr_b16 a[36:37], v32 offset:8192
    ds_read_b64_tr_b16 a[38:39], v32 offset:8704
    ds_read_b64_tr_b16 a[40:41], v33 offset:0
    ds_read_b64_tr_b16 a[42:43], v33 offset:512
    ds_read_b64_tr_b16 a[44:45], v33 offset:8192
    ds_read_b64_tr_b16 a[46:47], v33 offset:8704
    s_waitcnt vmcnt(20) lgkmcnt(0)
    s_barrier
    s_add_u32 m0, s46, 32768
    s_add_u32 s47, s44, 4194304
    buffer_load_dwordx4 v24, s[64:67], s47 offen lds
    s_add_u32 m0, s46, 36864
    s_add_u32 s47, s44, 4325376
    buffer_load_dwordx4 v24, s[64:67], s47 offen lds
    s_add_u32 m0, s46, 40960
    s_add_u32 s47, s44, 4456448
    buffer_load_dwordx4 v24, s[64:67], s47 offen lds
    s_add_u32 m0, s46, 45056
    s_add_u32 s47, s44, 4587520
    buffer_load_dwordx4 v24, s[64:67], s47 offen lds
    v_add_u32 v32, 81920, v27
    v_add_u32 v33, 81920, v28
    ds_read_b64_tr_b16 a[48:49], v32 offset:0
    ds_read_b64_tr_b16 a[50:51], v32 offset:512
    ds_read_b64_tr_b16 a[52:53], v32 offset:8192
    ds_read_b64_tr_b16 a[54:55], v32 offset:8704
    ds_read_b64_tr_b16 a[56:57], v33 offset:0
    ds_read_b64_tr_b16 a[58:59], v33 offset:512
    ds_read_b64_tr_b16 a[60:61], v33 offset:8192
    ds_read_b64_tr_b16 a[62:63], v33 offset:8704
    s_waitcnt vmcnt(20) lgkmcnt(0)
    s_barrier
    s_add_u32 m0, s46, 49152
    s_add_u32 s47, s45, 0
    buffer_load_dwordx4 v25, s[68:71], s47 offen lds
    s_add_u32 m0, s46, 53248
    s_add_u32 s47, s45, 18432
    buffer_load_dwordx4 v25, s[68:71], s47 offen lds
    s_add_u32 m0, s46, 57344
    s_add_u32 s47, s45, 36864
    buffer_load_dwordx4 v25, s[68:71], s47 offen lds
    s_add_u32 m0, s46, 61440
    s_add_u32 s47, s45, 55296
    buffer_load_dwordx4 v25, s[68:71], s47 offen lds
    v_add_u32 v32, 98304, v27
    v_add_u32 v33, 98304, v28
    ds_read_b64_tr_b16 a[64:65], v32 offset:0
    ds_read_b64_tr_b16 a[66:67], v32 offset:512
    ds_read_b64_tr_b16 a[68:69], v32 offset:8192
    ds_read_b64_tr_b16 a[70:71], v32 offset:8704
    ds_read_b64_tr_b16 a[72:73], v33 offset:0
    ds_read_b64_tr_b16 a[74:75], v33 offset:512
    ds_read_b64_tr_b16 a[76:77], v33 offset:8192
    ds_read_b64_tr_b16 a[78:79], v33 offset:8704
    s_waitcnt vmcnt(20) lgkmcnt(0)
    s_barrier
    s_add_u32 m0, s46, 65536
    s_add_u32 s47, s45, 73728
    buffer_load_dwordx4 v25, s[68:71], s47 offen lds
    s_add_u32 m0, s46, 69632
    s_add_u32 s47, s45, 92160
    buffer_load_dwordx4 v25, s[68:71], s47 offen lds
    s_add_u32 m0, s46, 73728
    s_add_u32 s47, s45, 110592
    buffer_load_dwordx4 v25, s[68:71], s47 offen lds
    s_add_u32 m0, s46, 77824
    s_add_u32 s47, s45, 129024
    buffer_load_dwordx4 v25, s[68:71], s47 offen lds
    v_add_u32 v32, 114688, v27
    v_add_u32 v33, 114688, v28
    ds_read_b64_tr_b16 a[80:81], v32 offset:0
    ds_read_b64_tr_b16 a[82:83], v32 offset:512
    ds_read_b64_tr_b16 a[84:85], v32 offset:8192
    ds_read_b64_tr_b16 a[86:87], v32 offset:8704
    ds_read_b64_tr_b16 a[88:89], v33 offset:0
    ds_read_b64_tr_b16 a[90:91], v33 offset:512
    ds_read_b64_tr_b16 a[92:93], v33 offset:8192
    ds_read_b64_tr_b16 a[94:95], v33 offset:8704
    s_waitcnt vmcnt(20) lgkmcnt(0)
    s_barrier
    s_add_u32 m0, s46, 81920
    s_add_u32 s47, s45, 256
    buffer_load_dwordx4 v25, s[68:71], s47 offen lds
    s_add_u32 m0, s46, 86016
    s_add_u32 s47, s45, 18688
    buffer_load_dwordx4 v25, s[68:71], s47 offen lds
    s_add_u32 m0, s46, 90112
    s_add_u32 s47, s45, 37120
    buffer_load_dwordx4 v25, s[68:71], s47 offen lds
    s_add_u32 m0, s46, 94208
    s_add_u32 s47, s45, 55552
    buffer_load_dwordx4 v25, s[68:71], s47 offen lds
    v_add_u32 v32, 131072, v27
    v_add_u32 v33, 131072, v28
    ds_read_b64_tr_b16 a[96:97], v32 offset:0
    ds_read_b64_tr_b16 a[98:99], v32 offset:512
    ds_read_b64_tr_b16 a[100:101], v32 offset:8192
    ds_read_b64_tr_b16 a[102:103], v32 offset:8704
    ds_read_b64_tr_b16 a[104:105], v33 offset:0
    ds_read_b64_tr_b16 a[106:107], v33 offset:512
    ds_read_b64_tr_b16 a[108:109], v33 offset:8192
    ds_read_b64_tr_b16 a[110:111], v33 offset:8704
    s_waitcnt vmcnt(20) lgkmcnt(0)
    s_barrier
    s_add_u32 m0, s46, 98304
    s_add_u32 s47, s45, 73984
    buffer_load_dwordx4 v25, s[68:71], s47 offen lds
    s_add_u32 m0, s46, 102400
    s_add_u32 s47, s45, 92416
    buffer_load_dwordx4 v25, s[68:71], s47 offen lds
    s_add_u32 m0, s46, 106496
    s_add_u32 s47, s45, 110848
    buffer_load_dwordx4 v25, s[68:71], s47 offen lds
    s_add_u32 m0, s46, 110592
    s_add_u32 s47, s45, 129280
    buffer_load_dwordx4 v25, s[68:71], s47 offen lds
    v_add_u32 v32, 0, v27
    v_add_u32 v33, 0, v28
    ds_read_b64_tr_b16 a[112:113], v32 offset:0
    ds_read_b64_tr_b16 a[114:115], v32 offset:512
    ds_read_b64_tr_b16 a[116:117], v32 offset:8192
    ds_read_b64_tr_b16 a[118:119], v32 offset:8704
    ds_read_b64_tr_b16 a[120:121], v33 offset:0
    ds_read_b64_tr_b16 a[122:123], v33 offset:512
    ds_read_b64_tr_b16 a[124:125], v33 offset:8192
    ds_read_b64_tr_b16 a[126:127], v33 offset:8704
    s_waitcnt vmcnt(20) lgkmcnt(0)
    s_barrier
    s_add_u32 m0, s46, 114688
    s_add_u32 s47, s45, 512
    buffer_load_dwordx4 v25, s[68:71], s47 offen lds
    s_add_u32 m0, s46, 118784
    s_add_u32 s47, s45, 18944
    buffer_load_dwordx4 v25, s[68:71], s47 offen lds
    s_add_u32 m0, s46, 122880
    s_add_u32 s47, s45, 37376
    buffer_load_dwordx4 v25, s[68:71], s47 offen lds
    s_add_u32 m0, s46, 126976
    s_add_u32 s47, s45, 55808
    buffer_load_dwordx4 v25, s[68:71], s47 offen lds
    v_add_u32 v32, 16384, v27
    v_add_u32 v33, 16384, v28
    ds_read_b64_tr_b16 a[128:129], v32 offset:0
    ds_read_b64_tr_b16 a[130:131], v32 offset:512
    ds_read_b64_tr_b16 a[132:133], v32 offset:8192
    ds_read_b64_tr_b16 a[134:135], v32 offset:8704
    ds_read_b64_tr_b16 a[136:137], v33 offset:0
    ds_read_b64_tr_b16 a[138:139], v33 offset:512
    ds_read_b64_tr_b16 a[140:141], v33 offset:8192
    ds_read_b64_tr_b16 a[142:143], v33 offset:8704
    s_waitcnt vmcnt(20) lgkmcnt(0)
    s_barrier
    s_add_u32 m0, s46, 131072
    s_add_u32 s47, s45, 74240
    buffer_load_dwordx4 v25, s[68:71], s47 offen lds
    s_add_u32 m0, s46, 135168
    s_add_u32 s47, s45, 92672
    buffer_load_dwordx4 v25, s[68:71], s47 offen lds
    s_add_u32 m0, s46, 139264
    s_add_u32 s47, s45, 111104
    buffer_load_dwordx4 v25, s[68:71], s47 offen lds
    s_add_u32 m0, s46, 143360
    s_add_u32 s47, s45, 129536
    buffer_load_dwordx4 v25, s[68:71], s47 offen lds
    v_add_u32 v32, 32768, v27
    v_add_u32 v33, 32768, v28
    ds_read_b64_tr_b16 a[144:145], v32 offset:0
    ds_read_b64_tr_b16 a[146:147], v32 offset:512
    ds_read_b64_tr_b16 a[148:149], v32 offset:8192
    ds_read_b64_tr_b16 a[150:151], v32 offset:8704
    ds_read_b64_tr_b16 a[152:153], v33 offset:0
    ds_read_b64_tr_b16 a[154:155], v33 offset:512
    ds_read_b64_tr_b16 a[156:157], v33 offset:8192
    ds_read_b64_tr_b16 a[158:159], v33 offset:8704
    s_waitcnt vmcnt(20) lgkmcnt(0)
    s_barrier
    s_add_u32 m0, s46, 0
    s_add_u32 s47, s44, 4194304
    buffer_load_dwordx4 v24, s[56:59], s47 offen lds
    s_add_u32 m0, s46, 4096
    s_add_u32 s47, s44, 4325376
    buffer_load_dwordx4 v24, s[56:59], s47 offen lds
    s_add_u32 m0, s46, 8192
    s_add_u32 s47, s44, 4456448
    buffer_load_dwordx4 v24, s[56:59], s47 offen lds
    s_add_u32 m0, s46, 12288
    s_add_u32 s47, s44, 4587520
    buffer_load_dwordx4 v24, s[56:59], s47 offen lds
    v_add_u32 v32, 49152, v29
    v_add_u32 v33, 49152, v30
    ds_read_b64_tr_b16 a[160:161], v32 offset:0
    ds_read_b64_tr_b16 a[162:163], v32 offset:512
    ds_read_b64_tr_b16 a[164:165], v32 offset:4096
    ds_read_b64_tr_b16 a[166:167], v32 offset:4608
    ds_read_b64_tr_b16 a[168:169], v33 offset:0
    ds_read_b64_tr_b16 a[170:171], v33 offset:512
    ds_read_b64_tr_b16 a[172:173], v33 offset:4096
    ds_read_b64_tr_b16 a[174:175], v33 offset:4608
    s_waitcnt vmcnt(20) lgkmcnt(0)
    s_barrier
    s_add_u32 m0, s46, 16384
    s_add_u32 s47, s44, 1572864
    buffer_load_dwordx4 v24, s[60:63], s47 offen lds
    s_add_u32 m0, s46, 20480
    s_add_u32 s47, s44, 1703936
    buffer_load_dwordx4 v24, s[60:63], s47 offen lds
    s_add_u32 m0, s46, 24576
    s_add_u32 s47, s44, 1835008
    buffer_load_dwordx4 v24, s[60:63], s47 offen lds
    s_add_u32 m0, s46, 28672
    s_add_u32 s47, s44, 1966080
    buffer_load_dwordx4 v24, s[60:63], s47 offen lds
    v_add_u32 v32, 65536, v29
    v_add_u32 v33, 65536, v30
    ds_read_b64_tr_b16 a[176:177], v32 offset:0
    ds_read_b64_tr_b16 a[178:179], v32 offset:512
    ds_read_b64_tr_b16 a[180:181], v32 offset:4096
    ds_read_b64_tr_b16 a[182:183], v32 offset:4608
    ds_read_b64_tr_b16 a[184:185], v33 offset:0
    ds_read_b64_tr_b16 a[186:187], v33 offset:512
    ds_read_b64_tr_b16 a[188:189], v33 offset:4096
    ds_read_b64_tr_b16 a[190:191], v33 offset:4608
    s_waitcnt vmcnt(20) lgkmcnt(0)
    s_barrier
    s_add_u32 m0, s46, 32768
    s_add_u32 s47, s44, 3670016
    buffer_load_dwordx4 v24, s[60:63], s47 offen lds
    s_add_u32 m0, s46, 36864
    s_add_u32 s47, s44, 3801088
    buffer_load_dwordx4 v24, s[60:63], s47 offen lds
    s_add_u32 m0, s46, 40960
    s_add_u32 s47, s44, 3932160
    buffer_load_dwordx4 v24, s[60:63], s47 offen lds
    s_add_u32 m0, s46, 45056
    s_add_u32 s47, s44, 4063232
    buffer_load_dwordx4 v24, s[60:63], s47 offen lds
    v_add_u32 v32, 81920, v29
    v_add_u32 v33, 81920, v30
    ds_read_b64_tr_b16 a[192:193], v32 offset:0
    ds_read_b64_tr_b16 a[194:195], v32 offset:512
    ds_read_b64_tr_b16 a[196:197], v32 offset:4096
    ds_read_b64_tr_b16 a[198:199], v32 offset:4608
    ds_read_b64_tr_b16 a[200:201], v33 offset:0
    ds_read_b64_tr_b16 a[202:203], v33 offset:512
    ds_read_b64_tr_b16 a[204:205], v33 offset:4096
    ds_read_b64_tr_b16 a[206:207], v33 offset:4608
    s_waitcnt vmcnt(20) lgkmcnt(0)
    s_barrier
    s_add_u32 m0, s46, 49152
    s_add_u32 s47, s44, 524288
    buffer_load_dwordx4 v24, s[64:67], s47 offen lds
    s_add_u32 m0, s46, 53248
    s_add_u32 s47, s44, 655360
    buffer_load_dwordx4 v24, s[64:67], s47 offen lds
    s_add_u32 m0, s46, 57344
    s_add_u32 s47, s44, 786432
    buffer_load_dwordx4 v24, s[64:67], s47 offen lds
    s_add_u32 m0, s46, 61440
    s_add_u32 s47, s44, 917504
    buffer_load_dwordx4 v24, s[64:67], s47 offen lds
    v_add_u32 v32, 98304, v29
    v_add_u32 v33, 98304, v30
    ds_read_b64_tr_b16 a[208:209], v32 offset:0
    ds_read_b64_tr_b16 a[210:211], v32 offset:512
    ds_read_b64_tr_b16 a[212:213], v32 offset:4096
    ds_read_b64_tr_b16 a[214:215], v32 offset:4608
    ds_read_b64_tr_b16 a[216:217], v33 offset:0
    ds_read_b64_tr_b16 a[218:219], v33 offset:512
    ds_read_b64_tr_b16 a[220:221], v33 offset:4096
    ds_read_b64_tr_b16 a[222:223], v33 offset:4608
    s_waitcnt vmcnt(20) lgkmcnt(0)
    s_barrier
    s_add_u32 m0, s46, 65536
    s_add_u32 s47, s44, 1572864
    buffer_load_dwordx4 v24, s[64:67], s47 offen lds
    s_add_u32 m0, s46, 69632
    s_add_u32 s47, s44, 1703936
    buffer_load_dwordx4 v24, s[64:67], s47 offen lds
    s_add_u32 m0, s46, 73728
    s_add_u32 s47, s44, 1835008
    buffer_load_dwordx4 v24, s[64:67], s47 offen lds
    s_add_u32 m0, s46, 77824
    s_add_u32 s47, s44, 1966080
    buffer_load_dwordx4 v24, s[64:67], s47 offen lds
    v_add_u32 v32, 114688, v29
    v_add_u32 v33, 114688, v30
    ds_read_b64_tr_b16 a[224:225], v32 offset:0
    ds_read_b64_tr_b16 a[226:227], v32 offset:512
    ds_read_b64_tr_b16 a[228:229], v32 offset:4096
    ds_read_b64_tr_b16 a[230:231], v32 offset:4608
    ds_read_b64_tr_b16 a[232:233], v33 offset:0
    ds_read_b64_tr_b16 a[234:235], v33 offset:512
    ds_read_b64_tr_b16 a[236:237], v33 offset:4096
    ds_read_b64_tr_b16 a[238:239], v33 offset:4608
    s_waitcnt vmcnt(20) lgkmcnt(0)
    s_barrier
    s_add_u32 m0, s46, 81920
    s_add_u32 s47, s44, 2621440
    buffer_load_dwordx4 v24, s[64:67], s47 offen lds
    s_add_u32 m0, s46, 86016
    s_add_u32 s47, s44, 2752512
    buffer_load_dwordx4 v24, s[64:67], s47 offen lds
    s_add_u32 m0, s46, 90112
    s_add_u32 s47, s44, 2883584
    buffer_load_dwordx4 v24, s[64:67], s47 offen lds
    s_add_u32 m0, s46, 94208
    s_add_u32 s47, s44, 3014656
    buffer_load_dwordx4 v24, s[64:67], s47 offen lds
    v_add_u32 v32, 131072, v29
    v_add_u32 v33, 131072, v30
    ds_read_b64_tr_b16 a[240:241], v32 offset:0
    ds_read_b64_tr_b16 a[242:243], v32 offset:512
    ds_read_b64_tr_b16 a[244:245], v32 offset:4096
    ds_read_b64_tr_b16 a[246:247], v32 offset:4608
    ds_read_b64_tr_b16 a[248:249], v33 offset:0
    ds_read_b64_tr_b16 a[250:251], v33 offset:512
    ds_read_b64_tr_b16 a[252:253], v33 offset:4096
    ds_read_b64_tr_b16 a[254:255], v33 offset:4608
    s_waitcnt vmcnt(20) lgkmcnt(0)
    s_barrier
    s_add_u32 m0, s46, 98304
    s_add_u32 s47, s45, 0
    buffer_load_dwordx4 v26, s[68:71], s47 offen lds
    s_add_u32 m0, s46, 102400
    s_add_u32 s47, s45, 18432
    buffer_load_dwordx4 v26, s[68:71], s47 offen lds
    s_add_u32 m0, s46, 106496
    s_add_u32 s47, s45, 36864
    buffer_load_dwordx4 v26, s[68:71], s47 offen lds
    s_add_u32 m0, s46, 110592
    s_add_u32 s47, s45, 55296
    buffer_load_dwordx4 v26, s[68:71], s47 offen lds
    v_add_u32 v32, 0, v27
    v_add_u32 v33, 0, v28
    ds_read_b64_tr_b16 v[52:53], v32 offset:0
    ds_read_b64_tr_b16 v[54:55], v32 offset:512
    ds_read_b64_tr_b16 v[56:57], v32 offset:8192
    ds_read_b64_tr_b16 v[58:59], v32 offset:8704
    ds_read_b64_tr_b16 v[60:61], v33 offset:0
    ds_read_b64_tr_b16 v[62:63], v33 offset:512
    ds_read_b64_tr_b16 v[64:65], v33 offset:8192
    ds_read_b64_tr_b16 v[66:67], v33 offset:8704
    s_waitcnt vmcnt(20) lgkmcnt(0)
    s_barrier
    s_add_u32 m0, s46, 114688
    s_add_u32 s47, s45, 768
    buffer_load_dwordx4 v25, s[68:71], s47 offen lds
    s_add_u32 m0, s46, 118784
    s_add_u32 s47, s45, 19200
    buffer_load_dwordx4 v25, s[68:71], s47 offen lds
    s_add_u32 m0, s46, 122880
    s_add_u32 s47, s45, 37632
    buffer_load_dwordx4 v25, s[68:71], s47 offen lds
    s_add_u32 m0, s46, 126976
    s_add_u32 s47, s45, 56064
    buffer_load_dwordx4 v25, s[68:71], s47 offen lds
    s_lshl_b32 s42, s4, 12
    s_add_u32 s42, s42, 16384
    v_add_u32 v31, s42, v77
    ds_write_b128 v31, v[52:55] offset:0
    ds_write_b128 v31, v[56:59] offset:1024
    ds_write_b128 v31, v[60:63] offset:2048
    ds_write_b128 v31, v[64:67] offset:3072
    v_add_u32 v32, 16384, v27
    v_add_u32 v33, 16384, v28
    ds_read_b64_tr_b16 v[36:37], v32 offset:0
    ds_read_b64_tr_b16 v[38:39], v32 offset:512
    ds_read_b64_tr_b16 v[40:41], v32 offset:8192
    ds_read_b64_tr_b16 v[42:43], v32 offset:8704
    ds_read_b64_tr_b16 v[44:45], v33 offset:0
    ds_read_b64_tr_b16 v[46:47], v33 offset:512
    ds_read_b64_tr_b16 v[48:49], v33 offset:8192
    ds_read_b64_tr_b16 v[50:51], v33 offset:8704
    s_waitcnt vmcnt(20) lgkmcnt(0)
    s_barrier
    s_add_u32 m0, s46, 131072
    s_add_u32 s47, s45, 74496
    buffer_load_dwordx4 v25, s[68:71], s47 offen lds
    s_add_u32 m0, s46, 135168
    s_add_u32 s47, s45, 92928
    buffer_load_dwordx4 v25, s[68:71], s47 offen lds
    s_add_u32 m0, s46, 139264
    s_add_u32 s47, s45, 111360
    buffer_load_dwordx4 v25, s[68:71], s47 offen lds
    s_add_u32 m0, s46, 143360
    s_add_u32 s47, s45, 129792
    buffer_load_dwordx4 v25, s[68:71], s47 offen lds
    s_lshl_b32 s42, s4, 12
    s_add_u32 s42, s42, 32768
    v_add_u32 v31, s42, v77
    ds_write_b128 v31, v[36:39] offset:0
    ds_write_b128 v31, v[40:43] offset:1024
    ds_write_b128 v31, v[44:47] offset:2048
    ds_write_b128 v31, v[48:51] offset:3072
    v_add_u32 v32, 32768, v27
    v_add_u32 v33, 32768, v28
    ds_read_b64_tr_b16 v[52:53], v32 offset:0
    ds_read_b64_tr_b16 v[54:55], v32 offset:512
    ds_read_b64_tr_b16 v[56:57], v32 offset:8192
    ds_read_b64_tr_b16 v[58:59], v32 offset:8704
    ds_read_b64_tr_b16 v[60:61], v33 offset:0
    ds_read_b64_tr_b16 v[62:63], v33 offset:512
    ds_read_b64_tr_b16 v[64:65], v33 offset:8192
    ds_read_b64_tr_b16 v[66:67], v33 offset:8704
    s_waitcnt vmcnt(20) lgkmcnt(0)
    s_barrier
    s_lshl_b32 s42, s4, 12
    s_add_u32 s42, s42, 49152
    v_add_u32 v31, s42, v77
    ds_write_b128 v31, v[52:55] offset:0
    ds_write_b128 v31, v[56:59] offset:1024
    ds_write_b128 v31, v[60:63] offset:2048
    ds_write_b128 v31, v[64:67] offset:3072
    v_add_u32 v32, 49152, v27
    v_add_u32 v33, 49152, v28
    ds_read_b64_tr_b16 v[36:37], v32 offset:0
    ds_read_b64_tr_b16 v[38:39], v32 offset:512
    ds_read_b64_tr_b16 v[40:41], v32 offset:8192
    ds_read_b64_tr_b16 v[42:43], v32 offset:8704
    ds_read_b64_tr_b16 v[44:45], v33 offset:0
    ds_read_b64_tr_b16 v[46:47], v33 offset:512
    ds_read_b64_tr_b16 v[48:49], v33 offset:8192
    ds_read_b64_tr_b16 v[50:51], v33 offset:8704
    s_waitcnt vmcnt(16) lgkmcnt(0)
    s_barrier
    s_lshl_b32 s42, s4, 12
    s_add_u32 s42, s42, 65536
    v_add_u32 v31, s42, v77
    ds_write_b128 v31, v[36:39] offset:0
    ds_write_b128 v31, v[40:43] offset:1024
    ds_write_b128 v31, v[44:47] offset:2048
    ds_write_b128 v31, v[48:51] offset:3072
    v_add_u32 v32, 65536, v27
    v_add_u32 v33, 65536, v28
    ds_read_b64_tr_b16 v[52:53], v32 offset:0
    ds_read_b64_tr_b16 v[54:55], v32 offset:512
    ds_read_b64_tr_b16 v[56:57], v32 offset:8192
    ds_read_b64_tr_b16 v[58:59], v32 offset:8704
    ds_read_b64_tr_b16 v[60:61], v33 offset:0
    ds_read_b64_tr_b16 v[62:63], v33 offset:512
    ds_read_b64_tr_b16 v[64:65], v33 offset:8192
    ds_read_b64_tr_b16 v[66:67], v33 offset:8704
    s_waitcnt vmcnt(12) lgkmcnt(0)
    s_barrier
    s_lshl_b32 s42, s4, 12
    s_add_u32 s42, s42, 81920
    v_add_u32 v31, s42, v77
    ds_write_b128 v31, v[52:55] offset:0
    ds_write_b128 v31, v[56:59] offset:1024
    ds_write_b128 v31, v[60:63] offset:2048
    ds_write_b128 v31, v[64:67] offset:3072
    v_add_u32 v32, 81920, v27
    v_add_u32 v33, 81920, v28
    ds_read_b64_tr_b16 v[36:37], v32 offset:0
    ds_read_b64_tr_b16 v[38:39], v32 offset:512
    ds_read_b64_tr_b16 v[40:41], v32 offset:8192
    ds_read_b64_tr_b16 v[42:43], v32 offset:8704
    ds_read_b64_tr_b16 v[44:45], v33 offset:0
    ds_read_b64_tr_b16 v[46:47], v33 offset:512
    ds_read_b64_tr_b16 v[48:49], v33 offset:8192
    ds_read_b64_tr_b16 v[50:51], v33 offset:8704
    s_waitcnt vmcnt(8) lgkmcnt(0)
    s_barrier
    s_lshl_b32 s42, s4, 12
    s_add_u32 s42, s42, 98304
    v_add_u32 v31, s42, v77
    ds_write_b128 v31, v[36:39] offset:0
    ds_write_b128 v31, v[40:43] offset:1024
    ds_write_b128 v31, v[44:47] offset:2048
    ds_write_b128 v31, v[48:51] offset:3072
    v_add_u32 v32, 98304, v29
    v_add_u32 v33, 98304, v30
    ds_read_b64_tr_b16 v[52:53], v32 offset:0
    ds_read_b64_tr_b16 v[54:55], v32 offset:512
    ds_read_b64_tr_b16 v[56:57], v32 offset:4096
    ds_read_b64_tr_b16 v[58:59], v32 offset:4608
    ds_read_b64_tr_b16 v[60:61], v33 offset:0
    ds_read_b64_tr_b16 v[62:63], v33 offset:512
    ds_read_b64_tr_b16 v[64:65], v33 offset:4096
    ds_read_b64_tr_b16 v[66:67], v33 offset:4608
    s_waitcnt vmcnt(4) lgkmcnt(0)
    s_barrier
    s_lshl_b32 s42, s4, 12
    s_add_u32 s42, s42, 114688
    v_add_u32 v31, s42, v77
    ds_write_b128 v31, v[52:55] offset:0
    ds_write_b128 v31, v[56:59] offset:1024
    ds_write_b128 v31, v[60:63] offset:2048
    ds_write_b128 v31, v[64:67] offset:3072
    v_add_u32 v32, 114688, v29
    v_add_u32 v33, 114688, v30
    ds_read_b64_tr_b16 v[36:37], v32 offset:0
    ds_read_b64_tr_b16 v[38:39], v32 offset:512
    ds_read_b64_tr_b16 v[40:41], v32 offset:4096
    ds_read_b64_tr_b16 v[42:43], v32 offset:4608
    ds_read_b64_tr_b16 v[44:45], v33 offset:0
    ds_read_b64_tr_b16 v[46:47], v33 offset:512
    ds_read_b64_tr_b16 v[48:49], v33 offset:4096
    ds_read_b64_tr_b16 v[50:51], v33 offset:4608
    s_waitcnt vmcnt(0) lgkmcnt(0)
    s_barrier
    s_lshl_b32 s42, s4, 12
    s_add_u32 s42, s42, 131072
    v_add_u32 v31, s42, v77
    ds_write_b128 v31, v[36:39] offset:0
    ds_write_b128 v31, v[40:43] offset:1024
    ds_write_b128 v31, v[44:47] offset:2048
    ds_write_b128 v31, v[48:51] offset:3072
    v_add_u32 v32, 131072, v29
    v_add_u32 v33, 131072, v30
    ds_read_b64_tr_b16 v[52:53], v32 offset:0
    ds_read_b64_tr_b16 v[54:55], v32 offset:512
    ds_read_b64_tr_b16 v[56:57], v32 offset:4096
    ds_read_b64_tr_b16 v[58:59], v32 offset:4608
    ds_read_b64_tr_b16 v[60:61], v33 offset:0
    ds_read_b64_tr_b16 v[62:63], v33 offset:512
    ds_read_b64_tr_b16 v[64:65], v33 offset:4096
    ds_read_b64_tr_b16 v[66:67], v33 offset:4608
    s_waitcnt lgkmcnt(0)
    s_barrier
    s_lshl_b32 s42, s4, 12
    s_add_u32 s42, s42, 147456
    v_add_u32 v31, s42, v77
    ds_write_b128 v31, v[52:55] offset:0
    ds_write_b128 v31, v[56:59] offset:1024
    ds_write_b128 v31, v[60:63] offset:2048
    ds_write_b128 v31, v[64:67] offset:3072
    s_waitcnt lgkmcnt(0)
    s_mov_b32 s32, 0x33333333
    s_mov_b32 s33, 0x33333333
    s_mov_b32 s34, 0xaaaaaaaa
    s_mov_b32 s35, 0xaaaaaaaa
    s_mov_b32 s36, 0x00ff00ff
    s_mov_b32 s37, 0x00ff00ff
    s_mov_b32 s56, 0x03030303
    s_mov_b32 s57, 0x03030303
    s_mov_b32 s58, 0x0c0c0c0c
    s_mov_b32 s59, 0x0c0c0c0c
    s_mov_b32 s60, 0x30303030
    s_mov_b32 s61, 0x30303030
    s_mov_b32 s62, 0xc0c0c0c0
    s_mov_b32 s63, 0xc0c0c0c0
    s_mov_b32 s40, 0x3e0293ee
    s_mov_b32 s16, 0
    s_lshl_b32 s42, s3, 19
    s_lshl_b32 s43, s4, 11
    s_add_u32 s42, s42, s43
    s_add_u32 s17, s42, 19136512
    s_add_u32 s18, s42, 35913728
    s_lshl_b32 s42, s3, 12
    s_lshl_b32 s43, s4, 10
    s_add_u32 s42, s42, s43
    s_add_u32 s19, s42, 99876864
    s_lshl_b32 s42, s3, 1
    s_add_u32 s42, s42, s4
    s_add_u32 s43, s3, 64
    s_cmp_lt_u32 s4, 2
    s_cselect_b32 s42, s42, s43
    s_min_u32 s42, s42, 71
    s_lshr_b32 s43, s42, 1
    s_lshl_b32 s43, s43, 8
    s_and_b32 s44, s42, 1
    s_lshl_b32 s44, s44, 4
    s_add_u32 s6, s43, s44
    s_lshl_b32 s42, s42, 7
    s_add_u32 s20, s42, 116948992
    s_add_u32 s21, s42, 117022720
    s_add_u32 s22, s42, 117096448
    s_add_u32 s23, s42, 117170176
    s_mul_i32 s42, s3, 9216
    s_lshl_b32 s43, s4, 8
    s_add_u32 s42, s42, s43
    s_add_u32 s24, s42, 116654080
    s_add_u32 s25, s42, 116658176
    s_add_u32 s26, s42, 116662272
    s_mov_b32 s48, -294912
    s_mov_b32 s72, 117262336
    s_mov_b32 s30, 117243904
    s_mov_b32 s38, 117253120
    s_mul_i32 s39, s3, 288
    s_mul_i32 s42, s3, 9216
    s_mul_i32 s43, s4, 3072
    s_add_u32 s42, s42, s43
    s_add_u32 s49, s42, 116948992
    s_lshl_b32 s42, s4, 10
    s_add_u32 s27, s42, 117243904
    s_add_u32 s28, s42, 117248000
    s_mov_b32 s29, 117252096
    s_lshl_b32 s51, s3, 2
    s_add_u32 s51, s51, 128
    s_lshl_b32 s42, s4, 10
    s_add_u32 m0, s42, 0
    s_mov_b32 s51, 117297152
    s_cmp_eq_u32 s3, 0
    s_cselect_b32 s54, 0xfe, 0
    s_mov_b32 s55, 0
    v_mov_b64 v[52:53], 0
    v_mov_b64 v[54:55], 0
    v_mov_b64 v[56:57], 0
    v_mov_b64 v[58:59], 0
    s_cmp_lg_u32 s4, 3
    s_cbranch_scc1 CH_SW_6_w
    s_lshr_b32 s42, s3, 1
    s_lshl_b32 s42, s42, 2
    s_add_u32 s42, s42, 160
    v_lshrrev_b32 v1, 4, v77
    v_mul_u32_u24 v2, s42, v1
    v_cmp_eq_u32 vcc, 0, v1
    v_mov_b32 v3, 65535
    v_mov_b32 v5, 0xffc00000
    v_cndmask_b32 v3, v3, v5, vcc
    v_mov_b32 v4, 514
    v_mov_b32 v5, 0x8000000
    v_cndmask_b32 v4, v4, v5, vcc
    s_mov_b64 exec, 3
CH_SW_6_p:
    buffer_load_dword v0, v2, s[76:79], 0 offen sc1
    s_waitcnt vmcnt(0)
    v_and_b32 v5, v0, v3
    v_cmp_gt_u32 vcc, v4, v5
    s_cbranch_vccz CH_SW_6_d
    s_sub_u32 s41, s41, 1
    s_cbranch_scc0 CH_SW_6_p
    s_mov_b32 s41, 0
CH_SW_6_d:
    s_mov_b64 exec, -1
    ds_write_b32 v77, v0 offset:10240
CH_SW_6_w:
    s_waitcnt lgkmcnt(0)
    s_barrier
    v_mov_b32 v1, 0
    ds_read_b32 v0, v1 offset:10240
    s_waitcnt lgkmcnt(0)
    v_readfirstlane_b32 s42, v0
    s_and_b32 s43, s42, 0x1ff
    s_mul_i32 s43, s43, s43
    s_bfe_u32 s42, s42, 0xd0009
    s_lshl_b32 s42, s42, 5
    s_cmp_eq_u32 s42, s43
    s_memtime s[82:83]
    s_cbranch_scc0 CH_slow
    s_cmp_eq_u32 s4, 0
    s_cbranch_scc1 CH_gof0
    s_cmp_eq_u32 s4, 1
    s_cbranch_scc1 CH_gof1
    s_cmp_eq_u32 s4, 2
    s_cbranch_scc1 CH_gof2
    s_cmp_eq_u32 s4, 3
    s_cbranch_scc1 CH_gof3
    s_endpgm
CH_slow:
    s_cmp_eq_u32 s4, 0
    s_cbranch_scc1 CH_gos0
    s_cmp_eq_u32 s4, 1
    s_cbranch_scc1 CH_gos1
    s_cmp_eq_u32 s4, 2
    s_cbranch_scc1 CH_gos2
    s_cmp_eq_u32 s4, 3
    s_cbranch_scc1 CH_gos3
    s_endpgm
CH_gof0:
    ds_read_b128 v[36:39], v77 offset:16384
    ds_read_b128 v[40:43], v77 offset:17408
    ds_read_b128 v[44:47], v77 offset:18432
    ds_read_b128 v[48:51], v77 offset:19456
CH_f0:
    buffer_load_dwordx4 v[0:3], v77, s[8:11], s27 offen sc1
    buffer_load_dwordx4 v[16:19], v77, s[8:11], s28 offen sc1
    v_mov_b64 v[60:61], 0
    v_mov_b64 v[62:63], 0
    v_mov_b64 v[64:65], 0
    v_mov_b64 v[66:67], 0
    s_add_u32 s20, s20, s48
    s_add_u32 s21, s21, s48
    s_add_u32 s22, s22, s48
    s_add_u32 s23, s23, s48
    s_sub_u32 s48, 0, s48
    s_bfe_u32 s49, s16, 0x10001
    s_mov_b32 s42, s72
    s_mov_b32 s72, s30
    s_mov_b32 s30, s38
    s_mov_b32 s38, s42
    s_add_u32 s31, s38, s39
    s_add_u32 s5, s30, s6
CH_f0_p2:
    s_waitcnt vmcnt(1)
    ds_write_b128 v77, v[0:3] offset:0
    v_max3_u32 v68, v0, v1, v2
    s_waitcnt vmcnt(0)
    ds_write_b128 v77, v[16:19] offset:4096
    v_max3_u32 v69, v16, v17, v18
    v_max3_u32 v68, v68, v3, v19
    v_max_u32 v68, v68, v69
    v_cmp_eq_u32 vcc, -1, v68
    s_cbranch_vccz CH_f0_p2_ok
CH_f0_p2_f:
    s_sub_u32 s41, s41, 1
    s_cbranch_scc1 CH_f0_p2_x
    buffer_load_dwordx4 v[0:3], v77, s[8:11], s27 offen sc1
    buffer_load_dwordx4 v[16:19], v77, s[8:11], s28 offen sc1
    s_branch CH_f0_p2
CH_f0_p2_x:
    s_mov_b32 s41, 0
CH_f0_p2_ok:
    v_smfmac_f32_16x16x64_bf16 v[52:55], v[0:3], v[80:87], v76
    v_smfmac_f32_16x16x64_bf16 v[56:59], v[0:3], v[88:95], v76
    s_waitcnt lgkmcnt(0)
    s_barrier
    v_smfmac_f32_16x16x64_bf16 v[52:55], v[16:19], v[144:151], v76
    buffer_load_dwordx4 v[68:71], v77, s[8:11], s17 offen
    buffer_load_dwordx4 v[72:75], v77, s[8:11], s17 offen offset:1024
    v_smfmac_f32_16x16x64_bf16 v[56:59], v[16:19], v[152:159], v76
    ds_read_b128 v[32:35], v77 offset:8192
    v_smfmac_f32_16x16x64_bf16 v[60:63], v[0:3], v[208:215], v76
    ds_read_b128 v[4:7], v77 offset:1024
    v_smfmac_f32_16x16x64_bf16 v[64:67], v[0:3], v[216:223], v76
    ds_read_b128 v[8:11], v77 offset:2048
    v_smfmac_f32_16x16x64_bf16 v[60:63], v[16:19], a[0:7], v76
    ds_read_b128 v[12:15], v77 offset:3072
    v_smfmac_f32_16x16x64_bf16 v[64:67], v[16:19], a[8:15], v76
    ds_read_b128 v[20:23], v77 offset:5120
    s_waitcnt lgkmcnt(4)
    v_smfmac_f32_16x16x64_bf16 v[52:55], v[32:35], v[36:43], v76
    ds_read_b128 v[36:39], v77 offset:32768
    v_smfmac_f32_16x16x64_bf16 v[56:59], v[32:35], v[44:51], v76
    ds_read_b128 v[40:43], v77 offset:33792
    s_waitcnt lgkmcnt(5)
    v_smfmac_f32_16x16x64_bf16 v[52:55], v[4:7], v[96:103], v76
    ds_read_b128 v[44:47], v77 offset:34816
    v_smfmac_f32_16x16x64_bf16 v[56:59], v[4:7], v[104:111], v76
    ds_read_b128 v[48:51], v77 offset:35840
    s_waitcnt lgkmcnt(6)
    v_smfmac_f32_16x16x64_bf16 v[52:55], v[8:11], v[112:119], v76
    ds_read_b128 v[24:27], v77 offset:6144
    v_smfmac_f32_16x16x64_bf16 v[56:59], v[8:11], v[120:127], v76
    ds_read_b128 v[28:31], v77 offset:7168
    s_waitcnt lgkmcnt(7)
    v_smfmac_f32_16x16x64_bf16 v[52:55], v[12:15], v[128:135], v76
    v_smfmac_f32_16x16x64_bf16 v[56:59], v[12:15], v[136:143], v76
    s_waitcnt lgkmcnt(4)
    v_smfmac_f32_16x16x64_bf16 v[60:63], v[12:15], v[36:43], v76
    ds_read_b128 v[36:39], v77 offset:49152
    s_waitcnt lgkmcnt(3)
    v_smfmac_f32_16x16x64_bf16 v[64:67], v[12:15], v[44:51], v76
    ds_read_b128 v[40:43], v77 offset:50176
    v_smfmac_f32_16x16x64_bf16 v[52:55], v[20:23], v[160:167], v76
    ds_read_b128 v[44:47], v77 offset:51200
    v_smfmac_f32_16x16x64_bf16 v[56:59], v[20:23], v[168:175], v76
    ds_read_b128 v[48:51], v77 offset:52224
    s_waitcnt lgkmcnt(5)
    v_smfmac_f32_16x16x64_bf16 v[52:55], v[24:27], v[176:183], v76
    v_smfmac_f32_16x16x64_bf16 v[56:59], v[24:27], v[184:191], v76
    s_waitcnt lgkmcnt(4)
    v_smfmac_f32_16x16x64_bf16 v[52:55], v[28:31], v[192:199], v76
    v_smfmac_f32_16x16x64_bf16 v[56:59], v[28:31], v[200:207], v76
    v_smfmac_f32_16x16x64_bf16 v[60:63], v[32:35], a[48:55], v76
    v_add_f32 v52, v52, v53
    v_add_f32 v54, v54, v55
    v_cvt_pk_bf16_f32 v52, v52, v54
    s_nop 0
    v_add_f32 v56, v56, v57
    v_add_f32 v58, v58, v59
    v_cvt_pk_bf16_f32 v53, v56, v58
    v_smfmac_f32_16x16x64_bf16 v[60:63], v[4:7], v[224:231], v76
    s_nop 0
    v_mfma_f32_16x16x16_bf16 v[56:59], v[52:53], v[78:79], 0
    s_waitcnt lgkmcnt(2)
    v_smfmac_f32_16x16x64_bf16 v[60:63], v[28:31], v[36:43], v76
    s_waitcnt lgkmcnt(0)
    v_smfmac_f32_16x16x64_bf16 v[64:67], v[28:31], v[44:51], v76
    v_cvt_pk_bf16_f32 v54, v56, v57
    v_cvt_pk_bf16_f32 v55, v58, v59
    v_smfmac_f32_16x16x64_bf16 v[60:63], v[8:11], v[240:247], v76
    v_mov_b32_dpp v56, v54 quad_perm:[2,3,0,1] row_mask:0xf bank_mask:0xf
    v_mov_b32_dpp v57, v55 quad_perm:[2,3,0,1] row_mask:0xf bank_mask:0xf
    v_smfmac_f32_16x16x64_bf16 v[60:63], v[20:23], a[16:23], v76
    v_add_u32 v51, 65536, v77
    s_waitcnt vmcnt(1)
    v_mfma_f32_16x16x32_bf16 v[68:71], v[68:71], v[54:57], 0
    ds_read_b128 v[36:39], v51 offset:0
    ds_read_b128 v[40:43], v51 offset:1024
    s_waitcnt vmcnt(0)
    v_mfma_f32_16x16x32_bf16 v[72:75], v[72:75], v[54:57], 0
    ds_read_b128 v[44:47], v51 offset:2048
    ds_read_b128 v[48:51], v51 offset:3072
    v_smfmac_f32_16x16x64_bf16 v[60:63], v[24:27], a[32:39], v76
    v_smfmac_f32_16x16x64_bf16 v[64:67], v[32:35], a[56:63], v76
    v_cndmask_b32 v68, v72, v68, s[32:33]
    v_cndmask_b32 v69, v73, v69, s[32:33]
    v_cndmask_b32 v70, v74, v70, s[32:33]
    v_cndmask_b32 v71, v75, v71, s[32:33]
    ds_write_b128 v77, v[68:71] offset:10240
    v_mov_b64 v[68:69], 0
    v_mov_b64 v[70:71], 0
    v_smfmac_f32_16x16x64_bf16 v[64:67], v[4:7], v[232:239], v76
    v_mov_b64 v[72:73], 0
    v_mov_b64 v[74:75], 0
    v_smfmac_f32_16x16x64_bf16 v[64:67], v[8:11], v[248:255], v76
    v_add_f32 v60, v60, v61
    v_smfmac_f32_16x16x64_bf16 v[64:67], v[20:23], a[24:31], v76
    v_add_f32 v62, v62, v63
    v_smfmac_f32_16x16x64_bf16 v[64:67], v[24:27], a[40:47], v76
    v_cvt_pk_bf16_f32 v60, v60, v62
    s_waitcnt lgkmcnt(3)
    v_smfmac_f32_16x16x64_bf16 v[68:71], v[4:7], v[36:43], v76
    s_waitcnt lgkmcnt(1)
    v_smfmac_f32_16x16x64_bf16 v[72:75], v[4:7], v[44:51], v76
    v_add_f32 v64, v64, v65
    v_add_f32 v66, v66, v67
    v_cvt_pk_bf16_f32 v61, v64, v66
    v_add_u32 v51, 65536, v77
    ds_read_b128 v[36:39], v51 offset:16384
    v_mfma_f32_16x16x16_bf16 v[64:67], v[60:61], v[78:79], 0
    ds_read_b128 v[40:43], v51 offset:17408
    ds_read_b128 v[44:47], v51 offset:18432
    ds_read_b128 v[48:51], v51 offset:19456
    v_smfmac_f32_16x16x64_bf16 v[68:71], v[0:3], a[64:71], v76
    v_smfmac_f32_16x16x64_bf16 v[72:75], v[0:3], a[72:79], v76
    v_cvt_pk_bf16_f32 v62, v64, v65
    v_cvt_pk_bf16_f32 v63, v66, v67
    v_smfmac_f32_16x16x64_bf16 v[68:71], v[8:11], a[80:87], v76
    v_mov_b32_dpp v64, v62 quad_perm:[2,3,0,1] row_mask:0xf bank_mask:0xf
    v_mov_b32_dpp v65, v63 quad_perm:[2,3,0,1] row_mask:0xf bank_mask:0xf
    s_nop 1
    v_mfma_f32_16x16x32_bf16 v[58:61], v[62:65], v[54:57], 0
    buffer_load_dwordx4 v[52:55], v77, s[8:11], s18 offen
    v_smfmac_f32_16x16x64_bf16 v[72:75], v[8:11], a[88:95], v76
    s_waitcnt lgkmcnt(2)
    v_smfmac_f32_16x16x64_bf16 v[68:71], v[12:15], v[36:43], v76
    v_cndmask_b32 v58, v61, v58, s[32:33]
    ds_write_b32 v77, v58 offset:14336
    buffer_load_dwordx4 v[56:59], v77, s[8:11], s18 offen offset:1024
    s_waitcnt lgkmcnt(1)
    v_smfmac_f32_16x16x64_bf16 v[72:75], v[12:15], v[44:51], v76
    v_add_u32 v51, 65536, v77
    v_smfmac_f32_16x16x64_bf16 v[68:71], v[16:19], a[96:103], v76
    ds_read_b128 v[36:39], v51 offset:32768
    v_smfmac_f32_16x16x64_bf16 v[72:75], v[16:19], a[104:111], v76
    ds_read_b128 v[40:43], v51 offset:33792
    v_smfmac_f32_16x16x64_bf16 v[68:71], v[24:27], a[112:119], v76
    ds_read_b128 v[44:47], v51 offset:34816
    s_waitcnt lgkmcnt(3)
    s_barrier
    v_smfmac_f32_16x16x64_bf16 v[72:75], v[24:27], a[120:127], v76
    v_mov_b64 v[24:25], -1
    v_mov_b64 v[26:27], -1
    ds_read_b128 v[16:19], v77 offset:14336
    ds_read_b128 v[0:3], v77 offset:10240
    ds_read_b128 v[4:7], v77 offset:11264
    ds_read_b128 v[8:11], v77 offset:12288
    ds_read_b128 v[12:15], v77 offset:13312
    v_smfmac_f32_16x16x64_bf16 v[68:71], v[32:35], a[144:151], v76
    ds_read_b128 v[48:51], v51 offset:35840
    v_smfmac_f32_16x16x64_bf16 v[72:75], v[32:35], a[152:159], v76
    ds_read_b64 v[66:67], v77 offset:15368
    v_smfmac_f32_16x16x64_bf16 v[68:71], v[28:31], a[128:135], v76
    ds_read_b64 v[60:61], v77 offset:15360
    s_waitcnt lgkmcnt(7)
    v_add_f32 v16, v16, v17
    v_add_f32 v18, v18, v19
    v_smfmac_f32_16x16x64_bf16 v[72:75], v[28:31], a[136:143], v76
    v_mov_b64 v[28:29], 0
    s_mov_b64 exec, 0x3ffff
    buffer_store_dwordx4 v[24:27], v77, s[8:11], s31 offen
    s_mov_b64 exec, -1
    v_smfmac_f32_16x16x64_bf16 v[68:71], v[20:23], v[36:43], v76
    s_waitcnt lgkmcnt(5)
    v_add_f32 v0, v0, v4
    v_add_f32 v1, v1, v5
    v_add_f32 v2, v2, v6
    v_add_f32 v3, v3, v7
    v_add_f32 v4, v16, v18
    v_cndmask_b32 v16, 16, 0, s[32:33]
    s_waitcnt lgkmcnt(3)
    v_add_f32 v8, v8, v12
    v_add_f32 v9, v9, v13
    v_add_f32 v10, v10, v14
    v_add_f32 v11, v11, v15
    v_add_f32 v0, v0, v8
    v_add_f32 v1, v1, v9
    v_add_f32 v2, v2, v10
    v_add_f32 v3, v3, v11
    v_max3_f32 v5, v0, v1, v4
    v_max3_f32 v5, v5, v2, v3
    v_mov_b32 v9, 0
    v_mov_b32 v10, 0
    v_max_f32_dpp v5, v5, v5 quad_perm:[2,3,0,1] row_mask:0xf bank_mask:0xf
    v_mov_b32 v6, v5
    s_waitcnt lgkmcnt(2)
    v_smfmac_f32_16x16x64_bf16 v[72:75], v[20:23], v[44:51], v76
    v_permlane16_swap_b32 v5, v6
    v_max_f32 v5, v5, v6
    v_mov_b32 v6, v5
    v_add_f32 v68, v68, v69
    v_add_f32 v70, v70, v71
    v_permlane32_swap_b32 v5, v6
    v_max_f32 v5, v5, v6
    v_mul_f32 v5, s40, v5
    v_fma_f32 v0, v0, s40, -v5
    v_fma_f32 v1, v1, s40, -v5
    v_fma_f32 v2, v2, s40, -v5
    v_fma_f32 v3, v3, s40, -v5
    v_exp_f32 v0, v0
    v_exp_f32 v1, v1
    v_fma_f32 v4, v4, s40, -v5
    v_exp_f32 v2, v2
    v_exp_f32 v3, v3
    v_exp_f32 v4, v4
    v_cvt_pk_bf16_f32 v5, v0, v1
    v_cvt_pk_bf16_f32 v6, v2, v3
    v_add_f32 v0, v0, v1
    v_add_f32 v2, v2, v3
    v_add_f32 v0, v0, v4
    v_cndmask_b32 v12, 0, v5, s[32:33]
    v_cndmask_b32 v13, 0, v6, s[32:33]
    v_cndmask_b32 v14, v5, 0, s[32:33]
    v_cndmask_b32 v15, v6, 0, s[32:33]
    v_add_f32 v0, v0, v2
    v_add_f32 v72, v72, v73
    v_add_f32 v74, v74, v75
    v_cvt_pk_bf16_f32 v7, v4, 0
    s_waitcnt vmcnt(2)
    v_mfma_f32_16x16x32_bf16 v[52:55], v[52:55], v[12:15], 0
    v_add_f32_dpp v0, v0, v0 quad_perm:[2,3,0,1] row_mask:0xf bank_mask:0xf
    v_cvt_pk_bf16_f32 v64, v68, v74
    s_waitcnt vmcnt(1)
    v_mfma_f32_16x16x32_bf16 v[56:59], v[56:59], v[12:15], 0
    v_cvt_pk_bf16_f32 v65, v72, v70
    buffer_store_dwordx4 v[62:65], v77, s[8:11], s19 offen sc1
    s_cmp_eq_u32 s16, 63
    s_cbranch_scc1 CH_END
    v_lshlrev_b32 v8, v16, v7
    v_lshlrev_b32 v11, v16, v7
    v_mov_b32 v1, v0
    v_mfma_f32_16x16x16_bf16 v[52:55], v[64:65], v[8:9], v[52:55]
    s_waitcnt lgkmcnt(0)
    v_and_b32 v17, 0xffff, v60
    v_permlane16_swap_b32 v0, v1
    v_mfma_f32_16x16x16_bf16 v[56:59], v[64:65], v[10:11], v[56:59]
    v_add_f32 v0, v0, v1
    v_mov_b32 v1, v0
    v_and_b32 v14, 0xffff, v61
    v_and_b32 v15, 0x80, v77
    v_permlane32_swap_b32 v0, v1
    v_add_f32 v0, v0, v1
    v_rcp_f32 v0, v0
    s_nop 0
    v_add_f32_dpp v52, v56, v52 quad_perm:[2,3,0,1] row_mask:0xf bank_mask:0xf
    v_add_f32_dpp v53, v57, v53 quad_perm:[2,3,0,1] row_mask:0xf bank_mask:0xf
    v_add_f32_dpp v54, v58, v54 quad_perm:[2,3,0,1] row_mask:0xf bank_mask:0xf
    v_add_f32_dpp v55, v59, v55 quad_perm:[2,3,0,1] row_mask:0xf bank_mask:0xf
    v_mul_f32 v52, v52, v0
    v_mul_f32 v53, v53, v0
    v_mul_f32 v54, v54, v0
    v_mul_f32 v55, v55, v0
    v_cvt_pk_bf16_f32 v52, v52, v53
    v_cvt_pk_bf16_f32 v53, v54, v55
    ds_write_b64 v17, v[52:53] offset:8192
    v_lshl_add_u32 v15, v15, 3, v14
    v_add_u32 v51, 65536, v77
    ds_read_b128 v[36:39], v51 offset:49152
    ds_read_b128 v[40:43], v51 offset:50176
    ds_read_b128 v[44:47], v51 offset:51200
    ds_read_b128 v[48:51], v51 offset:52224
    v_add_u32 v63, 131072, v77
    ds_read_b128 v[68:71], v63 offset:0
    ds_read_b128 v[72:75], v63 offset:1024
    v_lshrrev_b32 v61, 16, v61
    v_mov_b64 v[24:25], 0
    v_mov_b64 v[26:27], 0
    v_mov_b64 v[16:17], 0
    v_mov_b64 v[18:19], 0
    v_and_b32 v62, 0xffff, v66
    v_mov_b64 v[30:31], 0
    v_mov_b64 v[32:33], 0
    v_mov_b64 v[34:35], 0
    v_mov_b64 v[20:21], 0
    v_mov_b64 v[22:23], 0
    v_lshrrev_b32 v60, 12, v60
    s_waitcnt lgkmcnt(6)
    s_barrier
    v_lshrrev_b32 v66, 16, v66
    ds_read_b128 v[52:55], v15 offset:8192
    ds_read_b128 v[56:59], v15 offset:8704
    ds_read_b128 v[0:3], v14 offset:8192
    ds_read_b128 v[4:7], v14 offset:8704
    ds_read_b128 v[8:11], v14 offset:9216
    ds_read_b128 v[12:15], v14 offset:9728
    s_waitcnt lgkmcnt(5)
    v_smfmac_f32_16x16x64_bf16 v[24:27], v[52:55], v[36:43], v61
    ds_read_b128 v[36:39], v63 offset:2048
    s_waitcnt lgkmcnt(5)
    v_smfmac_f32_16x16x64_bf16 v[24:27], v[56:59], v[44:51], v61
    ds_read_b128 v[40:43], v63 offset:3072
    s_waitcnt lgkmcnt(5)
    v_smfmac_f32_16x16x64_bf16 v[16:19], v[0:3], v[68:75], v61
    ds_read_b128 v[44:47], v63 offset:16384
    v_smfmac_f32_16x16x64_bf16 v[28:31], v[0:3], a[160:167], v61
    ds_read_b128 v[48:51], v63 offset:17408
    s_waitcnt lgkmcnt(6)
    v_smfmac_f32_16x16x64_bf16 v[28:31], v[4:7], a[168:175], v61
    ds_read_b128 v[68:71], v63 offset:18432
    s_waitcnt lgkmcnt(6)
    v_smfmac_f32_16x16x64_bf16 v[28:31], v[8:11], a[176:183], v61
    ds_read_b128 v[72:75], v63 offset:19456
    s_waitcnt lgkmcnt(6)
    v_smfmac_f32_16x16x64_bf16 v[28:31], v[12:15], a[184:191], v61
    v_permlane32_swap_b32 v24, v26
    v_smfmac_f32_16x16x64_bf16 v[32:35], v[0:3], a[192:199], v61
    v_permlane32_swap_b32 v25, v27
    v_smfmac_f32_16x16x64_bf16 v[32:35], v[4:7], a[200:207], v61
    v_cvt_pk_bf16_f32 v28, v28, v29
    v_smfmac_f32_16x16x64_bf16 v[32:35], v[8:11], a[208:215], v61
    v_cvt_pk_bf16_f32 v29, v30, v31
    v_smfmac_f32_16x16x64_bf16 v[32:35], v[12:15], a[216:223], v61
    v_add_f32 v24, v24, v26
    s_waitcnt lgkmcnt(4)
    v_smfmac_f32_16x16x64_bf16 v[16:19], v[4:7], v[36:43], v61
    v_add_f32 v25, v25, v27
    s_waitcnt lgkmcnt(2)
    v_smfmac_f32_16x16x64_bf16 v[16:19], v[8:11], v[44:51], v61
    v_cvt_pk_bf16_f32 v30, v32, v33
    v_cvt_pk_bf16_f32 v31, v34, v35
    s_waitcnt lgkmcnt(0)
    v_smfmac_f32_16x16x64_bf16 v[16:19], v[12:15], v[68:75], v61
    v_permlane16_swap_b32 v28, v30
    v_permlane16_swap_b32 v29, v31
    v_and_or_b32 v28, v28, -2, s49
    buffer_store_dwordx4 v[28:31], v62, s[8:11], s24 offen
    v_smfmac_f32_16x16x64_bf16 v[20:23], v[0:3], a[224:231], v61
    s_nop 2
    v_cvt_pk_bf16_f32 v19, v18, v19
    v_cvt_pk_bf16_f32 v18, v16, v17
    v_smfmac_f32_16x16x64_bf16 v[20:23], v[4:7], a[232:239], v61
    v_cvt_pk_bf16_f32 v25, v24, v25
    v_smfmac_f32_16x16x64_bf16 v[20:23], v[8:11], a[240:247], v61
    v_mov_b32 v24, v25
    v_smfmac_f32_16x16x64_bf16 v[20:23], v[12:15], a[248:255], v61
    s_nop 0
    v_permlane32_swap_b32 v24, v25
    v_and_or_b32 v24, v24, -2, s49
    s_mov_b32 exec_hi, 0
    buffer_store_dwordx2 v[24:25], v67, s[8:11], s26 offen
    s_mov_b32 exec_hi, -1
    s_nop 1
    v_cvt_pk_bf16_f32 v16, v20, v21
    v_cvt_pk_bf16_f32 v17, v22, v23
    s_nop 0
    v_permlane16_swap_b32 v16, v18
    v_permlane16_swap_b32 v17, v19
    v_and_or_b32 v16, v16, -2, s49
    buffer_store_dwordx4 v[16:19], v62, s[8:11], s25 offen
    v_mov_b32 v35, 0x3f80
    v_cndmask_b32 v35, v35, 1.0, s[34:35]
    v_cndmask_b32 v32, 0, v35, s[56:57]
    v_cndmask_b32 v33, 0, v35, s[58:59]
    v_cndmask_b32 v34, 0, v35, s[60:61]
    v_cndmask_b32 v35, 0, v35, s[62:63]
    ds_read_b128 v[36:39], v77 offset:16384
    ds_read_b128 v[40:43], v77 offset:17408
    ds_read_b128 v[44:47], v77 offset:18432
    ds_read_b128 v[48:51], v77 offset:19456
    v_mov_b64 v[52:53], 0
    v_mov_b64 v[54:55], 0
    v_mov_b64 v[56:57], 0
    v_mov_b64 v[58:59], 0
    s_add_u32 s17, s17, 8192
    s_add_u32 s18, s18, 8192
    s_add_u32 s19, s19, 131072
    s_add_u32 s24, s24, s48
    s_add_u32 s25, s25, s48
    s_add_u32 s26, s26, s48
    s_add_u32 s27, s30, 0
    s_add_u32 s28, s30, 4096
    s_add_u32 s16, s16, 1
    s_waitcnt vmcnt(1)
    buffer_load_dwordx4 v[0:3], v60, s[8:11], s20 offen sc1
    buffer_load_dwordx4 v[4:7], v60, s[8:11], s21 offen sc1
    buffer_load_dwordx4 v[8:11], v60, s[8:11], s22 offen sc1
    buffer_load_dwordx4 v[12:15], v60, s[8:11], s23 offen sc1
CH_f0_p1:
    s_waitcnt vmcnt(3)
    v_mfma_f32_16x16x32_bf16 v[68:71], v[0:3], v[32:35], 0
    s_waitcnt vmcnt(2)
    v_mfma_f32_16x16x32_bf16 v[68:71], v[4:7], v[32:35], v[68:71]
    v_bitop3_b32 v64, v0, v4, s49 bitop3:0x7e
    s_waitcnt vmcnt(1)
    v_mfma_f32_16x16x32_bf16 v[68:71], v[8:11], v[32:35], v[68:71]
    s_waitcnt vmcnt(0)
    v_mfma_f32_16x16x32_bf16 v[68:71], v[12:15], v[32:35], v[68:71]
    v_bitop3_b32 v65, v8, v12, s49 bitop3:0x7e
    v_bitop3_b32 v64, v64, v65, 1 bitop3:0xa8
    v_cmp_ne_u32 vcc, 0, v64
    s_cbranch_vccz CH_f0_p1_ok
    s_sub_u32 s41, s41, 1
    s_cbranch_scc1 CH_f0_p1_x
    buffer_load_dwordx4 v[0:3], v60, s[8:11], s20 offen sc1
    buffer_load_dwordx4 v[4:7], v60, s[8:11], s21 offen sc1
    buffer_load_dwordx4 v[8:11], v60, s[8:11], s22 offen sc1
    buffer_load_dwordx4 v[12:15], v60, s[8:11], s23 offen sc1
    s_branch CH_f0_p1
CH_f0_p1_x:
    s_mov_b32 s41, 0
CH_f0_p1_ok:
    s_nop 3
    v_add_f32 v68, v68, v69
    v_add_f32 v70, v70, v71
    s_mov_b64 exec, s[36:37]
    v_cvt_pk_bf16_f32 v68, v68, v70
    buffer_store_dword v68, v66, s[8:11], s5 offen
    s_mov_b64 exec, -1
    s_waitcnt vmcnt(0)
    s_barrier
    s_cmp_lt_u32 s16, 64
    s_cbranch_scc1 CH_f0
    s_branch CH_END
CH_gof1:
    ds_read_b128 v[36:39], v77 offset:20480
    ds_read_b128 v[40:43], v77 offset:21504
    ds_read_b128 v[44:47], v77 offset:22528
    ds_read_b128 v[48:51], v77 offset:23552
CH_f1:
    buffer_load_dwordx4 v[4:7], v77, s[8:11], s27 offen sc1
    buffer_load_dwordx4 v[20:23], v77, s[8:11], s28 offen sc1
    v_mov_b64 v[60:61], 0
    v_mov_b64 v[62:63], 0
    v_mov_b64 v[64:65], 0
    v_mov_b64 v[66:67], 0
    s_add_u32 s20, s20, s48
    s_add_u32 s21, s21, s48
    s_add_u32 s22, s22, s48
    s_add_u32 s23, s23, s48
    s_sub_u32 s48, 0, s48
    s_bfe_u32 s49, s16, 0x10001
    s_mov_b32 s42, s72
    s_mov_b32 s72, s30
    s_mov_b32 s30, s38
    s_mov_b32 s38, s42
    s_add_u32 s31, s38, s39
    s_add_u32 s5, s30, s6
CH_f1_p2:
    s_waitcnt vmcnt(1)
    ds_write_b128 v77, v[4:7] offset:1024
    v_max3_u32 v68, v4, v5, v6
    s_waitcnt vmcnt(0)
    ds_write_b128 v77, v[20:23] offset:5120
    v_max3_u32 v69, v20, v21, v22
    v_max3_u32 v68, v68, v7, v23
    v_max_u32 v68, v68, v69
    v_cmp_eq_u32 vcc, -1, v68
    s_cbranch_vccz CH_f1_p2_ok
CH_f1_p2_f:
    s_sub_u32 s41, s41, 1
    s_cbranch_scc1 CH_f1_p2_x
    buffer_load_dwordx4 v[4:7], v77, s[8:11], s27 offen sc1
    buffer_load_dwordx4 v[20:23], v77, s[8:11], s28 offen sc1
    s_branch CH_f1_p2
CH_f1_p2_x:
    s_mov_b32 s41, 0
CH_f1_p2_ok:
    v_smfmac_f32_16x16x64_bf16 v[52:55], v[4:7], v[96:103], v76
    v_smfmac_f32_16x16x64_bf16 v[56:59], v[4:7], v[104:111], v76
    s_waitcnt lgkmcnt(0)
    s_barrier
    v_smfmac_f32_16x16x64_bf16 v[52:55], v[20:23], v[160:167], v76
    buffer_load_dwordx4 v[68:71], v77, s[8:11], s17 offen
    buffer_load_dwordx4 v[72:75], v77, s[8:11], s17 offen offset:1024
    v_smfmac_f32_16x16x64_bf16 v[56:59], v[20:23], v[168:175], v76
    ds_read_b128 v[32:35], v77 offset:8192
    v_smfmac_f32_16x16x64_bf16 v[60:63], v[4:7], v[224:231], v76
    ds_read_b128 v[0:3], v77 offset:0
    v_smfmac_f32_16x16x64_bf16 v[64:67], v[4:7], v[232:239], v76
    ds_read_b128 v[8:11], v77 offset:2048
    v_smfmac_f32_16x16x64_bf16 v[60:63], v[20:23], a[16:23], v76
    ds_read_b128 v[12:15], v77 offset:3072
    v_smfmac_f32_16x16x64_bf16 v[64:67], v[20:23], a[24:31], v76
    ds_read_b128 v[16:19], v77 offset:4096
    s_waitcnt lgkmcnt(4)
    v_smfmac_f32_16x16x64_bf16 v[52:55], v[32:35], v[36:43], v76
    ds_read_b128 v[36:39], v77 offset:36864
    v_smfmac_f32_16x16x64_bf16 v[56:59], v[32:35], v[44:51], v76
    ds_read_b128 v[40:43], v77 offset:37888
    s_waitcnt lgkmcnt(5)
    v_smfmac_f32_16x16x64_bf16 v[52:55], v[0:3], v[80:87], v76
    ds_read_b128 v[44:47], v77 offset:38912
    v_smfmac_f32_16x16x64_bf16 v[56:59], v[0:3], v[88:95], v76
    ds_read_b128 v[48:51], v77 offset:39936
    s_waitcnt lgkmcnt(6)
    v_smfmac_f32_16x16x64_bf16 v[52:55], v[8:11], v[112:119], v76
    ds_read_b128 v[24:27], v77 offset:6144
    v_smfmac_f32_16x16x64_bf16 v[56:59], v[8:11], v[120:127], v76
    ds_read_b128 v[28:31], v77 offset:7168
    s_waitcnt lgkmcnt(7)
    v_smfmac_f32_16x16x64_bf16 v[52:55], v[12:15], v[128:135], v76
    v_smfmac_f32_16x16x64_bf16 v[56:59], v[12:15], v[136:143], v76
    s_waitcnt lgkmcnt(4)
    v_smfmac_f32_16x16x64_bf16 v[60:63], v[12:15], v[36:43], v76
    ds_read_b128 v[36:39], v77 offset:53248
    s_waitcnt lgkmcnt(3)
    v_smfmac_f32_16x16x64_bf16 v[64:67], v[12:15], v[44:51], v76
    ds_read_b128 v[40:43], v77 offset:54272
    v_smfmac_f32_16x16x64_bf16 v[52:55], v[16:19], v[144:151], v76
    ds_read_b128 v[44:47], v77 offset:55296
    v_smfmac_f32_16x16x64_bf16 v[56:59], v[16:19], v[152:159], v76
    ds_read_b128 v[48:51], v77 offset:56320
    s_waitcnt lgkmcnt(5)
    v_smfmac_f32_16x16x64_bf16 v[52:55], v[24:27], v[176:183], v76
    v_smfmac_f32_16x16x64_bf16 v[56:59], v[24:27], v[184:191], v76
    s_waitcnt lgkmcnt(4)
    v_smfmac_f32_16x16x64_bf16 v[52:55], v[28:31], v[192:199], v76
    v_smfmac_f32_16x16x64_bf16 v[56:59], v[28:31], v[200:207], v76
    v_smfmac_f32_16x16x64_bf16 v[60:63], v[32:35], a[48:55], v76
    v_add_f32 v52, v52, v53
    v_add_f32 v54, v54, v55
    v_cvt_pk_bf16_f32 v52, v52, v54
    s_nop 0
    v_add_f32 v56, v56, v57
    v_add_f32 v58, v58, v59
    v_cvt_pk_bf16_f32 v53, v56, v58
    v_smfmac_f32_16x16x64_bf16 v[60:63], v[0:3], v[208:215], v76
    s_nop 0
    v_mfma_f32_16x16x16_bf16 v[56:59], v[52:53], v[78:79], 0
    s_waitcnt lgkmcnt(2)
    v_smfmac_f32_16x16x64_bf16 v[60:63], v[28:31], v[36:43], v76
    s_waitcnt lgkmcnt(0)
    v_smfmac_f32_16x16x64_bf16 v[64:67], v[28:31], v[44:51], v76
    v_cvt_pk_bf16_f32 v54, v56, v57
    v_cvt_pk_bf16_f32 v55, v58, v59
    v_smfmac_f32_16x16x64_bf16 v[60:63], v[8:11], v[240:247], v76
    v_mov_b32_dpp v56, v54 quad_perm:[2,3,0,1] row_mask:0xf bank_mask:0xf
    v_mov_b32_dpp v57, v55 quad_perm:[2,3,0,1] row_mask:0xf bank_mask:0xf
    v_smfmac_f32_16x16x64_bf16 v[60:63], v[16:19], a[0:7], v76
    v_add_u32 v51, 65536, v77
    s_waitcnt vmcnt(1)
    v_mfma_f32_16x16x32_bf16 v[68:71], v[68:71], v[54:57], 0
    ds_read_b128 v[36:39], v51 offset:4096
    ds_read_b128 v[40:43], v51 offset:5120
    s_waitcnt vmcnt(0)
    v_mfma_f32_16x16x32_bf16 v[72:75], v[72:75], v[54:57], 0
    ds_read_b128 v[44:47], v51 offset:6144
    ds_read_b128 v[48:51], v51 offset:7168
    v_smfmac_f32_16x16x64_bf16 v[60:63], v[24:27], a[32:39], v76
    v_smfmac_f32_16x16x64_bf16 v[64:67], v[32:35], a[56:63], v76
    v_cndmask_b32 v68, v72, v68, s[32:33]
    v_cndmask_b32 v69, v73, v69, s[32:33]
    v_cndmask_b32 v70, v74, v70, s[32:33]
    v_cndmask_b32 v71, v75, v71, s[32:33]
    ds_write_b128 v77, v[68:71] offset:11264
    v_mov_b64 v[68:69], 0
    v_mov_b64 v[70:71], 0
    v_smfmac_f32_16x16x64_bf16 v[64:67], v[0:3], v[216:223], v76
    v_mov_b64 v[72:73], 0
    v_mov_b64 v[74:75], 0
    v_smfmac_f32_16x16x64_bf16 v[64:67], v[8:11], v[248:255], v76
    v_add_f32 v60, v60, v61
    v_smfmac_f32_16x16x64_bf16 v[64:67], v[16:19], a[8:15], v76
    v_add_f32 v62, v62, v63
    v_smfmac_f32_16x16x64_bf16 v[64:67], v[24:27], a[40:47], v76
    v_cvt_pk_bf16_f32 v60, v60, v62
    s_waitcnt lgkmcnt(3)
    v_smfmac_f32_16x16x64_bf16 v[68:71], v[4:7], v[36:43], v76
    s_waitcnt lgkmcnt(1)
    v_smfmac_f32_16x16x64_bf16 v[72:75], v[4:7], v[44:51], v76
    v_add_f32 v64, v64, v65
    v_add_f32 v66, v66, v67
    v_cvt_pk_bf16_f32 v61, v64, v66
    v_add_u32 v51, 65536, v77
    ds_read_b128 v[36:39], v51 offset:20480
    v_mfma_f32_16x16x16_bf16 v[64:67], v[60:61], v[78:79], 0
    ds_read_b128 v[40:43], v51 offset:21504
    ds_read_b128 v[44:47], v51 offset:22528
    ds_read_b128 v[48:51], v51 offset:23552
    v_smfmac_f32_16x16x64_bf16 v[68:71], v[0:3], a[64:71], v76
    v_smfmac_f32_16x16x64_bf16 v[72:75], v[0:3], a[72:79], v76
    v_cvt_pk_bf16_f32 v62, v64, v65
    v_cvt_pk_bf16_f32 v63, v66, v67
    v_smfmac_f32_16x16x64_bf16 v[68:71], v[8:11], a[80:87], v76
    v_mov_b32_dpp v64, v62 quad_perm:[2,3,0,1] row_mask:0xf bank_mask:0xf
    v_mov_b32_dpp v65, v63 quad_perm:[2,3,0,1] row_mask:0xf bank_mask:0xf
    s_nop 1
    v_mfma_f32_16x16x32_bf16 v[58:61], v[62:65], v[54:57], 0
    buffer_load_dwordx4 v[52:55], v77, s[8:11], s18 offen
    v_smfmac_f32_16x16x64_bf16 v[72:75], v[8:11], a[88:95], v76
    s_waitcnt lgkmcnt(2)
    v_smfmac_f32_16x16x64_bf16 v[68:71], v[12:15], v[36:43], v76
    v_cndmask_b32 v58, v61, v58, s[32:33]
    ds_write_b32 v77, v58 offset:14340
    buffer_load_dwordx4 v[56:59], v77, s[8:11], s18 offen offset:1024
    s_waitcnt lgkmcnt(1)
    v_smfmac_f32_16x16x64_bf16 v[72:75], v[12:15], v[44:51], v76
    v_add_u32 v51, 65536, v77
    v_smfmac_f32_16x16x64_bf16 v[68:71], v[16:19], a[96:103], v76
    ds_read_b128 v[36:39], v51 offset:36864
    v_smfmac_f32_16x16x64_bf16 v[72:75], v[16:19], a[104:111], v76
    ds_read_b128 v[40:43], v51 offset:37888
    v_smfmac_f32_16x16x64_bf16 v[68:71], v[24:27], a[112:119], v76
    ds_read_b128 v[44:47], v51 offset:38912
    s_waitcnt lgkmcnt(3)
    s_barrier
    v_smfmac_f32_16x16x64_bf16 v[72:75], v[24:27], a[120:127], v76
    ds_read_b128 v[16:19], v77 offset:14336
    ds_read_b128 v[0:3], v77 offset:10240
    ds_read_b128 v[4:7], v77 offset:11264
    ds_read_b128 v[8:11], v77 offset:12288
    ds_read_b128 v[12:15], v77 offset:13312
    v_smfmac_f32_16x16x64_bf16 v[68:71], v[32:35], a[144:151], v76
    ds_read_b128 v[48:51], v51 offset:39936
    v_smfmac_f32_16x16x64_bf16 v[72:75], v[32:35], a[152:159], v76
    ds_read_b64 v[66:67], v77 offset:15368
    v_smfmac_f32_16x16x64_bf16 v[68:71], v[28:31], a[128:135], v76
    ds_read_b64 v[60:61], v77 offset:15360
    s_waitcnt lgkmcnt(7)
    v_add_f32 v16, v16, v17
    v_add_f32 v18, v18, v19
    v_smfmac_f32_16x16x64_bf16 v[72:75], v[28:31], a[136:143], v76
    v_mov_b64 v[24:25], 0
    v_smfmac_f32_16x16x64_bf16 v[68:71], v[20:23], v[36:43], v76
    s_waitcnt lgkmcnt(5)
    v_add_f32 v0, v0, v4
    v_add_f32 v1, v1, v5
    v_add_f32 v2, v2, v6
    v_add_f32 v3, v3, v7
    v_add_f32 v4, v16, v18
    v_cndmask_b32 v16, 16, 0, s[32:33]
    v_mov_b64 v[26:27], 0
    s_waitcnt lgkmcnt(3)
    v_add_f32 v8, v8, v12
    v_add_f32 v9, v9, v13
    v_add_f32 v10, v10, v14
    v_add_f32 v11, v11, v15
    v_add_f32 v0, v0, v8
    v_add_f32 v1, v1, v9
    v_add_f32 v2, v2, v10
    v_add_f32 v3, v3, v11
    v_max3_f32 v5, v0, v1, v4
    v_max3_f32 v5, v5, v2, v3
    v_mov_b32 v9, 0
    v_mov_b32 v10, 0
    v_max_f32_dpp v5, v5, v5 quad_perm:[2,3,0,1] row_mask:0xf bank_mask:0xf
    v_mov_b32 v6, v5
    s_waitcnt lgkmcnt(2)
    v_smfmac_f32_16x16x64_bf16 v[72:75], v[20:23], v[44:51], v76
    v_permlane16_swap_b32 v5, v6
    v_max_f32 v5, v5, v6
    v_mov_b32 v6, v5
    v_add_f32 v68, v68, v69
    v_add_f32 v70, v70, v71
    v_permlane32_swap_b32 v5, v6
    v_max_f32 v5, v5, v6
    v_mul_f32 v5, s40, v5
    v_fma_f32 v0, v0, s40, -v5
    v_fma_f32 v1, v1, s40, -v5
    v_fma_f32 v2, v2, s40, -v5
    v_fma_f32 v3, v3, s40, -v5
    v_exp_f32 v0, v0
    v_exp_f32 v1, v1
    v_fma_f32 v4, v4, s40, -v5
    v_exp_f32 v2, v2
    v_exp_f32 v3, v3
    v_exp_f32 v4, v4
    v_cvt_pk_bf16_f32 v5, v0, v1
    v_cvt_pk_bf16_f32 v6, v2, v3
    v_add_f32 v0, v0, v1
    v_add_f32 v2, v2, v3
    v_add_f32 v0, v0, v4
    v_cndmask_b32 v12, 0, v5, s[32:33]
    v_cndmask_b32 v13, 0, v6, s[32:33]
    v_cndmask_b32 v14, v5, 0, s[32:33]
    v_cndmask_b32 v15, v6, 0, s[32:33]
    v_add_f32 v0, v0, v2
    v_add_f32 v72, v72, v73
    v_add_f32 v74, v74, v75
    v_cvt_pk_bf16_f32 v7, v4, 0
    s_waitcnt vmcnt(1)
    v_mfma_f32_16x16x32_bf16 v[52:55], v[52:55], v[12:15], 0
    v_add_f32_dpp v0, v0, v0 quad_perm:[2,3,0,1] row_mask:0xf bank_mask:0xf
    v_cvt_pk_bf16_f32 v64, v68, v74
    s_waitcnt vmcnt(0)
    v_mfma_f32_16x16x32_bf16 v[56:59], v[56:59], v[12:15], 0
    v_cvt_pk_bf16_f32 v65, v72, v70
    buffer_store_dwordx4 v[62:65], v77, s[8:11], s19 offen sc1
    s_cmp_eq_u32 s16, 63
    s_cbranch_scc1 CH_END
    v_lshlrev_b32 v8, v16, v7
    v_lshlrev_b32 v11, v16, v7
    v_mov_b32 v1, v0
    v_mfma_f32_16x16x16_bf16 v[52:55], v[64:65], v[8:9], v[52:55]
    s_waitcnt lgkmcnt(0)
    v_and_b32 v17, 0xffff, v60
    v_permlane16_swap_b32 v0, v1
    v_mfma_f32_16x16x16_bf16 v[56:59], v[64:65], v[10:11], v[56:59]
    v_add_f32 v0, v0, v1
    v_mov_b32 v1, v0
    v_and_b32 v14, 0xffff, v61
    v_and_b32 v15, 0x80, v77
    v_permlane32_swap_b32 v0, v1
    v_add_f32 v0, v0, v1
    v_rcp_f32 v0, v0
    s_nop 0
    v_add_f32_dpp v52, v56, v52 quad_perm:[2,3,0,1] row_mask:0xf bank_mask:0xf
    v_add_f32_dpp v53, v57, v53 quad_perm:[2,3,0,1] row_mask:0xf bank_mask:0xf
    v_add_f32_dpp v54, v58, v54 quad_perm:[2,3,0,1] row_mask:0xf bank_mask:0xf
    v_add_f32_dpp v55, v59, v55 quad_perm:[2,3,0,1] row_mask:0xf bank_mask:0xf
    v_mul_f32 v52, v52, v0
    v_mul_f32 v53, v53, v0
    v_mul_f32 v54, v54, v0
    v_mul_f32 v55, v55, v0
    v_cvt_pk_bf16_f32 v52, v52, v53
    v_cvt_pk_bf16_f32 v53, v54, v55
    ds_write_b64 v17, v[52:53] offset:8704
    v_lshl_add_u32 v15, v15, 3, v14
    v_add_u32 v51, 65536, v77
    ds_read_b128 v[36:39], v51 offset:53248
    ds_read_b128 v[40:43], v51 offset:54272
    ds_read_b128 v[44:47], v51 offset:55296
    ds_read_b128 v[48:51], v51 offset:56320
    v_add_u32 v63, 131072, v77
    ds_read_b128 v[68:71], v63 offset:4096
    ds_read_b128 v[72:75], v63 offset:5120
    v_lshrrev_b32 v61, 16, v61
    v_mov_b64 v[16:17], 0
    v_mov_b64 v[18:19], 0
    v_and_b32 v62, 0xffff, v66
    v_mov_b64 v[28:29], 0
    v_mov_b64 v[30:31], 0
    v_mov_b64 v[32:33], 0
    v_mov_b64 v[34:35], 0
    v_mov_b64 v[20:21], 0
    v_mov_b64 v[22:23], 0
    v_lshrrev_b32 v60, 12, v60
    v_lshrrev_b32 v66, 16, v66
    s_waitcnt lgkmcnt(6)
    s_barrier
    ds_read_b128 v[52:55], v15 offset:8192
    ds_read_b128 v[56:59], v15 offset:8704
    ds_read_b128 v[0:3], v14 offset:8192
    ds_read_b128 v[4:7], v14 offset:8704
    ds_read_b128 v[8:11], v14 offset:9216
    ds_read_b128 v[12:15], v14 offset:9728
    s_waitcnt lgkmcnt(5)
    v_smfmac_f32_16x16x64_bf16 v[24:27], v[52:55], v[36:43], v61
    ds_read_b128 v[36:39], v63 offset:6144
    s_waitcnt lgkmcnt(5)
    v_smfmac_f32_16x16x64_bf16 v[24:27], v[56:59], v[44:51], v61
    ds_read_b128 v[40:43], v63 offset:7168
    s_waitcnt lgkmcnt(5)
    v_smfmac_f32_16x16x64_bf16 v[16:19], v[0:3], v[68:75], v61
    ds_read_b128 v[44:47], v63 offset:20480
    v_smfmac_f32_16x16x64_bf16 v[28:31], v[0:3], a[160:167], v61
    ds_read_b128 v[48:51], v63 offset:21504
    s_waitcnt lgkmcnt(6)
    v_smfmac_f32_16x16x64_bf16 v[28:31], v[4:7], a[168:175], v61
    ds_read_b128 v[68:71], v63 offset:22528
    s_waitcnt lgkmcnt(6)
    v_smfmac_f32_16x16x64_bf16 v[28:31], v[8:11], a[176:183], v61
    ds_read_b128 v[72:75], v63 offset:23552
    s_waitcnt lgkmcnt(6)
    v_smfmac_f32_16x16x64_bf16 v[28:31], v[12:15], a[184:191], v61
    v_permlane32_swap_b32 v24, v26
    v_smfmac_f32_16x16x64_bf16 v[32:35], v[0:3], a[192:199], v61
    v_permlane32_swap_b32 v25, v27
    v_smfmac_f32_16x16x64_bf16 v[32:35], v[4:7], a[200:207], v61
    v_cvt_pk_bf16_f32 v28, v28, v29
    v_smfmac_f32_16x16x64_bf16 v[32:35], v[8:11], a[208:215], v61
    v_cvt_pk_bf16_f32 v29, v30, v31
    v_smfmac_f32_16x16x64_bf16 v[32:35], v[12:15], a[216:223], v61
    v_add_f32 v24, v24, v26
    s_waitcnt lgkmcnt(4)
    v_smfmac_f32_16x16x64_bf16 v[16:19], v[4:7], v[36:43], v61
    v_add_f32 v25, v25, v27
    s_waitcnt lgkmcnt(2)
    v_smfmac_f32_16x16x64_bf16 v[16:19], v[8:11], v[44:51], v61
    v_cvt_pk_bf16_f32 v30, v32, v33
    v_cvt_pk_bf16_f32 v31, v34, v35
    s_waitcnt lgkmcnt(0)
    v_smfmac_f32_16x16x64_bf16 v[16:19], v[12:15], v[68:75], v61
    v_permlane16_swap_b32 v28, v30
    v_permlane16_swap_b32 v29, v31
    v_and_or_b32 v28, v28, -2, s49
    buffer_store_dwordx4 v[28:31], v62, s[8:11], s24 offen
    v_smfmac_f32_16x16x64_bf16 v[20:23], v[0:3], a[224:231], v61
    s_nop 2
    v_cvt_pk_bf16_f32 v19, v18, v19
    v_cvt_pk_bf16_f32 v18, v16, v17
    v_smfmac_f32_16x16x64_bf16 v[20:23], v[4:7], a[232:239], v61
    v_cvt_pk_bf16_f32 v25, v24, v25
    v_smfmac_f32_16x16x64_bf16 v[20:23], v[8:11], a[240:247], v61
    v_mov_b32 v24, v25
    v_smfmac_f32_16x16x64_bf16 v[20:23], v[12:15], a[248:255], v61
    s_nop 0
    v_permlane32_swap_b32 v24, v25
    v_and_or_b32 v24, v24, -2, s49
    s_mov_b32 exec_hi, 0
    buffer_store_dwordx2 v[24:25], v67, s[8:11], s26 offen
    s_mov_b32 exec_hi, -1
    s_nop 1
    v_cvt_pk_bf16_f32 v16, v20, v21
    v_cvt_pk_bf16_f32 v17, v22, v23
    s_nop 0
    v_permlane16_swap_b32 v16, v18
    v_permlane16_swap_b32 v17, v19
    v_and_or_b32 v16, v16, -2, s49
    buffer_store_dwordx4 v[16:19], v62, s[8:11], s25 offen
    v_mov_b32 v35, 0x3f80
    v_cndmask_b32 v35, v35, 1.0, s[34:35]
    v_cndmask_b32 v32, 0, v35, s[56:57]
    v_cndmask_b32 v33, 0, v35, s[58:59]
    v_cndmask_b32 v34, 0, v35, s[60:61]
    v_cndmask_b32 v35, 0, v35, s[62:63]
    ds_read_b128 v[36:39], v77 offset:20480
    ds_read_b128 v[40:43], v77 offset:21504
    ds_read_b128 v[44:47], v77 offset:22528
    ds_read_b128 v[48:51], v77 offset:23552
    v_mov_b64 v[52:53], 0
    v_mov_b64 v[54:55], 0
    v_mov_b64 v[56:57], 0
    v_mov_b64 v[58:59], 0
    s_add_u32 s17, s17, 8192
    s_add_u32 s18, s18, 8192
    s_add_u32 s19, s19, 131072
    s_add_u32 s24, s24, s48
    s_add_u32 s25, s25, s48
    s_add_u32 s26, s26, s48
    s_add_u32 s27, s30, 1024
    s_add_u32 s28, s30, 5120
    s_add_u32 s16, s16, 1
    s_waitcnt vmcnt(1)
    buffer_load_dwordx4 v[0:3], v60, s[8:11], s20 offen sc1
    buffer_load_dwordx4 v[4:7], v60, s[8:11], s21 offen sc1
    buffer_load_dwordx4 v[8:11], v60, s[8:11], s22 offen sc1
    buffer_load_dwordx4 v[12:15], v60, s[8:11], s23 offen sc1
CH_f1_p1:
    s_waitcnt vmcnt(3)
    v_mfma_f32_16x16x32_bf16 v[68:71], v[0:3], v[32:35], 0
    s_waitcnt vmcnt(2)
    v_mfma_f32_16x16x32_bf16 v[68:71], v[4:7], v[32:35], v[68:71]
    v_bitop3_b32 v64, v0, v4, s49 bitop3:0x7e
    s_waitcnt vmcnt(1)
    v_mfma_f32_16x16x32_bf16 v[68:71], v[8:11], v[32:35], v[68:71]
    s_waitcnt vmcnt(0)
    v_mfma_f32_16x16x32_bf16 v[68:71], v[12:15], v[32:35], v[68:71]
    v_bitop3_b32 v65, v8, v12, s49 bitop3:0x7e
    v_bitop3_b32 v64, v64, v65, 1 bitop3:0xa8
    v_cmp_ne_u32 vcc, 0, v64
    s_cbranch_vccz CH_f1_p1_ok
    s_sub_u32 s41, s41, 1
    s_cbranch_scc1 CH_f1_p1_x
    buffer_load_dwordx4 v[0:3], v60, s[8:11], s20 offen sc1
    buffer_load_dwordx4 v[4:7], v60, s[8:11], s21 offen sc1
    buffer_load_dwordx4 v[8:11], v60, s[8:11], s22 offen sc1
    buffer_load_dwordx4 v[12:15], v60, s[8:11], s23 offen sc1
    s_branch CH_f1_p1
CH_f1_p1_x:
    s_mov_b32 s41, 0
CH_f1_p1_ok:
    s_nop 3
    v_add_f32 v68, v68, v69
    v_add_f32 v70, v70, v71
    s_mov_b64 exec, s[36:37]
    v_cvt_pk_bf16_f32 v68, v68, v70
    buffer_store_dword v68, v66, s[8:11], s5 offen
    s_mov_b64 exec, -1
    s_waitcnt vmcnt(0)
    s_barrier
    s_cmp_lt_u32 s16, 64
    s_cbranch_scc1 CH_f1
    s_branch CH_END
CH_gof2:
    ds_read_b128 v[36:39], v77 offset:24576
    ds_read_b128 v[40:43], v77 offset:25600
    ds_read_b128 v[44:47], v77 offset:26624
    ds_read_b128 v[48:51], v77 offset:27648
CH_f2:
    buffer_load_dwordx4 v[8:11], v77, s[8:11], s27 offen sc1
    buffer_load_dwordx4 v[24:27], v77, s[8:11], s28 offen sc1
    v_mov_b64 v[60:61], 0
    v_mov_b64 v[62:63], 0
    v_mov_b64 v[64:65], 0
    v_mov_b64 v[66:67], 0
    s_add_u32 s20, s20, s48
    s_add_u32 s21, s21, s48
    s_add_u32 s22, s22, s48
    s_add_u32 s23, s23, s48
    s_sub_u32 s48, 0, s48
    s_bfe_u32 s49, s16, 0x10001
    s_mov_b32 s42, s72
    s_mov_b32 s72, s30
    s_mov_b32 s30, s38
    s_mov_b32 s38, s42
    s_add_u32 s31, s38, s39
    s_add_u32 s5, s30, s6
CH_f2_p2:
    s_waitcnt vmcnt(1)
    ds_write_b128 v77, v[8:11] offset:2048
    v_max3_u32 v68, v8, v9, v10
    s_waitcnt vmcnt(0)
    ds_write_b128 v77, v[24:27] offset:6144
    v_max3_u32 v69, v24, v25, v26
    v_max3_u32 v68, v68, v11, v27
    v_max_u32 v68, v68, v69
    v_cmp_eq_u32 vcc, -1, v68
    s_cbranch_vccz CH_f2_p2_ok
CH_f2_p2_f:
    s_sub_u32 s41, s41, 1
    s_cbranch_scc1 CH_f2_p2_x
    buffer_load_dwordx4 v[8:11], v77, s[8:11], s27 offen sc1
    buffer_load_dwordx4 v[24:27], v77, s[8:11], s28 offen sc1
    s_branch CH_f2_p2
CH_f2_p2_x:
    s_mov_b32 s41, 0
CH_f2_p2_ok:
    v_smfmac_f32_16x16x64_bf16 v[52:55], v[8:11], v[112:119], v76
    v_smfmac_f32_16x16x64_bf16 v[56:59], v[8:11], v[120:127], v76
    s_waitcnt lgkmcnt(0)
    s_barrier
    v_smfmac_f32_16x16x64_bf16 v[52:55], v[24:27], v[176:183], v76
    buffer_load_dwordx4 v[68:71], v77, s[8:11], s17 offen
    buffer_load_dwordx4 v[72:75], v77, s[8:11], s17 offen offset:1024
    v_smfmac_f32_16x16x64_bf16 v[56:59], v[24:27], v[184:191], v76
    ds_read_b128 v[32:35], v77 offset:8192
    v_smfmac_f32_16x16x64_bf16 v[60:63], v[8:11], v[240:247], v76
    ds_read_b128 v[0:3], v77 offset:0
    v_smfmac_f32_16x16x64_bf16 v[64:67], v[8:11], v[248:255], v76
    ds_read_b128 v[4:7], v77 offset:1024
    v_smfmac_f32_16x16x64_bf16 v[60:63], v[24:27], a[32:39], v76
    ds_read_b128 v[12:15], v77 offset:3072
    v_smfmac_f32_16x16x64_bf16 v[64:67], v[24:27], a[40:47], v76
    ds_read_b128 v[16:19], v77 offset:4096
    s_waitcnt lgkmcnt(4)
    v_smfmac_f32_16x16x64_bf16 v[52:55], v[32:35], v[36:43], v76
    ds_read_b128 v[36:39], v77 offset:40960
    v_smfmac_f32_16x16x64_bf16 v[56:59], v[32:35], v[44:51], v76
    ds_read_b128 v[40:43], v77 offset:41984
    s_waitcnt lgkmcnt(5)
    v_smfmac_f32_16x16x64_bf16 v[52:55], v[0:3], v[80:87], v76
    ds_read_b128 v[44:47], v77 offset:43008
    v_smfmac_f32_16x16x64_bf16 v[56:59], v[0:3], v[88:95], v76
    ds_read_b128 v[48:51], v77 offset:44032
    s_waitcnt lgkmcnt(6)
    v_smfmac_f32_16x16x64_bf16 v[52:55], v[4:7], v[96:103], v76
    ds_read_b128 v[20:23], v77 offset:5120
    v_smfmac_f32_16x16x64_bf16 v[56:59], v[4:7], v[104:111], v76
    ds_read_b128 v[28:31], v77 offset:7168
    s_waitcnt lgkmcnt(7)
    v_smfmac_f32_16x16x64_bf16 v[52:55], v[12:15], v[128:135], v76
    v_smfmac_f32_16x16x64_bf16 v[56:59], v[12:15], v[136:143], v76
    s_waitcnt lgkmcnt(4)
    v_smfmac_f32_16x16x64_bf16 v[60:63], v[12:15], v[36:43], v76
    ds_read_b128 v[36:39], v77 offset:57344
    s_waitcnt lgkmcnt(3)
    v_smfmac_f32_16x16x64_bf16 v[64:67], v[12:15], v[44:51], v76
    ds_read_b128 v[40:43], v77 offset:58368
    v_smfmac_f32_16x16x64_bf16 v[52:55], v[16:19], v[144:151], v76
    ds_read_b128 v[44:47], v77 offset:59392
    v_smfmac_f32_16x16x64_bf16 v[56:59], v[16:19], v[152:159], v76
    ds_read_b128 v[48:51], v77 offset:60416
    s_waitcnt lgkmcnt(5)
    v_smfmac_f32_16x16x64_bf16 v[52:55], v[20:23], v[160:167], v76
    v_smfmac_f32_16x16x64_bf16 v[56:59], v[20:23], v[168:175], v76
    s_waitcnt lgkmcnt(4)
    v_smfmac_f32_16x16x64_bf16 v[52:55], v[28:31], v[192:199], v76
    v_smfmac_f32_16x16x64_bf16 v[56:59], v[28:31], v[200:207], v76
    v_smfmac_f32_16x16x64_bf16 v[60:63], v[32:35], a[48:55], v76
    v_add_f32 v52, v52, v53
    v_add_f32 v54, v54, v55
    v_cvt_pk_bf16_f32 v52, v52, v54
    s_nop 0
    v_add_f32 v56, v56, v57
    v_add_f32 v58, v58, v59
    v_cvt_pk_bf16_f32 v53, v56, v58
    v_smfmac_f32_16x16x64_bf16 v[60:63], v[0:3], v[208:215], v76
    s_nop 0
    v_mfma_f32_16x16x16_bf16 v[56:59], v[52:53], v[78:79], 0
    s_waitcnt lgkmcnt(2)
    v_smfmac_f32_16x16x64_bf16 v[60:63], v[28:31], v[36:43], v76
    s_waitcnt lgkmcnt(0)
    v_smfmac_f32_16x16x64_bf16 v[64:67], v[28:31], v[44:51], v76
    v_cvt_pk_bf16_f32 v54, v56, v57
    v_cvt_pk_bf16_f32 v55, v58, v59
    v_smfmac_f32_16x16x64_bf16 v[60:63], v[4:7], v[224:231], v76
    v_mov_b32_dpp v56, v54 quad_perm:[2,3,0,1] row_mask:0xf bank_mask:0xf
    v_mov_b32_dpp v57, v55 quad_perm:[2,3,0,1] row_mask:0xf bank_mask:0xf
    v_smfmac_f32_16x16x64_bf16 v[60:63], v[16:19], a[0:7], v76
    v_add_u32 v51, 65536, v77
    s_waitcnt vmcnt(1)
    v_mfma_f32_16x16x32_bf16 v[68:71], v[68:71], v[54:57], 0
    ds_read_b128 v[36:39], v51 offset:8192
    ds_read_b128 v[40:43], v51 offset:9216
    s_waitcnt vmcnt(0)
    v_mfma_f32_16x16x32_bf16 v[72:75], v[72:75], v[54:57], 0
    ds_read_b128 v[44:47], v51 offset:10240
    ds_read_b128 v[48:51], v51 offset:11264
    v_smfmac_f32_16x16x64_bf16 v[60:63], v[20:23], a[16:23], v76
    v_smfmac_f32_16x16x64_bf16 v[64:67], v[32:35], a[56:63], v76
    v_cndmask_b32 v68, v72, v68, s[32:33]
    v_cndmask_b32 v69, v73, v69, s[32:33]
    v_cndmask_b32 v70, v74, v70, s[32:33]
    v_cndmask_b32 v71, v75, v71, s[32:33]
    ds_write_b128 v77, v[68:71] offset:12288
    v_mov_b64 v[68:69], 0
    v_mov_b64 v[70:71], 0
    v_smfmac_f32_16x16x64_bf16 v[64:67], v[0:3], v[216:223], v76
    v_mov_b64 v[72:73], 0
    v_mov_b64 v[74:75], 0
    v_smfmac_f32_16x16x64_bf16 v[64:67], v[4:7], v[232:239], v76
    v_add_f32 v60, v60, v61
    v_smfmac_f32_16x16x64_bf16 v[64:67], v[16:19], a[8:15], v76
    v_add_f32 v62, v62, v63
    v_smfmac_f32_16x16x64_bf16 v[64:67], v[20:23], a[24:31], v76
    v_cvt_pk_bf16_f32 v60, v60, v62
    s_waitcnt lgkmcnt(3)
    v_smfmac_f32_16x16x64_bf16 v[68:71], v[4:7], v[36:43], v76
    s_waitcnt lgkmcnt(1)
    v_smfmac_f32_16x16x64_bf16 v[72:75], v[4:7], v[44:51], v76
    v_add_f32 v64, v64, v65
    v_add_f32 v66, v66, v67
    v_cvt_pk_bf16_f32 v61, v64, v66
    v_add_u32 v51, 65536, v77
    ds_read_b128 v[36:39], v51 offset:24576
    v_mfma_f32_16x16x16_bf16 v[64:67], v[60:61], v[78:79], 0
    ds_read_b128 v[40:43], v51 offset:25600
    ds_read_b128 v[44:47], v51 offset:26624
    ds_read_b128 v[48:51], v51 offset:27648
    v_smfmac_f32_16x16x64_bf16 v[68:71], v[0:3], a[64:71], v76
    v_smfmac_f32_16x16x64_bf16 v[72:75], v[0:3], a[72:79], v76
    v_cvt_pk_bf16_f32 v62, v64, v65
    v_cvt_pk_bf16_f32 v63, v66, v67
    v_smfmac_f32_16x16x64_bf16 v[68:71], v[8:11], a[80:87], v76
    v_mov_b32_dpp v64, v62 quad_perm:[2,3,0,1] row_mask:0xf bank_mask:0xf
    v_mov_b32_dpp v65, v63 quad_perm:[2,3,0,1] row_mask:0xf bank_mask:0xf
    s_nop 1
    v_mfma_f32_16x16x32_bf16 v[58:61], v[62:65], v[54:57], 0
    buffer_load_dwordx4 v[52:55], v77, s[8:11], s18 offen
    v_smfmac_f32_16x16x64_bf16 v[72:75], v[8:11], a[88:95], v76
    s_waitcnt lgkmcnt(2)
    v_smfmac_f32_16x16x64_bf16 v[68:71], v[12:15], v[36:43], v76
    v_cndmask_b32 v58, v61, v58, s[32:33]
    ds_write_b32 v77, v58 offset:14344
    buffer_load_dwordx4 v[56:59], v77, s[8:11], s18 offen offset:1024
    s_waitcnt lgkmcnt(1)
    v_smfmac_f32_16x16x64_bf16 v[72:75], v[12:15], v[44:51], v76
    v_add_u32 v51, 65536, v77
    v_smfmac_f32_16x16x64_bf16 v[68:71], v[16:19], a[96:103], v76
    ds_read_b128 v[36:39], v51 offset:40960
    v_smfmac_f32_16x16x64_bf16 v[72:75], v[16:19], a[104:111], v76
    ds_read_b128 v[40:43], v51 offset:41984
    v_smfmac_f32_16x16x64_bf16 v[68:71], v[24:27], a[112:119], v76
    ds_read_b128 v[44:47], v51 offset:43008
    s_waitcnt lgkmcnt(3)
    s_barrier
    v_smfmac_f32_16x16x64_bf16 v[72:75], v[24:27], a[120:127], v76
    ds_read_b128 v[16:19], v77 offset:14336
    ds_read_b128 v[0:3], v77 offset:10240
    ds_read_b128 v[4:7], v77 offset:11264
    ds_read_b128 v[8:11], v77 offset:12288
    ds_read_b128 v[12:15], v77 offset:13312
    v_smfmac_f32_16x16x64_bf16 v[68:71], v[32:35], a[144:151], v76
    ds_read_b128 v[48:51], v51 offset:44032
    v_smfmac_f32_16x16x64_bf16 v[72:75], v[32:35], a[152:159], v76
    ds_read_b64 v[66:67], v77 offset:15368
    v_smfmac_f32_16x16x64_bf16 v[68:71], v[28:31], a[128:135], v76
    ds_read_b64 v[60:61], v77 offset:15360
    s_waitcnt lgkmcnt(7)
    v_add_f32 v16, v16, v17
    v_add_f32 v18, v18, v19
    v_smfmac_f32_16x16x64_bf16 v[72:75], v[28:31], a[136:143], v76
    v_mov_b64 v[24:25], 0
    v_smfmac_f32_16x16x64_bf16 v[68:71], v[20:23], v[36:43], v76
    s_waitcnt lgkmcnt(5)
    v_add_f32 v0, v0, v4
    v_add_f32 v1, v1, v5
    v_add_f32 v2, v2, v6
    v_add_f32 v3, v3, v7
    v_add_f32 v4, v16, v18
    v_cndmask_b32 v16, 16, 0, s[32:33]
    v_mov_b64 v[26:27], 0
    s_waitcnt lgkmcnt(3)
    v_add_f32 v8, v8, v12
    v_add_f32 v9, v9, v13
    v_add_f32 v10, v10, v14
    v_add_f32 v11, v11, v15
    v_add_f32 v0, v0, v8
    v_add_f32 v1, v1, v9
    v_add_f32 v2, v2, v10
    v_add_f32 v3, v3, v11
    v_max3_f32 v5, v0, v1, v4
    v_max3_f32 v5, v5, v2, v3
    v_mov_b32 v9, 0
    v_mov_b32 v10, 0
    v_max_f32_dpp v5, v5, v5 quad_perm:[2,3,0,1] row_mask:0xf bank_mask:0xf
    v_mov_b32 v6, v5
    s_waitcnt lgkmcnt(2)
    v_smfmac_f32_16x16x64_bf16 v[72:75], v[20:23], v[44:51], v76
    v_permlane16_swap_b32 v5, v6
    v_max_f32 v5, v5, v6
    v_mov_b32 v6, v5
    v_add_f32 v68, v68, v69
    v_add_f32 v70, v70, v71
    v_permlane32_swap_b32 v5, v6
    v_max_f32 v5, v5, v6
    v_mul_f32 v5, s40, v5
    v_fma_f32 v0, v0, s40, -v5
    v_fma_f32 v1, v1, s40, -v5
    v_fma_f32 v2, v2, s40, -v5
    v_fma_f32 v3, v3, s40, -v5
    v_exp_f32 v0, v0
    v_exp_f32 v1, v1
    v_fma_f32 v4, v4, s40, -v5
    v_exp_f32 v2, v2
    v_exp_f32 v3, v3
    v_exp_f32 v4, v4
    v_cvt_pk_bf16_f32 v5, v0, v1
    v_cvt_pk_bf16_f32 v6, v2, v3
    v_add_f32 v0, v0, v1
    v_add_f32 v2, v2, v3
    v_add_f32 v0, v0, v4
    v_cndmask_b32 v12, 0, v5, s[32:33]
    v_cndmask_b32 v13, 0, v6, s[32:33]
    v_cndmask_b32 v14, v5, 0, s[32:33]
    v_cndmask_b32 v15, v6, 0, s[32:33]
    v_add_f32 v0, v0, v2
    v_add_f32 v72, v72, v73
    v_add_f32 v74, v74, v75
    v_cvt_pk_bf16_f32 v7, v4, 0
    s_waitcnt vmcnt(1)
    v_mfma_f32_16x16x32_bf16 v[52:55], v[52:55], v[12:15], 0
    v_add_f32_dpp v0, v0, v0 quad_perm:[2,3,0,1] row_mask:0xf bank_mask:0xf
    v_cvt_pk_bf16_f32 v64, v68, v74
    s_waitcnt vmcnt(0)
    v_mfma_f32_16x16x32_bf16 v[56:59], v[56:59], v[12:15], 0
    v_cvt_pk_bf16_f32 v65, v72, v70
    buffer_store_dwordx4 v[62:65], v77, s[8:11], s19 offen sc1
    s_cmp_eq_u32 s16, 63
    s_cbranch_scc1 CH_END
    v_lshlrev_b32 v8, v16, v7
    v_lshlrev_b32 v11, v16, v7
    v_mov_b32 v1, v0
    v_mfma_f32_16x16x16_bf16 v[52:55], v[64:65], v[8:9], v[52:55]
    s_waitcnt lgkmcnt(0)
    v_and_b32 v17, 0xffff, v60
    v_permlane16_swap_b32 v0, v1
    v_mfma_f32_16x16x16_bf16 v[56:59], v[64:65], v[10:11], v[56:59]
    v_add_f32 v0, v0, v1
    v_mov_b32 v1, v0
    v_and_b32 v14, 0xffff, v61
    v_and_b32 v15, 0x80, v77
    v_permlane32_swap_b32 v0, v1
    v_add_f32 v0, v0, v1
    v_rcp_f32 v0, v0
    s_nop 0
    v_add_f32_dpp v52, v56, v52 quad_perm:[2,3,0,1] row_mask:0xf bank_mask:0xf
    v_add_f32_dpp v53, v57, v53 quad_perm:[2,3,0,1] row_mask:0xf bank_mask:0xf
    v_add_f32_dpp v54, v58, v54 quad_perm:[2,3,0,1] row_mask:0xf bank_mask:0xf
    v_add_f32_dpp v55, v59, v55 quad_perm:[2,3,0,1] row_mask:0xf bank_mask:0xf
    v_mul_f32 v52, v52, v0
    v_mul_f32 v53, v53, v0
    v_mul_f32 v54, v54, v0
    v_mul_f32 v55, v55, v0
    v_cvt_pk_bf16_f32 v52, v52, v53
    v_cvt_pk_bf16_f32 v53, v54, v55
    ds_write_b64 v17, v[52:53] offset:9216
    v_lshl_add_u32 v15, v15, 3, v14
    v_add_u32 v51, 65536, v77
    ds_read_b128 v[36:39], v51 offset:57344
    ds_read_b128 v[40:43], v51 offset:58368
    ds_read_b128 v[44:47], v51 offset:59392
    ds_read_b128 v[48:51], v51 offset:60416
    v_add_u32 v63, 131072, v77
    ds_read_b128 v[68:71], v63 offset:8192
    ds_read_b128 v[72:75], v63 offset:9216
    v_lshrrev_b32 v61, 16, v61
    v_mov_b64 v[16:17], 0
    v_mov_b64 v[18:19], 0
    v_and_b32 v62, 0xffff, v66
    v_mov_b64 v[28:29], 0
    v_mov_b64 v[30:31], 0
    v_mov_b64 v[32:33], 0
    v_mov_b64 v[34:35], 0
    v_mov_b64 v[20:21], 0
    v_mov_b64 v[22:23], 0
    v_lshrrev_b32 v60, 12, v60
    v_lshrrev_b32 v66, 16, v66
    s_waitcnt lgkmcnt(6)
    s_barrier
    ds_read_b128 v[52:55], v15 offset:8192
    ds_read_b128 v[56:59], v15 offset:8704
    ds_read_b128 v[0:3], v14 offset:8192
    ds_read_b128 v[4:7], v14 offset:8704
    ds_read_b128 v[8:11], v14 offset:9216
    ds_read_b128 v[12:15], v14 offset:9728
    s_waitcnt lgkmcnt(5)
    v_smfmac_f32_16x16x64_bf16 v[24:27], v[52:55], v[36:43], v61
    ds_read_b128 v[36:39], v63 offset:10240
    s_waitcnt lgkmcnt(5)
    v_smfmac_f32_16x16x64_bf16 v[24:27], v[56:59], v[44:51], v61
    ds_read_b128 v[40:43], v63 offset:11264
    s_waitcnt lgkmcnt(5)
    v_smfmac_f32_16x16x64_bf16 v[16:19], v[0:3], v[68:75], v61
    ds_read_b128 v[44:47], v63 offset:24576
    v_smfmac_f32_16x16x64_bf16 v[28:31], v[0:3], a[160:167], v61
    ds_read_b128 v[48:51], v63 offset:25600
    s_waitcnt lgkmcnt(6)
    v_smfmac_f32_16x16x64_bf16 v[28:31], v[4:7], a[168:175], v61
    ds_read_b128 v[68:71], v63 offset:26624
    s_waitcnt lgkmcnt(6)
    v_smfmac_f32_16x16x64_bf16 v[28:31], v[8:11], a[176:183], v61
    ds_read_b128 v[72:75], v63 offset:27648
    s_waitcnt lgkmcnt(6)
    v_smfmac_f32_16x16x64_bf16 v[28:31], v[12:15], a[184:191], v61
    v_permlane32_swap_b32 v24, v26
    v_smfmac_f32_16x16x64_bf16 v[32:35], v[0:3], a[192:199], v61
    v_permlane32_swap_b32 v25, v27
    v_smfmac_f32_16x16x64_bf16 v[32:35], v[4:7], a[200:207], v61
    v_cvt_pk_bf16_f32 v28, v28, v29
    v_smfmac_f32_16x16x64_bf16 v[32:35], v[8:11], a[208:215], v61
    v_cvt_pk_bf16_f32 v29, v30, v31
    v_smfmac_f32_16x16x64_bf16 v[32:35], v[12:15], a[216:223], v61
    v_add_f32 v24, v24, v26
    s_waitcnt lgkmcnt(4)
    v_smfmac_f32_16x16x64_bf16 v[16:19], v[4:7], v[36:43], v61
    v_add_f32 v25, v25, v27
    s_waitcnt lgkmcnt(2)
    v_smfmac_f32_16x16x64_bf16 v[16:19], v[8:11], v[44:51], v61
    v_cvt_pk_bf16_f32 v30, v32, v33
    v_cvt_pk_bf16_f32 v31, v34, v35
    s_waitcnt lgkmcnt(0)
    v_smfmac_f32_16x16x64_bf16 v[16:19], v[12:15], v[68:75], v61
    v_permlane16_swap_b32 v28, v30
    v_permlane16_swap_b32 v29, v31
    v_and_or_b32 v28, v28, -2, s49
    buffer_store_dwordx4 v[28:31], v62, s[8:11], s24 offen
    v_smfmac_f32_16x16x64_bf16 v[20:23], v[0:3], a[224:231], v61
    s_nop 2
    v_cvt_pk_bf16_f32 v19, v18, v19
    v_cvt_pk_bf16_f32 v18, v16, v17
    v_smfmac_f32_16x16x64_bf16 v[20:23], v[4:7], a[232:239], v61
    v_cvt_pk_bf16_f32 v25, v24, v25
    v_smfmac_f32_16x16x64_bf16 v[20:23], v[8:11], a[240:247], v61
    v_mov_b32 v24, v25
    v_smfmac_f32_16x16x64_bf16 v[20:23], v[12:15], a[248:255], v61
    s_nop 0
    v_permlane32_swap_b32 v24, v25
    v_and_or_b32 v24, v24, -2, s49
    s_mov_b32 exec_hi, 0
    buffer_store_dwordx2 v[24:25], v67, s[8:11], s26 offen
    s_mov_b32 exec_hi, -1
    s_nop 1
    v_cvt_pk_bf16_f32 v16, v20, v21
    v_cvt_pk_bf16_f32 v17, v22, v23
    s_nop 0
    v_permlane16_swap_b32 v16, v18
    v_permlane16_swap_b32 v17, v19
    v_and_or_b32 v16, v16, -2, s49
    buffer_store_dwordx4 v[16:19], v62, s[8:11], s25 offen
    ds_read_b128 v[36:39], v77 offset:24576
    ds_read_b128 v[40:43], v77 offset:25600
    ds_read_b128 v[44:47], v77 offset:26624
    ds_read_b128 v[48:51], v77 offset:27648
    v_mov_b64 v[52:53], 0
    v_mov_b64 v[54:55], 0
    v_mov_b64 v[56:57], 0
    v_mov_b64 v[58:59], 0
    s_add_u32 s17, s17, 8192
    s_add_u32 s18, s18, 8192
    s_add_u32 s19, s19, 131072
    s_add_u32 s24, s24, s48
    s_add_u32 s25, s25, s48
    s_add_u32 s26, s26, s48
    s_add_u32 s27, s30, 2048
    s_add_u32 s28, s30, 6144
    s_add_u32 s16, s16, 1
    s_cmp_lt_u32 s3, 8
    s_cbranch_scc0 CH_f2_nh
    v_mov_b32 v35, 0x3f80
    v_cndmask_b32 v35, v35, 1.0, s[34:35]
    v_cndmask_b32 v32, 0, v35, s[56:57]
    v_cndmask_b32 v33, 0, v35, s[58:59]
    v_cndmask_b32 v34, 0, v35, s[60:61]
    v_cndmask_b32 v35, 0, v35, s[62:63]
    s_waitcnt vmcnt(1)
    buffer_load_dwordx4 v[0:3], v60, s[8:11], s20 offen sc1
    buffer_load_dwordx4 v[4:7], v60, s[8:11], s21 offen sc1
    buffer_load_dwordx4 v[8:11], v60, s[8:11], s22 offen sc1
    buffer_load_dwordx4 v[12:15], v60, s[8:11], s23 offen sc1
CH_f2_p1:
    s_waitcnt vmcnt(3)
    v_mfma_f32_16x16x32_bf16 v[68:71], v[0:3], v[32:35], 0
    v_bitop3_b32 v64, v0, v2, s49 bitop3:0x7e
    s_waitcnt vmcnt(2)
    v_mfma_f32_16x16x32_bf16 v[68:71], v[4:7], v[32:35], v[68:71]
    v_bitop3_b32 v65, v4, v6, s49 bitop3:0x7e
    v_or_b32 v64, v64, v65
    s_waitcnt vmcnt(1)
    v_mfma_f32_16x16x32_bf16 v[68:71], v[8:11], v[32:35], v[68:71]
    v_bitop3_b32 v65, v8, v10, s49 bitop3:0x7e
    v_or_b32 v64, v64, v65
    s_waitcnt vmcnt(0)
    v_mfma_f32_16x16x32_bf16 v[68:71], v[12:15], v[32:35], v[68:71]
    v_bitop3_b32 v65, v12, v14, s49 bitop3:0x7e
    v_bitop3_b32 v64, v64, v65, 1 bitop3:0xa8
    v_cmp_ne_u32 vcc, 0, v64
    s_cbranch_vccz CH_f2_p1_ok
    s_sub_u32 s41, s41, 1
    s_cbranch_scc1 CH_f2_p1_x
    buffer_load_dwordx4 v[0:3], v60, s[8:11], s20 offen sc1
    buffer_load_dwordx4 v[4:7], v60, s[8:11], s21 offen sc1
    buffer_load_dwordx4 v[8:11], v60, s[8:11], s22 offen sc1
    buffer_load_dwordx4 v[12:15], v60, s[8:11], s23 offen sc1
    s_branch CH_f2_p1
CH_f2_p1_x:
    s_mov_b32 s41, 0
CH_f2_p1_ok:
    s_nop 3
    v_add_f32 v68, v68, v69
    v_add_f32 v70, v70, v71
    s_mov_b64 exec, s[36:37]
    v_cvt_pk_bf16_f32 v68, v68, v70
    buffer_store_dword v68, v66, s[8:11], s5 offen
    s_mov_b64 exec, -1
CH_f2_nh:
    s_waitcnt vmcnt(0)
    s_barrier
    s_cmp_lt_u32 s16, 64
    s_cbranch_scc1 CH_f2
    s_branch CH_END
CH_gof3:
    ds_read_b128 v[36:39], v77 offset:28672
    ds_read_b128 v[40:43], v77 offset:29696
    ds_read_b128 v[44:47], v77 offset:30720
    ds_read_b128 v[48:51], v77 offset:31744
CH_f3:
    buffer_load_dwordx4 v[32:35], v77, s[8:11], s29 offen sc1
    buffer_load_dwordx4 v[12:15], v77, s[8:11], s27 offen sc1
    buffer_load_dwordx4 v[28:31], v77, s[8:11], s28 offen sc1
    v_mov_b64 v[52:53], 0
    v_mov_b64 v[54:55], 0
    v_mov_b64 v[56:57], 0
    v_mov_b64 v[58:59], 0
    v_mov_b64 v[60:61], 0
    v_mov_b64 v[62:63], 0
    v_mov_b64 v[64:65], 0
    v_mov_b64 v[66:67], 0
    ds_read_b128 v[36:39], v77 offset:28672
    ds_read_b128 v[40:43], v77 offset:29696
    ds_read_b128 v[44:47], v77 offset:30720
    ds_read_b128 v[48:51], v77 offset:31744
    s_add_u32 s20, s20, s48
    s_add_u32 s21, s21, s48
    s_add_u32 s22, s22, s48
    s_add_u32 s23, s23, s48
    s_sub_u32 s48, 0, s48
    s_bfe_u32 s49, s16, 0x10001
    s_mov_b32 s42, s72
    s_mov_b32 s72, s30
    s_mov_b32 s30, s38
    s_mov_b32 s38, s42
    s_add_u32 s31, s38, s39
    s_add_u32 s5, s30, s6
    s_movk_i32 s50, 2048
    s_cmp_eq_u32 s16, 63
    s_cselect_b32 s50, -6144, s50
CH_f3_p2:
    s_waitcnt vmcnt(2)
    v_max3_u32 v68, v32, v33, v34
    v_max_u32 v68, v68, v35
    v_cmp_eq_u32 vcc, -1, v68
    s_cbranch_vccnz CH_f3_p2_f
    ds_write_b128 v77, v[32:35] offset:8192
    s_waitcnt vmcnt(1)
    ds_write_b128 v77, v[12:15] offset:3072
    v_max3_u32 v68, v12, v13, v14
    s_waitcnt vmcnt(0)
    ds_write_b128 v77, v[28:31] offset:7168
    v_max3_u32 v69, v28, v29, v30
    v_max3_u32 v68, v68, v15, v31
    v_max_u32 v68, v68, v69
    v_cmp_eq_u32 vcc, -1, v68
    s_cbranch_vccz CH_f3_p2_ok
CH_f3_p2_f:
    s_sub_u32 s41, s41, 1
    s_cbranch_scc1 CH_f3_p2_x
    buffer_load_dwordx4 v[32:35], v77, s[8:11], s29 offen sc1
    buffer_load_dwordx4 v[12:15], v77, s[8:11], s27 offen sc1
    buffer_load_dwordx4 v[28:31], v77, s[8:11], s28 offen sc1
    s_branch CH_f3_p2
CH_f3_p2_x:
    s_mov_b32 s41, 0
CH_f3_p2_ok:
    v_lshlrev_b32 v24, 3, v77
    v_mov_b32 v25, s16
    s_waitcnt lgkmcnt(5)
    v_smfmac_f32_16x16x64_bf16 v[52:55], v[32:35], v[36:43], v76
    ds_read_b128 v[36:39], v77 offset:45056
    s_waitcnt lgkmcnt(4)
    v_smfmac_f32_16x16x64_bf16 v[56:59], v[32:35], v[44:51], v76
    s_waitcnt lgkmcnt(1)
    s_barrier
    v_smfmac_f32_16x16x64_bf16 v[52:55], v[12:15], v[128:135], v76
    buffer_load_dwordx4 v[68:71], v77, s[8:11], s17 offen
    buffer_load_dwordx4 v[72:75], v77, s[8:11], s17 offen offset:1024
    s_movk_i32 m0, 9728
    s_add_u32 s43, s17, s50
    buffer_load_dword v24, s[8:11], s43 offen lds
    s_mov_b64 exec, s[54:55]
    buffer_store_dword v25, v24, s[8:11], s51 offen sc1
    s_mov_b64 exec, -1
    v_smfmac_f32_16x16x64_bf16 v[56:59], v[12:15], v[136:143], v76
    ds_read_b128 v[0:3], v77 offset:0
    v_smfmac_f32_16x16x64_bf16 v[52:55], v[28:31], v[192:199], v76
    ds_read_b128 v[40:43], v77 offset:46080
    v_smfmac_f32_16x16x64_bf16 v[56:59], v[28:31], v[200:207], v76
    ds_read_b128 v[44:47], v77 offset:47104
    v_smfmac_f32_16x16x64_bf16 v[60:63], v[32:35], a[48:55], v76
    ds_read_b128 v[48:51], v77 offset:48128
    v_smfmac_f32_16x16x64_bf16 v[64:67], v[32:35], a[56:63], v76
    ds_read_b128 v[4:7], v77 offset:1024
    s_waitcnt lgkmcnt(4)
    v_smfmac_f32_16x16x64_bf16 v[52:55], v[0:3], v[80:87], v76
    ds_read_b128 v[8:11], v77 offset:2048
    v_smfmac_f32_16x16x64_bf16 v[56:59], v[0:3], v[88:95], v76
    ds_read_b128 v[16:19], v77 offset:4096
    s_waitcnt lgkmcnt(5)
    v_smfmac_f32_16x16x64_bf16 v[60:63], v[12:15], v[36:43], v76
    ds_read_b128 v[36:39], v77 offset:61440
    s_waitcnt lgkmcnt(4)
    v_smfmac_f32_16x16x64_bf16 v[64:67], v[12:15], v[44:51], v76
    ds_read_b128 v[40:43], v77 offset:62464
    s_waitcnt lgkmcnt(4)
    v_smfmac_f32_16x16x64_bf16 v[52:55], v[4:7], v[96:103], v76
    ds_read_b128 v[44:47], v77 offset:63488
    v_smfmac_f32_16x16x64_bf16 v[56:59], v[4:7], v[104:111], v76
    ds_read_b128 v[48:51], v77 offset:64512
    s_waitcnt lgkmcnt(5)
    v_smfmac_f32_16x16x64_bf16 v[52:55], v[8:11], v[112:119], v76
    ds_read_b128 v[20:23], v77 offset:5120
    v_smfmac_f32_16x16x64_bf16 v[56:59], v[8:11], v[120:127], v76
    ds_read_b128 v[24:27], v77 offset:6144
    s_waitcnt lgkmcnt(6)
    v_smfmac_f32_16x16x64_bf16 v[52:55], v[16:19], v[144:151], v76
    v_smfmac_f32_16x16x64_bf16 v[56:59], v[16:19], v[152:159], v76
    s_waitcnt lgkmcnt(4)
    v_smfmac_f32_16x16x64_bf16 v[60:63], v[28:31], v[36:43], v76
    s_waitcnt lgkmcnt(2)
    v_smfmac_f32_16x16x64_bf16 v[64:67], v[28:31], v[44:51], v76
    v_add_u32 v51, 65536, v77
    s_waitcnt lgkmcnt(1)
    v_smfmac_f32_16x16x64_bf16 v[52:55], v[20:23], v[160:167], v76
    ds_read_b128 v[36:39], v51 offset:12288
    v_smfmac_f32_16x16x64_bf16 v[56:59], v[20:23], v[168:175], v76
    ds_read_b128 v[40:43], v51 offset:13312
    s_waitcnt lgkmcnt(2)
    v_smfmac_f32_16x16x64_bf16 v[52:55], v[24:27], v[176:183], v76
    ds_read_b128 v[44:47], v51 offset:14336
    v_smfmac_f32_16x16x64_bf16 v[56:59], v[24:27], v[184:191], v76
    ds_read_b128 v[48:51], v51 offset:15360
    v_smfmac_f32_16x16x64_bf16 v[60:63], v[0:3], v[208:215], v76
    v_add_f32 v52, v52, v53
    v_add_f32 v54, v54, v55
    v_cvt_pk_bf16_f32 v52, v52, v54
    s_nop 0
    v_add_f32 v56, v56, v57
    v_add_f32 v58, v58, v59
    v_cvt_pk_bf16_f32 v53, v56, v58
    v_smfmac_f32_16x16x64_bf16 v[60:63], v[4:7], v[224:231], v76
    s_nop 0
    v_mfma_f32_16x16x16_bf16 v[56:59], v[52:53], v[78:79], 0
    v_smfmac_f32_16x16x64_bf16 v[60:63], v[8:11], v[240:247], v76
    v_smfmac_f32_16x16x64_bf16 v[60:63], v[16:19], a[0:7], v76
    v_cvt_pk_bf16_f32 v54, v56, v57
    v_cvt_pk_bf16_f32 v55, v58, v59
    v_smfmac_f32_16x16x64_bf16 v[60:63], v[20:23], a[16:23], v76
    v_mov_b32_dpp v56, v54 quad_perm:[2,3,0,1] row_mask:0xf bank_mask:0xf
    v_mov_b32_dpp v57, v55 quad_perm:[2,3,0,1] row_mask:0xf bank_mask:0xf
    v_smfmac_f32_16x16x64_bf16 v[60:63], v[24:27], a[32:39], v76
    s_waitcnt vmcnt(3)
    v_mfma_f32_16x16x32_bf16 v[68:71], v[68:71], v[54:57], 0
    s_waitcnt vmcnt(2)
    v_mfma_f32_16x16x32_bf16 v[72:75], v[72:75], v[54:57], 0
    v_add_f32 v60, v60, v61
    v_add_f32 v62, v62, v63
    v_smfmac_f32_16x16x64_bf16 v[64:67], v[0:3], v[216:223], v76
    v_cvt_pk_bf16_f32 v60, v60, v62
    v_smfmac_f32_16x16x64_bf16 v[64:67], v[4:7], v[232:239], v76
    v_cndmask_b32 v68, v72, v68, s[32:33]
    v_cndmask_b32 v69, v73, v69, s[32:33]
    v_cndmask_b32 v70, v74, v70, s[32:33]
    v_cndmask_b32 v71, v75, v71, s[32:33]
    ds_write_b128 v77, v[68:71] offset:13312
    v_mov_b64 v[68:69], 0
    v_mov_b64 v[70:71], 0
    v_smfmac_f32_16x16x64_bf16 v[64:67], v[8:11], v[248:255], v76
    v_mov_b64 v[72:73], 0
    v_mov_b64 v[74:75], 0
    v_smfmac_f32_16x16x64_bf16 v[64:67], v[16:19], a[8:15], v76
    v_smfmac_f32_16x16x64_bf16 v[64:67], v[20:23], a[24:31], v76
    v_smfmac_f32_16x16x64_bf16 v[64:67], v[24:27], a[40:47], v76
    s_waitcnt lgkmcnt(3)
    v_smfmac_f32_16x16x64_bf16 v[68:71], v[4:7], v[36:43], v76
    s_waitcnt lgkmcnt(1)
    v_smfmac_f32_16x16x64_bf16 v[72:75], v[4:7], v[44:51], v76
    v_add_f32 v64, v64, v65
    v_add_f32 v66, v66, v67
    v_cvt_pk_bf16_f32 v61, v64, v66
    v_add_u32 v51, 65536, v77
    ds_read_b128 v[36:39], v51 offset:28672
    v_mfma_f32_16x16x16_bf16 v[64:67], v[60:61], v[78:79], 0
    ds_read_b128 v[40:43], v51 offset:29696
    ds_read_b128 v[44:47], v51 offset:30720
    ds_read_b128 v[48:51], v51 offset:31744
    v_smfmac_f32_16x16x64_bf16 v[68:71], v[0:3], a[64:71], v76
    v_smfmac_f32_16x16x64_bf16 v[72:75], v[0:3], a[72:79], v76
    v_cvt_pk_bf16_f32 v62, v64, v65
    v_cvt_pk_bf16_f32 v63, v66, v67
    v_smfmac_f32_16x16x64_bf16 v[68:71], v[8:11], a[80:87], v76
    v_mov_b32_dpp v64, v62 quad_perm:[2,3,0,1] row_mask:0xf bank_mask:0xf
    v_mov_b32_dpp v65, v63 quad_perm:[2,3,0,1] row_mask:0xf bank_mask:0xf
    s_nop 1
    v_mfma_f32_16x16x32_bf16 v[58:61], v[62:65], v[54:57], 0
    buffer_load_dwordx4 v[52:55], v77, s[8:11], s18 offen
    v_smfmac_f32_16x16x64_bf16 v[72:75], v[8:11], a[88:95], v76
    s_waitcnt lgkmcnt(2)
    v_smfmac_f32_16x16x64_bf16 v[68:71], v[12:15], v[36:43], v76
    v_cndmask_b32 v58, v61, v58, s[32:33]
    ds_write_b32 v77, v58 offset:14348
    buffer_load_dwordx4 v[56:59], v77, s[8:11], s18 offen offset:1024
    s_waitcnt lgkmcnt(1)
    v_smfmac_f32_16x16x64_bf16 v[72:75], v[12:15], v[44:51], v76
    v_add_u32 v51, 65536, v77
    v_smfmac_f32_16x16x64_bf16 v[68:71], v[16:19], a[96:103], v76
    ds_read_b128 v[36:39], v51 offset:45056
    v_smfmac_f32_16x16x64_bf16 v[72:75], v[16:19], a[104:111], v76
    ds_read_b128 v[40:43], v51 offset:46080
    v_smfmac_f32_16x16x64_bf16 v[68:71], v[24:27], a[112:119], v76
    ds_read_b128 v[44:47], v51 offset:47104
    s_waitcnt lgkmcnt(3)
    s_barrier
    v_smfmac_f32_16x16x64_bf16 v[72:75], v[24:27], a[120:127], v76
    ds_read_b128 v[16:19], v77 offset:14336
    ds_read_b128 v[0:3], v77 offset:10240
    ds_read_b128 v[4:7], v77 offset:11264
    ds_read_b128 v[8:11], v77 offset:12288
    ds_read_b128 v[12:15], v77 offset:13312
    v_smfmac_f32_16x16x64_bf16 v[68:71], v[32:35], a[144:151], v76
    ds_read_b128 v[48:51], v51 offset:48128
    v_smfmac_f32_16x16x64_bf16 v[72:75], v[32:35], a[152:159], v76
    v_lshlrev_b32 v33, 3, v77
    s_movk_i32 m0, 3072
    s_add_u32 s43, s18, s50
    buffer_load_dword v33, s[8:11], s43 offen lds
    v_smfmac_f32_16x16x64_bf16 v[68:71], v[28:31], a[128:135], v76
    s_waitcnt lgkmcnt(5)
    v_add_f32 v16, v16, v17
    v_add_f32 v18, v18, v19
    v_smfmac_f32_16x16x64_bf16 v[72:75], v[28:31], a[136:143], v76
    ds_read_b64 v[66:67], v77 offset:15368
    v_smfmac_f32_16x16x64_bf16 v[68:71], v[20:23], v[36:43], v76
    s_waitcnt lgkmcnt(4)
    v_add_f32 v0, v0, v4
    v_add_f32 v1, v1, v5
    v_add_f32 v2, v2, v6
    v_add_f32 v3, v3, v7
    v_add_f32 v4, v16, v18
    v_cndmask_b32 v16, 16, 0, s[32:33]
    ds_read_b64 v[60:61], v77 offset:15360
    s_waitcnt lgkmcnt(3)
    v_add_f32 v8, v8, v12
    v_add_f32 v9, v9, v13
    v_add_f32 v10, v10, v14
    v_add_f32 v11, v11, v15
    v_add_f32 v0, v0, v8
    v_add_f32 v1, v1, v9
    v_add_f32 v2, v2, v10
    v_add_f32 v3, v3, v11
    v_max3_f32 v5, v0, v1, v4
    v_max3_f32 v5, v5, v2, v3
    v_mov_b32 v9, 0
    v_mov_b32 v10, 0
    v_max_f32_dpp v5, v5, v5 quad_perm:[2,3,0,1] row_mask:0xf bank_mask:0xf
    v_mov_b32 v6, v5
    s_waitcnt lgkmcnt(2)
    v_smfmac_f32_16x16x64_bf16 v[72:75], v[20:23], v[44:51], v76
    v_permlane16_swap_b32 v5, v6
    v_max_f32 v5, v5, v6
    v_mov_b32 v6, v5
    v_add_f32 v68, v68, v69
    v_add_f32 v70, v70, v71
    v_permlane32_swap_b32 v5, v6
    v_max_f32 v5, v5, v6
    v_mul_f32 v5, s40, v5
    v_fma_f32 v0, v0, s40, -v5
    v_fma_f32 v1, v1, s40, -v5
    v_fma_f32 v2, v2, s40, -v5
    v_fma_f32 v3, v3, s40, -v5
    v_exp_f32 v0, v0
    v_exp_f32 v1, v1
    v_fma_f32 v4, v4, s40, -v5
    v_exp_f32 v2, v2
    v_exp_f32 v3, v3
    v_exp_f32 v4, v4
    v_cvt_pk_bf16_f32 v5, v0, v1
    v_cvt_pk_bf16_f32 v6, v2, v3
    v_add_f32 v0, v0, v1
    v_add_f32 v2, v2, v3
    v_add_f32 v0, v0, v4
    v_cndmask_b32 v12, 0, v5, s[32:33]
    v_cndmask_b32 v13, 0, v6, s[32:33]
    v_cndmask_b32 v14, v5, 0, s[32:33]
    v_cndmask_b32 v15, v6, 0, s[32:33]
    v_add_f32 v0, v0, v2
    v_add_f32 v72, v72, v73
    v_add_f32 v74, v74, v75
    v_cvt_pk_bf16_f32 v7, v4, 0
    s_waitcnt vmcnt(2)
    v_mfma_f32_16x16x32_bf16 v[52:55], v[52:55], v[12:15], 0
    v_add_f32_dpp v0, v0, v0 quad_perm:[2,3,0,1] row_mask:0xf bank_mask:0xf
    v_cvt_pk_bf16_f32 v64, v68, v74
    s_waitcnt vmcnt(1)
    v_mfma_f32_16x16x32_bf16 v[56:59], v[56:59], v[12:15], 0
    v_cvt_pk_bf16_f32 v65, v72, v70
    buffer_store_dwordx4 v[62:65], v77, s[8:11], s19 offen sc1
    s_cmp_eq_u32 s16, 63
    s_cbranch_scc1 CH_END
    v_lshlrev_b32 v8, v16, v7
    v_lshlrev_b32 v11, v16, v7
    v_mov_b32 v1, v0
    v_mfma_f32_16x16x16_bf16 v[52:55], v[64:65], v[8:9], v[52:55]
    s_waitcnt lgkmcnt(0)
    v_and_b32 v17, 0xffff, v60
    v_permlane16_swap_b32 v0, v1
    v_mfma_f32_16x16x16_bf16 v[56:59], v[64:65], v[10:11], v[56:59]
    v_add_f32 v0, v0, v1
    v_mov_b32 v1, v0
    v_and_b32 v14, 0xffff, v61
    v_and_b32 v15, 0x80, v77
    v_permlane32_swap_b32 v0, v1
    v_add_f32 v0, v0, v1
    v_rcp_f32 v0, v0
    s_nop 0
    v_add_f32_dpp v52, v56, v52 quad_perm:[2,3,0,1] row_mask:0xf bank_mask:0xf
    v_add_f32_dpp v53, v57, v53 quad_perm:[2,3,0,1] row_mask:0xf bank_mask:0xf
    v_add_f32_dpp v54, v58, v54 quad_perm:[2,3,0,1] row_mask:0xf bank_mask:0xf
    v_add_f32_dpp v55, v59, v55 quad_perm:[2,3,0,1] row_mask:0xf bank_mask:0xf
    v_mul_f32 v52, v52, v0
    v_mul_f32 v53, v53, v0
    v_mul_f32 v54, v54, v0
    v_mul_f32 v55, v55, v0
    v_cvt_pk_bf16_f32 v52, v52, v53
    v_cvt_pk_bf16_f32 v53, v54, v55
    ds_write_b64 v17, v[52:53] offset:9728
    v_lshl_add_u32 v15, v15, 3, v14
    v_add_u32 v51, 65536, v77
    ds_read_b128 v[36:39], v51 offset:61440
    ds_read_b128 v[40:43], v51 offset:62464
    ds_read_b128 v[44:47], v51 offset:63488
    ds_read_b128 v[48:51], v51 offset:64512
    v_add_u32 v63, 131072, v77
    ds_read_b128 v[68:71], v63 offset:12288
    ds_read_b128 v[72:75], v63 offset:13312
    v_lshrrev_b32 v61, 16, v61
    v_mov_b64 v[24:25], 0
    v_mov_b64 v[26:27], 0
    v_mov_b64 v[16:17], 0
    v_mov_b64 v[18:19], 0
    v_and_b32 v62, 0xffff, v66
    v_mov_b64 v[28:29], 0
    v_mov_b64 v[30:31], 0
    v_mov_b64 v[32:33], 0
    v_mov_b64 v[34:35], 0
    v_mov_b64 v[20:21], 0
    v_mov_b64 v[22:23], 0
    s_waitcnt lgkmcnt(6)
    s_barrier
    v_lshrrev_b32 v60, 12, v60
    v_lshrrev_b32 v66, 16, v66
    ds_read_b128 v[52:55], v15 offset:8192
    ds_read_b128 v[56:59], v15 offset:8704
    ds_read_b128 v[0:3], v14 offset:8192
    ds_read_b128 v[4:7], v14 offset:8704
    ds_read_b128 v[8:11], v14 offset:9216
    ds_read_b128 v[12:15], v14 offset:9728
    s_waitcnt lgkmcnt(5)
    v_smfmac_f32_16x16x64_bf16 v[24:27], v[52:55], v[36:43], v61
    ds_read_b128 v[36:39], v63 offset:14336
    s_waitcnt lgkmcnt(5)
    v_smfmac_f32_16x16x64_bf16 v[24:27], v[56:59], v[44:51], v61
    ds_read_b128 v[40:43], v63 offset:15360
    s_waitcnt lgkmcnt(5)
    v_smfmac_f32_16x16x64_bf16 v[16:19], v[0:3], v[68:75], v61
    ds_read_b128 v[44:47], v63 offset:28672
    v_smfmac_f32_16x16x64_bf16 v[28:31], v[0:3], a[160:167], v61
    ds_read_b128 v[48:51], v63 offset:29696
    s_waitcnt lgkmcnt(6)
    v_smfmac_f32_16x16x64_bf16 v[28:31], v[4:7], a[168:175], v61
    ds_read_b128 v[68:71], v63 offset:30720
    s_waitcnt lgkmcnt(6)
    v_smfmac_f32_16x16x64_bf16 v[28:31], v[8:11], a[176:183], v61
    ds_read_b128 v[72:75], v63 offset:31744
    s_waitcnt lgkmcnt(6)
    v_smfmac_f32_16x16x64_bf16 v[28:31], v[12:15], a[184:191], v61
    v_permlane32_swap_b32 v24, v26
    v_smfmac_f32_16x16x64_bf16 v[32:35], v[0:3], a[192:199], v61
    v_permlane32_swap_b32 v25, v27
    v_smfmac_f32_16x16x64_bf16 v[32:35], v[4:7], a[200:207], v61
    v_cvt_pk_bf16_f32 v28, v28, v29
    v_smfmac_f32_16x16x64_bf16 v[32:35], v[8:11], a[208:215], v61
    v_cvt_pk_bf16_f32 v29, v30, v31
    v_smfmac_f32_16x16x64_bf16 v[32:35], v[12:15], a[216:223], v61
    v_add_f32 v24, v24, v26
    s_waitcnt lgkmcnt(4)
    v_smfmac_f32_16x16x64_bf16 v[16:19], v[4:7], v[36:43], v61
    v_add_f32 v25, v25, v27
    s_waitcnt lgkmcnt(2)
    v_smfmac_f32_16x16x64_bf16 v[16:19], v[8:11], v[44:51], v61
    v_cvt_pk_bf16_f32 v30, v32, v33
    v_cvt_pk_bf16_f32 v31, v34, v35
    s_waitcnt lgkmcnt(0)
    v_smfmac_f32_16x16x64_bf16 v[16:19], v[12:15], v[68:75], v61
    v_permlane16_swap_b32 v28, v30
    v_permlane16_swap_b32 v29, v31
    v_and_or_b32 v28, v28, -2, s49
    buffer_store_dwordx4 v[28:31], v62, s[8:11], s24 offen
    v_smfmac_f32_16x16x64_bf16 v[20:23], v[0:3], a[224:231], v61
    s_nop 2
    v_cvt_pk_bf16_f32 v19, v18, v19
    v_cvt_pk_bf16_f32 v18, v16, v17
    v_smfmac_f32_16x16x64_bf16 v[20:23], v[4:7], a[232:239], v61
    v_cvt_pk_bf16_f32 v25, v24, v25
    v_smfmac_f32_16x16x64_bf16 v[20:23], v[8:11], a[240:247], v61
    v_mov_b32 v24, v25
    v_smfmac_f32_16x16x64_bf16 v[20:23], v[12:15], a[248:255], v61
    s_nop 0
    v_permlane32_swap_b32 v24, v25
    v_and_or_b32 v24, v24, -2, s49
    s_mov_b32 exec_hi, 0
    buffer_store_dwordx2 v[24:25], v67, s[8:11], s26 offen
    s_mov_b32 exec_hi, -1
    s_nop 1
    v_cvt_pk_bf16_f32 v16, v20, v21
    v_cvt_pk_bf16_f32 v17, v22, v23
    s_nop 0
    v_permlane16_swap_b32 v16, v18
    v_permlane16_swap_b32 v17, v19
    v_and_or_b32 v16, v16, -2, s49
    buffer_store_dwordx4 v[16:19], v62, s[8:11], s25 offen
    s_add_u32 s17, s17, 8192
    s_add_u32 s18, s18, 8192
    s_add_u32 s19, s19, 131072
    s_add_u32 s24, s24, s48
    s_add_u32 s25, s25, s48
    s_add_u32 s26, s26, s48
    s_add_u32 s27, s30, 3072
    s_add_u32 s28, s30, 7168
    s_add_u32 s29, s30, 8192
    s_add_u32 s16, s16, 1
    s_and_b32 s42, s16, 7
    s_cmp_lg_u32 s42, 7
    s_cbranch_scc1 CH_f3_nk
    s_cmp_ge_u32 s16, 63
    s_cbranch_scc1 CH_f3_nk
    s_add_u32 s42, s16, 1
    s_lshr_b32 s42, s42, 3
    s_lshl_b32 s43, s42, 4
    s_lshr_b32 s44, s3, 1
    s_add_u32 s43, s43, s44
    s_lshl_b32 s43, s43, 7
    s_add_u32 s43, s43, 117273600
    s_load_dwordx2 s[44:45], s[8:9], s43
    s_waitcnt lgkmcnt(0)
    s_cmp_lt_u32 s44, 2
    s_cbranch_scc1 CH_f3_ks
    s_cmp_ge_u32 s45, 2
    s_cbranch_scc1 CH_f3_nk
CH_f3_ks:
    s_lshl_b32 s42, s42, 4
    s_lshr_b32 s43, s3, 1
    s_add_u32 s42, s42, s43
    s_lshl_b32 s42, s42, 7
    s_add_u32 s42, s42, 117273600
    v_lshrrev_b32 v1, 2, v77
    s_mov_b64 exec, 3
CH_f3_kv:
    buffer_load_dword v0, v1, s[8:11], s42 offen sc1
    s_waitcnt vmcnt(0)
    v_cmp_gt_u32 vcc, 2, v0
    s_cbranch_vccz CH_f3_kv_ok
    s_sub_u32 s41, s41, 1
    s_cbranch_scc0 CH_f3_kv
    s_mov_b32 s41, 0
CH_f3_kv_ok:
    s_mov_b64 exec, -1
CH_f3_nk:
    s_barrier
    s_cmp_lt_u32 s16, 64
    s_cbranch_scc1 CH_f3
    s_branch CH_END
CH_gos0:
    ds_read_b128 v[36:39], v77 offset:16384
    ds_read_b128 v[40:43], v77 offset:17408
    ds_read_b128 v[44:47], v77 offset:18432
    ds_read_b128 v[48:51], v77 offset:19456
CH_s0:
    buffer_load_dwordx4 v[0:3], v77, s[8:11], s27 offen sc1
    buffer_load_dwordx4 v[16:19], v77, s[8:11], s28 offen sc1
    v_mov_b64 v[60:61], 0
    v_mov_b64 v[62:63], 0
    v_mov_b64 v[64:65], 0
    v_mov_b64 v[66:67], 0
    s_add_u32 s20, s20, s48
    s_add_u32 s21, s21, s48
    s_add_u32 s22, s22, s48
    s_add_u32 s23, s23, s48
    s_sub_u32 s48, 0, s48
    s_bfe_u32 s49, s16, 0x10001
    s_mov_b32 s42, s72
    s_mov_b32 s72, s30
    s_mov_b32 s30, s38
    s_mov_b32 s38, s42
    s_add_u32 s31, s38, s39
    s_add_u32 s5, s30, s6
CH_s0_p2:
    s_waitcnt vmcnt(1)
    ds_write_b128 v77, v[0:3] offset:0
    v_max3_u32 v68, v0, v1, v2
    s_waitcnt vmcnt(0)
    ds_write_b128 v77, v[16:19] offset:4096
    v_max3_u32 v69, v16, v17, v18
    v_max3_u32 v68, v68, v3, v19
    v_max_u32 v68, v68, v69
    v_cmp_eq_u32 vcc, -1, v68
    s_cbranch_vccz CH_s0_p2_ok
CH_s0_p2_f:
    s_sub_u32 s41, s41, 1
    s_cbranch_scc1 CH_s0_p2_x
    buffer_load_dwordx4 v[0:3], v77, s[8:11], s27 offen sc1
    buffer_load_dwordx4 v[16:19], v77, s[8:11], s28 offen sc1
    s_branch CH_s0_p2
CH_s0_p2_x:
    s_mov_b32 s41, 0
CH_s0_p2_ok:
    v_smfmac_f32_16x16x64_bf16 v[52:55], v[0:3], v[80:87], v76
    v_smfmac_f32_16x16x64_bf16 v[56:59], v[0:3], v[88:95], v76
    s_waitcnt lgkmcnt(0)
    s_barrier
    v_smfmac_f32_16x16x64_bf16 v[52:55], v[16:19], v[144:151], v76
    buffer_load_dwordx4 v[68:71], v77, s[8:11], s17 offen
    buffer_load_dwordx4 v[72:75], v77, s[8:11], s17 offen offset:1024
    v_smfmac_f32_16x16x64_bf16 v[56:59], v[16:19], v[152:159], v76
    ds_read_b128 v[32:35], v77 offset:8192
    v_smfmac_f32_16x16x64_bf16 v[60:63], v[0:3], v[208:215], v76
    ds_read_b128 v[4:7], v77 offset:1024
    v_smfmac_f32_16x16x64_bf16 v[64:67], v[0:3], v[216:223], v76
    ds_read_b128 v[8:11], v77 offset:2048
    v_smfmac_f32_16x16x64_bf16 v[60:63], v[16:19], a[0:7], v76
    ds_read_b128 v[12:15], v77 offset:3072
    v_smfmac_f32_16x16x64_bf16 v[64:67], v[16:19], a[8:15], v76
    ds_read_b128 v[20:23], v77 offset:5120
    s_waitcnt lgkmcnt(4)
    v_smfmac_f32_16x16x64_bf16 v[52:55], v[32:35], v[36:43], v76
    ds_read_b128 v[36:39], v77 offset:32768
    v_smfmac_f32_16x16x64_bf16 v[56:59], v[32:35], v[44:51], v76
    ds_read_b128 v[40:43], v77 offset:33792
    s_waitcnt lgkmcnt(5)
    v_smfmac_f32_16x16x64_bf16 v[52:55], v[4:7], v[96:103], v76
    ds_read_b128 v[44:47], v77 offset:34816
    v_smfmac_f32_16x16x64_bf16 v[56:59], v[4:7], v[104:111], v76
    ds_read_b128 v[48:51], v77 offset:35840
    s_waitcnt lgkmcnt(6)
    v_smfmac_f32_16x16x64_bf16 v[52:55], v[8:11], v[112:119], v76
    ds_read_b128 v[24:27], v77 offset:6144
    v_smfmac_f32_16x16x64_bf16 v[56:59], v[8:11], v[120:127], v76
    ds_read_b128 v[28:31], v77 offset:7168
    s_waitcnt lgkmcnt(7)
    v_smfmac_f32_16x16x64_bf16 v[52:55], v[12:15], v[128:135], v76
    v_smfmac_f32_16x16x64_bf16 v[56:59], v[12:15], v[136:143], v76
    s_waitcnt lgkmcnt(4)
    v_smfmac_f32_16x16x64_bf16 v[60:63], v[12:15], v[36:43], v76
    ds_read_b128 v[36:39], v77 offset:49152
    s_waitcnt lgkmcnt(3)
    v_smfmac_f32_16x16x64_bf16 v[64:67], v[12:15], v[44:51], v76
    ds_read_b128 v[40:43], v77 offset:50176
    v_smfmac_f32_16x16x64_bf16 v[52:55], v[20:23], v[160:167], v76
    ds_read_b128 v[44:47], v77 offset:51200
    v_smfmac_f32_16x16x64_bf16 v[56:59], v[20:23], v[168:175], v76
    ds_read_b128 v[48:51], v77 offset:52224
    s_waitcnt lgkmcnt(5)
    v_smfmac_f32_16x16x64_bf16 v[52:55], v[24:27], v[176:183], v76
    v_smfmac_f32_16x16x64_bf16 v[56:59], v[24:27], v[184:191], v76
    s_waitcnt lgkmcnt(4)
    v_smfmac_f32_16x16x64_bf16 v[52:55], v[28:31], v[192:199], v76
    v_smfmac_f32_16x16x64_bf16 v[56:59], v[28:31], v[200:207], v76
    v_smfmac_f32_16x16x64_bf16 v[60:63], v[32:35], a[48:55], v76
    v_add_f32 v52, v52, v53
    v_add_f32 v54, v54, v55
    v_cvt_pk_bf16_f32 v52, v52, v54
    s_nop 0
    v_add_f32 v56, v56, v57
    v_add_f32 v58, v58, v59
    v_cvt_pk_bf16_f32 v53, v56, v58
    v_smfmac_f32_16x16x64_bf16 v[60:63], v[4:7], v[224:231], v76
    s_nop 0
    v_mfma_f32_16x16x16_bf16 v[56:59], v[52:53], v[78:79], 0
    s_waitcnt lgkmcnt(2)
    v_smfmac_f32_16x16x64_bf16 v[60:63], v[28:31], v[36:43], v76
    s_waitcnt lgkmcnt(0)
    v_smfmac_f32_16x16x64_bf16 v[64:67], v[28:31], v[44:51], v76
    v_cvt_pk_bf16_f32 v54, v56, v57
    v_cvt_pk_bf16_f32 v55, v58, v59
    v_smfmac_f32_16x16x64_bf16 v[60:63], v[8:11], v[240:247], v76
    v_mov_b32_dpp v56, v54 quad_perm:[2,3,0,1] row_mask:0xf bank_mask:0xf
    v_mov_b32_dpp v57, v55 quad_perm:[2,3,0,1] row_mask:0xf bank_mask:0xf
    v_smfmac_f32_16x16x64_bf16 v[60:63], v[20:23], a[16:23], v76
    v_add_u32 v51, 65536, v77
    s_waitcnt vmcnt(1)
    v_mfma_f32_16x16x32_bf16 v[68:71], v[68:71], v[54:57], 0
    ds_read_b128 v[36:39], v51 offset:0
    ds_read_b128 v[40:43], v51 offset:1024
    s_waitcnt vmcnt(0)
    v_mfma_f32_16x16x32_bf16 v[72:75], v[72:75], v[54:57], 0
    ds_read_b128 v[44:47], v51 offset:2048
    ds_read_b128 v[48:51], v51 offset:3072
    v_smfmac_f32_16x16x64_bf16 v[60:63], v[24:27], a[32:39], v76
    v_smfmac_f32_16x16x64_bf16 v[64:67], v[32:35], a[56:63], v76
    v_cndmask_b32 v68, v72, v68, s[32:33]
    v_cndmask_b32 v69, v73, v69, s[32:33]
    v_cndmask_b32 v70, v74, v70, s[32:33]
    v_cndmask_b32 v71, v75, v71, s[32:33]
    ds_write_b128 v77, v[68:71] offset:10240
    v_mov_b64 v[68:69], 0
    v_mov_b64 v[70:71], 0
    v_smfmac_f32_16x16x64_bf16 v[64:67], v[4:7], v[232:239], v76
    v_mov_b64 v[72:73], 0
    v_mov_b64 v[74:75], 0
    v_smfmac_f32_16x16x64_bf16 v[64:67], v[8:11], v[248:255], v76
    v_add_f32 v60, v60, v61
    v_smfmac_f32_16x16x64_bf16 v[64:67], v[20:23], a[24:31], v76
    v_add_f32 v62, v62, v63
    v_smfmac_f32_16x16x64_bf16 v[64:67], v[24:27], a[40:47], v76
    v_cvt_pk_bf16_f32 v60, v60, v62
    s_waitcnt lgkmcnt(3)
    v_smfmac_f32_16x16x64_bf16 v[68:71], v[4:7], v[36:43], v76
    s_waitcnt lgkmcnt(1)
    v_smfmac_f32_16x16x64_bf16 v[72:75], v[4:7], v[44:51], v76
    v_add_f32 v64, v64, v65
    v_add_f32 v66, v66, v67
    v_cvt_pk_bf16_f32 v61, v64, v66
    v_add_u32 v51, 65536, v77
    ds_read_b128 v[36:39], v51 offset:16384
    v_mfma_f32_16x16x16_bf16 v[64:67], v[60:61], v[78:79], 0
    ds_read_b128 v[40:43], v51 offset:17408
    ds_read_b128 v[44:47], v51 offset:18432
    ds_read_b128 v[48:51], v51 offset:19456
    v_smfmac_f32_16x16x64_bf16 v[68:71], v[0:3], a[64:71], v76
    v_smfmac_f32_16x16x64_bf16 v[72:75], v[0:3], a[72:79], v76
    v_cvt_pk_bf16_f32 v62, v64, v65
    v_cvt_pk_bf16_f32 v63, v66, v67
    v_smfmac_f32_16x16x64_bf16 v[68:71], v[8:11], a[80:87], v76
    v_mov_b32_dpp v64, v62 quad_perm:[2,3,0,1] row_mask:0xf bank_mask:0xf
    v_mov_b32_dpp v65, v63 quad_perm:[2,3,0,1] row_mask:0xf bank_mask:0xf
    s_nop 1
    v_mfma_f32_16x16x32_bf16 v[58:61], v[62:65], v[54:57], 0
    buffer_load_dwordx4 v[52:55], v77, s[8:11], s18 offen
    v_smfmac_f32_16x16x64_bf16 v[72:75], v[8:11], a[88:95], v76
    s_waitcnt lgkmcnt(2)
    v_smfmac_f32_16x16x64_bf16 v[68:71], v[12:15], v[36:43], v76
    v_cndmask_b32 v58, v61, v58, s[32:33]
    ds_write_b32 v77, v58 offset:14336
    buffer_load_dwordx4 v[56:59], v77, s[8:11], s18 offen offset:1024
    s_waitcnt lgkmcnt(1)
    v_smfmac_f32_16x16x64_bf16 v[72:75], v[12:15], v[44:51], v76
    v_add_u32 v51, 65536, v77
    v_smfmac_f32_16x16x64_bf16 v[68:71], v[16:19], a[96:103], v76
    ds_read_b128 v[36:39], v51 offset:32768
    v_smfmac_f32_16x16x64_bf16 v[72:75], v[16:19], a[104:111], v76
    ds_read_b128 v[40:43], v51 offset:33792
    v_smfmac_f32_16x16x64_bf16 v[68:71], v[24:27], a[112:119], v76
    ds_read_b128 v[44:47], v51 offset:34816
    s_waitcnt lgkmcnt(3)
    s_barrier
    v_smfmac_f32_16x16x64_bf16 v[72:75], v[24:27], a[120:127], v76
    v_mov_b64 v[24:25], -1
    v_mov_b64 v[26:27], -1
    ds_read_b128 v[16:19], v77 offset:14336
    ds_read_b128 v[0:3], v77 offset:10240
    ds_read_b128 v[4:7], v77 offset:11264
    ds_read_b128 v[8:11], v77 offset:12288
    ds_read_b128 v[12:15], v77 offset:13312
    v_smfmac_f32_16x16x64_bf16 v[68:71], v[32:35], a[144:151], v76
    ds_read_b128 v[48:51], v51 offset:35840
    v_smfmac_f32_16x16x64_bf16 v[72:75], v[32:35], a[152:159], v76
    ds_read_b64 v[66:67], v77 offset:15368
    v_smfmac_f32_16x16x64_bf16 v[68:71], v[28:31], a[128:135], v76
    ds_read_b64 v[60:61], v77 offset:15360
    s_waitcnt lgkmcnt(7)
    v_add_f32 v16, v16, v17
    v_add_f32 v18, v18, v19
    v_smfmac_f32_16x16x64_bf16 v[72:75], v[28:31], a[136:143], v76
    v_mov_b64 v[28:29], 0
    s_mov_b64 exec, 0x3ffff
    buffer_store_dwordx4 v[24:27], v77, s[8:11], s31 offen sc1
    s_mov_b64 exec, -1
    v_smfmac_f32_16x16x64_bf16 v[68:71], v[20:23], v[36:43], v76
    s_waitcnt lgkmcnt(5)
    v_add_f32 v0, v0, v4
    v_add_f32 v1, v1, v5
    v_add_f32 v2, v2, v6
    v_add_f32 v3, v3, v7
    v_add_f32 v4, v16, v18
    v_cndmask_b32 v16, 16, 0, s[32:33]
    s_waitcnt lgkmcnt(3)
    v_add_f32 v8, v8, v12
    v_add_f32 v9, v9, v13
    v_add_f32 v10, v10, v14
    v_add_f32 v11, v11, v15
    v_add_f32 v0, v0, v8
    v_add_f32 v1, v1, v9
    v_add_f32 v2, v2, v10
    v_add_f32 v3, v3, v11
    v_max3_f32 v5, v0, v1, v4
    v_max3_f32 v5, v5, v2, v3
    v_mov_b32 v9, 0
    v_mov_b32 v10, 0
    v_max_f32_dpp v5, v5, v5 quad_perm:[2,3,0,1] row_mask:0xf bank_mask:0xf
    v_mov_b32 v6, v5
    s_waitcnt lgkmcnt(2)
    v_smfmac_f32_16x16x64_bf16 v[72:75], v[20:23], v[44:51], v76
    v_permlane16_swap_b32 v5, v6
    v_max_f32 v5, v5, v6
    v_mov_b32 v6, v5
    v_add_f32 v68, v68, v69
    v_add_f32 v70, v70, v71
    v_permlane32_swap_b32 v5, v6
    v_max_f32 v5, v5, v6
    v_mul_f32 v5, s40, v5
    v_fma_f32 v0, v0, s40, -v5
    v_fma_f32 v1, v1, s40, -v5
    v_fma_f32 v2, v2, s40, -v5
    v_fma_f32 v3, v3, s40, -v5
    v_exp_f32 v0, v0
    v_exp_f32 v1, v1
    v_fma_f32 v4, v4, s40, -v5
    v_exp_f32 v2, v2
    v_exp_f32 v3, v3
    v_exp_f32 v4, v4
    v_cvt_pk_bf16_f32 v5, v0, v1
    v_cvt_pk_bf16_f32 v6, v2, v3
    v_add_f32 v0, v0, v1
    v_add_f32 v2, v2, v3
    v_add_f32 v0, v0, v4
    v_cndmask_b32 v12, 0, v5, s[32:33]
    v_cndmask_b32 v13, 0, v6, s[32:33]
    v_cndmask_b32 v14, v5, 0, s[32:33]
    v_cndmask_b32 v15, v6, 0, s[32:33]
    v_add_f32 v0, v0, v2
    v_add_f32 v72, v72, v73
    v_add_f32 v74, v74, v75
    v_cvt_pk_bf16_f32 v7, v4, 0
    s_waitcnt vmcnt(2)
    v_mfma_f32_16x16x32_bf16 v[52:55], v[52:55], v[12:15], 0
    v_add_f32_dpp v0, v0, v0 quad_perm:[2,3,0,1] row_mask:0xf bank_mask:0xf
    v_cvt_pk_bf16_f32 v64, v68, v74
    s_waitcnt vmcnt(1)
    v_mfma_f32_16x16x32_bf16 v[56:59], v[56:59], v[12:15], 0
    v_cvt_pk_bf16_f32 v65, v72, v70
    buffer_store_dwordx4 v[62:65], v77, s[8:11], s19 offen sc1
    s_cmp_eq_u32 s16, 63
    s_cbranch_scc1 CH_END
    v_lshlrev_b32 v8, v16, v7
    v_lshlrev_b32 v11, v16, v7
    v_mov_b32 v1, v0
    v_mfma_f32_16x16x16_bf16 v[52:55], v[64:65], v[8:9], v[52:55]
    s_waitcnt lgkmcnt(0)
    v_and_b32 v17, 0xffff, v60
    v_permlane16_swap_b32 v0, v1
    v_mfma_f32_16x16x16_bf16 v[56:59], v[64:65], v[10:11], v[56:59]
    v_add_f32 v0, v0, v1
    v_mov_b32 v1, v0
    v_and_b32 v14, 0xffff, v61
    v_and_b32 v15, 0x80, v77
    v_permlane32_swap_b32 v0, v1
    v_add_f32 v0, v0, v1
    v_rcp_f32 v0, v0
    s_nop 0
    v_add_f32_dpp v52, v56, v52 quad_perm:[2,3,0,1] row_mask:0xf bank_mask:0xf
    v_add_f32_dpp v53, v57, v53 quad_perm:[2,3,0,1] row_mask:0xf bank_mask:0xf
    v_add_f32_dpp v54, v58, v54 quad_perm:[2,3,0,1] row_mask:0xf bank_mask:0xf
    v_add_f32_dpp v55, v59, v55 quad_perm:[2,3,0,1] row_mask:0xf bank_mask:0xf
    v_mul_f32 v52, v52, v0
    v_mul_f32 v53, v53, v0
    v_mul_f32 v54, v54, v0
    v_mul_f32 v55, v55, v0
    v_cvt_pk_bf16_f32 v52, v52, v53
    v_cvt_pk_bf16_f32 v53, v54, v55
    ds_write_b64 v17, v[52:53] offset:8192
    v_lshl_add_u32 v15, v15, 3, v14
    v_add_u32 v51, 65536, v77
    ds_read_b128 v[36:39], v51 offset:49152
    ds_read_b128 v[40:43], v51 offset:50176
    ds_read_b128 v[44:47], v51 offset:51200
    ds_read_b128 v[48:51], v51 offset:52224
    v_add_u32 v63, 131072, v77
    ds_read_b128 v[68:71], v63 offset:0
    ds_read_b128 v[72:75], v63 offset:1024
    v_lshrrev_b32 v61, 16, v61
    v_mov_b64 v[24:25], 0
    v_mov_b64 v[26:27], 0
    v_mov_b64 v[16:17], 0
    v_mov_b64 v[18:19], 0
    v_and_b32 v62, 0xffff, v66
    v_mov_b64 v[30:31], 0
    v_mov_b64 v[32:33], 0
    v_mov_b64 v[34:35], 0
    v_mov_b64 v[20:21], 0
    v_mov_b64 v[22:23], 0
    v_lshrrev_b32 v60, 12, v60
    s_waitcnt lgkmcnt(6)
    s_barrier
    v_lshrrev_b32 v66, 16, v66
    ds_read_b128 v[52:55], v15 offset:8192
    ds_read_b128 v[56:59], v15 offset:8704
    ds_read_b128 v[0:3], v14 offset:8192
    ds_read_b128 v[4:7], v14 offset:8704
    ds_read_b128 v[8:11], v14 offset:9216
    ds_read_b128 v[12:15], v14 offset:9728
    s_waitcnt lgkmcnt(5)
    v_smfmac_f32_16x16x64_bf16 v[24:27], v[52:55], v[36:43], v61
    ds_read_b128 v[36:39], v63 offset:2048
    s_waitcnt lgkmcnt(5)
    v_smfmac_f32_16x16x64_bf16 v[24:27], v[56:59], v[44:51], v61
    ds_read_b128 v[40:43], v63 offset:3072
    s_waitcnt lgkmcnt(5)
    v_smfmac_f32_16x16x64_bf16 v[16:19], v[0:3], v[68:75], v61
    ds_read_b128 v[44:47], v63 offset:16384
    v_smfmac_f32_16x16x64_bf16 v[28:31], v[0:3], a[160:167], v61
    ds_read_b128 v[48:51], v63 offset:17408
    s_waitcnt lgkmcnt(6)
    v_smfmac_f32_16x16x64_bf16 v[28:31], v[4:7], a[168:175], v61
    ds_read_b128 v[68:71], v63 offset:18432
    s_waitcnt lgkmcnt(6)
    v_smfmac_f32_16x16x64_bf16 v[28:31], v[8:11], a[176:183], v61
    ds_read_b128 v[72:75], v63 offset:19456
    s_waitcnt lgkmcnt(6)
    v_smfmac_f32_16x16x64_bf16 v[28:31], v[12:15], a[184:191], v61
    v_permlane32_swap_b32 v24, v26
    v_smfmac_f32_16x16x64_bf16 v[32:35], v[0:3], a[192:199], v61
    v_permlane32_swap_b32 v25, v27
    v_smfmac_f32_16x16x64_bf16 v[32:35], v[4:7], a[200:207], v61
    v_cvt_pk_bf16_f32 v28, v28, v29
    v_smfmac_f32_16x16x64_bf16 v[32:35], v[8:11], a[208:215], v61
    v_cvt_pk_bf16_f32 v29, v30, v31
    v_smfmac_f32_16x16x64_bf16 v[32:35], v[12:15], a[216:223], v61
    v_add_f32 v24, v24, v26
    s_waitcnt lgkmcnt(4)
    v_smfmac_f32_16x16x64_bf16 v[16:19], v[4:7], v[36:43], v61
    v_add_f32 v25, v25, v27
    s_waitcnt lgkmcnt(2)
    v_smfmac_f32_16x16x64_bf16 v[16:19], v[8:11], v[44:51], v61
    v_cvt_pk_bf16_f32 v30, v32, v33
    v_cvt_pk_bf16_f32 v31, v34, v35
    s_waitcnt lgkmcnt(0)
    v_smfmac_f32_16x16x64_bf16 v[16:19], v[12:15], v[68:75], v61
    v_permlane16_swap_b32 v28, v30
    v_permlane16_swap_b32 v29, v31
    v_and_or_b32 v28, v28, -2, s49
    buffer_store_dwordx4 v[28:31], v62, s[8:11], s24 offen sc1
    v_smfmac_f32_16x16x64_bf16 v[20:23], v[0:3], a[224:231], v61
    s_nop 2
    v_cvt_pk_bf16_f32 v19, v18, v19
    v_cvt_pk_bf16_f32 v18, v16, v17
    v_smfmac_f32_16x16x64_bf16 v[20:23], v[4:7], a[232:239], v61
    v_cvt_pk_bf16_f32 v25, v24, v25
    v_smfmac_f32_16x16x64_bf16 v[20:23], v[8:11], a[240:247], v61
    v_mov_b32 v24, v25
    v_smfmac_f32_16x16x64_bf16 v[20:23], v[12:15], a[248:255], v61
    s_nop 0
    v_permlane32_swap_b32 v24, v25
    v_and_or_b32 v24, v24, -2, s49
    s_mov_b32 exec_hi, 0
    buffer_store_dwordx2 v[24:25], v67, s[8:11], s26 offen sc1
    s_mov_b32 exec_hi, -1
    s_nop 1
    v_cvt_pk_bf16_f32 v16, v20, v21
    v_cvt_pk_bf16_f32 v17, v22, v23
    s_nop 0
    v_permlane16_swap_b32 v16, v18
    v_permlane16_swap_b32 v17, v19
    v_and_or_b32 v16, v16, -2, s49
    buffer_store_dwordx4 v[16:19], v62, s[8:11], s25 offen sc1
    v_mov_b32 v35, 0x3f80
    v_cndmask_b32 v35, v35, 1.0, s[34:35]
    v_cndmask_b32 v32, 0, v35, s[56:57]
    v_cndmask_b32 v33, 0, v35, s[58:59]
    v_cndmask_b32 v34, 0, v35, s[60:61]
    v_cndmask_b32 v35, 0, v35, s[62:63]
    ds_read_b128 v[36:39], v77 offset:16384
    ds_read_b128 v[40:43], v77 offset:17408
    ds_read_b128 v[44:47], v77 offset:18432
    ds_read_b128 v[48:51], v77 offset:19456
    v_mov_b64 v[52:53], 0
    v_mov_b64 v[54:55], 0
    v_mov_b64 v[56:57], 0
    v_mov_b64 v[58:59], 0
    s_add_u32 s17, s17, 8192
    s_add_u32 s18, s18, 8192
    s_add_u32 s19, s19, 131072
    s_add_u32 s24, s24, s48
    s_add_u32 s25, s25, s48
    s_add_u32 s26, s26, s48
    s_add_u32 s27, s30, 0
    s_add_u32 s28, s30, 4096
    s_add_u32 s16, s16, 1
    s_waitcnt vmcnt(1)
    buffer_load_dwordx4 v[0:3], v60, s[8:11], s20 offen sc1
    buffer_load_dwordx4 v[4:7], v60, s[8:11], s21 offen sc1
    buffer_load_dwordx4 v[8:11], v60, s[8:11], s22 offen sc1
    buffer_load_dwordx4 v[12:15], v60, s[8:11], s23 offen sc1
CH_s0_p1:
    s_waitcnt vmcnt(3)
    v_mfma_f32_16x16x32_bf16 v[68:71], v[0:3], v[32:35], 0
    s_waitcnt vmcnt(2)
    v_mfma_f32_16x16x32_bf16 v[68:71], v[4:7], v[32:35], v[68:71]
    v_bitop3_b32 v64, v0, v4, s49 bitop3:0x7e
    s_waitcnt vmcnt(1)
    v_mfma_f32_16x16x32_bf16 v[68:71], v[8:11], v[32:35], v[68:71]
    s_waitcnt vmcnt(0)
    v_mfma_f32_16x16x32_bf16 v[68:71], v[12:15], v[32:35], v[68:71]
    v_bitop3_b32 v65, v8, v12, s49 bitop3:0x7e
    v_bitop3_b32 v64, v64, v65, 1 bitop3:0xa8
    v_cmp_ne_u32 vcc, 0, v64
    s_cbranch_vccz CH_s0_p1_ok
    s_sub_u32 s41, s41, 1
    s_cbranch_scc1 CH_s0_p1_x
    buffer_load_dwordx4 v[0:3], v60, s[8:11], s20 offen sc1
    buffer_load_dwordx4 v[4:7], v60, s[8:11], s21 offen sc1
    buffer_load_dwordx4 v[8:11], v60, s[8:11], s22 offen sc1
    buffer_load_dwordx4 v[12:15], v60, s[8:11], s23 offen sc1
    s_branch CH_s0_p1
CH_s0_p1_x:
    s_mov_b32 s41, 0
CH_s0_p1_ok:
    s_nop 3
    v_add_f32 v68, v68, v69
    v_add_f32 v70, v70, v71
    s_mov_b64 exec, s[36:37]
    v_cvt_pk_bf16_f32 v68, v68, v70
    buffer_store_dword v68, v66, s[8:11], s5 offen sc1
    s_mov_b64 exec, -1
    s_waitcnt vmcnt(0)
    s_barrier
    s_cmp_lt_u32 s16, 64
    s_cbranch_scc1 CH_s0
    s_branch CH_END
CH_gos1:
    ds_read_b128 v[36:39], v77 offset:20480
    ds_read_b128 v[40:43], v77 offset:21504
    ds_read_b128 v[44:47], v77 offset:22528
    ds_read_b128 v[48:51], v77 offset:23552
CH_s1:
    buffer_load_dwordx4 v[4:7], v77, s[8:11], s27 offen sc1
    buffer_load_dwordx4 v[20:23], v77, s[8:11], s28 offen sc1
    v_mov_b64 v[60:61], 0
    v_mov_b64 v[62:63], 0
    v_mov_b64 v[64:65], 0
    v_mov_b64 v[66:67], 0
    s_add_u32 s20, s20, s48
    s_add_u32 s21, s21, s48
    s_add_u32 s22, s22, s48
    s_add_u32 s23, s23, s48
    s_sub_u32 s48, 0, s48
    s_bfe_u32 s49, s16, 0x10001
    s_mov_b32 s42, s72
    s_mov_b32 s72, s30
    s_mov_b32 s30, s38
    s_mov_b32 s38, s42
    s_add_u32 s31, s38, s39
    s_add_u32 s5, s30, s6
CH_s1_p2:
    s_waitcnt vmcnt(1)
    ds_write_b128 v77, v[4:7] offset:1024
    v_max3_u32 v68, v4, v5, v6
    s_waitcnt vmcnt(0)
    ds_write_b128 v77, v[20:23] offset:5120
    v_max3_u32 v69, v20, v21, v22
    v_max3_u32 v68, v68, v7, v23
    v_max_u32 v68, v68, v69
    v_cmp_eq_u32 vcc, -1, v68
    s_cbranch_vccz CH_s1_p2_ok
CH_s1_p2_f:
    s_sub_u32 s41, s41, 1
    s_cbranch_scc1 CH_s1_p2_x
    buffer_load_dwordx4 v[4:7], v77, s[8:11], s27 offen sc1
    buffer_load_dwordx4 v[20:23], v77, s[8:11], s28 offen sc1
    s_branch CH_s1_p2
CH_s1_p2_x:
    s_mov_b32 s41, 0
CH_s1_p2_ok:
    v_smfmac_f32_16x16x64_bf16 v[52:55], v[4:7], v[96:103], v76
    v_smfmac_f32_16x16x64_bf16 v[56:59], v[4:7], v[104:111], v76
    s_waitcnt lgkmcnt(0)
    s_barrier
    v_smfmac_f32_16x16x64_bf16 v[52:55], v[20:23], v[160:167], v76
    buffer_load_dwordx4 v[68:71], v77, s[8:11], s17 offen
    buffer_load_dwordx4 v[72:75], v77, s[8:11], s17 offen offset:1024
    v_smfmac_f32_16x16x64_bf16 v[56:59], v[20:23], v[168:175], v76
    ds_read_b128 v[32:35], v77 offset:8192
    v_smfmac_f32_16x16x64_bf16 v[60:63], v[4:7], v[224:231], v76
    ds_read_b128 v[0:3], v77 offset:0
    v_smfmac_f32_16x16x64_bf16 v[64:67], v[4:7], v[232:239], v76
    ds_read_b128 v[8:11], v77 offset:2048
    v_smfmac_f32_16x16x64_bf16 v[60:63], v[20:23], a[16:23], v76
    ds_read_b128 v[12:15], v77 offset:3072
    v_smfmac_f32_16x16x64_bf16 v[64:67], v[20:23], a[24:31], v76
    ds_read_b128 v[16:19], v77 offset:4096
    s_waitcnt lgkmcnt(4)
    v_smfmac_f32_16x16x64_bf16 v[52:55], v[32:35], v[36:43], v76
    ds_read_b128 v[36:39], v77 offset:36864
    v_smfmac_f32_16x16x64_bf16 v[56:59], v[32:35], v[44:51], v76
    ds_read_b128 v[40:43], v77 offset:37888
    s_waitcnt lgkmcnt(5)
    v_smfmac_f32_16x16x64_bf16 v[52:55], v[0:3], v[80:87], v76
    ds_read_b128 v[44:47], v77 offset:38912
    v_smfmac_f32_16x16x64_bf16 v[56:59], v[0:3], v[88:95], v76
    ds_read_b128 v[48:51], v77 offset:39936
    s_waitcnt lgkmcnt(6)
    v_smfmac_f32_16x16x64_bf16 v[52:55], v[8:11], v[112:119], v76
    ds_read_b128 v[24:27], v77 offset:6144
    v_smfmac_f32_16x16x64_bf16 v[56:59], v[8:11], v[120:127], v76
    ds_read_b128 v[28:31], v77 offset:7168
    s_waitcnt lgkmcnt(7)
    v_smfmac_f32_16x16x64_bf16 v[52:55], v[12:15], v[128:135], v76
    v_smfmac_f32_16x16x64_bf16 v[56:59], v[12:15], v[136:143], v76
    s_waitcnt lgkmcnt(4)
    v_smfmac_f32_16x16x64_bf16 v[60:63], v[12:15], v[36:43], v76
    ds_read_b128 v[36:39], v77 offset:53248
    s_waitcnt lgkmcnt(3)
    v_smfmac_f32_16x16x64_bf16 v[64:67], v[12:15], v[44:51], v76
    ds_read_b128 v[40:43], v77 offset:54272
    v_smfmac_f32_16x16x64_bf16 v[52:55], v[16:19], v[144:151], v76
    ds_read_b128 v[44:47], v77 offset:55296
    v_smfmac_f32_16x16x64_bf16 v[56:59], v[16:19], v[152:159], v76
    ds_read_b128 v[48:51], v77 offset:56320
    s_waitcnt lgkmcnt(5)
    v_smfmac_f32_16x16x64_bf16 v[52:55], v[24:27], v[176:183], v76
    v_smfmac_f32_16x16x64_bf16 v[56:59], v[24:27], v[184:191], v76
    s_waitcnt lgkmcnt(4)
    v_smfmac_f32_16x16x64_bf16 v[52:55], v[28:31], v[192:199], v76
    v_smfmac_f32_16x16x64_bf16 v[56:59], v[28:31], v[200:207], v76
    v_smfmac_f32_16x16x64_bf16 v[60:63], v[32:35], a[48:55], v76
    v_add_f32 v52, v52, v53
    v_add_f32 v54, v54, v55
    v_cvt_pk_bf16_f32 v52, v52, v54
    s_nop 0
    v_add_f32 v56, v56, v57
    v_add_f32 v58, v58, v59
    v_cvt_pk_bf16_f32 v53, v56, v58
    v_smfmac_f32_16x16x64_bf16 v[60:63], v[0:3], v[208:215], v76
    s_nop 0
    v_mfma_f32_16x16x16_bf16 v[56:59], v[52:53], v[78:79], 0
    s_waitcnt lgkmcnt(2)
    v_smfmac_f32_16x16x64_bf16 v[60:63], v[28:31], v[36:43], v76
    s_waitcnt lgkmcnt(0)
    v_smfmac_f32_16x16x64_bf16 v[64:67], v[28:31], v[44:51], v76
    v_cvt_pk_bf16_f32 v54, v56, v57
    v_cvt_pk_bf16_f32 v55, v58, v59
    v_smfmac_f32_16x16x64_bf16 v[60:63], v[8:11], v[240:247], v76
    v_mov_b32_dpp v56, v54 quad_perm:[2,3,0,1] row_mask:0xf bank_mask:0xf
    v_mov_b32_dpp v57, v55 quad_perm:[2,3,0,1] row_mask:0xf bank_mask:0xf
    v_smfmac_f32_16x16x64_bf16 v[60:63], v[16:19], a[0:7], v76
    v_add_u32 v51, 65536, v77
    s_waitcnt vmcnt(1)
    v_mfma_f32_16x16x32_bf16 v[68:71], v[68:71], v[54:57], 0
    ds_read_b128 v[36:39], v51 offset:4096
    ds_read_b128 v[40:43], v51 offset:5120
    s_waitcnt vmcnt(0)
    v_mfma_f32_16x16x32_bf16 v[72:75], v[72:75], v[54:57], 0
    ds_read_b128 v[44:47], v51 offset:6144
    ds_read_b128 v[48:51], v51 offset:7168
    v_smfmac_f32_16x16x64_bf16 v[60:63], v[24:27], a[32:39], v76
    v_smfmac_f32_16x16x64_bf16 v[64:67], v[32:35], a[56:63], v76
    v_cndmask_b32 v68, v72, v68, s[32:33]
    v_cndmask_b32 v69, v73, v69, s[32:33]
    v_cndmask_b32 v70, v74, v70, s[32:33]
    v_cndmask_b32 v71, v75, v71, s[32:33]
    ds_write_b128 v77, v[68:71] offset:11264
    v_mov_b64 v[68:69], 0
    v_mov_b64 v[70:71], 0
    v_smfmac_f32_16x16x64_bf16 v[64:67], v[0:3], v[216:223], v76
    v_mov_b64 v[72:73], 0
    v_mov_b64 v[74:75], 0
    v_smfmac_f32_16x16x64_bf16 v[64:67], v[8:11], v[248:255], v76
    v_add_f32 v60, v60, v61
    v_smfmac_f32_16x16x64_bf16 v[64:67], v[16:19], a[8:15], v76
    v_add_f32 v62, v62, v63
    v_smfmac_f32_16x16x64_bf16 v[64:67], v[24:27], a[40:47], v76
    v_cvt_pk_bf16_f32 v60, v60, v62
    s_waitcnt lgkmcnt(3)
    v_smfmac_f32_16x16x64_bf16 v[68:71], v[4:7], v[36:43], v76
    s_waitcnt lgkmcnt(1)
    v_smfmac_f32_16x16x64_bf16 v[72:75], v[4:7], v[44:51], v76
    v_add_f32 v64, v64, v65
    v_add_f32 v66, v66, v67
    v_cvt_pk_bf16_f32 v61, v64, v66
    v_add_u32 v51, 65536, v77
    ds_read_b128 v[36:39], v51 offset:20480
    v_mfma_f32_16x16x16_bf16 v[64:67], v[60:61], v[78:79], 0
    ds_read_b128 v[40:43], v51 offset:21504
    ds_read_b128 v[44:47], v51 offset:22528
    ds_read_b128 v[48:51], v51 offset:23552
    v_smfmac_f32_16x16x64_bf16 v[68:71], v[0:3], a[64:71], v76
    v_smfmac_f32_16x16x64_bf16 v[72:75], v[0:3], a[72:79], v76
    v_cvt_pk_bf16_f32 v62, v64, v65
    v_cvt_pk_bf16_f32 v63, v66, v67
    v_smfmac_f32_16x16x64_bf16 v[68:71], v[8:11], a[80:87], v76
    v_mov_b32_dpp v64, v62 quad_perm:[2,3,0,1] row_mask:0xf bank_mask:0xf
    v_mov_b32_dpp v65, v63 quad_perm:[2,3,0,1] row_mask:0xf bank_mask:0xf
    s_nop 1
    v_mfma_f32_16x16x32_bf16 v[58:61], v[62:65], v[54:57], 0
    buffer_load_dwordx4 v[52:55], v77, s[8:11], s18 offen
    v_smfmac_f32_16x16x64_bf16 v[72:75], v[8:11], a[88:95], v76
    s_waitcnt lgkmcnt(2)
    v_smfmac_f32_16x16x64_bf16 v[68:71], v[12:15], v[36:43], v76
    v_cndmask_b32 v58, v61, v58, s[32:33]
    ds_write_b32 v77, v58 offset:14340
    buffer_load_dwordx4 v[56:59], v77, s[8:11], s18 offen offset:1024
    s_waitcnt lgkmcnt(1)
    v_smfmac_f32_16x16x64_bf16 v[72:75], v[12:15], v[44:51], v76
    v_add_u32 v51, 65536, v77
    v_smfmac_f32_16x16x64_bf16 v[68:71], v[16:19], a[96:103], v76
    ds_read_b128 v[36:39], v51 offset:36864
    v_smfmac_f32_16x16x64_bf16 v[72:75], v[16:19], a[104:111], v76
    ds_read_b128 v[40:43], v51 offset:37888
    v_smfmac_f32_16x16x64_bf16 v[68:71], v[24:27], a[112:119], v76
    ds_read_b128 v[44:47], v51 offset:38912
    s_waitcnt lgkmcnt(3)
    s_barrier
    v_smfmac_f32_16x16x64_bf16 v[72:75], v[24:27], a[120:127], v76
    ds_read_b128 v[16:19], v77 offset:14336
    ds_read_b128 v[0:3], v77 offset:10240
    ds_read_b128 v[4:7], v77 offset:11264
    ds_read_b128 v[8:11], v77 offset:12288
    ds_read_b128 v[12:15], v77 offset:13312
    v_smfmac_f32_16x16x64_bf16 v[68:71], v[32:35], a[144:151], v76
    ds_read_b128 v[48:51], v51 offset:39936
    v_smfmac_f32_16x16x64_bf16 v[72:75], v[32:35], a[152:159], v76
    ds_read_b64 v[66:67], v77 offset:15368
    v_smfmac_f32_16x16x64_bf16 v[68:71], v[28:31], a[128:135], v76
    ds_read_b64 v[60:61], v77 offset:15360
    s_waitcnt lgkmcnt(7)
    v_add_f32 v16, v16, v17
    v_add_f32 v18, v18, v19
    v_smfmac_f32_16x16x64_bf16 v[72:75], v[28:31], a[136:143], v76
    v_mov_b64 v[24:25], 0
    v_smfmac_f32_16x16x64_bf16 v[68:71], v[20:23], v[36:43], v76
    s_waitcnt lgkmcnt(5)
    v_add_f32 v0, v0, v4
    v_add_f32 v1, v1, v5
    v_add_f32 v2, v2, v6
    v_add_f32 v3, v3, v7
    v_add_f32 v4, v16, v18
    v_cndmask_b32 v16, 16, 0, s[32:33]
    v_mov_b64 v[26:27], 0
    s_waitcnt lgkmcnt(3)
    v_add_f32 v8, v8, v12
    v_add_f32 v9, v9, v13
    v_add_f32 v10, v10, v14
    v_add_f32 v11, v11, v15
    v_add_f32 v0, v0, v8
    v_add_f32 v1, v1, v9
    v_add_f32 v2, v2, v10
    v_add_f32 v3, v3, v11
    v_max3_f32 v5, v0, v1, v4
    v_max3_f32 v5, v5, v2, v3
    v_mov_b32 v9, 0
    v_mov_b32 v10, 0
    v_max_f32_dpp v5, v5, v5 quad_perm:[2,3,0,1] row_mask:0xf bank_mask:0xf
    v_mov_b32 v6, v5
    s_waitcnt lgkmcnt(2)
    v_smfmac_f32_16x16x64_bf16 v[72:75], v[20:23], v[44:51], v76
    v_permlane16_swap_b32 v5, v6
    v_max_f32 v5, v5, v6
    v_mov_b32 v6, v5
    v_add_f32 v68, v68, v69
    v_add_f32 v70, v70, v71
    v_permlane32_swap_b32 v5, v6
    v_max_f32 v5, v5, v6
    v_mul_f32 v5, s40, v5
    v_fma_f32 v0, v0, s40, -v5
    v_fma_f32 v1, v1, s40, -v5
    v_fma_f32 v2, v2, s40, -v5
    v_fma_f32 v3, v3, s40, -v5
    v_exp_f32 v0, v0
    v_exp_f32 v1, v1
    v_fma_f32 v4, v4, s40, -v5
    v_exp_f32 v2, v2
    v_exp_f32 v3, v3
    v_exp_f32 v4, v4
    v_cvt_pk_bf16_f32 v5, v0, v1
    v_cvt_pk_bf16_f32 v6, v2, v3
    v_add_f32 v0, v0, v1
    v_add_f32 v2, v2, v3
    v_add_f32 v0, v0, v4
    v_cndmask_b32 v12, 0, v5, s[32:33]
    v_cndmask_b32 v13, 0, v6, s[32:33]
    v_cndmask_b32 v14, v5, 0, s[32:33]
    v_cndmask_b32 v15, v6, 0, s[32:33]
    v_add_f32 v0, v0, v2
    v_add_f32 v72, v72, v73
    v_add_f32 v74, v74, v75
    v_cvt_pk_bf16_f32 v7, v4, 0
    s_waitcnt vmcnt(1)
    v_mfma_f32_16x16x32_bf16 v[52:55], v[52:55], v[12:15], 0
    v_add_f32_dpp v0, v0, v0 quad_perm:[2,3,0,1] row_mask:0xf bank_mask:0xf
    v_cvt_pk_bf16_f32 v64, v68, v74
    s_waitcnt vmcnt(0)
    v_mfma_f32_16x16x32_bf16 v[56:59], v[56:59], v[12:15], 0
    v_cvt_pk_bf16_f32 v65, v72, v70
    buffer_store_dwordx4 v[62:65], v77, s[8:11], s19 offen sc1
    s_cmp_eq_u32 s16, 63
    s_cbranch_scc1 CH_END
    v_lshlrev_b32 v8, v16, v7
    v_lshlrev_b32 v11, v16, v7
    v_mov_b32 v1, v0
    v_mfma_f32_16x16x16_bf16 v[52:55], v[64:65], v[8:9], v[52:55]
    s_waitcnt lgkmcnt(0)
    v_and_b32 v17, 0xffff, v60
    v_permlane16_swap_b32 v0, v1
    v_mfma_f32_16x16x16_bf16 v[56:59], v[64:65], v[10:11], v[56:59]
    v_add_f32 v0, v0, v1
    v_mov_b32 v1, v0
    v_and_b32 v14, 0xffff, v61
    v_and_b32 v15, 0x80, v77
    v_permlane32_swap_b32 v0, v1
    v_add_f32 v0, v0, v1
    v_rcp_f32 v0, v0
    s_nop 0
    v_add_f32_dpp v52, v56, v52 quad_perm:[2,3,0,1] row_mask:0xf bank_mask:0xf
    v_add_f32_dpp v53, v57, v53 quad_perm:[2,3,0,1] row_mask:0xf bank_mask:0xf
    v_add_f32_dpp v54, v58, v54 quad_perm:[2,3,0,1] row_mask:0xf bank_mask:0xf
    v_add_f32_dpp v55, v59, v55 quad_perm:[2,3,0,1] row_mask:0xf bank_mask:0xf
    v_mul_f32 v52, v52, v0
    v_mul_f32 v53, v53, v0
    v_mul_f32 v54, v54, v0
    v_mul_f32 v55, v55, v0
    v_cvt_pk_bf16_f32 v52, v52, v53
    v_cvt_pk_bf16_f32 v53, v54, v55
    ds_write_b64 v17, v[52:53] offset:8704
    v_lshl_add_u32 v15, v15, 3, v14
    v_add_u32 v51, 65536, v77
    ds_read_b128 v[36:39], v51 offset:53248
    ds_read_b128 v[40:43], v51 offset:54272
    ds_read_b128 v[44:47], v51 offset:55296
    ds_read_b128 v[48:51], v51 offset:56320
    v_add_u32 v63, 131072, v77
    ds_read_b128 v[68:71], v63 offset:4096
    ds_read_b128 v[72:75], v63 offset:5120
    v_lshrrev_b32 v61, 16, v61
    v_mov_b64 v[16:17], 0
    v_mov_b64 v[18:19], 0
    v_and_b32 v62, 0xffff, v66
    v_mov_b64 v[28:29], 0
    v_mov_b64 v[30:31], 0
    v_mov_b64 v[32:33], 0
    v_mov_b64 v[34:35], 0
    v_mov_b64 v[20:21], 0
    v_mov_b64 v[22:23], 0
    v_lshrrev_b32 v60, 12, v60
    v_lshrrev_b32 v66, 16, v66
    s_waitcnt lgkmcnt(6)
    s_barrier
    ds_read_b128 v[52:55], v15 offset:8192
    ds_read_b128 v[56:59], v15 offset:8704
    ds_read_b128 v[0:3], v14 offset:8192
    ds_read_b128 v[4:7], v14 offset:8704
    ds_read_b128 v[8:11], v14 offset:9216
    ds_read_b128 v[12:15], v14 offset:9728
    s_waitcnt lgkmcnt(5)
    v_smfmac_f32_16x16x64_bf16 v[24:27], v[52:55], v[36:43], v61
    ds_read_b128 v[36:39], v63 offset:6144
    s_waitcnt lgkmcnt(5)
    v_smfmac_f32_16x16x64_bf16 v[24:27], v[56:59], v[44:51], v61
    ds_read_b128 v[40:43], v63 offset:7168
    s_waitcnt lgkmcnt(5)
    v_smfmac_f32_16x16x64_bf16 v[16:19], v[0:3], v[68:75], v61
    ds_read_b128 v[44:47], v63 offset:20480
    v_smfmac_f32_16x16x64_bf16 v[28:31], v[0:3], a[160:167], v61
    ds_read_b128 v[48:51], v63 offset:21504
    s_waitcnt lgkmcnt(6)
    v_smfmac_f32_16x16x64_bf16 v[28:31], v[4:7], a[168:175], v61
    ds_read_b128 v[68:71], v63 offset:22528
    s_waitcnt lgkmcnt(6)
    v_smfmac_f32_16x16x64_bf16 v[28:31], v[8:11], a[176:183], v61
    ds_read_b128 v[72:75], v63 offset:23552
    s_waitcnt lgkmcnt(6)
    v_smfmac_f32_16x16x64_bf16 v[28:31], v[12:15], a[184:191], v61
    v_permlane32_swap_b32 v24, v26
    v_smfmac_f32_16x16x64_bf16 v[32:35], v[0:3], a[192:199], v61
    v_permlane32_swap_b32 v25, v27
    v_smfmac_f32_16x16x64_bf16 v[32:35], v[4:7], a[200:207], v61
    v_cvt_pk_bf16_f32 v28, v28, v29
    v_smfmac_f32_16x16x64_bf16 v[32:35], v[8:11], a[208:215], v61
    v_cvt_pk_bf16_f32 v29, v30, v31
    v_smfmac_f32_16x16x64_bf16 v[32:35], v[12:15], a[216:223], v61
    v_add_f32 v24, v24, v26
    s_waitcnt lgkmcnt(4)
    v_smfmac_f32_16x16x64_bf16 v[16:19], v[4:7], v[36:43], v61
    v_add_f32 v25, v25, v27
    s_waitcnt lgkmcnt(2)
    v_smfmac_f32_16x16x64_bf16 v[16:19], v[8:11], v[44:51], v61
    v_cvt_pk_bf16_f32 v30, v32, v33
    v_cvt_pk_bf16_f32 v31, v34, v35
    s_waitcnt lgkmcnt(0)
    v_smfmac_f32_16x16x64_bf16 v[16:19], v[12:15], v[68:75], v61
    v_permlane16_swap_b32 v28, v30
    v_permlane16_swap_b32 v29, v31
    v_and_or_b32 v28, v28, -2, s49
    buffer_store_dwordx4 v[28:31], v62, s[8:11], s24 offen sc1
    v_smfmac_f32_16x16x64_bf16 v[20:23], v[0:3], a[224:231], v61
    s_nop 2
    v_cvt_pk_bf16_f32 v19, v18, v19
    v_cvt_pk_bf16_f32 v18, v16, v17
    v_smfmac_f32_16x16x64_bf16 v[20:23], v[4:7], a[232:239], v61
    v_cvt_pk_bf16_f32 v25, v24, v25
    v_smfmac_f32_16x16x64_bf16 v[20:23], v[8:11], a[240:247], v61
    v_mov_b32 v24, v25
    v_smfmac_f32_16x16x64_bf16 v[20:23], v[12:15], a[248:255], v61
    s_nop 0
    v_permlane32_swap_b32 v24, v25
    v_and_or_b32 v24, v24, -2, s49
    s_mov_b32 exec_hi, 0
    buffer_store_dwordx2 v[24:25], v67, s[8:11], s26 offen sc1
    s_mov_b32 exec_hi, -1
    s_nop 1
    v_cvt_pk_bf16_f32 v16, v20, v21
    v_cvt_pk_bf16_f32 v17, v22, v23
    s_nop 0
    v_permlane16_swap_b32 v16, v18
    v_permlane16_swap_b32 v17, v19
    v_and_or_b32 v16, v16, -2, s49
    buffer_store_dwordx4 v[16:19], v62, s[8:11], s25 offen sc1
    v_mov_b32 v35, 0x3f80
    v_cndmask_b32 v35, v35, 1.0, s[34:35]
    v_cndmask_b32 v32, 0, v35, s[56:57]
    v_cndmask_b32 v33, 0, v35, s[58:59]
    v_cndmask_b32 v34, 0, v35, s[60:61]
    v_cndmask_b32 v35, 0, v35, s[62:63]
    ds_read_b128 v[36:39], v77 offset:20480
    ds_read_b128 v[40:43], v77 offset:21504
    ds_read_b128 v[44:47], v77 offset:22528
    ds_read_b128 v[48:51], v77 offset:23552
    v_mov_b64 v[52:53], 0
    v_mov_b64 v[54:55], 0
    v_mov_b64 v[56:57], 0
    v_mov_b64 v[58:59], 0
    s_add_u32 s17, s17, 8192
    s_add_u32 s18, s18, 8192
    s_add_u32 s19, s19, 131072
    s_add_u32 s24, s24, s48
    s_add_u32 s25, s25, s48
    s_add_u32 s26, s26, s48
    s_add_u32 s27, s30, 1024
    s_add_u32 s28, s30, 5120
    s_add_u32 s16, s16, 1
    s_waitcnt vmcnt(1)
    buffer_load_dwordx4 v[0:3], v60, s[8:11], s20 offen sc1
    buffer_load_dwordx4 v[4:7], v60, s[8:11], s21 offen sc1
    buffer_load_dwordx4 v[8:11], v60, s[8:11], s22 offen sc1
    buffer_load_dwordx4 v[12:15], v60, s[8:11], s23 offen sc1
CH_s1_p1:
    s_waitcnt vmcnt(3)
    v_mfma_f32_16x16x32_bf16 v[68:71], v[0:3], v[32:35], 0
    s_waitcnt vmcnt(2)
    v_mfma_f32_16x16x32_bf16 v[68:71], v[4:7], v[32:35], v[68:71]
    v_bitop3_b32 v64, v0, v4, s49 bitop3:0x7e
    s_waitcnt vmcnt(1)
    v_mfma_f32_16x16x32_bf16 v[68:71], v[8:11], v[32:35], v[68:71]
    s_waitcnt vmcnt(0)
    v_mfma_f32_16x16x32_bf16 v[68:71], v[12:15], v[32:35], v[68:71]
    v_bitop3_b32 v65, v8, v12, s49 bitop3:0x7e
    v_bitop3_b32 v64, v64, v65, 1 bitop3:0xa8
    v_cmp_ne_u32 vcc, 0, v64
    s_cbranch_vccz CH_s1_p1_ok
    s_sub_u32 s41, s41, 1
    s_cbranch_scc1 CH_s1_p1_x
    buffer_load_dwordx4 v[0:3], v60, s[8:11], s20 offen sc1
    buffer_load_dwordx4 v[4:7], v60, s[8:11], s21 offen sc1
    buffer_load_dwordx4 v[8:11], v60, s[8:11], s22 offen sc1
    buffer_load_dwordx4 v[12:15], v60, s[8:11], s23 offen sc1
    s_branch CH_s1_p1
CH_s1_p1_x:
    s_mov_b32 s41, 0
CH_s1_p1_ok:
    s_nop 3
    v_add_f32 v68, v68, v69
    v_add_f32 v70, v70, v71
    s_mov_b64 exec, s[36:37]
    v_cvt_pk_bf16_f32 v68, v68, v70
    buffer_store_dword v68, v66, s[8:11], s5 offen sc1
    s_mov_b64 exec, -1
    s_waitcnt vmcnt(0)
    s_barrier
    s_cmp_lt_u32 s16, 64
    s_cbranch_scc1 CH_s1
    s_branch CH_END
CH_gos2:
    ds_read_b128 v[36:39], v77 offset:24576
    ds_read_b128 v[40:43], v77 offset:25600
    ds_read_b128 v[44:47], v77 offset:26624
    ds_read_b128 v[48:51], v77 offset:27648
CH_s2:
    buffer_load_dwordx4 v[8:11], v77, s[8:11], s27 offen sc1
    buffer_load_dwordx4 v[24:27], v77, s[8:11], s28 offen sc1
    v_mov_b64 v[60:61], 0
    v_mov_b64 v[62:63], 0
    v_mov_b64 v[64:65], 0
    v_mov_b64 v[66:67], 0
    s_add_u32 s20, s20, s48
    s_add_u32 s21, s21, s48
    s_add_u32 s22, s22, s48
    s_add_u32 s23, s23, s48
    s_sub_u32 s48, 0, s48
    s_bfe_u32 s49, s16, 0x10001
    s_mov_b32 s42, s72
    s_mov_b32 s72, s30
    s_mov_b32 s30, s38
    s_mov_b32 s38, s42
    s_add_u32 s31, s38, s39
    s_add_u32 s5, s30, s6
CH_s2_p2:
    s_waitcnt vmcnt(1)
    ds_write_b128 v77, v[8:11] offset:2048
    v_max3_u32 v68, v8, v9, v10
    s_waitcnt vmcnt(0)
    ds_write_b128 v77, v[24:27] offset:6144
    v_max3_u32 v69, v24, v25, v26
    v_max3_u32 v68, v68, v11, v27
    v_max_u32 v68, v68, v69
    v_cmp_eq_u32 vcc, -1, v68
    s_cbranch_vccz CH_s2_p2_ok
CH_s2_p2_f:
    s_sub_u32 s41, s41, 1
    s_cbranch_scc1 CH_s2_p2_x
    buffer_load_dwordx4 v[8:11], v77, s[8:11], s27 offen sc1
    buffer_load_dwordx4 v[24:27], v77, s[8:11], s28 offen sc1
    s_branch CH_s2_p2
CH_s2_p2_x:
    s_mov_b32 s41, 0
CH_s2_p2_ok:
    v_smfmac_f32_16x16x64_bf16 v[52:55], v[8:11], v[112:119], v76
    v_smfmac_f32_16x16x64_bf16 v[56:59], v[8:11], v[120:127], v76
    s_waitcnt lgkmcnt(0)
    s_barrier
    v_smfmac_f32_16x16x64_bf16 v[52:55], v[24:27], v[176:183], v76
    buffer_load_dwordx4 v[68:71], v77, s[8:11], s17 offen
    buffer_load_dwordx4 v[72:75], v77, s[8:11], s17 offen offset:1024
    v_smfmac_f32_16x16x64_bf16 v[56:59], v[24:27], v[184:191], v76
    ds_read_b128 v[32:35], v77 offset:8192
    v_smfmac_f32_16x16x64_bf16 v[60:63], v[8:11], v[240:247], v76
    ds_read_b128 v[0:3], v77 offset:0
    v_smfmac_f32_16x16x64_bf16 v[64:67], v[8:11], v[248:255], v76
    ds_read_b128 v[4:7], v77 offset:1024
    v_smfmac_f32_16x16x64_bf16 v[60:63], v[24:27], a[32:39], v76
    ds_read_b128 v[12:15], v77 offset:3072
    v_smfmac_f32_16x16x64_bf16 v[64:67], v[24:27], a[40:47], v76
    ds_read_b128 v[16:19], v77 offset:4096
    s_waitcnt lgkmcnt(4)
    v_smfmac_f32_16x16x64_bf16 v[52:55], v[32:35], v[36:43], v76
    ds_read_b128 v[36:39], v77 offset:40960
    v_smfmac_f32_16x16x64_bf16 v[56:59], v[32:35], v[44:51], v76
    ds_read_b128 v[40:43], v77 offset:41984
    s_waitcnt lgkmcnt(5)
    v_smfmac_f32_16x16x64_bf16 v[52:55], v[0:3], v[80:87], v76
    ds_read_b128 v[44:47], v77 offset:43008
    v_smfmac_f32_16x16x64_bf16 v[56:59], v[0:3], v[88:95], v76
    ds_read_b128 v[48:51], v77 offset:44032
    s_waitcnt lgkmcnt(6)
    v_smfmac_f32_16x16x64_bf16 v[52:55], v[4:7], v[96:103], v76
    ds_read_b128 v[20:23], v77 offset:5120
    v_smfmac_f32_16x16x64_bf16 v[56:59], v[4:7], v[104:111], v76
    ds_read_b128 v[28:31], v77 offset:7168
    s_waitcnt lgkmcnt(7)
    v_smfmac_f32_16x16x64_bf16 v[52:55], v[12:15], v[128:135], v76
    v_smfmac_f32_16x16x64_bf16 v[56:59], v[12:15], v[136:143], v76
    s_waitcnt lgkmcnt(4)
    v_smfmac_f32_16x16x64_bf16 v[60:63], v[12:15], v[36:43], v76
    ds_read_b128 v[36:39], v77 offset:57344
    s_waitcnt lgkmcnt(3)
    v_smfmac_f32_16x16x64_bf16 v[64:67], v[12:15], v[44:51], v76
    ds_read_b128 v[40:43], v77 offset:58368
    v_smfmac_f32_16x16x64_bf16 v[52:55], v[16:19], v[144:151], v76
    ds_read_b128 v[44:47], v77 offset:59392
    v_smfmac_f32_16x16x64_bf16 v[56:59], v[16:19], v[152:159], v76
    ds_read_b128 v[48:51], v77 offset:60416
    s_waitcnt lgkmcnt(5)
    v_smfmac_f32_16x16x64_bf16 v[52:55], v[20:23], v[160:167], v76
    v_smfmac_f32_16x16x64_bf16 v[56:59], v[20:23], v[168:175], v76
    s_waitcnt lgkmcnt(4)
    v_smfmac_f32_16x16x64_bf16 v[52:55], v[28:31], v[192:199], v76
    v_smfmac_f32_16x16x64_bf16 v[56:59], v[28:31], v[200:207], v76
    v_smfmac_f32_16x16x64_bf16 v[60:63], v[32:35], a[48:55], v76
    v_add_f32 v52, v52, v53
    v_add_f32 v54, v54, v55
    v_cvt_pk_bf16_f32 v52, v52, v54
    s_nop 0
    v_add_f32 v56, v56, v57
    v_add_f32 v58, v58, v59
    v_cvt_pk_bf16_f32 v53, v56, v58
    v_smfmac_f32_16x16x64_bf16 v[60:63], v[0:3], v[208:215], v76
    s_nop 0
    v_mfma_f32_16x16x16_bf16 v[56:59], v[52:53], v[78:79], 0
    s_waitcnt lgkmcnt(2)
    v_smfmac_f32_16x16x64_bf16 v[60:63], v[28:31], v[36:43], v76
    s_waitcnt lgkmcnt(0)
    v_smfmac_f32_16x16x64_bf16 v[64:67], v[28:31], v[44:51], v76
    v_cvt_pk_bf16_f32 v54, v56, v57
    v_cvt_pk_bf16_f32 v55, v58, v59
    v_smfmac_f32_16x16x64_bf16 v[60:63], v[4:7], v[224:231], v76
    v_mov_b32_dpp v56, v54 quad_perm:[2,3,0,1] row_mask:0xf bank_mask:0xf
    v_mov_b32_dpp v57, v55 quad_perm:[2,3,0,1] row_mask:0xf bank_mask:0xf
    v_smfmac_f32_16x16x64_bf16 v[60:63], v[16:19], a[0:7], v76
    v_add_u32 v51, 65536, v77
    s_waitcnt vmcnt(1)
    v_mfma_f32_16x16x32_bf16 v[68:71], v[68:71], v[54:57], 0
    ds_read_b128 v[36:39], v51 offset:8192
    ds_read_b128 v[40:43], v51 offset:9216
    s_waitcnt vmcnt(0)
    v_mfma_f32_16x16x32_bf16 v[72:75], v[72:75], v[54:57], 0
    ds_read_b128 v[44:47], v51 offset:10240
    ds_read_b128 v[48:51], v51 offset:11264
    v_smfmac_f32_16x16x64_bf16 v[60:63], v[20:23], a[16:23], v76
    v_smfmac_f32_16x16x64_bf16 v[64:67], v[32:35], a[56:63], v76
    v_cndmask_b32 v68, v72, v68, s[32:33]
    v_cndmask_b32 v69, v73, v69, s[32:33]
    v_cndmask_b32 v70, v74, v70, s[32:33]
    v_cndmask_b32 v71, v75, v71, s[32:33]
    ds_write_b128 v77, v[68:71] offset:12288
    v_mov_b64 v[68:69], 0
    v_mov_b64 v[70:71], 0
    v_smfmac_f32_16x16x64_bf16 v[64:67], v[0:3], v[216:223], v76
    v_mov_b64 v[72:73], 0
    v_mov_b64 v[74:75], 0
    v_smfmac_f32_16x16x64_bf16 v[64:67], v[4:7], v[232:239], v76
    v_add_f32 v60, v60, v61
    v_smfmac_f32_16x16x64_bf16 v[64:67], v[16:19], a[8:15], v76
    v_add_f32 v62, v62, v63
    v_smfmac_f32_16x16x64_bf16 v[64:67], v[20:23], a[24:31], v76
    v_cvt_pk_bf16_f32 v60, v60, v62
    s_waitcnt lgkmcnt(3)
    v_smfmac_f32_16x16x64_bf16 v[68:71], v[4:7], v[36:43], v76
    s_waitcnt lgkmcnt(1)
    v_smfmac_f32_16x16x64_bf16 v[72:75], v[4:7], v[44:51], v76
    v_add_f32 v64, v64, v65
    v_add_f32 v66, v66, v67
    v_cvt_pk_bf16_f32 v61, v64, v66
    v_add_u32 v51, 65536, v77
    ds_read_b128 v[36:39], v51 offset:24576
    v_mfma_f32_16x16x16_bf16 v[64:67], v[60:61], v[78:79], 0
    ds_read_b128 v[40:43], v51 offset:25600
    ds_read_b128 v[44:47], v51 offset:26624
    ds_read_b128 v[48:51], v51 offset:27648
    v_smfmac_f32_16x16x64_bf16 v[68:71], v[0:3], a[64:71], v76
    v_smfmac_f32_16x16x64_bf16 v[72:75], v[0:3], a[72:79], v76
    v_cvt_pk_bf16_f32 v62, v64, v65
    v_cvt_pk_bf16_f32 v63, v66, v67
    v_smfmac_f32_16x16x64_bf16 v[68:71], v[8:11], a[80:87], v76
    v_mov_b32_dpp v64, v62 quad_perm:[2,3,0,1] row_mask:0xf bank_mask:0xf
    v_mov_b32_dpp v65, v63 quad_perm:[2,3,0,1] row_mask:0xf bank_mask:0xf
    s_nop 1
    v_mfma_f32_16x16x32_bf16 v[58:61], v[62:65], v[54:57], 0
    buffer_load_dwordx4 v[52:55], v77, s[8:11], s18 offen
    v_smfmac_f32_16x16x64_bf16 v[72:75], v[8:11], a[88:95], v76
    s_waitcnt lgkmcnt(2)
    v_smfmac_f32_16x16x64_bf16 v[68:71], v[12:15], v[36:43], v76
    v_cndmask_b32 v58, v61, v58, s[32:33]
    ds_write_b32 v77, v58 offset:14344
    buffer_load_dwordx4 v[56:59], v77, s[8:11], s18 offen offset:1024
    s_waitcnt lgkmcnt(1)
    v_smfmac_f32_16x16x64_bf16 v[72:75], v[12:15], v[44:51], v76
    v_add_u32 v51, 65536, v77
    v_smfmac_f32_16x16x64_bf16 v[68:71], v[16:19], a[96:103], v76
    ds_read_b128 v[36:39], v51 offset:40960
    v_smfmac_f32_16x16x64_bf16 v[72:75], v[16:19], a[104:111], v76
    ds_read_b128 v[40:43], v51 offset:41984
    v_smfmac_f32_16x16x64_bf16 v[68:71], v[24:27], a[112:119], v76
    ds_read_b128 v[44:47], v51 offset:43008
    s_waitcnt lgkmcnt(3)
    s_barrier
    v_smfmac_f32_16x16x64_bf16 v[72:75], v[24:27], a[120:127], v76
    ds_read_b128 v[16:19], v77 offset:14336
    ds_read_b128 v[0:3], v77 offset:10240
    ds_read_b128 v[4:7], v77 offset:11264
    ds_read_b128 v[8:11], v77 offset:12288
    ds_read_b128 v[12:15], v77 offset:13312
    v_smfmac_f32_16x16x64_bf16 v[68:71], v[32:35], a[144:151], v76
    ds_read_b128 v[48:51], v51 offset:44032
    v_smfmac_f32_16x16x64_bf16 v[72:75], v[32:35], a[152:159], v76
    ds_read_b64 v[66:67], v77 offset:15368
    v_smfmac_f32_16x16x64_bf16 v[68:71], v[28:31], a[128:135], v76
    ds_read_b64 v[60:61], v77 offset:15360
    s_waitcnt lgkmcnt(7)
    v_add_f32 v16, v16, v17
    v_add_f32 v18, v18, v19
    v_smfmac_f32_16x16x64_bf16 v[72:75], v[28:31], a[136:143], v76
    v_mov_b64 v[24:25], 0
    v_smfmac_f32_16x16x64_bf16 v[68:71], v[20:23], v[36:43], v76
    s_waitcnt lgkmcnt(5)
    v_add_f32 v0, v0, v4
    v_add_f32 v1, v1, v5
    v_add_f32 v2, v2, v6
    v_add_f32 v3, v3, v7
    v_add_f32 v4, v16, v18
    v_cndmask_b32 v16, 16, 0, s[32:33]
    v_mov_b64 v[26:27], 0
    s_waitcnt lgkmcnt(3)
    v_add_f32 v8, v8, v12
    v_add_f32 v9, v9, v13
    v_add_f32 v10, v10, v14
    v_add_f32 v11, v11, v15
    v_add_f32 v0, v0, v8
    v_add_f32 v1, v1, v9
    v_add_f32 v2, v2, v10
    v_add_f32 v3, v3, v11
    v_max3_f32 v5, v0, v1, v4
    v_max3_f32 v5, v5, v2, v3
    v_mov_b32 v9, 0
    v_mov_b32 v10, 0
    v_max_f32_dpp v5, v5, v5 quad_perm:[2,3,0,1] row_mask:0xf bank_mask:0xf
    v_mov_b32 v6, v5
    s_waitcnt lgkmcnt(2)
    v_smfmac_f32_16x16x64_bf16 v[72:75], v[20:23], v[44:51], v76
    v_permlane16_swap_b32 v5, v6
    v_max_f32 v5, v5, v6
    v_mov_b32 v6, v5
    v_add_f32 v68, v68, v69
    v_add_f32 v70, v70, v71
    v_permlane32_swap_b32 v5, v6
    v_max_f32 v5, v5, v6
    v_mul_f32 v5, s40, v5
    v_fma_f32 v0, v0, s40, -v5
    v_fma_f32 v1, v1, s40, -v5
    v_fma_f32 v2, v2, s40, -v5
    v_fma_f32 v3, v3, s40, -v5
    v_exp_f32 v0, v0
    v_exp_f32 v1, v1
    v_fma_f32 v4, v4, s40, -v5
    v_exp_f32 v2, v2
    v_exp_f32 v3, v3
    v_exp_f32 v4, v4
    v_cvt_pk_bf16_f32 v5, v0, v1
    v_cvt_pk_bf16_f32 v6, v2, v3
    v_add_f32 v0, v0, v1
    v_add_f32 v2, v2, v3
    v_add_f32 v0, v0, v4
    v_cndmask_b32 v12, 0, v5, s[32:33]
    v_cndmask_b32 v13, 0, v6, s[32:33]
    v_cndmask_b32 v14, v5, 0, s[32:33]
    v_cndmask_b32 v15, v6, 0, s[32:33]
    v_add_f32 v0, v0, v2
    v_add_f32 v72, v72, v73
    v_add_f32 v74, v74, v75
    v_cvt_pk_bf16_f32 v7, v4, 0
    s_waitcnt vmcnt(1)
    v_mfma_f32_16x16x32_bf16 v[52:55], v[52:55], v[12:15], 0
    v_add_f32_dpp v0, v0, v0 quad_perm:[2,3,0,1] row_mask:0xf bank_mask:0xf
    v_cvt_pk_bf16_f32 v64, v68, v74
    s_waitcnt vmcnt(0)
    v_mfma_f32_16x16x32_bf16 v[56:59], v[56:59], v[12:15], 0
    v_cvt_pk_bf16_f32 v65, v72, v70
    buffer_store_dwordx4 v[62:65], v77, s[8:11], s19 offen sc1
    s_cmp_eq_u32 s16, 63
    s_cbranch_scc1 CH_END
    v_lshlrev_b32 v8, v16, v7
    v_lshlrev_b32 v11, v16, v7
    v_mov_b32 v1, v0
    v_mfma_f32_16x16x16_bf16 v[52:55], v[64:65], v[8:9], v[52:55]
    s_waitcnt lgkmcnt(0)
    v_and_b32 v17, 0xffff, v60
    v_permlane16_swap_b32 v0, v1
    v_mfma_f32_16x16x16_bf16 v[56:59], v[64:65], v[10:11], v[56:59]
    v_add_f32 v0, v0, v1
    v_mov_b32 v1, v0
    v_and_b32 v14, 0xffff, v61
    v_and_b32 v15, 0x80, v77
    v_permlane32_swap_b32 v0, v1
    v_add_f32 v0, v0, v1
    v_rcp_f32 v0, v0
    s_nop 0
    v_add_f32_dpp v52, v56, v52 quad_perm:[2,3,0,1] row_mask:0xf bank_mask:0xf
    v_add_f32_dpp v53, v57, v53 quad_perm:[2,3,0,1] row_mask:0xf bank_mask:0xf
    v_add_f32_dpp v54, v58, v54 quad_perm:[2,3,0,1] row_mask:0xf bank_mask:0xf
    v_add_f32_dpp v55, v59, v55 quad_perm:[2,3,0,1] row_mask:0xf bank_mask:0xf
    v_mul_f32 v52, v52, v0
    v_mul_f32 v53, v53, v0
    v_mul_f32 v54, v54, v0
    v_mul_f32 v55, v55, v0
    v_cvt_pk_bf16_f32 v52, v52, v53
    v_cvt_pk_bf16_f32 v53, v54, v55
    ds_write_b64 v17, v[52:53] offset:9216
    v_lshl_add_u32 v15, v15, 3, v14
    v_add_u32 v51, 65536, v77
    ds_read_b128 v[36:39], v51 offset:57344
    ds_read_b128 v[40:43], v51 offset:58368
    ds_read_b128 v[44:47], v51 offset:59392
    ds_read_b128 v[48:51], v51 offset:60416
    v_add_u32 v63, 131072, v77
    ds_read_b128 v[68:71], v63 offset:8192
    ds_read_b128 v[72:75], v63 offset:9216
    v_lshrrev_b32 v61, 16, v61
    v_mov_b64 v[16:17], 0
    v_mov_b64 v[18:19], 0
    v_and_b32 v62, 0xffff, v66
    v_mov_b64 v[28:29], 0
    v_mov_b64 v[30:31], 0
    v_mov_b64 v[32:33], 0
    v_mov_b64 v[34:35], 0
    v_mov_b64 v[20:21], 0
    v_mov_b64 v[22:23], 0
    v_lshrrev_b32 v60, 12, v60
    v_lshrrev_b32 v66, 16, v66
    s_waitcnt lgkmcnt(6)
    s_barrier
    ds_read_b128 v[52:55], v15 offset:8192
    ds_read_b128 v[56:59], v15 offset:8704
    ds_read_b128 v[0:3], v14 offset:8192
    ds_read_b128 v[4:7], v14 offset:8704
    ds_read_b128 v[8:11], v14 offset:9216
    ds_read_b128 v[12:15], v14 offset:9728
    s_waitcnt lgkmcnt(5)
    v_smfmac_f32_16x16x64_bf16 v[24:27], v[52:55], v[36:43], v61
    ds_read_b128 v[36:39], v63 offset:10240
    s_waitcnt lgkmcnt(5)
    v_smfmac_f32_16x16x64_bf16 v[24:27], v[56:59], v[44:51], v61
    ds_read_b128 v[40:43], v63 offset:11264
    s_waitcnt lgkmcnt(5)
    v_smfmac_f32_16x16x64_bf16 v[16:19], v[0:3], v[68:75], v61
    ds_read_b128 v[44:47], v63 offset:24576
    v_smfmac_f32_16x16x64_bf16 v[28:31], v[0:3], a[160:167], v61
    ds_read_b128 v[48:51], v63 offset:25600
    s_waitcnt lgkmcnt(6)
    v_smfmac_f32_16x16x64_bf16 v[28:31], v[4:7], a[168:175], v61
    ds_read_b128 v[68:71], v63 offset:26624
    s_waitcnt lgkmcnt(6)
    v_smfmac_f32_16x16x64_bf16 v[28:31], v[8:11], a[176:183], v61
    ds_read_b128 v[72:75], v63 offset:27648
    s_waitcnt lgkmcnt(6)
    v_smfmac_f32_16x16x64_bf16 v[28:31], v[12:15], a[184:191], v61
    v_permlane32_swap_b32 v24, v26
    v_smfmac_f32_16x16x64_bf16 v[32:35], v[0:3], a[192:199], v61
    v_permlane32_swap_b32 v25, v27
    v_smfmac_f32_16x16x64_bf16 v[32:35], v[4:7], a[200:207], v61
    v_cvt_pk_bf16_f32 v28, v28, v29
    v_smfmac_f32_16x16x64_bf16 v[32:35], v[8:11], a[208:215], v61
    v_cvt_pk_bf16_f32 v29, v30, v31
    v_smfmac_f32_16x16x64_bf16 v[32:35], v[12:15], a[216:223], v61
    v_add_f32 v24, v24, v26
    s_waitcnt lgkmcnt(4)
    v_smfmac_f32_16x16x64_bf16 v[16:19], v[4:7], v[36:43], v61
    v_add_f32 v25, v25, v27
    s_waitcnt lgkmcnt(2)
    v_smfmac_f32_16x16x64_bf16 v[16:19], v[8:11], v[44:51], v61
    v_cvt_pk_bf16_f32 v30, v32, v33
    v_cvt_pk_bf16_f32 v31, v34, v35
    s_waitcnt lgkmcnt(0)
    v_smfmac_f32_16x16x64_bf16 v[16:19], v[12:15], v[68:75], v61
    v_permlane16_swap_b32 v28, v30
    v_permlane16_swap_b32 v29, v31
    v_and_or_b32 v28, v28, -2, s49
    buffer_store_dwordx4 v[28:31], v62, s[8:11], s24 offen sc1
    v_smfmac_f32_16x16x64_bf16 v[20:23], v[0:3], a[224:231], v61
    s_nop 2
    v_cvt_pk_bf16_f32 v19, v18, v19
    v_cvt_pk_bf16_f32 v18, v16, v17
    v_smfmac_f32_16x16x64_bf16 v[20:23], v[4:7], a[232:239], v61
    v_cvt_pk_bf16_f32 v25, v24, v25
    v_smfmac_f32_16x16x64_bf16 v[20:23], v[8:11], a[240:247], v61
    v_mov_b32 v24, v25
    v_smfmac_f32_16x16x64_bf16 v[20:23], v[12:15], a[248:255], v61
    s_nop 0
    v_permlane32_swap_b32 v24, v25
    v_and_or_b32 v24, v24, -2, s49
    s_mov_b32 exec_hi, 0
    buffer_store_dwordx2 v[24:25], v67, s[8:11], s26 offen sc1
    s_mov_b32 exec_hi, -1
    s_nop 1
    v_cvt_pk_bf16_f32 v16, v20, v21
    v_cvt_pk_bf16_f32 v17, v22, v23
    s_nop 0
    v_permlane16_swap_b32 v16, v18
    v_permlane16_swap_b32 v17, v19
    v_and_or_b32 v16, v16, -2, s49
    buffer_store_dwordx4 v[16:19], v62, s[8:11], s25 offen sc1
    ds_read_b128 v[36:39], v77 offset:24576
    ds_read_b128 v[40:43], v77 offset:25600
    ds_read_b128 v[44:47], v77 offset:26624
    ds_read_b128 v[48:51], v77 offset:27648
    v_mov_b64 v[52:53], 0
    v_mov_b64 v[54:55], 0
    v_mov_b64 v[56:57], 0
    v_mov_b64 v[58:59], 0
    s_add_u32 s17, s17, 8192
    s_add_u32 s18, s18, 8192
    s_add_u32 s19, s19, 131072
    s_add_u32 s24, s24, s48
    s_add_u32 s25, s25, s48
    s_add_u32 s26, s26, s48
    s_add_u32 s27, s30, 2048
    s_add_u32 s28, s30, 6144
    s_add_u32 s16, s16, 1
    s_cmp_lt_u32 s3, 8
    s_cbranch_scc0 CH_s2_nh
    v_mov_b32 v35, 0x3f80
    v_cndmask_b32 v35, v35, 1.0, s[34:35]
    v_cndmask_b32 v32, 0, v35, s[56:57]
    v_cndmask_b32 v33, 0, v35, s[58:59]
    v_cndmask_b32 v34, 0, v35, s[60:61]
    v_cndmask_b32 v35, 0, v35, s[62:63]
    s_waitcnt vmcnt(1)
    buffer_load_dwordx4 v[0:3], v60, s[8:11], s20 offen sc1
    buffer_load_dwordx4 v[4:7], v60, s[8:11], s21 offen sc1
    buffer_load_dwordx4 v[8:11], v60, s[8:11], s22 offen sc1
    buffer_load_dwordx4 v[12:15], v60, s[8:11], s23 offen sc1
CH_s2_p1:
    s_waitcnt vmcnt(3)
    v_mfma_f32_16x16x32_bf16 v[68:71], v[0:3], v[32:35], 0
    v_bitop3_b32 v64, v0, v2, s49 bitop3:0x7e
    s_waitcnt vmcnt(2)
    v_mfma_f32_16x16x32_bf16 v[68:71], v[4:7], v[32:35], v[68:71]
    v_bitop3_b32 v65, v4, v6, s49 bitop3:0x7e
    v_or_b32 v64, v64, v65
    s_waitcnt vmcnt(1)
    v_mfma_f32_16x16x32_bf16 v[68:71], v[8:11], v[32:35], v[68:71]
    v_bitop3_b32 v65, v8, v10, s49 bitop3:0x7e
    v_or_b32 v64, v64, v65
    s_waitcnt vmcnt(0)
    v_mfma_f32_16x16x32_bf16 v[68:71], v[12:15], v[32:35], v[68:71]
    v_bitop3_b32 v65, v12, v14, s49 bitop3:0x7e
    v_bitop3_b32 v64, v64, v65, 1 bitop3:0xa8
    v_cmp_ne_u32 vcc, 0, v64
    s_cbranch_vccz CH_s2_p1_ok
    s_sub_u32 s41, s41, 1
    s_cbranch_scc1 CH_s2_p1_x
    buffer_load_dwordx4 v[0:3], v60, s[8:11], s20 offen sc1
    buffer_load_dwordx4 v[4:7], v60, s[8:11], s21 offen sc1
    buffer_load_dwordx4 v[8:11], v60, s[8:11], s22 offen sc1
    buffer_load_dwordx4 v[12:15], v60, s[8:11], s23 offen sc1
    s_branch CH_s2_p1
CH_s2_p1_x:
    s_mov_b32 s41, 0
CH_s2_p1_ok:
    s_nop 3
    v_add_f32 v68, v68, v69
    v_add_f32 v70, v70, v71
    s_mov_b64 exec, s[36:37]
    v_cvt_pk_bf16_f32 v68, v68, v70
    buffer_store_dword v68, v66, s[8:11], s5 offen sc1
    s_mov_b64 exec, -1
CH_s2_nh:
    s_waitcnt vmcnt(0)
    s_barrier
    s_cmp_lt_u32 s16, 64
    s_cbranch_scc1 CH_s2
    s_branch CH_END
CH_gos3:
    ds_read_b128 v[36:39], v77 offset:28672
    ds_read_b128 v[40:43], v77 offset:29696
    ds_read_b128 v[44:47], v77 offset:30720
    ds_read_b128 v[48:51], v77 offset:31744
CH_s3:
    buffer_load_dwordx4 v[32:35], v77, s[8:11], s29 offen sc1
    buffer_load_dwordx4 v[12:15], v77, s[8:11], s27 offen sc1
    buffer_load_dwordx4 v[28:31], v77, s[8:11], s28 offen sc1
    v_mov_b64 v[52:53], 0
    v_mov_b64 v[54:55], 0
    v_mov_b64 v[56:57], 0
    v_mov_b64 v[58:59], 0
    v_mov_b64 v[60:61], 0
    v_mov_b64 v[62:63], 0
    v_mov_b64 v[64:65], 0
    v_mov_b64 v[66:67], 0
    ds_read_b128 v[36:39], v77 offset:28672
    ds_read_b128 v[40:43], v77 offset:29696
    ds_read_b128 v[44:47], v77 offset:30720
    ds_read_b128 v[48:51], v77 offset:31744
    s_add_u32 s20, s20, s48
    s_add_u32 s21, s21, s48
    s_add_u32 s22, s22, s48
    s_add_u32 s23, s23, s48
    s_sub_u32 s48, 0, s48
    s_bfe_u32 s49, s16, 0x10001
    s_mov_b32 s42, s72
    s_mov_b32 s72, s30
    s_mov_b32 s30, s38
    s_mov_b32 s38, s42
    s_add_u32 s31, s38, s39
    s_add_u32 s5, s30, s6
    s_movk_i32 s50, 2048
    s_cmp_eq_u32 s16, 63
    s_cselect_b32 s50, -6144, s50
CH_s3_p2:
    s_waitcnt vmcnt(2)
    v_max3_u32 v68, v32, v33, v34
    v_max_u32 v68, v68, v35
    v_cmp_eq_u32 vcc, -1, v68
    s_cbranch_vccnz CH_s3_p2_f
    ds_write_b128 v77, v[32:35] offset:8192
    s_waitcnt vmcnt(1)
    ds_write_b128 v77, v[12:15] offset:3072
    v_max3_u32 v68, v12, v13, v14
    s_waitcnt vmcnt(0)
    ds_write_b128 v77, v[28:31] offset:7168
    v_max3_u32 v69, v28, v29, v30
    v_max3_u32 v68, v68, v15, v31
    v_max_u32 v68, v68, v69
    v_cmp_eq_u32 vcc, -1, v68
    s_cbranch_vccz CH_s3_p2_ok
CH_s3_p2_f:
    s_sub_u32 s41, s41, 1
    s_cbranch_scc1 CH_s3_p2_x
    buffer_load_dwordx4 v[32:35], v77, s[8:11], s29 offen sc1
    buffer_load_dwordx4 v[12:15], v77, s[8:11], s27 offen sc1
    buffer_load_dwordx4 v[28:31], v77, s[8:11], s28 offen sc1
    s_branch CH_s3_p2
CH_s3_p2_x:
    s_mov_b32 s41, 0
CH_s3_p2_ok:
    v_lshlrev_b32 v24, 3, v77
    v_mov_b32 v25, s16
    s_waitcnt lgkmcnt(5)
    v_smfmac_f32_16x16x64_bf16 v[52:55], v[32:35], v[36:43], v76
    ds_read_b128 v[36:39], v77 offset:45056
    s_waitcnt lgkmcnt(4)
    v_smfmac_f32_16x16x64_bf16 v[56:59], v[32:35], v[44:51], v76
    s_waitcnt lgkmcnt(1)
    s_barrier
    v_smfmac_f32_16x16x64_bf16 v[52:55], v[12:15], v[128:135], v76
    buffer_load_dwordx4 v[68:71], v77, s[8:11], s17 offen
    buffer_load_dwordx4 v[72:75], v77, s[8:11], s17 offen offset:1024
    s_movk_i32 m0, 9728
    s_add_u32 s43, s17, s50
    buffer_load_dword v24, s[8:11], s43 offen lds
    s_mov_b64 exec, s[54:55]
    buffer_store_dword v25, v24, s[8:11], s51 offen sc1
    s_mov_b64 exec, -1
    v_smfmac_f32_16x16x64_bf16 v[56:59], v[12:15], v[136:143], v76
    ds_read_b128 v[0:3], v77 offset:0
    v_smfmac_f32_16x16x64_bf16 v[52:55], v[28:31], v[192:199], v76
    ds_read_b128 v[40:43], v77 offset:46080
    v_smfmac_f32_16x16x64_bf16 v[56:59], v[28:31], v[200:207], v76
    ds_read_b128 v[44:47], v77 offset:47104
    v_smfmac_f32_16x16x64_bf16 v[60:63], v[32:35], a[48:55], v76
    ds_read_b128 v[48:51], v77 offset:48128
    v_smfmac_f32_16x16x64_bf16 v[64:67], v[32:35], a[56:63], v76
    ds_read_b128 v[4:7], v77 offset:1024
    s_waitcnt lgkmcnt(4)
    v_smfmac_f32_16x16x64_bf16 v[52:55], v[0:3], v[80:87], v76
    ds_read_b128 v[8:11], v77 offset:2048
    v_smfmac_f32_16x16x64_bf16 v[56:59], v[0:3], v[88:95], v76
    ds_read_b128 v[16:19], v77 offset:4096
    s_waitcnt lgkmcnt(5)
    v_smfmac_f32_16x16x64_bf16 v[60:63], v[12:15], v[36:43], v76
    ds_read_b128 v[36:39], v77 offset:61440
    s_waitcnt lgkmcnt(4)
    v_smfmac_f32_16x16x64_bf16 v[64:67], v[12:15], v[44:51], v76
    ds_read_b128 v[40:43], v77 offset:62464
    s_waitcnt lgkmcnt(4)
    v_smfmac_f32_16x16x64_bf16 v[52:55], v[4:7], v[96:103], v76
    ds_read_b128 v[44:47], v77 offset:63488
    v_smfmac_f32_16x16x64_bf16 v[56:59], v[4:7], v[104:111], v76
    ds_read_b128 v[48:51], v77 offset:64512
    s_waitcnt lgkmcnt(5)
    v_smfmac_f32_16x16x64_bf16 v[52:55], v[8:11], v[112:119], v76
    ds_read_b128 v[20:23], v77 offset:5120
    v_smfmac_f32_16x16x64_bf16 v[56:59], v[8:11], v[120:127], v76
    ds_read_b128 v[24:27], v77 offset:6144
    s_waitcnt lgkmcnt(6)
    v_smfmac_f32_16x16x64_bf16 v[52:55], v[16:19], v[144:151], v76
    v_smfmac_f32_16x16x64_bf16 v[56:59], v[16:19], v[152:159], v76
    s_waitcnt lgkmcnt(4)
    v_smfmac_f32_16x16x64_bf16 v[60:63], v[28:31], v[36:43], v76
    s_waitcnt lgkmcnt(2)
    v_smfmac_f32_16x16x64_bf16 v[64:67], v[28:31], v[44:51], v76
    v_add_u32 v51, 65536, v77
    s_waitcnt lgkmcnt(1)
    v_smfmac_f32_16x16x64_bf16 v[52:55], v[20:23], v[160:167], v76
    ds_read_b128 v[36:39], v51 offset:12288
    v_smfmac_f32_16x16x64_bf16 v[56:59], v[20:23], v[168:175], v76
    ds_read_b128 v[40:43], v51 offset:13312
    s_waitcnt lgkmcnt(2)
    v_smfmac_f32_16x16x64_bf16 v[52:55], v[24:27], v[176:183], v76
    ds_read_b128 v[44:47], v51 offset:14336
    v_smfmac_f32_16x16x64_bf16 v[56:59], v[24:27], v[184:191], v76
    ds_read_b128 v[48:51], v51 offset:15360
    v_smfmac_f32_16x16x64_bf16 v[60:63], v[0:3], v[208:215], v76
    v_add_f32 v52, v52, v53
    v_add_f32 v54, v54, v55
    v_cvt_pk_bf16_f32 v52, v52, v54
    s_nop 0
    v_add_f32 v56, v56, v57
    v_add_f32 v58, v58, v59
    v_cvt_pk_bf16_f32 v53, v56, v58
    v_smfmac_f32_16x16x64_bf16 v[60:63], v[4:7], v[224:231], v76
    s_nop 0
    v_mfma_f32_16x16x16_bf16 v[56:59], v[52:53], v[78:79], 0
    v_smfmac_f32_16x16x64_bf16 v[60:63], v[8:11], v[240:247], v76
    v_smfmac_f32_16x16x64_bf16 v[60:63], v[16:19], a[0:7], v76
    v_cvt_pk_bf16_f32 v54, v56, v57
    v_cvt_pk_bf16_f32 v55, v58, v59
    v_smfmac_f32_16x16x64_bf16 v[60:63], v[20:23], a[16:23], v76
    v_mov_b32_dpp v56, v54 quad_perm:[2,3,0,1] row_mask:0xf bank_mask:0xf
    v_mov_b32_dpp v57, v55 quad_perm:[2,3,0,1] row_mask:0xf bank_mask:0xf
    v_smfmac_f32_16x16x64_bf16 v[60:63], v[24:27], a[32:39], v76
    s_waitcnt vmcnt(3)
    v_mfma_f32_16x16x32_bf16 v[68:71], v[68:71], v[54:57], 0
    s_waitcnt vmcnt(2)
    v_mfma_f32_16x16x32_bf16 v[72:75], v[72:75], v[54:57], 0
    v_add_f32 v60, v60, v61
    v_add_f32 v62, v62, v63
    v_smfmac_f32_16x16x64_bf16 v[64:67], v[0:3], v[216:223], v76
    v_cvt_pk_bf16_f32 v60, v60, v62
    v_smfmac_f32_16x16x64_bf16 v[64:67], v[4:7], v[232:239], v76
    v_cndmask_b32 v68, v72, v68, s[32:33]
    v_cndmask_b32 v69, v73, v69, s[32:33]
    v_cndmask_b32 v70, v74, v70, s[32:33]
    v_cndmask_b32 v71, v75, v71, s[32:33]
    ds_write_b128 v77, v[68:71] offset:13312
    v_mov_b64 v[68:69], 0
    v_mov_b64 v[70:71], 0
    v_smfmac_f32_16x16x64_bf16 v[64:67], v[8:11], v[248:255], v76
    v_mov_b64 v[72:73], 0
    v_mov_b64 v[74:75], 0
    v_smfmac_f32_16x16x64_bf16 v[64:67], v[16:19], a[8:15], v76
    v_smfmac_f32_16x16x64_bf16 v[64:67], v[20:23], a[24:31], v76
    v_smfmac_f32_16x16x64_bf16 v[64:67], v[24:27], a[40:47], v76
    s_waitcnt lgkmcnt(3)
    v_smfmac_f32_16x16x64_bf16 v[68:71], v[4:7], v[36:43], v76
    s_waitcnt lgkmcnt(1)
    v_smfmac_f32_16x16x64_bf16 v[72:75], v[4:7], v[44:51], v76
    v_add_f32 v64, v64, v65
    v_add_f32 v66, v66, v67
    v_cvt_pk_bf16_f32 v61, v64, v66
    v_add_u32 v51, 65536, v77
    ds_read_b128 v[36:39], v51 offset:28672
    v_mfma_f32_16x16x16_bf16 v[64:67], v[60:61], v[78:79], 0
    ds_read_b128 v[40:43], v51 offset:29696
    ds_read_b128 v[44:47], v51 offset:30720
    ds_read_b128 v[48:51], v51 offset:31744
    v_smfmac_f32_16x16x64_bf16 v[68:71], v[0:3], a[64:71], v76
    v_smfmac_f32_16x16x64_bf16 v[72:75], v[0:3], a[72:79], v76
    v_cvt_pk_bf16_f32 v62, v64, v65
    v_cvt_pk_bf16_f32 v63, v66, v67
    v_smfmac_f32_16x16x64_bf16 v[68:71], v[8:11], a[80:87], v76
    v_mov_b32_dpp v64, v62 quad_perm:[2,3,0,1] row_mask:0xf bank_mask:0xf
    v_mov_b32_dpp v65, v63 quad_perm:[2,3,0,1] row_mask:0xf bank_mask:0xf
    s_nop 1
    v_mfma_f32_16x16x32_bf16 v[58:61], v[62:65], v[54:57], 0
    buffer_load_dwordx4 v[52:55], v77, s[8:11], s18 offen
    v_smfmac_f32_16x16x64_bf16 v[72:75], v[8:11], a[88:95], v76
    s_waitcnt lgkmcnt(2)
    v_smfmac_f32_16x16x64_bf16 v[68:71], v[12:15], v[36:43], v76
    v_cndmask_b32 v58, v61, v58, s[32:33]
    ds_write_b32 v77, v58 offset:14348
    buffer_load_dwordx4 v[56:59], v77, s[8:11], s18 offen offset:1024
    s_waitcnt lgkmcnt(1)
    v_smfmac_f32_16x16x64_bf16 v[72:75], v[12:15], v[44:51], v76
    v_add_u32 v51, 65536, v77
    v_smfmac_f32_16x16x64_bf16 v[68:71], v[16:19], a[96:103], v76
    ds_read_b128 v[36:39], v51 offset:45056
    v_smfmac_f32_16x16x64_bf16 v[72:75], v[16:19], a[104:111], v76
    ds_read_b128 v[40:43], v51 offset:46080
    v_smfmac_f32_16x16x64_bf16 v[68:71], v[24:27], a[112:119], v76
    ds_read_b128 v[44:47], v51 offset:47104
    s_waitcnt lgkmcnt(3)
    s_barrier
    v_smfmac_f32_16x16x64_bf16 v[72:75], v[24:27], a[120:127], v76
    ds_read_b128 v[16:19], v77 offset:14336
    ds_read_b128 v[0:3], v77 offset:10240
    ds_read_b128 v[4:7], v77 offset:11264
    ds_read_b128 v[8:11], v77 offset:12288
    ds_read_b128 v[12:15], v77 offset:13312
    v_smfmac_f32_16x16x64_bf16 v[68:71], v[32:35], a[144:151], v76
    ds_read_b128 v[48:51], v51 offset:48128
    v_smfmac_f32_16x16x64_bf16 v[72:75], v[32:35], a[152:159], v76
    v_lshlrev_b32 v33, 3, v77
    s_movk_i32 m0, 3072
    s_add_u32 s43, s18, s50
    buffer_load_dword v33, s[8:11], s43 offen lds
    v_smfmac_f32_16x16x64_bf16 v[68:71], v[28:31], a[128:135], v76
    s_waitcnt lgkmcnt(5)
    v_add_f32 v16, v16, v17
    v_add_f32 v18, v18, v19
    v_smfmac_f32_16x16x64_bf16 v[72:75], v[28:31], a[136:143], v76
    ds_read_b64 v[66:67], v77 offset:15368
    v_smfmac_f32_16x16x64_bf16 v[68:71], v[20:23], v[36:43], v76
    s_waitcnt lgkmcnt(4)
    v_add_f32 v0, v0, v4
    v_add_f32 v1, v1, v5
    v_add_f32 v2, v2, v6
    v_add_f32 v3, v3, v7
    v_add_f32 v4, v16, v18
    v_cndmask_b32 v16, 16, 0, s[32:33]
    ds_read_b64 v[60:61], v77 offset:15360
    s_waitcnt lgkmcnt(3)
    v_add_f32 v8, v8, v12
    v_add_f32 v9, v9, v13
    v_add_f32 v10, v10, v14
    v_add_f32 v11, v11, v15
    v_add_f32 v0, v0, v8
    v_add_f32 v1, v1, v9
    v_add_f32 v2, v2, v10
    v_add_f32 v3, v3, v11
    v_max3_f32 v5, v0, v1, v4
    v_max3_f32 v5, v5, v2, v3
    v_mov_b32 v9, 0
    v_mov_b32 v10, 0
    v_max_f32_dpp v5, v5, v5 quad_perm:[2,3,0,1] row_mask:0xf bank_mask:0xf
    v_mov_b32 v6, v5
    s_waitcnt lgkmcnt(2)
    v_smfmac_f32_16x16x64_bf16 v[72:75], v[20:23], v[44:51], v76
    v_permlane16_swap_b32 v5, v6
    v_max_f32 v5, v5, v6
    v_mov_b32 v6, v5
    v_add_f32 v68, v68, v69
    v_add_f32 v70, v70, v71
    v_permlane32_swap_b32 v5, v6
    v_max_f32 v5, v5, v6
    v_mul_f32 v5, s40, v5
    v_fma_f32 v0, v0, s40, -v5
    v_fma_f32 v1, v1, s40, -v5
    v_fma_f32 v2, v2, s40, -v5
    v_fma_f32 v3, v3, s40, -v5
    v_exp_f32 v0, v0
    v_exp_f32 v1, v1
    v_fma_f32 v4, v4, s40, -v5
    v_exp_f32 v2, v2
    v_exp_f32 v3, v3
    v_exp_f32 v4, v4
    v_cvt_pk_bf16_f32 v5, v0, v1
    v_cvt_pk_bf16_f32 v6, v2, v3
    v_add_f32 v0, v0, v1
    v_add_f32 v2, v2, v3
    v_add_f32 v0, v0, v4
    v_cndmask_b32 v12, 0, v5, s[32:33]
    v_cndmask_b32 v13, 0, v6, s[32:33]
    v_cndmask_b32 v14, v5, 0, s[32:33]
    v_cndmask_b32 v15, v6, 0, s[32:33]
    v_add_f32 v0, v0, v2
    v_add_f32 v72, v72, v73
    v_add_f32 v74, v74, v75
    v_cvt_pk_bf16_f32 v7, v4, 0
    s_waitcnt vmcnt(2)
    v_mfma_f32_16x16x32_bf16 v[52:55], v[52:55], v[12:15], 0
    v_add_f32_dpp v0, v0, v0 quad_perm:[2,3,0,1] row_mask:0xf bank_mask:0xf
    v_cvt_pk_bf16_f32 v64, v68, v74
    s_waitcnt vmcnt(1)
    v_mfma_f32_16x16x32_bf16 v[56:59], v[56:59], v[12:15], 0
    v_cvt_pk_bf16_f32 v65, v72, v70
    buffer_store_dwordx4 v[62:65], v77, s[8:11], s19 offen sc1
    s_cmp_eq_u32 s16, 63
    s_cbranch_scc1 CH_END
    v_lshlrev_b32 v8, v16, v7
    v_lshlrev_b32 v11, v16, v7
    v_mov_b32 v1, v0
    v_mfma_f32_16x16x16_bf16 v[52:55], v[64:65], v[8:9], v[52:55]
    s_waitcnt lgkmcnt(0)
    v_and_b32 v17, 0xffff, v60
    v_permlane16_swap_b32 v0, v1
    v_mfma_f32_16x16x16_bf16 v[56:59], v[64:65], v[10:11], v[56:59]
    v_add_f32 v0, v0, v1
    v_mov_b32 v1, v0
    v_and_b32 v14, 0xffff, v61
    v_and_b32 v15, 0x80, v77
    v_permlane32_swap_b32 v0, v1
    v_add_f32 v0, v0, v1
    v_rcp_f32 v0, v0
    s_nop 0
    v_add_f32_dpp v52, v56, v52 quad_perm:[2,3,0,1] row_mask:0xf bank_mask:0xf
    v_add_f32_dpp v53, v57, v53 quad_perm:[2,3,0,1] row_mask:0xf bank_mask:0xf
    v_add_f32_dpp v54, v58, v54 quad_perm:[2,3,0,1] row_mask:0xf bank_mask:0xf
    v_add_f32_dpp v55, v59, v55 quad_perm:[2,3,0,1] row_mask:0xf bank_mask:0xf
    v_mul_f32 v52, v52, v0
    v_mul_f32 v53, v53, v0
    v_mul_f32 v54, v54, v0
    v_mul_f32 v55, v55, v0
    v_cvt_pk_bf16_f32 v52, v52, v53
    v_cvt_pk_bf16_f32 v53, v54, v55
    ds_write_b64 v17, v[52:53] offset:9728
    v_lshl_add_u32 v15, v15, 3, v14
    v_add_u32 v51, 65536, v77
    ds_read_b128 v[36:39], v51 offset:61440
    ds_read_b128 v[40:43], v51 offset:62464
    ds_read_b128 v[44:47], v51 offset:63488
    ds_read_b128 v[48:51], v51 offset:64512
    v_add_u32 v63, 131072, v77
    ds_read_b128 v[68:71], v63 offset:12288
    ds_read_b128 v[72:75], v63 offset:13312
    v_lshrrev_b32 v61, 16, v61
    v_mov_b64 v[24:25], 0
    v_mov_b64 v[26:27], 0
    v_mov_b64 v[16:17], 0
    v_mov_b64 v[18:19], 0
    v_and_b32 v62, 0xffff, v66
    v_mov_b64 v[28:29], 0
    v_mov_b64 v[30:31], 0
    v_mov_b64 v[32:33], 0
    v_mov_b64 v[34:35], 0
    v_mov_b64 v[20:21], 0
    v_mov_b64 v[22:23], 0
    s_waitcnt lgkmcnt(6)
    s_barrier
    v_lshrrev_b32 v60, 12, v60
    v_lshrrev_b32 v66, 16, v66
    ds_read_b128 v[52:55], v15 offset:8192
    ds_read_b128 v[56:59], v15 offset:8704
    ds_read_b128 v[0:3], v14 offset:8192
    ds_read_b128 v[4:7], v14 offset:8704
    ds_read_b128 v[8:11], v14 offset:9216
    ds_read_b128 v[12:15], v14 offset:9728
    s_waitcnt lgkmcnt(5)
    v_smfmac_f32_16x16x64_bf16 v[24:27], v[52:55], v[36:43], v61
    ds_read_b128 v[36:39], v63 offset:14336
    s_waitcnt lgkmcnt(5)
    v_smfmac_f32_16x16x64_bf16 v[24:27], v[56:59], v[44:51], v61
    ds_read_b128 v[40:43], v63 offset:15360
    s_waitcnt lgkmcnt(5)
    v_smfmac_f32_16x16x64_bf16 v[16:19], v[0:3], v[68:75], v61
    ds_read_b128 v[44:47], v63 offset:28672
    v_smfmac_f32_16x16x64_bf16 v[28:31], v[0:3], a[160:167], v61
    ds_read_b128 v[48:51], v63 offset:29696
    s_waitcnt lgkmcnt(6)
    v_smfmac_f32_16x16x64_bf16 v[28:31], v[4:7], a[168:175], v61
    ds_read_b128 v[68:71], v63 offset:30720
    s_waitcnt lgkmcnt(6)
    v_smfmac_f32_16x16x64_bf16 v[28:31], v[8:11], a[176:183], v61
    ds_read_b128 v[72:75], v63 offset:31744
    s_waitcnt lgkmcnt(6)
    v_smfmac_f32_16x16x64_bf16 v[28:31], v[12:15], a[184:191], v61
    v_permlane32_swap_b32 v24, v26
    v_smfmac_f32_16x16x64_bf16 v[32:35], v[0:3], a[192:199], v61
    v_permlane32_swap_b32 v25, v27
    v_smfmac_f32_16x16x64_bf16 v[32:35], v[4:7], a[200:207], v61
    v_cvt_pk_bf16_f32 v28, v28, v29
    v_smfmac_f32_16x16x64_bf16 v[32:35], v[8:11], a[208:215], v61
    v_cvt_pk_bf16_f32 v29, v30, v31
    v_smfmac_f32_16x16x64_bf16 v[32:35], v[12:15], a[216:223], v61
    v_add_f32 v24, v24, v26
    s_waitcnt lgkmcnt(4)
    v_smfmac_f32_16x16x64_bf16 v[16:19], v[4:7], v[36:43], v61
    v_add_f32 v25, v25, v27
    s_waitcnt lgkmcnt(2)
    v_smfmac_f32_16x16x64_bf16 v[16:19], v[8:11], v[44:51], v61
    v_cvt_pk_bf16_f32 v30, v32, v33
    v_cvt_pk_bf16_f32 v31, v34, v35
    s_waitcnt lgkmcnt(0)
    v_smfmac_f32_16x16x64_bf16 v[16:19], v[12:15], v[68:75], v61
    v_permlane16_swap_b32 v28, v30
    v_permlane16_swap_b32 v29, v31
    v_and_or_b32 v28, v28, -2, s49
    buffer_store_dwordx4 v[28:31], v62, s[8:11], s24 offen sc1
    v_smfmac_f32_16x16x64_bf16 v[20:23], v[0:3], a[224:231], v61
    s_nop 2
    v_cvt_pk_bf16_f32 v19, v18, v19
    v_cvt_pk_bf16_f32 v18, v16, v17
    v_smfmac_f32_16x16x64_bf16 v[20:23], v[4:7], a[232:239], v61
    v_cvt_pk_bf16_f32 v25, v24, v25
    v_smfmac_f32_16x16x64_bf16 v[20:23], v[8:11], a[240:247], v61
    v_mov_b32 v24, v25
    v_smfmac_f32_16x16x64_bf16 v[20:23], v[12:15], a[248:255], v61
    s_nop 0
    v_permlane32_swap_b32 v24, v25
    v_and_or_b32 v24, v24, -2, s49
    s_mov_b32 exec_hi, 0
    buffer_store_dwordx2 v[24:25], v67, s[8:11], s26 offen sc1
    s_mov_b32 exec_hi, -1
    s_nop 1
    v_cvt_pk_bf16_f32 v16, v20, v21
    v_cvt_pk_bf16_f32 v17, v22, v23
    s_nop 0
    v_permlane16_swap_b32 v16, v18
    v_permlane16_swap_b32 v17, v19
    v_and_or_b32 v16, v16, -2, s49
    buffer_store_dwordx4 v[16:19], v62, s[8:11], s25 offen sc1
    s_add_u32 s17, s17, 8192
    s_add_u32 s18, s18, 8192
    s_add_u32 s19, s19, 131072
    s_add_u32 s24, s24, s48
    s_add_u32 s25, s25, s48
    s_add_u32 s26, s26, s48
    s_add_u32 s27, s30, 3072
    s_add_u32 s28, s30, 7168
    s_add_u32 s29, s30, 8192
    s_add_u32 s16, s16, 1
    s_and_b32 s42, s16, 7
    s_cmp_lg_u32 s42, 7
    s_cbranch_scc1 CH_s3_nk
    s_cmp_ge_u32 s16, 63
    s_cbranch_scc1 CH_s3_nk
    s_add_u32 s42, s16, 1
    s_lshr_b32 s42, s42, 3
    s_lshl_b32 s43, s42, 4
    s_lshr_b32 s44, s3, 1
    s_add_u32 s43, s43, s44
    s_lshl_b32 s43, s43, 7
    s_add_u32 s43, s43, 117273600
    s_load_dwordx2 s[44:45], s[8:9], s43
    s_waitcnt lgkmcnt(0)
    s_cmp_lt_u32 s44, 2
    s_cbranch_scc1 CH_s3_ks
    s_cmp_ge_u32 s45, 2
    s_cbranch_scc1 CH_s3_nk
CH_s3_ks:
    s_lshl_b32 s42, s42, 4
    s_lshr_b32 s43, s3, 1
    s_add_u32 s42, s42, s43
    s_lshl_b32 s42, s42, 7
    s_add_u32 s42, s42, 117273600
    v_lshrrev_b32 v1, 2, v77
    s_mov_b64 exec, 3
CH_s3_kv:
    buffer_load_dword v0, v1, s[8:11], s42 offen sc1
    s_waitcnt vmcnt(0)
    v_cmp_gt_u32 vcc, 2, v0
    s_cbranch_vccz CH_s3_kv_ok
    s_sub_u32 s41, s41, 1
    s_cbranch_scc0 CH_s3_kv
    s_mov_b32 s41, 0
CH_s3_kv_ok:
    s_mov_b64 exec, -1
CH_s3_nk:
    s_barrier
    s_cmp_lt_u32 s16, 64
    s_cbranch_scc1 CH_s3
    s_branch CH_END
CH_END:
    s_waitcnt vmcnt(0) lgkmcnt(0)
    s_barrier
    s_memtime s[74:75]
    s_cmp_lg_u32 s4, 0
    s_cbranch_scc1 CH_X
    v_mov_b32 v0, s16
    v_mov_b32 v1, 0
    v_mov_b32 v2, 1
    s_mov_b64 exec, 1
    buffer_atomic_add v2, v1, s[76:79], 0 offen offset:12 sc1
    s_waitcnt lgkmcnt(0)
CH_X:
    s_endpgm
W_go:
    s_and_b32 s80, s2, 7
    s_lshr_b32 s81, s2, 3
    s_load_dwordx2 s[84:85], s[0:1], 88
    s_mov_b32 s86, 256
    s_mov_b32 s87, 0x00020000
    s_load_dwordx2 s[8:9], s[0:1], 96
    s_load_dwordx2 s[16:17], s[0:1], 0
    s_load_dwordx2 s[20:21], s[0:1], 80
    s_load_dwordx2 s[24:25], s[0:1], 16
    s_load_dwordx2 s[26:27], s[0:1], 24
    s_load_dwordx2 s[28:29], s[0:1], 32
    s_load_dwordx2 s[30:31], s[0:1], 64
    s_load_dwordx2 s[32:33], s[0:1], 72
    s_load_dwordx2 s[34:35], s[0:1], 40
    s_mov_b32 s10, 268435456
    s_mov_b32 s11, 0x00020000
    s_mov_b32 s18, 2359296
    s_mov_b32 s19, 0x00020000
    s_mov_b32 s22, 2359296
    s_mov_b32 s23, 0x00020000
    s_mov_b32 s15, 0x00020000
    v_lshrrev_b32 v1, 6, v0
    s_nop 0
    v_readfirstlane_b32 s3, v1
    s_waitcnt lgkmcnt(0)
    s_mov_b32 s83, 200000
    s_cmp_ge_u32 s80, 3
    s_cselect_b32 s82, 1, 0
    s_sub_u32 s92, s80, 1
    s_lshl_b32 s92, s92, 5
    s_add_u32 s92, s92, s81
    s_cmp_lt_u32 s92, 128
    s_cbranch_scc0 W_noln
    s_mov_b32 s60, s92
    v_and_b32 v1, 63, v0
    v_and_b32 v2, 15, v1
    v_lshrrev_b32 v3, 4, v1
    s_lshl_b32 s40, s60, 4
    v_add_u32 v4, s40, v2
    v_mul_u32_u24 v4, 1152, v4
    v_lshl_add_u32 v4, v3, 4, v4
    s_lshl_b32 s41, s3, 6
    v_add_u32 v4, s41, v4
    v_lshlrev_b32 v5, 4, v1
    v_lshlrev_b32 v6, 4, v2
    s_lshl_b32 s41, s3, 2
    v_add_u32 v7, s41, v6
    s_mul_i32 s42, s60, 18432
    s_lshl_b32 s41, s3, 10
    s_add_u32 s42, s42, s41
    s_add_u32 s42, s42, 0
    s_cmp_ge_u32 s3, 2
    s_cbranch_scc1 LN_4
    buffer_load_dwordx4 v[8:11], v4, s[16:19], 0 offen offset:0
    buffer_load_dwordx4 v[12:15], v4, s[16:19], 0 offen offset:256
    buffer_load_dwordx4 v[16:19], v4, s[16:19], 0 offen offset:512
    buffer_load_dwordx4 v[20:23], v4, s[16:19], 0 offen offset:768
    buffer_load_dwordx4 v[24:27], v4, s[16:19], 0 offen offset:1024
    s_waitcnt vmcnt(4)
    v_lshlrev_b32 v32, 16, v8
    v_and_b32 v33, 0xffff0000, v8
    v_lshlrev_b32 v34, 16, v9
    v_and_b32 v35, 0xffff0000, v9
    v_lshlrev_b32 v36, 16, v10
    v_and_b32 v37, 0xffff0000, v10
    v_lshlrev_b32 v38, 16, v11
    v_and_b32 v39, 0xffff0000, v11
    s_waitcnt vmcnt(3)
    v_lshlrev_b32 v40, 16, v12
    v_and_b32 v41, 0xffff0000, v12
    v_lshlrev_b32 v42, 16, v13
    v_and_b32 v43, 0xffff0000, v13
    v_lshlrev_b32 v44, 16, v14
    v_and_b32 v45, 0xffff0000, v14
    v_lshlrev_b32 v46, 16, v15
    v_and_b32 v47, 0xffff0000, v15
    s_waitcnt vmcnt(2)
    v_lshlrev_b32 v48, 16, v16
    v_and_b32 v49, 0xffff0000, v16
    v_lshlrev_b32 v50, 16, v17
    v_and_b32 v51, 0xffff0000, v17
    v_lshlrev_b32 v52, 16, v18
    v_and_b32 v53, 0xffff0000, v18
    v_lshlrev_b32 v54, 16, v19
    v_and_b32 v55, 0xffff0000, v19
    s_waitcnt vmcnt(1)
    v_lshlrev_b32 v56, 16, v20
    v_and_b32 v57, 0xffff0000, v20
    v_lshlrev_b32 v58, 16, v21
    v_and_b32 v59, 0xffff0000, v21
    v_lshlrev_b32 v60, 16, v22
    v_and_b32 v61, 0xffff0000, v22
    v_lshlrev_b32 v62, 16, v23
    v_and_b32 v63, 0xffff0000, v23
    s_waitcnt vmcnt(0)
    v_lshlrev_b32 v64, 16, v24
    v_and_b32 v65, 0xffff0000, v24
    v_lshlrev_b32 v66, 16, v25
    v_and_b32 v67, 0xffff0000, v25
    v_lshlrev_b32 v68, 16, v26
    v_and_b32 v69, 0xffff0000, v26
    v_lshlrev_b32 v70, 16, v27
    v_and_b32 v71, 0xffff0000, v27
    v_add_f32 v72, v32, v33
    v_add_f32 v73, v34, v35
    v_add_f32 v72, v72, v36
    v_add_f32 v73, v73, v37
    v_add_f32 v72, v72, v38
    v_add_f32 v73, v73, v39
    v_add_f32 v72, v72, v40
    v_add_f32 v73, v73, v41
    v_add_f32 v72, v72, v42
    v_add_f32 v73, v73, v43
    v_add_f32 v72, v72, v44
    v_add_f32 v73, v73, v45
    v_add_f32 v72, v72, v46
    v_add_f32 v73, v73, v47
    v_add_f32 v72, v72, v48
    v_add_f32 v73, v73, v49
    v_add_f32 v72, v72, v50
    v_add_f32 v73, v73, v51
    v_add_f32 v72, v72, v52
    v_add_f32 v73, v73, v53
    v_add_f32 v72, v72, v54
    v_add_f32 v73, v73, v55
    v_add_f32 v72, v72, v56
    v_add_f32 v73, v73, v57
    v_add_f32 v72, v72, v58
    v_add_f32 v73, v73, v59
    v_add_f32 v72, v72, v60
    v_add_f32 v73, v73, v61
    v_add_f32 v72, v72, v62
    v_add_f32 v73, v73, v63
    v_add_f32 v72, v72, v64
    v_add_f32 v73, v73, v65
    v_add_f32 v72, v72, v66
    v_add_f32 v73, v73, v67
    v_add_f32 v72, v72, v68
    v_add_f32 v73, v73, v69
    v_add_f32 v72, v72, v70
    v_add_f32 v73, v73, v71
    v_add_f32 v72, v72, v73
    v_mov_b32 v74, v72
    s_nop 1
    v_permlane16_swap_b32 v72, v74
    v_add_f32 v72, v72, v74
    v_mov_b32 v74, v72
    s_nop 1
    v_permlane32_swap_b32 v72, v74
    v_add_f32 v72, v72, v74
    ds_write_b32 v7, v72
    s_waitcnt lgkmcnt(0)
    s_barrier
    ds_read_b128 v[76:79], v6
    s_waitcnt lgkmcnt(0)
    v_add_f32 v76, v76, v77
    v_add_f32 v78, v78, v79
    v_add_f32 v76, v76, v78
    v_mul_f32 v76, 0x3ae38e39, v76
    v_sub_f32 v74, v32, v76
    v_mul_f32 v72, v74, v74
    v_sub_f32 v75, v33, v76
    v_mul_f32 v73, v75, v75
    v_sub_f32 v74, v34, v76
    v_sub_f32 v75, v35, v76
    v_fmac_f32 v72, v74, v74
    v_fmac_f32 v73, v75, v75
    v_sub_f32 v74, v36, v76
    v_sub_f32 v75, v37, v76
    v_fmac_f32 v72, v74, v74
    v_fmac_f32 v73, v75, v75
    v_sub_f32 v74, v38, v76
    v_sub_f32 v75, v39, v76
    v_fmac_f32 v72, v74, v74
    v_fmac_f32 v73, v75, v75
    v_sub_f32 v74, v40, v76
    v_sub_f32 v75, v41, v76
    v_fmac_f32 v72, v74, v74
    v_fmac_f32 v73, v75, v75
    v_sub_f32 v74, v42, v76
    v_sub_f32 v75, v43, v76
    v_fmac_f32 v72, v74, v74
    v_fmac_f32 v73, v75, v75
    v_sub_f32 v74, v44, v76
    v_sub_f32 v75, v45, v76
    v_fmac_f32 v72, v74, v74
    v_fmac_f32 v73, v75, v75
    v_sub_f32 v74, v46, v76
    v_sub_f32 v75, v47, v76
    v_fmac_f32 v72, v74, v74
    v_fmac_f32 v73, v75, v75
    v_sub_f32 v74, v48, v76
    v_sub_f32 v75, v49, v76
    v_fmac_f32 v72, v74, v74
    v_fmac_f32 v73, v75, v75
    v_sub_f32 v74, v50, v76
    v_sub_f32 v75, v51, v76
    v_fmac_f32 v72, v74, v74
    v_fmac_f32 v73, v75, v75
    v_sub_f32 v74, v52, v76
    v_sub_f32 v75, v53, v76
    v_fmac_f32 v72, v74, v74
    v_fmac_f32 v73, v75, v75
    v_sub_f32 v74, v54, v76
    v_sub_f32 v75, v55, v76
    v_fmac_f32 v72, v74, v74
    v_fmac_f32 v73, v75, v75
    v_sub_f32 v74, v56, v76
    v_sub_f32 v75, v57, v76
    v_fmac_f32 v72, v74, v74
    v_fmac_f32 v73, v75, v75
    v_sub_f32 v74, v58, v76
    v_sub_f32 v75, v59, v76
    v_fmac_f32 v72, v74, v74
    v_fmac_f32 v73, v75, v75
    v_sub_f32 v74, v60, v76
    v_sub_f32 v75, v61, v76
    v_fmac_f32 v72, v74, v74
    v_fmac_f32 v73, v75, v75
    v_sub_f32 v74, v62, v76
    v_sub_f32 v75, v63, v76
    v_fmac_f32 v72, v74, v74
    v_fmac_f32 v73, v75, v75
    v_sub_f32 v74, v64, v76
    v_sub_f32 v75, v65, v76
    v_fmac_f32 v72, v74, v74
    v_fmac_f32 v73, v75, v75
    v_sub_f32 v74, v66, v76
    v_sub_f32 v75, v67, v76
    v_fmac_f32 v72, v74, v74
    v_fmac_f32 v73, v75, v75
    v_sub_f32 v74, v68, v76
    v_sub_f32 v75, v69, v76
    v_fmac_f32 v72, v74, v74
    v_fmac_f32 v73, v75, v75
    v_sub_f32 v74, v70, v76
    v_sub_f32 v75, v71, v76
    v_fmac_f32 v72, v74, v74
    v_fmac_f32 v73, v75, v75
    v_add_f32 v72, v72, v73
    v_mov_b32 v74, v72
    s_nop 1
    v_permlane16_swap_b32 v72, v74
    v_add_f32 v72, v72, v74
    v_mov_b32 v74, v72
    s_nop 1
    v_permlane32_swap_b32 v72, v74
    v_add_f32 v72, v72, v74
    ds_write_b32 v7, v72 offset:256
    s_waitcnt lgkmcnt(0)
    s_barrier
    ds_read_b128 v[80:83], v6 offset:256
    s_waitcnt lgkmcnt(0)
    v_add_f32 v80, v80, v81
    v_add_f32 v82, v82, v83
    v_add_f32 v80, v80, v82
    v_mul_f32 v80, 0x3ae38e39, v80
    v_cvt_pk_bf16_f32 v77, v76, v80
    v_lshlrev_b32 v76, 16, v77
    v_and_b32 v80, 0xffff0000, v77
    v_add_f32 v80, 0x3727c5ac, v80
    v_cvt_pk_bf16_f32 v80, v80, v80
    v_and_b32 v80, 0xffff0000, v80
    v_sqrt_f32 v80, v80
    s_nop 0
    v_cvt_pk_bf16_f32 v80, v80, v80
    v_and_b32 v80, 0xffff0000, v80
    v_rcp_f32 v80, v80
    v_sub_f32 v32, v32, v76
    v_sub_f32 v33, v33, v76
    v_cvt_pk_bf16_f32 v32, v32, v33
    v_and_b32 v33, 0xffff0000, v32
    v_lshlrev_b32 v32, 16, v32
    v_mul_f32 v32, v32, v80
    v_mul_f32 v33, v33, v80
    v_cvt_pk_bf16_f32 v8, v32, v33
    v_sub_f32 v34, v34, v76
    v_sub_f32 v35, v35, v76
    v_cvt_pk_bf16_f32 v34, v34, v35
    v_and_b32 v35, 0xffff0000, v34
    v_lshlrev_b32 v34, 16, v34
    v_mul_f32 v34, v34, v80
    v_mul_f32 v35, v35, v80
    v_cvt_pk_bf16_f32 v9, v34, v35
    v_sub_f32 v36, v36, v76
    v_sub_f32 v37, v37, v76
    v_cvt_pk_bf16_f32 v36, v36, v37
    v_and_b32 v37, 0xffff0000, v36
    v_lshlrev_b32 v36, 16, v36
    v_mul_f32 v36, v36, v80
    v_mul_f32 v37, v37, v80
    v_cvt_pk_bf16_f32 v10, v36, v37
    v_sub_f32 v38, v38, v76
    v_sub_f32 v39, v39, v76
    v_cvt_pk_bf16_f32 v38, v38, v39
    v_and_b32 v39, 0xffff0000, v38
    v_lshlrev_b32 v38, 16, v38
    v_mul_f32 v38, v38, v80
    v_mul_f32 v39, v39, v80
    v_cvt_pk_bf16_f32 v11, v38, v39
    s_add_u32 s41, s42, 0
    buffer_store_dwordx4 v[8:11], v5, s[8:11], s41 offen sc1
    v_sub_f32 v40, v40, v76
    v_sub_f32 v41, v41, v76
    v_cvt_pk_bf16_f32 v40, v40, v41
    v_and_b32 v41, 0xffff0000, v40
    v_lshlrev_b32 v40, 16, v40
    v_mul_f32 v40, v40, v80
    v_mul_f32 v41, v41, v80
    v_cvt_pk_bf16_f32 v12, v40, v41
    v_sub_f32 v42, v42, v76
    v_sub_f32 v43, v43, v76
    v_cvt_pk_bf16_f32 v42, v42, v43
    v_and_b32 v43, 0xffff0000, v42
    v_lshlrev_b32 v42, 16, v42
    v_mul_f32 v42, v42, v80
    v_mul_f32 v43, v43, v80
    v_cvt_pk_bf16_f32 v13, v42, v43
    v_sub_f32 v44, v44, v76
    v_sub_f32 v45, v45, v76
    v_cvt_pk_bf16_f32 v44, v44, v45
    v_and_b32 v45, 0xffff0000, v44
    v_lshlrev_b32 v44, 16, v44
    v_mul_f32 v44, v44, v80
    v_mul_f32 v45, v45, v80
    v_cvt_pk_bf16_f32 v14, v44, v45
    v_sub_f32 v46, v46, v76
    v_sub_f32 v47, v47, v76
    v_cvt_pk_bf16_f32 v46, v46, v47
    v_and_b32 v47, 0xffff0000, v46
    v_lshlrev_b32 v46, 16, v46
    v_mul_f32 v46, v46, v80
    v_mul_f32 v47, v47, v80
    v_cvt_pk_bf16_f32 v15, v46, v47
    s_add_u32 s41, s42, 4096
    buffer_store_dwordx4 v[12:15], v5, s[8:11], s41 offen sc1
    v_sub_f32 v48, v48, v76
    v_sub_f32 v49, v49, v76
    v_cvt_pk_bf16_f32 v48, v48, v49
    v_and_b32 v49, 0xffff0000, v48
    v_lshlrev_b32 v48, 16, v48
    v_mul_f32 v48, v48, v80
    v_mul_f32 v49, v49, v80
    v_cvt_pk_bf16_f32 v16, v48, v49
    v_sub_f32 v50, v50, v76
    v_sub_f32 v51, v51, v76
    v_cvt_pk_bf16_f32 v50, v50, v51
    v_and_b32 v51, 0xffff0000, v50
    v_lshlrev_b32 v50, 16, v50
    v_mul_f32 v50, v50, v80
    v_mul_f32 v51, v51, v80
    v_cvt_pk_bf16_f32 v17, v50, v51
    v_sub_f32 v52, v52, v76
    v_sub_f32 v53, v53, v76
    v_cvt_pk_bf16_f32 v52, v52, v53
    v_and_b32 v53, 0xffff0000, v52
    v_lshlrev_b32 v52, 16, v52
    v_mul_f32 v52, v52, v80
    v_mul_f32 v53, v53, v80
    v_cvt_pk_bf16_f32 v18, v52, v53
    v_sub_f32 v54, v54, v76
    v_sub_f32 v55, v55, v76
    v_cvt_pk_bf16_f32 v54, v54, v55
    v_and_b32 v55, 0xffff0000, v54
    v_lshlrev_b32 v54, 16, v54
    v_mul_f32 v54, v54, v80
    v_mul_f32 v55, v55, v80
    v_cvt_pk_bf16_f32 v19, v54, v55
    s_add_u32 s41, s42, 8192
    buffer_store_dwordx4 v[16:19], v5, s[8:11], s41 offen sc1
    v_sub_f32 v56, v56, v76
    v_sub_f32 v57, v57, v76
    v_cvt_pk_bf16_f32 v56, v56, v57
    v_and_b32 v57, 0xffff0000, v56
    v_lshlrev_b32 v56, 16, v56
    v_mul_f32 v56, v56, v80
    v_mul_f32 v57, v57, v80
    v_cvt_pk_bf16_f32 v20, v56, v57
    v_sub_f32 v58, v58, v76
    v_sub_f32 v59, v59, v76
    v_cvt_pk_bf16_f32 v58, v58, v59
    v_and_b32 v59, 0xffff0000, v58
    v_lshlrev_b32 v58, 16, v58
    v_mul_f32 v58, v58, v80
    v_mul_f32 v59, v59, v80
    v_cvt_pk_bf16_f32 v21, v58, v59
    v_sub_f32 v60, v60, v76
    v_sub_f32 v61, v61, v76
    v_cvt_pk_bf16_f32 v60, v60, v61
    v_and_b32 v61, 0xffff0000, v60
    v_lshlrev_b32 v60, 16, v60
    v_mul_f32 v60, v60, v80
    v_mul_f32 v61, v61, v80
    v_cvt_pk_bf16_f32 v22, v60, v61
    v_sub_f32 v62, v62, v76
    v_sub_f32 v63, v63, v76
    v_cvt_pk_bf16_f32 v62, v62, v63
    v_and_b32 v63, 0xffff0000, v62
    v_lshlrev_b32 v62, 16, v62
    v_mul_f32 v62, v62, v80
    v_mul_f32 v63, v63, v80
    v_cvt_pk_bf16_f32 v23, v62, v63
    s_add_u32 s41, s42, 12288
    buffer_store_dwordx4 v[20:23], v5, s[8:11], s41 offen sc1
    v_sub_f32 v64, v64, v76
    v_sub_f32 v65, v65, v76
    v_cvt_pk_bf16_f32 v64, v64, v65
    v_and_b32 v65, 0xffff0000, v64
    v_lshlrev_b32 v64, 16, v64
    v_mul_f32 v64, v64, v80
    v_mul_f32 v65, v65, v80
    v_cvt_pk_bf16_f32 v24, v64, v65
    v_sub_f32 v66, v66, v76
    v_sub_f32 v67, v67, v76
    v_cvt_pk_bf16_f32 v66, v66, v67
    v_and_b32 v67, 0xffff0000, v66
    v_lshlrev_b32 v66, 16, v66
    v_mul_f32 v66, v66, v80
    v_mul_f32 v67, v67, v80
    v_cvt_pk_bf16_f32 v25, v66, v67
    v_sub_f32 v68, v68, v76
    v_sub_f32 v69, v69, v76
    v_cvt_pk_bf16_f32 v68, v68, v69
    v_and_b32 v69, 0xffff0000, v68
    v_lshlrev_b32 v68, 16, v68
    v_mul_f32 v68, v68, v80
    v_mul_f32 v69, v69, v80
    v_cvt_pk_bf16_f32 v26, v68, v69
    v_sub_f32 v70, v70, v76
    v_sub_f32 v71, v71, v76
    v_cvt_pk_bf16_f32 v70, v70, v71
    v_and_b32 v71, 0xffff0000, v70
    v_lshlrev_b32 v70, 16, v70
    v_mul_f32 v70, v70, v80
    v_mul_f32 v71, v71, v80
    v_cvt_pk_bf16_f32 v27, v70, v71
    s_add_u32 s41, s42, 16384
    buffer_store_dwordx4 v[24:27], v5, s[8:11], s41 offen sc1
    s_branch LN_done
LN_4:
    buffer_load_dwordx4 v[8:11], v4, s[16:19], 0 offen offset:0
    buffer_load_dwordx4 v[12:15], v4, s[16:19], 0 offen offset:256
    buffer_load_dwordx4 v[16:19], v4, s[16:19], 0 offen offset:512
    buffer_load_dwordx4 v[20:23], v4, s[16:19], 0 offen offset:768
    s_waitcnt vmcnt(3)
    v_lshlrev_b32 v32, 16, v8
    v_and_b32 v33, 0xffff0000, v8
    v_lshlrev_b32 v34, 16, v9
    v_and_b32 v35, 0xffff0000, v9
    v_lshlrev_b32 v36, 16, v10
    v_and_b32 v37, 0xffff0000, v10
    v_lshlrev_b32 v38, 16, v11
    v_and_b32 v39, 0xffff0000, v11
    s_waitcnt vmcnt(2)
    v_lshlrev_b32 v40, 16, v12
    v_and_b32 v41, 0xffff0000, v12
    v_lshlrev_b32 v42, 16, v13
    v_and_b32 v43, 0xffff0000, v13
    v_lshlrev_b32 v44, 16, v14
    v_and_b32 v45, 0xffff0000, v14
    v_lshlrev_b32 v46, 16, v15
    v_and_b32 v47, 0xffff0000, v15
    s_waitcnt vmcnt(1)
    v_lshlrev_b32 v48, 16, v16
    v_and_b32 v49, 0xffff0000, v16
    v_lshlrev_b32 v50, 16, v17
    v_and_b32 v51, 0xffff0000, v17
    v_lshlrev_b32 v52, 16, v18
    v_and_b32 v53, 0xffff0000, v18
    v_lshlrev_b32 v54, 16, v19
    v_and_b32 v55, 0xffff0000, v19
    s_waitcnt vmcnt(0)
    v_lshlrev_b32 v56, 16, v20
    v_and_b32 v57, 0xffff0000, v20
    v_lshlrev_b32 v58, 16, v21
    v_and_b32 v59, 0xffff0000, v21
    v_lshlrev_b32 v60, 16, v22
    v_and_b32 v61, 0xffff0000, v22
    v_lshlrev_b32 v62, 16, v23
    v_and_b32 v63, 0xffff0000, v23
    v_add_f32 v72, v32, v33
    v_add_f32 v73, v34, v35
    v_add_f32 v72, v72, v36
    v_add_f32 v73, v73, v37
    v_add_f32 v72, v72, v38
    v_add_f32 v73, v73, v39
    v_add_f32 v72, v72, v40
    v_add_f32 v73, v73, v41
    v_add_f32 v72, v72, v42
    v_add_f32 v73, v73, v43
    v_add_f32 v72, v72, v44
    v_add_f32 v73, v73, v45
    v_add_f32 v72, v72, v46
    v_add_f32 v73, v73, v47
    v_add_f32 v72, v72, v48
    v_add_f32 v73, v73, v49
    v_add_f32 v72, v72, v50
    v_add_f32 v73, v73, v51
    v_add_f32 v72, v72, v52
    v_add_f32 v73, v73, v53
    v_add_f32 v72, v72, v54
    v_add_f32 v73, v73, v55
    v_add_f32 v72, v72, v56
    v_add_f32 v73, v73, v57
    v_add_f32 v72, v72, v58
    v_add_f32 v73, v73, v59
    v_add_f32 v72, v72, v60
    v_add_f32 v73, v73, v61
    v_add_f32 v72, v72, v62
    v_add_f32 v73, v73, v63
    v_add_f32 v72, v72, v73
    v_mov_b32 v74, v72
    s_nop 1
    v_permlane16_swap_b32 v72, v74
    v_add_f32 v72, v72, v74
    v_mov_b32 v74, v72
    s_nop 1
    v_permlane32_swap_b32 v72, v74
    v_add_f32 v72, v72, v74
    ds_write_b32 v7, v72
    s_waitcnt lgkmcnt(0)
    s_barrier
    ds_read_b128 v[76:79], v6
    s_waitcnt lgkmcnt(0)
    v_add_f32 v76, v76, v77
    v_add_f32 v78, v78, v79
    v_add_f32 v76, v76, v78
    v_mul_f32 v76, 0x3ae38e39, v76
    v_sub_f32 v74, v32, v76
    v_mul_f32 v72, v74, v74
    v_sub_f32 v75, v33, v76
    v_mul_f32 v73, v75, v75
    v_sub_f32 v74, v34, v76
    v_sub_f32 v75, v35, v76
    v_fmac_f32 v72, v74, v74
    v_fmac_f32 v73, v75, v75
    v_sub_f32 v74, v36, v76
    v_sub_f32 v75, v37, v76
    v_fmac_f32 v72, v74, v74
    v_fmac_f32 v73, v75, v75
    v_sub_f32 v74, v38, v76
    v_sub_f32 v75, v39, v76
    v_fmac_f32 v72, v74, v74
    v_fmac_f32 v73, v75, v75
    v_sub_f32 v74, v40, v76
    v_sub_f32 v75, v41, v76
    v_fmac_f32 v72, v74, v74
    v_fmac_f32 v73, v75, v75
    v_sub_f32 v74, v42, v76
    v_sub_f32 v75, v43, v76
    v_fmac_f32 v72, v74, v74
    v_fmac_f32 v73, v75, v75
    v_sub_f32 v74, v44, v76
    v_sub_f32 v75, v45, v76
    v_fmac_f32 v72, v74, v74
    v_fmac_f32 v73, v75, v75
    v_sub_f32 v74, v46, v76
    v_sub_f32 v75, v47, v76
    v_fmac_f32 v72, v74, v74
    v_fmac_f32 v73, v75, v75
    v_sub_f32 v74, v48, v76
    v_sub_f32 v75, v49, v76
    v_fmac_f32 v72, v74, v74
    v_fmac_f32 v73, v75, v75
    v_sub_f32 v74, v50, v76
    v_sub_f32 v75, v51, v76
    v_fmac_f32 v72, v74, v74
    v_fmac_f32 v73, v75, v75
    v_sub_f32 v74, v52, v76
    v_sub_f32 v75, v53, v76
    v_fmac_f32 v72, v74, v74
    v_fmac_f32 v73, v75, v75
    v_sub_f32 v74, v54, v76
    v_sub_f32 v75, v55, v76
    v_fmac_f32 v72, v74, v74
    v_fmac_f32 v73, v75, v75
    v_sub_f32 v74, v56, v76
    v_sub_f32 v75, v57, v76
    v_fmac_f32 v72, v74, v74
    v_fmac_f32 v73, v75, v75
    v_sub_f32 v74, v58, v76
    v_sub_f32 v75, v59, v76
    v_fmac_f32 v72, v74, v74
    v_fmac_f32 v73, v75, v75
    v_sub_f32 v74, v60, v76
    v_sub_f32 v75, v61, v76
    v_fmac_f32 v72, v74, v74
    v_fmac_f32 v73, v75, v75
    v_sub_f32 v74, v62, v76
    v_sub_f32 v75, v63, v76
    v_fmac_f32 v72, v74, v74
    v_fmac_f32 v73, v75, v75
    v_add_f32 v72, v72, v73
    v_mov_b32 v74, v72
    s_nop 1
    v_permlane16_swap_b32 v72, v74
    v_add_f32 v72, v72, v74
    v_mov_b32 v74, v72
    s_nop 1
    v_permlane32_swap_b32 v72, v74
    v_add_f32 v72, v72, v74
    ds_write_b32 v7, v72 offset:256
    s_waitcnt lgkmcnt(0)
    s_barrier
    ds_read_b128 v[80:83], v6 offset:256
    s_waitcnt lgkmcnt(0)
    v_add_f32 v80, v80, v81
    v_add_f32 v82, v82, v83
    v_add_f32 v80, v80, v82
    v_mul_f32 v80, 0x3ae38e39, v80
    v_cvt_pk_bf16_f32 v77, v76, v80
    v_lshlrev_b32 v76, 16, v77
    v_and_b32 v80, 0xffff0000, v77
    v_add_f32 v80, 0x3727c5ac, v80
    v_cvt_pk_bf16_f32 v80, v80, v80
    v_and_b32 v80, 0xffff0000, v80
    v_sqrt_f32 v80, v80
    s_nop 0
    v_cvt_pk_bf16_f32 v80, v80, v80
    v_and_b32 v80, 0xffff0000, v80
    v_rcp_f32 v80, v80
    v_sub_f32 v32, v32, v76
    v_sub_f32 v33, v33, v76
    v_cvt_pk_bf16_f32 v32, v32, v33
    v_and_b32 v33, 0xffff0000, v32
    v_lshlrev_b32 v32, 16, v32
    v_mul_f32 v32, v32, v80
    v_mul_f32 v33, v33, v80
    v_cvt_pk_bf16_f32 v8, v32, v33
    v_sub_f32 v34, v34, v76
    v_sub_f32 v35, v35, v76
    v_cvt_pk_bf16_f32 v34, v34, v35
    v_and_b32 v35, 0xffff0000, v34
    v_lshlrev_b32 v34, 16, v34
    v_mul_f32 v34, v34, v80
    v_mul_f32 v35, v35, v80
    v_cvt_pk_bf16_f32 v9, v34, v35
    v_sub_f32 v36, v36, v76
    v_sub_f32 v37, v37, v76
    v_cvt_pk_bf16_f32 v36, v36, v37
    v_and_b32 v37, 0xffff0000, v36
    v_lshlrev_b32 v36, 16, v36
    v_mul_f32 v36, v36, v80
    v_mul_f32 v37, v37, v80
    v_cvt_pk_bf16_f32 v10, v36, v37
    v_sub_f32 v38, v38, v76
    v_sub_f32 v39, v39, v76
    v_cvt_pk_bf16_f32 v38, v38, v39
    v_and_b32 v39, 0xffff0000, v38
    v_lshlrev_b32 v38, 16, v38
    v_mul_f32 v38, v38, v80
    v_mul_f32 v39, v39, v80
    v_cvt_pk_bf16_f32 v11, v38, v39
    s_add_u32 s41, s42, 0
    buffer_store_dwordx4 v[8:11], v5, s[8:11], s41 offen sc1
    v_sub_f32 v40, v40, v76
    v_sub_f32 v41, v41, v76
    v_cvt_pk_bf16_f32 v40, v40, v41
    v_and_b32 v41, 0xffff0000, v40
    v_lshlrev_b32 v40, 16, v40
    v_mul_f32 v40, v40, v80
    v_mul_f32 v41, v41, v80
    v_cvt_pk_bf16_f32 v12, v40, v41
    v_sub_f32 v42, v42, v76
    v_sub_f32 v43, v43, v76
    v_cvt_pk_bf16_f32 v42, v42, v43
    v_and_b32 v43, 0xffff0000, v42
    v_lshlrev_b32 v42, 16, v42
    v_mul_f32 v42, v42, v80
    v_mul_f32 v43, v43, v80
    v_cvt_pk_bf16_f32 v13, v42, v43
    v_sub_f32 v44, v44, v76
    v_sub_f32 v45, v45, v76
    v_cvt_pk_bf16_f32 v44, v44, v45
    v_and_b32 v45, 0xffff0000, v44
    v_lshlrev_b32 v44, 16, v44
    v_mul_f32 v44, v44, v80
    v_mul_f32 v45, v45, v80
    v_cvt_pk_bf16_f32 v14, v44, v45
    v_sub_f32 v46, v46, v76
    v_sub_f32 v47, v47, v76
    v_cvt_pk_bf16_f32 v46, v46, v47
    v_and_b32 v47, 0xffff0000, v46
    v_lshlrev_b32 v46, 16, v46
    v_mul_f32 v46, v46, v80
    v_mul_f32 v47, v47, v80
    v_cvt_pk_bf16_f32 v15, v46, v47
    s_add_u32 s41, s42, 4096
    buffer_store_dwordx4 v[12:15], v5, s[8:11], s41 offen sc1
    v_sub_f32 v48, v48, v76
    v_sub_f32 v49, v49, v76
    v_cvt_pk_bf16_f32 v48, v48, v49
    v_and_b32 v49, 0xffff0000, v48
    v_lshlrev_b32 v48, 16, v48
    v_mul_f32 v48, v48, v80
    v_mul_f32 v49, v49, v80
    v_cvt_pk_bf16_f32 v16, v48, v49
    v_sub_f32 v50, v50, v76
    v_sub_f32 v51, v51, v76
    v_cvt_pk_bf16_f32 v50, v50, v51
    v_and_b32 v51, 0xffff0000, v50
    v_lshlrev_b32 v50, 16, v50
    v_mul_f32 v50, v50, v80
    v_mul_f32 v51, v51, v80
    v_cvt_pk_bf16_f32 v17, v50, v51
    v_sub_f32 v52, v52, v76
    v_sub_f32 v53, v53, v76
    v_cvt_pk_bf16_f32 v52, v52, v53
    v_and_b32 v53, 0xffff0000, v52
    v_lshlrev_b32 v52, 16, v52
    v_mul_f32 v52, v52, v80
    v_mul_f32 v53, v53, v80
    v_cvt_pk_bf16_f32 v18, v52, v53
    v_sub_f32 v54, v54, v76
    v_sub_f32 v55, v55, v76
    v_cvt_pk_bf16_f32 v54, v54, v55
    v_and_b32 v55, 0xffff0000, v54
    v_lshlrev_b32 v54, 16, v54
    v_mul_f32 v54, v54, v80
    v_mul_f32 v55, v55, v80
    v_cvt_pk_bf16_f32 v19, v54, v55
    s_add_u32 s41, s42, 8192
    buffer_store_dwordx4 v[16:19], v5, s[8:11], s41 offen sc1
    v_sub_f32 v56, v56, v76
    v_sub_f32 v57, v57, v76
    v_cvt_pk_bf16_f32 v56, v56, v57
    v_and_b32 v57, 0xffff0000, v56
    v_lshlrev_b32 v56, 16, v56
    v_mul_f32 v56, v56, v80
    v_mul_f32 v57, v57, v80
    v_cvt_pk_bf16_f32 v20, v56, v57
    v_sub_f32 v58, v58, v76
    v_sub_f32 v59, v59, v76
    v_cvt_pk_bf16_f32 v58, v58, v59
    v_and_b32 v59, 0xffff0000, v58
    v_lshlrev_b32 v58, 16, v58
    v_mul_f32 v58, v58, v80
    v_mul_f32 v59, v59, v80
    v_cvt_pk_bf16_f32 v21, v58, v59
    v_sub_f32 v60, v60, v76
    v_sub_f32 v61, v61, v76
    v_cvt_pk_bf16_f32 v60, v60, v61
    v_and_b32 v61, 0xffff0000, v60
    v_lshlrev_b32 v60, 16, v60
    v_mul_f32 v60, v60, v80
    v_mul_f32 v61, v61, v80
    v_cvt_pk_bf16_f32 v22, v60, v61
    v_sub_f32 v62, v62, v76
    v_sub_f32 v63, v63, v76
    v_cvt_pk_bf16_f32 v62, v62, v63
    v_and_b32 v63, 0xffff0000, v62
    v_lshlrev_b32 v62, 16, v62
    v_mul_f32 v62, v62, v80
    v_mul_f32 v63, v63, v80
    v_cvt_pk_bf16_f32 v23, v62, v63
    s_add_u32 s41, s42, 12288
    buffer_store_dwordx4 v[20:23], v5, s[8:11], s41 offen sc1
    s_branch LN_done
LN_done:
    s_waitcnt vmcnt(0)
    s_barrier
    s_branch W_init
W_noln:
    s_cmp_lt_u32 s92, 136
    s_cbranch_scc0 W_pf
    s_sub_u32 s40, s92, 128
    s_lshl_b32 s41, s40, 13
    s_add_u32 s41, s41, 117272576
    v_lshlrev_b32 v2, 4, v0
    v_mov_b32 v4, 0
    v_mov_b32 v5, 0
    v_mov_b32 v6, 0
    v_mov_b32 v7, 0
    buffer_store_dwordx4 v[4:7], v2, s[8:11], s41 offen sc1
    s_add_u32 s41, s41, 4096
    buffer_store_dwordx4 v[4:7], v2, s[8:11], s41 offen sc1
    s_waitcnt vmcnt(0)
    s_barrier
    s_cmp_lg_u32 s3, 0
    s_cbranch_scc1 W_init
    s_lshl_b32 s40, s40, 2
    s_add_u32 s40, s40, 128
    v_mov_b32 v3, 1
    s_mov_b64 exec, 1
    buffer_store_dword v3, off, s[84:87], s40 sc1
    s_mov_b64 exec, -1
    s_branch W_init
W_pf:
    s_sub_u32 s40, s92, 136
    s_lshl_b32 s40, s40, 2
    s_add_u32 s40, s40, s3
    s_lshl_b32 s40, s40, 10
    v_and_b32 v2, 63, v0
    v_lshlrev_b32 v2, 4, v2
    v_add_u32 v2, s40, v2
    s_mov_b32 s14, 4718592
    v_add_u32 v88, 0, v2
    v_add_u32 v89, 360448, v2
    v_add_u32 v90, 720896, v2
    v_add_u32 v91, 1081344, v2
    v_add_u32 v92, 1441792, v2
    v_add_u32 v93, 1802240, v2
    v_add_u32 v94, 2162688, v2
    v_add_u32 v95, 2523136, v2
    v_add_u32 v96, 2883584, v2
    v_add_u32 v97, 3244032, v2
    v_add_u32 v98, 3604480, v2
    v_add_u32 v99, 3964928, v2
    v_add_u32 v100, 4325376, v2
    v_add_u32 v101, 4685824, v2
    s_mov_b64 s[12:13], s[24:25]
    buffer_load_dwordx4 v[16:19], v88, s[12:15], 0 offen
    buffer_load_dwordx4 v[20:23], v89, s[12:15], 0 offen
    buffer_load_dwordx4 v[24:27], v90, s[12:15], 0 offen
    buffer_load_dwordx4 v[28:31], v91, s[12:15], 0 offen
    buffer_load_dwordx4 v[32:35], v92, s[12:15], 0 offen
    buffer_load_dwordx4 v[36:39], v93, s[12:15], 0 offen
    buffer_load_dwordx4 v[40:43], v94, s[12:15], 0 offen
    buffer_load_dwordx4 v[44:47], v95, s[12:15], 0 offen
    buffer_load_dwordx4 v[48:51], v96, s[12:15], 0 offen
    buffer_load_dwordx4 v[52:55], v97, s[12:15], 0 offen
    buffer_load_dwordx4 v[56:59], v98, s[12:15], 0 offen
    buffer_load_dwordx4 v[60:63], v99, s[12:15], 0 offen
    buffer_load_dwordx4 v[64:67], v100, s[12:15], 0 offen
    buffer_load_dwordx4 v[68:71], v101, s[12:15], 0 offen
    s_mov_b64 s[12:13], s[26:27]
    buffer_load_dwordx4 v[72:75], v88, s[12:15], 0 offen
    buffer_load_dwordx4 v[76:79], v89, s[12:15], 0 offen
    buffer_load_dwordx4 v[16:19], v90, s[12:15], 0 offen
    buffer_load_dwordx4 v[20:23], v91, s[12:15], 0 offen
    buffer_load_dwordx4 v[24:27], v92, s[12:15], 0 offen
    buffer_load_dwordx4 v[28:31], v93, s[12:15], 0 offen
    buffer_load_dwordx4 v[32:35], v94, s[12:15], 0 offen
    buffer_load_dwordx4 v[36:39], v95, s[12:15], 0 offen
    buffer_load_dwordx4 v[40:43], v96, s[12:15], 0 offen
    buffer_load_dwordx4 v[44:47], v97, s[12:15], 0 offen
    buffer_load_dwordx4 v[48:51], v98, s[12:15], 0 offen
    buffer_load_dwordx4 v[52:55], v99, s[12:15], 0 offen
    buffer_load_dwordx4 v[56:59], v100, s[12:15], 0 offen
    buffer_load_dwordx4 v[60:63], v101, s[12:15], 0 offen
    s_mov_b64 s[12:13], s[28:29]
    buffer_load_dwordx4 v[64:67], v88, s[12:15], 0 offen
    buffer_load_dwordx4 v[68:71], v89, s[12:15], 0 offen
    buffer_load_dwordx4 v[72:75], v90, s[12:15], 0 offen
    buffer_load_dwordx4 v[76:79], v91, s[12:15], 0 offen
    buffer_load_dwordx4 v[16:19], v92, s[12:15], 0 offen
    buffer_load_dwordx4 v[20:23], v93, s[12:15], 0 offen
    buffer_load_dwordx4 v[24:27], v94, s[12:15], 0 offen
    buffer_load_dwordx4 v[28:31], v95, s[12:15], 0 offen
    buffer_load_dwordx4 v[32:35], v96, s[12:15], 0 offen
    buffer_load_dwordx4 v[36:39], v97, s[12:15], 0 offen
    buffer_load_dwordx4 v[40:43], v98, s[12:15], 0 offen
    buffer_load_dwordx4 v[44:47], v99, s[12:15], 0 offen
    buffer_load_dwordx4 v[48:51], v100, s[12:15], 0 offen
    buffer_load_dwordx4 v[52:55], v101, s[12:15], 0 offen
W_init:
    s_cmp_lg_u32 s3, 0
    s_cbranch_scc1 W_NEXT
    v_lshlrev_b32 v2, 2, v0
    s_mov_b64 exec, 0xff
W_iw:
    buffer_load_dword v3, v2, s[84:87], 0 offen offset:128 sc1
    s_waitcnt vmcnt(0)
    v_cmp_eq_u32 vcc, 0, v3
    s_cbranch_vccz W_iw_ok
    s_sub_u32 s83, s83, 1
    s_cbranch_scc0 W_iw
    s_mov_b32 s83, 0
W_iw_ok:
    s_mov_b64 exec, -1
    s_cmp_lt_u32 s92, 128
    s_cbranch_scc0 W_NEXT
    s_lshr_b32 s40, s92, 4
    s_lshl_b32 s40, s40, 7
    s_and_b32 s41, s92, 15
    s_lshl_b32 s41, s41, 2
    s_add_u32 s40, s40, s41
    s_add_u32 s40, s40, 117272576
    v_mov_b32 v3, 2
    s_mov_b64 exec, 1
    buffer_store_dword v3, off, s[8:11], s40 sc1
    s_mov_b64 exec, -1
W_NEXT:
    s_cmp_eq_u32 s82, 4
    s_cbranch_scc1 W_TAIL
    s_sub_u32 s62, s80, 2
    s_mov_b32 s95, 0
    s_cmp_lt_u32 s82, 2
    s_cbranch_scc0 W_r1
    s_sub_u32 s40, s80, 1
    s_and_b32 s94, s40, 1
    s_lshr_b32 s40, s40, 1
    s_lshl_b32 s40, s40, 1
    s_lshr_b32 s41, s81, 4
    s_add_u32 s60, s40, s41
    s_and_b32 s61, s81, 15
    s_cmp_lt_u32 s80, 3
    s_cbranch_scc0 W_set
    s_mov_b32 s95, 1
    s_mov_b32 s60, s82
    s_mov_b32 s62, s41
    s_branch W_set
W_r1:
    s_and_b32 s60, s81, 7
    s_lshr_b32 s41, s81, 3
    s_cmp_eq_u32 s82, 2
    s_cbranch_scc0 W_r2
    s_cmp_eq_u32 s80, 1
    s_cbranch_scc0 W_r1b
    s_mov_b32 s94, 1
    s_lshr_b32 s60, s81, 4
    s_add_u32 s60, s60, 6
    s_and_b32 s61, s81, 15
    s_branch W_set
W_r1b:
    s_cmp_lt_u32 s81, 24
    s_cbranch_scc0 W_r1c
    s_mov_b32 s94, 3
    s_mul_i32 s61, s62, 3
    s_add_u32 s61, s61, s41
    s_branch W_set
W_r1c:
    s_mov_b32 s94, 2
    s_mov_b32 s61, s62
    s_branch W_set
W_r2:
    s_cmp_eq_u32 s80, 1
    s_cbranch_scc0 W_r2b
    s_mov_b32 s94, 2
    s_add_u32 s61, s41, 12
    s_branch W_set
W_r2b:
    s_cmp_lt_u32 s81, 24
    s_cbranch_scc0 W_r2c
    s_mov_b32 s94, 4
    s_mov_b32 s61, s41
    s_branch W_set
W_r2c:
    s_mov_b32 s94, 2
    s_add_u32 s61, s62, 6
W_set:
    s_lshl_b32 s88, s60, 7
    s_add_u32 s88, s88, 117272576
    s_mov_b32 s90, 0xffff
    s_mov_b32 s91, 0
    s_lshl_b32 s40, s60, 4
    s_add_u32 s40, s40, s61
    s_lshl_b32 s40, s40, 7
    s_lshl_b32 s41, s94, 2
    s_add_u32 s40, s40, s41
    s_add_u32 s93, s40, 117273600
    s_cmp_eq_u32 s95, 0
    s_cbranch_scc1 W_full
    s_lshl_b32 s40, s62, 3
    s_lshl_b32 s90, 0xff, s40
W_full:
    s_cmp_lt_u32 s94, 3
    s_cbranch_scc1 W_wait
    s_mul_i32 s40, s60, 6
    s_add_u32 s40, s40, s62
    s_lshl_b32 s40, s40, 7
    s_add_u32 s40, s40, 117289984
    s_lshr_b32 s41, s81, 3
    s_cmp_eq_u32 s94, 3
    s_cbranch_scc0 W_setf
    s_lshl_b32 s41, s41, 2
    s_add_u32 s93, s40, s41
    s_branch W_wait
W_setf:
    s_mov_b32 s88, s40
    s_mov_b32 s90, 7
    s_mul_i32 s40, s61, 6
    s_add_u32 s40, s40, s62
    s_lshl_b32 s40, s40, 2
    s_lshl_b32 s41, s60, 7
    s_add_u32 s40, s40, s41
    s_add_u32 s93, s40, 117296128
W_wait:
    s_cmp_lg_u32 s3, 0
    s_cbranch_scc1 W_wd
    v_lshlrev_b32 v2, 2, v0
    s_mov_b64 exec, s[90:91]
W_wp:
    buffer_load_dword v3, v2, s[8:11], s88 offen sc1
    s_waitcnt vmcnt(0)
    v_cmp_eq_u32 vcc, 0, v3
    s_cbranch_vccz W_wp_ok
    s_sub_u32 s83, s83, 1
    s_cbranch_scc0 W_wp
    s_mov_b32 s83, 0
W_wp_ok:
    s_mov_b64 exec, -1
W_wd:
    s_waitcnt vmcnt(0)
    s_barrier
    s_cmp_eq_u32 s95, 0
    s_cbranch_scc1 W_tfull
    s_cmp_eq_u32 s94, 0
    s_cbranch_scc0 W_thv
    s_mov_b64 s[12:13], s[26:27]
    s_mov_b32 s14, 4718592
    s_mov_b32 s63, 8192
    v_and_b32 v1, 63, v0
    v_lshrrev_b32 v2, 4, v1
    v_lshlrev_b32 v18, 4, v1
    s_lshr_b32 s54, s3, 1
    s_lshl_b32 s54, s54, 12
    v_add_u32 v8, s54, v18
    v_bfe_u32 v3, v1, 2, 2
    v_and_b32 v4, 3, v1
    v_and_b32 v5, 1, v2
    v_lshl_add_u32 v5, v5, 2, v3
    v_lshlrev_b32 v6, 12, v2
    v_lshl_add_u32 v6, v3, 9, v6
    v_lshl_add_u32 v6, v4, 3, v6
    v_add_u32 v6, 16384, v6
    s_and_b32 s54, s3, 1
    s_mul_i32 s54, s54, 8
    s_add_u32 s55, s54, 0
    v_xor_b32 v7, s55, v5
    v_lshl_add_u32 v10, v7, 5, v6
    s_add_u32 s55, s54, 1
    v_xor_b32 v7, s55, v5
    v_lshl_add_u32 v11, v7, 5, v6
    s_add_u32 s55, s54, 2
    v_xor_b32 v7, s55, v5
    v_lshl_add_u32 v12, v7, 5, v6
    s_add_u32 s55, s54, 3
    v_xor_b32 v7, s55, v5
    v_lshl_add_u32 v13, v7, 5, v6
    s_add_u32 s55, s54, 4
    v_xor_b32 v7, s55, v5
    v_lshl_add_u32 v14, v7, 5, v6
    s_add_u32 s55, s54, 5
    v_xor_b32 v7, s55, v5
    v_lshl_add_u32 v15, v7, 5, v6
    s_add_u32 s55, s54, 6
    v_xor_b32 v7, s55, v5
    v_lshl_add_u32 v16, v7, 5, v6
    s_add_u32 s55, s54, 7
    v_xor_b32 v7, s55, v5
    v_lshl_add_u32 v17, v7, 5, v6
    s_and_b32 s54, s3, 1
    s_lshl_b32 s54, s54, 1
    s_lshr_b32 s55, s3, 1
    s_lshl_b32 s55, s55, 2
    s_or_b32 s54, s54, s55
    v_lshrrev_b32 v3, 5, v1
    v_or_b32 v4, s54, v3
    v_lshlrev_b32 v4, 1, v4
    v_and_b32 v5, 31, v1
    v_xor_b32 v4, v4, v5
    v_mul_lo_u32 v3, v3, s63
    v_lshl_add_u32 v19, v4, 4, v3
    s_mul_i32 s64, s60, 294912
    s_add_u32 s64, s64, 0
    s_mul_i32 s54, s62, 147456
    s_add_u32 s64, s64, s54
    s_lshl_b32 s65, s61, 9
    s_mul_i32 s54, s3, 36864
    s_add_u32 s54, s54, s64
    s_add_u32 s40, s54, 0
    s_add_u32 s41, s54, 18432
    s_and_b32 s54, s3, 1
    s_lshl_b32 s54, s54, 1
    s_lshr_b32 s55, s3, 1
    s_mul_i32 s55, s55, 8
    s_add_u32 s54, s54, s55
    s_add_u32 s55, s54, 0
    s_mul_i32 s55, s55, s63
    s_add_u32 s44, s55, s65
    s_add_u32 s55, s54, 4
    s_mul_i32 s55, s55, s63
    s_add_u32 s45, s55, s65
    s_add_u32 s55, s54, 16
    s_mul_i32 s55, s55, s63
    s_add_u32 s46, s55, s65
    s_add_u32 s55, s54, 20
    s_mul_i32 s55, s55, s63
    s_add_u32 s47, s55, s65
    s_lshl_b32 s50, s63, 5
    s_lshl_b32 s48, s3, 11
    s_and_b32 s54, s3, 1
    s_lshl_b32 s54, s54, 10
    s_lshr_b32 s55, s3, 1
    s_lshl_b32 s55, s55, 12
    s_add_u32 s49, s54, s55
    s_add_u32 s49, s49, 16384
    s_add_u32 m0, s48, 0
    s_nop 0
    buffer_load_dwordx4 v18, s[8:11], s40 offen  lds
    s_add_u32 s40, s40, 1024
    s_add_u32 m0, s48, 1024
    s_nop 0
    buffer_load_dwordx4 v18, s[8:11], s41 offen  lds
    s_add_u32 s41, s41, 1024
    s_add_u32 s48, s48, 32768
    s_and_b32 s48, s48, 0x1ffff
    s_add_u32 m0, s49, 0
    s_nop 0
    buffer_load_dwordx4 v19, s[12:15], s44 offen lds
    s_add_u32 s44, s44, s50
    s_add_u32 m0, s49, 2048
    s_nop 0
    buffer_load_dwordx4 v19, s[12:15], s45 offen lds
    s_add_u32 s45, s45, s50
    s_add_u32 m0, s49, 8192
    s_nop 0
    buffer_load_dwordx4 v19, s[12:15], s46 offen lds
    s_add_u32 s46, s46, s50
    s_add_u32 m0, s49, 10240
    s_nop 0
    buffer_load_dwordx4 v19, s[12:15], s47 offen lds
    s_add_u32 s47, s47, s50
    s_add_u32 s49, s49, 32768
    s_and_b32 s49, s49, 0x1ffff
    s_add_u32 m0, s48, 0
    s_nop 0
    buffer_load_dwordx4 v18, s[8:11], s40 offen  lds
    s_add_u32 s40, s40, 1024
    s_add_u32 m0, s48, 1024
    s_nop 0
    buffer_load_dwordx4 v18, s[8:11], s41 offen  lds
    s_add_u32 s41, s41, 1024
    s_add_u32 s48, s48, 32768
    s_and_b32 s48, s48, 0x1ffff
    s_add_u32 m0, s49, 0
    s_nop 0
    buffer_load_dwordx4 v19, s[12:15], s44 offen lds
    s_add_u32 s44, s44, s50
    s_add_u32 m0, s49, 2048
    s_nop 0
    buffer_load_dwordx4 v19, s[12:15], s45 offen lds
    s_add_u32 s45, s45, s50
    s_add_u32 m0, s49, 8192
    s_nop 0
    buffer_load_dwordx4 v19, s[12:15], s46 offen lds
    s_add_u32 s46, s46, s50
    s_add_u32 m0, s49, 10240
    s_nop 0
    buffer_load_dwordx4 v19, s[12:15], s47 offen lds
    s_add_u32 s47, s47, s50
    s_add_u32 s49, s49, 32768
    s_and_b32 s49, s49, 0x1ffff
    s_add_u32 m0, s48, 0
    s_nop 0
    buffer_load_dwordx4 v18, s[8:11], s40 offen  lds
    s_add_u32 s40, s40, 1024
    s_add_u32 m0, s48, 1024
    s_nop 0
    buffer_load_dwordx4 v18, s[8:11], s41 offen  lds
    s_add_u32 s41, s41, 1024
    s_add_u32 s48, s48, 32768
    s_and_b32 s48, s48, 0x1ffff
    s_add_u32 m0, s49, 0
    s_nop 0
    buffer_load_dwordx4 v19, s[12:15], s44 offen lds
    s_add_u32 s44, s44, s50
    s_add_u32 m0, s49, 2048
    s_nop 0
    buffer_load_dwordx4 v19, s[12:15], s45 offen lds
    s_add_u32 s45, s45, s50
    s_add_u32 m0, s49, 8192
    s_nop 0
    buffer_load_dwordx4 v19, s[12:15], s46 offen lds
    s_add_u32 s46, s46, s50
    s_add_u32 m0, s49, 10240
    s_nop 0
    buffer_load_dwordx4 v19, s[12:15], s47 offen lds
    s_add_u32 s47, s47, s50
    s_add_u32 s49, s49, 32768
    s_and_b32 s49, s49, 0x1ffff
    s_add_u32 m0, s48, 0
    s_nop 0
    buffer_load_dwordx4 v18, s[8:11], s40 offen  lds
    s_add_u32 s40, s40, 1024
    s_add_u32 m0, s48, 1024
    s_nop 0
    buffer_load_dwordx4 v18, s[8:11], s41 offen  lds
    s_add_u32 s41, s41, 1024
    s_add_u32 s48, s48, 32768
    s_and_b32 s48, s48, 0x1ffff
    s_add_u32 m0, s49, 0
    s_nop 0
    buffer_load_dwordx4 v19, s[12:15], s44 offen lds
    s_add_u32 s44, s44, s50
    s_add_u32 m0, s49, 2048
    s_nop 0
    buffer_load_dwordx4 v19, s[12:15], s45 offen lds
    s_add_u32 s45, s45, s50
    s_add_u32 m0, s49, 8192
    s_nop 0
    buffer_load_dwordx4 v19, s[12:15], s46 offen lds
    s_add_u32 s46, s46, s50
    s_add_u32 m0, s49, 10240
    s_nop 0
    buffer_load_dwordx4 v19, s[12:15], s47 offen lds
    s_add_u32 s47, s47, s50
    s_add_u32 s49, s49, 32768
    s_and_b32 s49, s49, 0x1ffff
    v_accvgpr_write_b32 a0, 0
    v_accvgpr_write_b32 a1, 0
    v_accvgpr_write_b32 a2, 0
    v_accvgpr_write_b32 a3, 0
    v_accvgpr_write_b32 a4, 0
    v_accvgpr_write_b32 a5, 0
    v_accvgpr_write_b32 a6, 0
    v_accvgpr_write_b32 a7, 0
    v_accvgpr_write_b32 a8, 0
    v_accvgpr_write_b32 a9, 0
    v_accvgpr_write_b32 a10, 0
    v_accvgpr_write_b32 a11, 0
    v_accvgpr_write_b32 a12, 0
    v_accvgpr_write_b32 a13, 0
    v_accvgpr_write_b32 a14, 0
    v_accvgpr_write_b32 a15, 0
    v_accvgpr_write_b32 a32, 0
    v_accvgpr_write_b32 a33, 0
    v_accvgpr_write_b32 a34, 0
    v_accvgpr_write_b32 a35, 0
    v_accvgpr_write_b32 a36, 0
    v_accvgpr_write_b32 a37, 0
    v_accvgpr_write_b32 a38, 0
    v_accvgpr_write_b32 a39, 0
    v_accvgpr_write_b32 a40, 0
    v_accvgpr_write_b32 a41, 0
    v_accvgpr_write_b32 a42, 0
    v_accvgpr_write_b32 a43, 0
    v_accvgpr_write_b32 a44, 0
    v_accvgpr_write_b32 a45, 0
    v_accvgpr_write_b32 a46, 0
    v_accvgpr_write_b32 a47, 0
    v_accvgpr_write_b32 a64, 0
    v_accvgpr_write_b32 a65, 0
    v_accvgpr_write_b32 a66, 0
    v_accvgpr_write_b32 a67, 0
    v_accvgpr_write_b32 a68, 0
    v_accvgpr_write_b32 a69, 0
    v_accvgpr_write_b32 a70, 0
    v_accvgpr_write_b32 a71, 0
    v_accvgpr_write_b32 a72, 0
    v_accvgpr_write_b32 a73, 0
    v_accvgpr_write_b32 a74, 0
    v_accvgpr_write_b32 a75, 0
    v_accvgpr_write_b32 a76, 0
    v_accvgpr_write_b32 a77, 0
    v_accvgpr_write_b32 a78, 0
    v_accvgpr_write_b32 a79, 0
    v_accvgpr_write_b32 a96, 0
    v_accvgpr_write_b32 a97, 0
    v_accvgpr_write_b32 a98, 0
    v_accvgpr_write_b32 a99, 0
    v_accvgpr_write_b32 a100, 0
    v_accvgpr_write_b32 a101, 0
    v_accvgpr_write_b32 a102, 0
    v_accvgpr_write_b32 a103, 0
    v_accvgpr_write_b32 a104, 0
    v_accvgpr_write_b32 a105, 0
    v_accvgpr_write_b32 a106, 0
    v_accvgpr_write_b32 a107, 0
    v_accvgpr_write_b32 a108, 0
    v_accvgpr_write_b32 a109, 0
    v_accvgpr_write_b32 a110, 0
    v_accvgpr_write_b32 a111, 0
    v_accvgpr_write_b32 a128, 0
    v_accvgpr_write_b32 a129, 0
    v_accvgpr_write_b32 a130, 0
    v_accvgpr_write_b32 a131, 0
    v_accvgpr_write_b32 a132, 0
    v_accvgpr_write_b32 a133, 0
    v_accvgpr_write_b32 a134, 0
    v_accvgpr_write_b32 a135, 0
    v_accvgpr_write_b32 a136, 0
    v_accvgpr_write_b32 a137, 0
    v_accvgpr_write_b32 a138, 0
    v_accvgpr_write_b32 a139, 0
    v_accvgpr_write_b32 a140, 0
    v_accvgpr_write_b32 a141, 0
    v_accvgpr_write_b32 a142, 0
    v_accvgpr_write_b32 a143, 0
    v_accvgpr_write_b32 a160, 0
    v_accvgpr_write_b32 a161, 0
    v_accvgpr_write_b32 a162, 0
    v_accvgpr_write_b32 a163, 0
    v_accvgpr_write_b32 a164, 0
    v_accvgpr_write_b32 a165, 0
    v_accvgpr_write_b32 a166, 0
    v_accvgpr_write_b32 a167, 0
    v_accvgpr_write_b32 a168, 0
    v_accvgpr_write_b32 a169, 0
    v_accvgpr_write_b32 a170, 0
    v_accvgpr_write_b32 a171, 0
    v_accvgpr_write_b32 a172, 0
    v_accvgpr_write_b32 a173, 0
    v_accvgpr_write_b32 a174, 0
    v_accvgpr_write_b32 a175, 0
    v_accvgpr_write_b32 a192, 0
    v_accvgpr_write_b32 a193, 0
    v_accvgpr_write_b32 a194, 0
    v_accvgpr_write_b32 a195, 0
    v_accvgpr_write_b32 a196, 0
    v_accvgpr_write_b32 a197, 0
    v_accvgpr_write_b32 a198, 0
    v_accvgpr_write_b32 a199, 0
    v_accvgpr_write_b32 a200, 0
    v_accvgpr_write_b32 a201, 0
    v_accvgpr_write_b32 a202, 0
    v_accvgpr_write_b32 a203, 0
    v_accvgpr_write_b32 a204, 0
    v_accvgpr_write_b32 a205, 0
    v_accvgpr_write_b32 a206, 0
    v_accvgpr_write_b32 a207, 0
    v_accvgpr_write_b32 a224, 0
    v_accvgpr_write_b32 a225, 0
    v_accvgpr_write_b32 a226, 0
    v_accvgpr_write_b32 a227, 0
    v_accvgpr_write_b32 a228, 0
    v_accvgpr_write_b32 a229, 0
    v_accvgpr_write_b32 a230, 0
    v_accvgpr_write_b32 a231, 0
    v_accvgpr_write_b32 a232, 0
    v_accvgpr_write_b32 a233, 0
    v_accvgpr_write_b32 a234, 0
    v_accvgpr_write_b32 a235, 0
    v_accvgpr_write_b32 a236, 0
    v_accvgpr_write_b32 a237, 0
    v_accvgpr_write_b32 a238, 0
    v_accvgpr_write_b32 a239, 0
    s_waitcnt vmcnt(18)
    s_barrier
    ds_read_b64_tr_b16 v[96:97], v10 offset:0
    ds_read_b64_tr_b16 v[98:99], v10 offset:2048
    ds_read_b128 v[64:67], v8 offset:0
    ds_read_b64_tr_b16 v[100:101], v11 offset:0
    ds_read_b64_tr_b16 v[102:103], v11 offset:2048
    ds_read_b128 v[68:71], v8 offset:1024
    ds_read_b64_tr_b16 v[104:105], v12 offset:0
    ds_read_b64_tr_b16 v[106:107], v12 offset:2048
    ds_read_b128 v[72:75], v8 offset:2048
    ds_read_b64_tr_b16 v[108:109], v13 offset:0
    ds_read_b64_tr_b16 v[110:111], v13 offset:2048
    ds_read_b128 v[76:79], v8 offset:3072
    ds_read_b64_tr_b16 v[112:113], v14 offset:0
    ds_read_b64_tr_b16 v[114:115], v14 offset:2048
    ds_read_b64_tr_b16 v[116:117], v15 offset:0
    ds_read_b64_tr_b16 v[118:119], v15 offset:2048
    ds_read_b64_tr_b16 v[120:121], v16 offset:0
    ds_read_b64_tr_b16 v[122:123], v16 offset:2048
    ds_read_b64_tr_b16 v[124:125], v17 offset:0
    ds_read_b64_tr_b16 v[126:127], v17 offset:2048
    s_mov_b32 s51, 7
Gkh_loop:
    s_waitcnt vmcnt(12) lgkmcnt(0)
    s_barrier
    v_mfma_f32_16x16x32_bf16 a[0:3], v[96:99], v[64:67], a[0:3]
    ds_read_b64_tr_b16 v[160:161], v10 offset:32768
    v_mfma_f32_16x16x32_bf16 a[4:7], v[96:99], v[68:71], a[4:7]
    ds_read_b64_tr_b16 v[162:163], v10 offset:34816
    v_mfma_f32_16x16x32_bf16 a[8:11], v[96:99], v[72:75], a[8:11]
    ds_read_b128 v[128:131], v8 offset:32768
    s_add_u32 m0, s48, 0
    s_nop 0
    buffer_load_dwordx4 v18, s[8:11], s40 offen  lds
    s_add_u32 s40, s40, 1024
    v_mfma_f32_16x16x32_bf16 a[12:15], v[96:99], v[76:79], a[12:15]
    ds_read_b64_tr_b16 v[164:165], v11 offset:32768
    v_mfma_f32_16x16x32_bf16 a[32:35], v[100:103], v[64:67], a[32:35]
    ds_read_b64_tr_b16 v[166:167], v11 offset:34816
    v_mfma_f32_16x16x32_bf16 a[36:39], v[100:103], v[68:71], a[36:39]
    ds_read_b128 v[132:135], v8 offset:33792
    v_mfma_f32_16x16x32_bf16 a[40:43], v[100:103], v[72:75], a[40:43]
    ds_read_b64_tr_b16 v[168:169], v12 offset:32768
    s_add_u32 m0, s48, 1024
    s_nop 0
    buffer_load_dwordx4 v18, s[8:11], s41 offen  lds
    s_add_u32 s41, s41, 1024
    s_add_u32 s48, s48, 32768
    s_and_b32 s48, s48, 0x1ffff
    v_mfma_f32_16x16x32_bf16 a[44:47], v[100:103], v[76:79], a[44:47]
    ds_read_b64_tr_b16 v[170:171], v12 offset:34816
    v_mfma_f32_16x16x32_bf16 a[64:67], v[104:107], v[64:67], a[64:67]
    ds_read_b128 v[136:139], v8 offset:34816
    v_mfma_f32_16x16x32_bf16 a[68:71], v[104:107], v[68:71], a[68:71]
    ds_read_b64_tr_b16 v[172:173], v13 offset:32768
    v_mfma_f32_16x16x32_bf16 a[72:75], v[104:107], v[72:75], a[72:75]
    ds_read_b64_tr_b16 v[174:175], v13 offset:34816
    s_add_u32 m0, s49, 0
    s_nop 0
    buffer_load_dwordx4 v19, s[12:15], s44 offen lds
    s_add_u32 s44, s44, s50
    v_mfma_f32_16x16x32_bf16 a[76:79], v[104:107], v[76:79], a[76:79]
    ds_read_b128 v[140:143], v8 offset:35840
    v_mfma_f32_16x16x32_bf16 a[96:99], v[108:111], v[64:67], a[96:99]
    ds_read_b64_tr_b16 v[176:177], v14 offset:32768
    v_mfma_f32_16x16x32_bf16 a[100:103], v[108:111], v[68:71], a[100:103]
    ds_read_b64_tr_b16 v[178:179], v14 offset:34816
    v_mfma_f32_16x16x32_bf16 a[104:107], v[108:111], v[72:75], a[104:107]
    ds_read_b64_tr_b16 v[180:181], v15 offset:32768
    s_add_u32 m0, s49, 2048
    s_nop 0
    buffer_load_dwordx4 v19, s[12:15], s45 offen lds
    s_add_u32 s45, s45, s50
    v_mfma_f32_16x16x32_bf16 a[108:111], v[108:111], v[76:79], a[108:111]
    ds_read_b64_tr_b16 v[182:183], v15 offset:34816
    v_mfma_f32_16x16x32_bf16 a[128:131], v[112:115], v[64:67], a[128:131]
    ds_read_b64_tr_b16 v[184:185], v16 offset:32768
    v_mfma_f32_16x16x32_bf16 a[132:135], v[112:115], v[68:71], a[132:135]
    ds_read_b64_tr_b16 v[186:187], v16 offset:34816
    v_mfma_f32_16x16x32_bf16 a[136:139], v[112:115], v[72:75], a[136:139]
    ds_read_b64_tr_b16 v[188:189], v17 offset:32768
    s_add_u32 m0, s49, 8192
    s_nop 0
    buffer_load_dwordx4 v19, s[12:15], s46 offen lds
    s_add_u32 s46, s46, s50
    v_mfma_f32_16x16x32_bf16 a[140:143], v[112:115], v[76:79], a[140:143]
    ds_read_b64_tr_b16 v[190:191], v17 offset:34816
    v_mfma_f32_16x16x32_bf16 a[160:163], v[116:119], v[64:67], a[160:163]
    v_mfma_f32_16x16x32_bf16 a[164:167], v[116:119], v[68:71], a[164:167]
    v_mfma_f32_16x16x32_bf16 a[168:171], v[116:119], v[72:75], a[168:171]
    s_add_u32 m0, s49, 10240
    s_nop 0
    buffer_load_dwordx4 v19, s[12:15], s47 offen lds
    s_add_u32 s47, s47, s50
    s_add_u32 s49, s49, 32768
    s_and_b32 s49, s49, 0x1ffff
    v_mfma_f32_16x16x32_bf16 a[172:175], v[116:119], v[76:79], a[172:175]
    v_mfma_f32_16x16x32_bf16 a[192:195], v[120:123], v[64:67], a[192:195]
    v_mfma_f32_16x16x32_bf16 a[196:199], v[120:123], v[68:71], a[196:199]
    v_mfma_f32_16x16x32_bf16 a[200:203], v[120:123], v[72:75], a[200:203]
    v_mfma_f32_16x16x32_bf16 a[204:207], v[120:123], v[76:79], a[204:207]
    v_mfma_f32_16x16x32_bf16 a[224:227], v[124:127], v[64:67], a[224:227]
    v_mfma_f32_16x16x32_bf16 a[228:231], v[124:127], v[68:71], a[228:231]
    v_mfma_f32_16x16x32_bf16 a[232:235], v[124:127], v[72:75], a[232:235]
    v_mfma_f32_16x16x32_bf16 a[236:239], v[124:127], v[76:79], a[236:239]
    v_xor_b32 v8, 0x10000, v8
    v_xor_b32 v10, 0x10000, v10
    v_xor_b32 v11, 0x10000, v11
    v_xor_b32 v12, 0x10000, v12
    v_xor_b32 v13, 0x10000, v13
    v_xor_b32 v14, 0x10000, v14
    v_xor_b32 v15, 0x10000, v15
    v_xor_b32 v16, 0x10000, v16
    v_xor_b32 v17, 0x10000, v17
    s_waitcnt vmcnt(12) lgkmcnt(0)
    s_barrier
    v_mfma_f32_16x16x32_bf16 a[0:3], v[160:163], v[128:131], a[0:3]
    ds_read_b64_tr_b16 v[96:97], v10 offset:0
    v_mfma_f32_16x16x32_bf16 a[4:7], v[160:163], v[132:135], a[4:7]
    ds_read_b64_tr_b16 v[98:99], v10 offset:2048
    v_mfma_f32_16x16x32_bf16 a[8:11], v[160:163], v[136:139], a[8:11]
    ds_read_b128 v[64:67], v8 offset:0
    s_add_u32 m0, s48, 0
    s_nop 0
    buffer_load_dwordx4 v18, s[8:11], s40 offen  lds
    s_add_u32 s40, s40, 1024
    v_mfma_f32_16x16x32_bf16 a[12:15], v[160:163], v[140:143], a[12:15]
    ds_read_b64_tr_b16 v[100:101], v11 offset:0
    v_mfma_f32_16x16x32_bf16 a[32:35], v[164:167], v[128:131], a[32:35]
    ds_read_b64_tr_b16 v[102:103], v11 offset:2048
    v_mfma_f32_16x16x32_bf16 a[36:39], v[164:167], v[132:135], a[36:39]
    ds_read_b128 v[68:71], v8 offset:1024
    v_mfma_f32_16x16x32_bf16 a[40:43], v[164:167], v[136:139], a[40:43]
    ds_read_b64_tr_b16 v[104:105], v12 offset:0
    s_add_u32 m0, s48, 1024
    s_nop 0
    buffer_load_dwordx4 v18, s[8:11], s41 offen  lds
    s_add_u32 s41, s41, 1024
    s_add_u32 s48, s48, 32768
    s_and_b32 s48, s48, 0x1ffff
    v_mfma_f32_16x16x32_bf16 a[44:47], v[164:167], v[140:143], a[44:47]
    ds_read_b64_tr_b16 v[106:107], v12 offset:2048
    v_mfma_f32_16x16x32_bf16 a[64:67], v[168:171], v[128:131], a[64:67]
    ds_read_b128 v[72:75], v8 offset:2048
    v_mfma_f32_16x16x32_bf16 a[68:71], v[168:171], v[132:135], a[68:71]
    ds_read_b64_tr_b16 v[108:109], v13 offset:0
    v_mfma_f32_16x16x32_bf16 a[72:75], v[168:171], v[136:139], a[72:75]
    ds_read_b64_tr_b16 v[110:111], v13 offset:2048
    s_add_u32 m0, s49, 0
    s_nop 0
    buffer_load_dwordx4 v19, s[12:15], s44 offen lds
    s_add_u32 s44, s44, s50
    v_mfma_f32_16x16x32_bf16 a[76:79], v[168:171], v[140:143], a[76:79]
    ds_read_b128 v[76:79], v8 offset:3072
    v_mfma_f32_16x16x32_bf16 a[96:99], v[172:175], v[128:131], a[96:99]
    ds_read_b64_tr_b16 v[112:113], v14 offset:0
    v_mfma_f32_16x16x32_bf16 a[100:103], v[172:175], v[132:135], a[100:103]
    ds_read_b64_tr_b16 v[114:115], v14 offset:2048
    v_mfma_f32_16x16x32_bf16 a[104:107], v[172:175], v[136:139], a[104:107]
    ds_read_b64_tr_b16 v[116:117], v15 offset:0
    s_add_u32 m0, s49, 2048
    s_nop 0
    buffer_load_dwordx4 v19, s[12:15], s45 offen lds
    s_add_u32 s45, s45, s50
    v_mfma_f32_16x16x32_bf16 a[108:111], v[172:175], v[140:143], a[108:111]
    ds_read_b64_tr_b16 v[118:119], v15 offset:2048
    v_mfma_f32_16x16x32_bf16 a[128:131], v[176:179], v[128:131], a[128:131]
    ds_read_b64_tr_b16 v[120:121], v16 offset:0
    v_mfma_f32_16x16x32_bf16 a[132:135], v[176:179], v[132:135], a[132:135]
    ds_read_b64_tr_b16 v[122:123], v16 offset:2048
    v_mfma_f32_16x16x32_bf16 a[136:139], v[176:179], v[136:139], a[136:139]
    ds_read_b64_tr_b16 v[124:125], v17 offset:0
    s_add_u32 m0, s49, 8192
    s_nop 0
    buffer_load_dwordx4 v19, s[12:15], s46 offen lds
    s_add_u32 s46, s46, s50
    v_mfma_f32_16x16x32_bf16 a[140:143], v[176:179], v[140:143], a[140:143]
    ds_read_b64_tr_b16 v[126:127], v17 offset:2048
    v_mfma_f32_16x16x32_bf16 a[160:163], v[180:183], v[128:131], a[160:163]
    v_mfma_f32_16x16x32_bf16 a[164:167], v[180:183], v[132:135], a[164:167]
    v_mfma_f32_16x16x32_bf16 a[168:171], v[180:183], v[136:139], a[168:171]
    s_add_u32 m0, s49, 10240
    s_nop 0
    buffer_load_dwordx4 v19, s[12:15], s47 offen lds
    s_add_u32 s47, s47, s50
    s_add_u32 s49, s49, 32768
    s_and_b32 s49, s49, 0x1ffff
    v_mfma_f32_16x16x32_bf16 a[172:175], v[180:183], v[140:143], a[172:175]
    v_mfma_f32_16x16x32_bf16 a[192:195], v[184:187], v[128:131], a[192:195]
    v_mfma_f32_16x16x32_bf16 a[196:199], v[184:187], v[132:135], a[196:199]
    v_mfma_f32_16x16x32_bf16 a[200:203], v[184:187], v[136:139], a[200:203]
    v_mfma_f32_16x16x32_bf16 a[204:207], v[184:187], v[140:143], a[204:207]
    v_mfma_f32_16x16x32_bf16 a[224:227], v[188:191], v[128:131], a[224:227]
    v_mfma_f32_16x16x32_bf16 a[228:231], v[188:191], v[132:135], a[228:231]
    v_mfma_f32_16x16x32_bf16 a[232:235], v[188:191], v[136:139], a[232:235]
    v_mfma_f32_16x16x32_bf16 a[236:239], v[188:191], v[140:143], a[236:239]
    s_sub_u32 s51, s51, 1
    s_cmp_lg_u32 s51, 0
    s_cbranch_scc1 Gkh_loop
    s_waitcnt vmcnt(12) lgkmcnt(0)
    s_barrier
    v_mfma_f32_16x16x32_bf16 a[0:3], v[96:99], v[64:67], a[0:3]
    ds_read_b64_tr_b16 v[160:161], v10 offset:32768
    v_mfma_f32_16x16x32_bf16 a[4:7], v[96:99], v[68:71], a[4:7]
    ds_read_b64_tr_b16 v[162:163], v10 offset:34816
    v_mfma_f32_16x16x32_bf16 a[8:11], v[96:99], v[72:75], a[8:11]
    ds_read_b128 v[128:131], v8 offset:32768
    v_mfma_f32_16x16x32_bf16 a[12:15], v[96:99], v[76:79], a[12:15]
    ds_read_b64_tr_b16 v[164:165], v11 offset:32768
    v_mfma_f32_16x16x32_bf16 a[32:35], v[100:103], v[64:67], a[32:35]
    ds_read_b64_tr_b16 v[166:167], v11 offset:34816
    v_mfma_f32_16x16x32_bf16 a[36:39], v[100:103], v[68:71], a[36:39]
    ds_read_b128 v[132:135], v8 offset:33792
    v_mfma_f32_16x16x32_bf16 a[40:43], v[100:103], v[72:75], a[40:43]
    ds_read_b64_tr_b16 v[168:169], v12 offset:32768
    v_mfma_f32_16x16x32_bf16 a[44:47], v[100:103], v[76:79], a[44:47]
    ds_read_b64_tr_b16 v[170:171], v12 offset:34816
    v_mfma_f32_16x16x32_bf16 a[64:67], v[104:107], v[64:67], a[64:67]
    ds_read_b128 v[136:139], v8 offset:34816
    v_mfma_f32_16x16x32_bf16 a[68:71], v[104:107], v[68:71], a[68:71]
    ds_read_b64_tr_b16 v[172:173], v13 offset:32768
    v_mfma_f32_16x16x32_bf16 a[72:75], v[104:107], v[72:75], a[72:75]
    ds_read_b64_tr_b16 v[174:175], v13 offset:34816
    v_mfma_f32_16x16x32_bf16 a[76:79], v[104:107], v[76:79], a[76:79]
    ds_read_b128 v[140:143], v8 offset:35840
    v_mfma_f32_16x16x32_bf16 a[96:99], v[108:111], v[64:67], a[96:99]
    ds_read_b64_tr_b16 v[176:177], v14 offset:32768
    v_mfma_f32_16x16x32_bf16 a[100:103], v[108:111], v[68:71], a[100:103]
    ds_read_b64_tr_b16 v[178:179], v14 offset:34816
    v_mfma_f32_16x16x32_bf16 a[104:107], v[108:111], v[72:75], a[104:107]
    ds_read_b64_tr_b16 v[180:181], v15 offset:32768
    v_mfma_f32_16x16x32_bf16 a[108:111], v[108:111], v[76:79], a[108:111]
    ds_read_b64_tr_b16 v[182:183], v15 offset:34816
    v_mfma_f32_16x16x32_bf16 a[128:131], v[112:115], v[64:67], a[128:131]
    ds_read_b64_tr_b16 v[184:185], v16 offset:32768
    v_mfma_f32_16x16x32_bf16 a[132:135], v[112:115], v[68:71], a[132:135]
    ds_read_b64_tr_b16 v[186:187], v16 offset:34816
    v_mfma_f32_16x16x32_bf16 a[136:139], v[112:115], v[72:75], a[136:139]
    ds_read_b64_tr_b16 v[188:189], v17 offset:32768
    v_mfma_f32_16x16x32_bf16 a[140:143], v[112:115], v[76:79], a[140:143]
    ds_read_b64_tr_b16 v[190:191], v17 offset:34816
    v_mfma_f32_16x16x32_bf16 a[160:163], v[116:119], v[64:67], a[160:163]
    v_mfma_f32_16x16x32_bf16 a[164:167], v[116:119], v[68:71], a[164:167]
    v_mfma_f32_16x16x32_bf16 a[168:171], v[116:119], v[72:75], a[168:171]
    v_mfma_f32_16x16x32_bf16 a[172:175], v[116:119], v[76:79], a[172:175]
    v_mfma_f32_16x16x32_bf16 a[192:195], v[120:123], v[64:67], a[192:195]
    v_mfma_f32_16x16x32_bf16 a[196:199], v[120:123], v[68:71], a[196:199]
    v_mfma_f32_16x16x32_bf16 a[200:203], v[120:123], v[72:75], a[200:203]
    v_mfma_f32_16x16x32_bf16 a[204:207], v[120:123], v[76:79], a[204:207]
    v_mfma_f32_16x16x32_bf16 a[224:227], v[124:127], v[64:67], a[224:227]
    v_mfma_f32_16x16x32_bf16 a[228:231], v[124:127], v[68:71], a[228:231]
    v_mfma_f32_16x16x32_bf16 a[232:235], v[124:127], v[72:75], a[232:235]
    v_mfma_f32_16x16x32_bf16 a[236:239], v[124:127], v[76:79], a[236:239]
    v_xor_b32 v8, 0x10000, v8
    v_xor_b32 v10, 0x10000, v10
    v_xor_b32 v11, 0x10000, v11
    v_xor_b32 v12, 0x10000, v12
    v_xor_b32 v13, 0x10000, v13
    v_xor_b32 v14, 0x10000, v14
    v_xor_b32 v15, 0x10000, v15
    v_xor_b32 v16, 0x10000, v16
    v_xor_b32 v17, 0x10000, v17
    s_waitcnt vmcnt(6) lgkmcnt(0)
    s_barrier
    v_mfma_f32_16x16x32_bf16 a[0:3], v[160:163], v[128:131], a[0:3]
    ds_read_b64_tr_b16 v[96:97], v10 offset:0
    v_mfma_f32_16x16x32_bf16 a[4:7], v[160:163], v[132:135], a[4:7]
    ds_read_b64_tr_b16 v[98:99], v10 offset:2048
    v_mfma_f32_16x16x32_bf16 a[8:11], v[160:163], v[136:139], a[8:11]
    ds_read_b128 v[64:67], v8 offset:0
    v_mfma_f32_16x16x32_bf16 a[12:15], v[160:163], v[140:143], a[12:15]
    ds_read_b64_tr_b16 v[100:101], v11 offset:0
    v_mfma_f32_16x16x32_bf16 a[32:35], v[164:167], v[128:131], a[32:35]
    ds_read_b64_tr_b16 v[102:103], v11 offset:2048
    v_mfma_f32_16x16x32_bf16 a[36:39], v[164:167], v[132:135], a[36:39]
    ds_read_b128 v[68:71], v8 offset:1024
    v_mfma_f32_16x16x32_bf16 a[40:43], v[164:167], v[136:139], a[40:43]
    ds_read_b64_tr_b16 v[104:105], v12 offset:0
    v_mfma_f32_16x16x32_bf16 a[44:47], v[164:167], v[140:143], a[44:47]
    ds_read_b64_tr_b16 v[106:107], v12 offset:2048
    v_mfma_f32_16x16x32_bf16 a[64:67], v[168:171], v[128:131], a[64:67]
    ds_read_b128 v[72:75], v8 offset:2048
    v_mfma_f32_16x16x32_bf16 a[68:71], v[168:171], v[132:135], a[68:71]
    ds_read_b64_tr_b16 v[108:109], v13 offset:0
    v_mfma_f32_16x16x32_bf16 a[72:75], v[168:171], v[136:139], a[72:75]
    ds_read_b64_tr_b16 v[110:111], v13 offset:2048
    v_mfma_f32_16x16x32_bf16 a[76:79], v[168:171], v[140:143], a[76:79]
    ds_read_b128 v[76:79], v8 offset:3072
    v_mfma_f32_16x16x32_bf16 a[96:99], v[172:175], v[128:131], a[96:99]
    ds_read_b64_tr_b16 v[112:113], v14 offset:0
    v_mfma_f32_16x16x32_bf16 a[100:103], v[172:175], v[132:135], a[100:103]
    ds_read_b64_tr_b16 v[114:115], v14 offset:2048
    v_mfma_f32_16x16x32_bf16 a[104:107], v[172:175], v[136:139], a[104:107]
    ds_read_b64_tr_b16 v[116:117], v15 offset:0
    v_mfma_f32_16x16x32_bf16 a[108:111], v[172:175], v[140:143], a[108:111]
    ds_read_b64_tr_b16 v[118:119], v15 offset:2048
    v_mfma_f32_16x16x32_bf16 a[128:131], v[176:179], v[128:131], a[128:131]
    ds_read_b64_tr_b16 v[120:121], v16 offset:0
    v_mfma_f32_16x16x32_bf16 a[132:135], v[176:179], v[132:135], a[132:135]
    ds_read_b64_tr_b16 v[122:123], v16 offset:2048
    v_mfma_f32_16x16x32_bf16 a[136:139], v[176:179], v[136:139], a[136:139]
    ds_read_b64_tr_b16 v[124:125], v17 offset:0
    v_mfma_f32_16x16x32_bf16 a[140:143], v[176:179], v[140:143], a[140:143]
    ds_read_b64_tr_b16 v[126:127], v17 offset:2048
    v_mfma_f32_16x16x32_bf16 a[160:163], v[180:183], v[128:131], a[160:163]
    v_mfma_f32_16x16x32_bf16 a[164:167], v[180:183], v[132:135], a[164:167]
    v_mfma_f32_16x16x32_bf16 a[168:171], v[180:183], v[136:139], a[168:171]
    v_mfma_f32_16x16x32_bf16 a[172:175], v[180:183], v[140:143], a[172:175]
    v_mfma_f32_16x16x32_bf16 a[192:195], v[184:187], v[128:131], a[192:195]
    v_mfma_f32_16x16x32_bf16 a[196:199], v[184:187], v[132:135], a[196:199]
    v_mfma_f32_16x16x32_bf16 a[200:203], v[184:187], v[136:139], a[200:203]
    v_mfma_f32_16x16x32_bf16 a[204:207], v[184:187], v[140:143], a[204:207]
    v_mfma_f32_16x16x32_bf16 a[224:227], v[188:191], v[128:131], a[224:227]
    v_mfma_f32_16x16x32_bf16 a[228:231], v[188:191], v[132:135], a[228:231]
    v_mfma_f32_16x16x32_bf16 a[232:235], v[188:191], v[136:139], a[232:235]
    v_mfma_f32_16x16x32_bf16 a[236:239], v[188:191], v[140:143], a[236:239]
    s_waitcnt vmcnt(0) lgkmcnt(0)
    s_barrier
    v_mfma_f32_16x16x32_bf16 a[0:3], v[96:99], v[64:67], a[0:3]
    ds_read_b64_tr_b16 v[160:161], v10 offset:32768
    v_mfma_f32_16x16x32_bf16 a[4:7], v[96:99], v[68:71], a[4:7]
    ds_read_b64_tr_b16 v[162:163], v10 offset:34816
    v_mfma_f32_16x16x32_bf16 a[8:11], v[96:99], v[72:75], a[8:11]
    ds_read_b128 v[128:131], v8 offset:32768
    v_mfma_f32_16x16x32_bf16 a[12:15], v[96:99], v[76:79], a[12:15]
    ds_read_b64_tr_b16 v[164:165], v11 offset:32768
    v_mfma_f32_16x16x32_bf16 a[32:35], v[100:103], v[64:67], a[32:35]
    ds_read_b64_tr_b16 v[166:167], v11 offset:34816
    v_mfma_f32_16x16x32_bf16 a[36:39], v[100:103], v[68:71], a[36:39]
    ds_read_b128 v[132:135], v8 offset:33792
    v_mfma_f32_16x16x32_bf16 a[40:43], v[100:103], v[72:75], a[40:43]
    ds_read_b64_tr_b16 v[168:169], v12 offset:32768
    v_mfma_f32_16x16x32_bf16 a[44:47], v[100:103], v[76:79], a[44:47]
    ds_read_b64_tr_b16 v[170:171], v12 offset:34816
    v_mfma_f32_16x16x32_bf16 a[64:67], v[104:107], v[64:67], a[64:67]
    ds_read_b128 v[136:139], v8 offset:34816
    v_mfma_f32_16x16x32_bf16 a[68:71], v[104:107], v[68:71], a[68:71]
    ds_read_b64_tr_b16 v[172:173], v13 offset:32768
    v_mfma_f32_16x16x32_bf16 a[72:75], v[104:107], v[72:75], a[72:75]
    ds_read_b64_tr_b16 v[174:175], v13 offset:34816
    v_mfma_f32_16x16x32_bf16 a[76:79], v[104:107], v[76:79], a[76:79]
    ds_read_b128 v[140:143], v8 offset:35840
    v_mfma_f32_16x16x32_bf16 a[96:99], v[108:111], v[64:67], a[96:99]
    ds_read_b64_tr_b16 v[176:177], v14 offset:32768
    v_mfma_f32_16x16x32_bf16 a[100:103], v[108:111], v[68:71], a[100:103]
    ds_read_b64_tr_b16 v[178:179], v14 offset:34816
    v_mfma_f32_16x16x32_bf16 a[104:107], v[108:111], v[72:75], a[104:107]
    ds_read_b64_tr_b16 v[180:181], v15 offset:32768
    v_mfma_f32_16x16x32_bf16 a[108:111], v[108:111], v[76:79], a[108:111]
    ds_read_b64_tr_b16 v[182:183], v15 offset:34816
    v_mfma_f32_16x16x32_bf16 a[128:131], v[112:115], v[64:67], a[128:131]
    ds_read_b64_tr_b16 v[184:185], v16 offset:32768
    v_mfma_f32_16x16x32_bf16 a[132:135], v[112:115], v[68:71], a[132:135]
    ds_read_b64_tr_b16 v[186:187], v16 offset:34816
    v_mfma_f32_16x16x32_bf16 a[136:139], v[112:115], v[72:75], a[136:139]
    ds_read_b64_tr_b16 v[188:189], v17 offset:32768
    v_mfma_f32_16x16x32_bf16 a[140:143], v[112:115], v[76:79], a[140:143]
    ds_read_b64_tr_b16 v[190:191], v17 offset:34816
    v_mfma_f32_16x16x32_bf16 a[160:163], v[116:119], v[64:67], a[160:163]
    v_mfma_f32_16x16x32_bf16 a[164:167], v[116:119], v[68:71], a[164:167]
    v_mfma_f32_16x16x32_bf16 a[168:171], v[116:119], v[72:75], a[168:171]
    v_mfma_f32_16x16x32_bf16 a[172:175], v[116:119], v[76:79], a[172:175]
    v_mfma_f32_16x16x32_bf16 a[192:195], v[120:123], v[64:67], a[192:195]
    v_mfma_f32_16x16x32_bf16 a[196:199], v[120:123], v[68:71], a[196:199]
    v_mfma_f32_16x16x32_bf16 a[200:203], v[120:123], v[72:75], a[200:203]
    v_mfma_f32_16x16x32_bf16 a[204:207], v[120:123], v[76:79], a[204:207]
    v_mfma_f32_16x16x32_bf16 a[224:227], v[124:127], v[64:67], a[224:227]
    v_mfma_f32_16x16x32_bf16 a[228:231], v[124:127], v[68:71], a[228:231]
    v_mfma_f32_16x16x32_bf16 a[232:235], v[124:127], v[72:75], a[232:235]
    v_mfma_f32_16x16x32_bf16 a[236:239], v[124:127], v[76:79], a[236:239]
    s_waitcnt lgkmcnt(0)
    s_barrier
    v_mfma_f32_16x16x32_bf16 a[0:3], v[160:163], v[128:131], a[0:3]
    v_mfma_f32_16x16x32_bf16 a[4:7], v[160:163], v[132:135], a[4:7]
    v_mfma_f32_16x16x32_bf16 a[8:11], v[160:163], v[136:139], a[8:11]
    v_mfma_f32_16x16x32_bf16 a[12:15], v[160:163], v[140:143], a[12:15]
    v_mfma_f32_16x16x32_bf16 a[32:35], v[164:167], v[128:131], a[32:35]
    v_mfma_f32_16x16x32_bf16 a[36:39], v[164:167], v[132:135], a[36:39]
    v_mfma_f32_16x16x32_bf16 a[40:43], v[164:167], v[136:139], a[40:43]
    v_mfma_f32_16x16x32_bf16 a[44:47], v[164:167], v[140:143], a[44:47]
    v_mfma_f32_16x16x32_bf16 a[64:67], v[168:171], v[128:131], a[64:67]
    v_mfma_f32_16x16x32_bf16 a[68:71], v[168:171], v[132:135], a[68:71]
    v_mfma_f32_16x16x32_bf16 a[72:75], v[168:171], v[136:139], a[72:75]
    v_mfma_f32_16x16x32_bf16 a[76:79], v[168:171], v[140:143], a[76:79]
    v_mfma_f32_16x16x32_bf16 a[96:99], v[172:175], v[128:131], a[96:99]
    v_mfma_f32_16x16x32_bf16 a[100:103], v[172:175], v[132:135], a[100:103]
    v_mfma_f32_16x16x32_bf16 a[104:107], v[172:175], v[136:139], a[104:107]
    v_mfma_f32_16x16x32_bf16 a[108:111], v[172:175], v[140:143], a[108:111]
    v_mfma_f32_16x16x32_bf16 a[128:131], v[176:179], v[128:131], a[128:131]
    v_mfma_f32_16x16x32_bf16 a[132:135], v[176:179], v[132:135], a[132:135]
    v_mfma_f32_16x16x32_bf16 a[136:139], v[176:179], v[136:139], a[136:139]
    v_mfma_f32_16x16x32_bf16 a[140:143], v[176:179], v[140:143], a[140:143]
    v_mfma_f32_16x16x32_bf16 a[160:163], v[180:183], v[128:131], a[160:163]
    v_mfma_f32_16x16x32_bf16 a[164:167], v[180:183], v[132:135], a[164:167]
    v_mfma_f32_16x16x32_bf16 a[168:171], v[180:183], v[136:139], a[168:171]
    v_mfma_f32_16x16x32_bf16 a[172:175], v[180:183], v[140:143], a[172:175]
    v_mfma_f32_16x16x32_bf16 a[192:195], v[184:187], v[128:131], a[192:195]
    v_mfma_f32_16x16x32_bf16 a[196:199], v[184:187], v[132:135], a[196:199]
    v_mfma_f32_16x16x32_bf16 a[200:203], v[184:187], v[136:139], a[200:203]
    v_mfma_f32_16x16x32_bf16 a[204:207], v[184:187], v[140:143], a[204:207]
    v_mfma_f32_16x16x32_bf16 a[224:227], v[188:191], v[128:131], a[224:227]
    v_mfma_f32_16x16x32_bf16 a[228:231], v[188:191], v[132:135], a[228:231]
    v_mfma_f32_16x16x32_bf16 a[232:235], v[188:191], v[136:139], a[232:235]
    v_mfma_f32_16x16x32_bf16 a[236:239], v[188:191], v[140:143], a[236:239]
    s_lshl_b32 s54, s61, 1
    s_and_b32 s55, s3, 1
    s_add_u32 s54, s54, s55
    s_lshl_b32 s52, s54, 19
    s_lshl_b32 s54, s60, 1
    s_add_u32 s54, s54, s62
    s_lshl_b32 s54, s54, 1
    s_lshr_b32 s55, s3, 1
    s_add_u32 s54, s54, s55
    s_lshl_b32 s54, s54, 14
    s_add_u32 s52, s52, s54
    s_add_u32 s52, s52, 19136512
    v_accvgpr_read_b32 v68, a0
    v_accvgpr_read_b32 v69, a1
    v_accvgpr_read_b32 v70, a2
    v_accvgpr_read_b32 v71, a3
    v_cvt_pk_bf16_f32 v64, v68, v69
    v_cvt_pk_bf16_f32 v65, v70, v71
    v_accvgpr_read_b32 v68, a32
    v_accvgpr_read_b32 v69, a33
    v_accvgpr_read_b32 v70, a34
    v_accvgpr_read_b32 v71, a35
    v_cvt_pk_bf16_f32 v66, v68, v69
    v_cvt_pk_bf16_f32 v67, v70, v71
    s_add_u32 s54, s52, 0
    buffer_store_dwordx4 v[64:67], v18, s[8:11], s54 offen sc1
    v_accvgpr_read_b32 v84, a64
    v_accvgpr_read_b32 v85, a65
    v_accvgpr_read_b32 v86, a66
    v_accvgpr_read_b32 v87, a67
    v_cvt_pk_bf16_f32 v80, v84, v85
    v_cvt_pk_bf16_f32 v81, v86, v87
    v_accvgpr_read_b32 v84, a96
    v_accvgpr_read_b32 v85, a97
    v_accvgpr_read_b32 v86, a98
    v_accvgpr_read_b32 v87, a99
    v_cvt_pk_bf16_f32 v82, v84, v85
    v_cvt_pk_bf16_f32 v83, v86, v87
    s_add_u32 s54, s52, 2048
    buffer_store_dwordx4 v[80:83], v18, s[8:11], s54 offen sc1
    v_accvgpr_read_b32 v100, a128
    v_accvgpr_read_b32 v101, a129
    v_accvgpr_read_b32 v102, a130
    v_accvgpr_read_b32 v103, a131
    v_cvt_pk_bf16_f32 v96, v100, v101
    v_cvt_pk_bf16_f32 v97, v102, v103
    v_accvgpr_read_b32 v100, a160
    v_accvgpr_read_b32 v101, a161
    v_accvgpr_read_b32 v102, a162
    v_accvgpr_read_b32 v103, a163
    v_cvt_pk_bf16_f32 v98, v100, v101
    v_cvt_pk_bf16_f32 v99, v102, v103
    s_add_u32 s54, s52, 4096
    buffer_store_dwordx4 v[96:99], v18, s[8:11], s54 offen sc1
    v_accvgpr_read_b32 v116, a192
    v_accvgpr_read_b32 v117, a193
    v_accvgpr_read_b32 v118, a194
    v_accvgpr_read_b32 v119, a195
    v_cvt_pk_bf16_f32 v112, v116, v117
    v_cvt_pk_bf16_f32 v113, v118, v119
    v_accvgpr_read_b32 v116, a224
    v_accvgpr_read_b32 v117, a225
    v_accvgpr_read_b32 v118, a226
    v_accvgpr_read_b32 v119, a227
    v_cvt_pk_bf16_f32 v114, v116, v117
    v_cvt_pk_bf16_f32 v115, v118, v119
    s_add_u32 s54, s52, 6144
    buffer_store_dwordx4 v[112:115], v18, s[8:11], s54 offen sc1
    v_accvgpr_read_b32 v68, a4
    v_accvgpr_read_b32 v69, a5
    v_accvgpr_read_b32 v70, a6
    v_accvgpr_read_b32 v71, a7
    v_cvt_pk_bf16_f32 v66, v68, v69
    v_cvt_pk_bf16_f32 v67, v70, v71
    v_accvgpr_read_b32 v68, a36
    v_accvgpr_read_b32 v69, a37
    v_accvgpr_read_b32 v70, a38
    v_accvgpr_read_b32 v71, a39
    v_cvt_pk_bf16_f32 v64, v68, v69
    v_cvt_pk_bf16_f32 v65, v70, v71
    s_add_u32 s54, s52, 1024
    buffer_store_dwordx4 v[64:67], v18, s[8:11], s54 offen sc1
    v_accvgpr_read_b32 v84, a68
    v_accvgpr_read_b32 v85, a69
    v_accvgpr_read_b32 v86, a70
    v_accvgpr_read_b32 v87, a71
    v_cvt_pk_bf16_f32 v82, v84, v85
    v_cvt_pk_bf16_f32 v83, v86, v87
    v_accvgpr_read_b32 v84, a100
    v_accvgpr_read_b32 v85, a101
    v_accvgpr_read_b32 v86, a102
    v_accvgpr_read_b32 v87, a103
    v_cvt_pk_bf16_f32 v80, v84, v85
    v_cvt_pk_bf16_f32 v81, v86, v87
    s_add_u32 s54, s52, 3072
    buffer_store_dwordx4 v[80:83], v18, s[8:11], s54 offen sc1
    v_accvgpr_read_b32 v100, a132
    v_accvgpr_read_b32 v101, a133
    v_accvgpr_read_b32 v102, a134
    v_accvgpr_read_b32 v103, a135
    v_cvt_pk_bf16_f32 v98, v100, v101
    v_cvt_pk_bf16_f32 v99, v102, v103
    v_accvgpr_read_b32 v100, a164
    v_accvgpr_read_b32 v101, a165
    v_accvgpr_read_b32 v102, a166
    v_accvgpr_read_b32 v103, a167
    v_cvt_pk_bf16_f32 v96, v100, v101
    v_cvt_pk_bf16_f32 v97, v102, v103
    s_add_u32 s54, s52, 5120
    buffer_store_dwordx4 v[96:99], v18, s[8:11], s54 offen sc1
    v_accvgpr_read_b32 v116, a196
    v_accvgpr_read_b32 v117, a197
    v_accvgpr_read_b32 v118, a198
    v_accvgpr_read_b32 v119, a199
    v_cvt_pk_bf16_f32 v114, v116, v117
    v_cvt_pk_bf16_f32 v115, v118, v119
    v_accvgpr_read_b32 v116, a228
    v_accvgpr_read_b32 v117, a229
    v_accvgpr_read_b32 v118, a230
    v_accvgpr_read_b32 v119, a231
    v_cvt_pk_bf16_f32 v112, v116, v117
    v_cvt_pk_bf16_f32 v113, v118, v119
    s_add_u32 s54, s52, 7168
    buffer_store_dwordx4 v[112:115], v18, s[8:11], s54 offen sc1
    v_accvgpr_read_b32 v68, a8
    v_accvgpr_read_b32 v69, a9
    v_accvgpr_read_b32 v70, a10
    v_accvgpr_read_b32 v71, a11
    v_cvt_pk_bf16_f32 v64, v68, v69
    v_cvt_pk_bf16_f32 v65, v70, v71
    v_accvgpr_read_b32 v68, a40
    v_accvgpr_read_b32 v69, a41
    v_accvgpr_read_b32 v70, a42
    v_accvgpr_read_b32 v71, a43
    v_cvt_pk_bf16_f32 v66, v68, v69
    v_cvt_pk_bf16_f32 v67, v70, v71
    s_add_u32 s54, s52, 8192
    buffer_store_dwordx4 v[64:67], v18, s[8:11], s54 offen sc1
    v_accvgpr_read_b32 v84, a72
    v_accvgpr_read_b32 v85, a73
    v_accvgpr_read_b32 v86, a74
    v_accvgpr_read_b32 v87, a75
    v_cvt_pk_bf16_f32 v80, v84, v85
    v_cvt_pk_bf16_f32 v81, v86, v87
    v_accvgpr_read_b32 v84, a104
    v_accvgpr_read_b32 v85, a105
    v_accvgpr_read_b32 v86, a106
    v_accvgpr_read_b32 v87, a107
    v_cvt_pk_bf16_f32 v82, v84, v85
    v_cvt_pk_bf16_f32 v83, v86, v87
    s_add_u32 s54, s52, 10240
    buffer_store_dwordx4 v[80:83], v18, s[8:11], s54 offen sc1
    v_accvgpr_read_b32 v100, a136
    v_accvgpr_read_b32 v101, a137
    v_accvgpr_read_b32 v102, a138
    v_accvgpr_read_b32 v103, a139
    v_cvt_pk_bf16_f32 v96, v100, v101
    v_cvt_pk_bf16_f32 v97, v102, v103
    v_accvgpr_read_b32 v100, a168
    v_accvgpr_read_b32 v101, a169
    v_accvgpr_read_b32 v102, a170
    v_accvgpr_read_b32 v103, a171
    v_cvt_pk_bf16_f32 v98, v100, v101
    v_cvt_pk_bf16_f32 v99, v102, v103
    s_add_u32 s54, s52, 12288
    buffer_store_dwordx4 v[96:99], v18, s[8:11], s54 offen sc1
    v_accvgpr_read_b32 v116, a200
    v_accvgpr_read_b32 v117, a201
    v_accvgpr_read_b32 v118, a202
    v_accvgpr_read_b32 v119, a203
    v_cvt_pk_bf16_f32 v112, v116, v117
    v_cvt_pk_bf16_f32 v113, v118, v119
    v_accvgpr_read_b32 v116, a232
    v_accvgpr_read_b32 v117, a233
    v_accvgpr_read_b32 v118, a234
    v_accvgpr_read_b32 v119, a235
    v_cvt_pk_bf16_f32 v114, v116, v117
    v_cvt_pk_bf16_f32 v115, v118, v119
    s_add_u32 s54, s52, 14336
    buffer_store_dwordx4 v[112:115], v18, s[8:11], s54 offen sc1
    v_accvgpr_read_b32 v68, a12
    v_accvgpr_read_b32 v69, a13
    v_accvgpr_read_b32 v70, a14
    v_accvgpr_read_b32 v71, a15
    v_cvt_pk_bf16_f32 v66, v68, v69
    v_cvt_pk_bf16_f32 v67, v70, v71
    v_accvgpr_read_b32 v68, a44
    v_accvgpr_read_b32 v69, a45
    v_accvgpr_read_b32 v70, a46
    v_accvgpr_read_b32 v71, a47
    v_cvt_pk_bf16_f32 v64, v68, v69
    v_cvt_pk_bf16_f32 v65, v70, v71
    s_add_u32 s54, s52, 9216
    buffer_store_dwordx4 v[64:67], v18, s[8:11], s54 offen sc1
    v_accvgpr_read_b32 v84, a76
    v_accvgpr_read_b32 v85, a77
    v_accvgpr_read_b32 v86, a78
    v_accvgpr_read_b32 v87, a79
    v_cvt_pk_bf16_f32 v82, v84, v85
    v_cvt_pk_bf16_f32 v83, v86, v87
    v_accvgpr_read_b32 v84, a108
    v_accvgpr_read_b32 v85, a109
    v_accvgpr_read_b32 v86, a110
    v_accvgpr_read_b32 v87, a111
    v_cvt_pk_bf16_f32 v80, v84, v85
    v_cvt_pk_bf16_f32 v81, v86, v87
    s_add_u32 s54, s52, 11264
    buffer_store_dwordx4 v[80:83], v18, s[8:11], s54 offen sc1
    v_accvgpr_read_b32 v100, a140
    v_accvgpr_read_b32 v101, a141
    v_accvgpr_read_b32 v102, a142
    v_accvgpr_read_b32 v103, a143
    v_cvt_pk_bf16_f32 v98, v100, v101
    v_cvt_pk_bf16_f32 v99, v102, v103
    v_accvgpr_read_b32 v100, a172
    v_accvgpr_read_b32 v101, a173
    v_accvgpr_read_b32 v102, a174
    v_accvgpr_read_b32 v103, a175
    v_cvt_pk_bf16_f32 v96, v100, v101
    v_cvt_pk_bf16_f32 v97, v102, v103
    s_add_u32 s54, s52, 13312
    buffer_store_dwordx4 v[96:99], v18, s[8:11], s54 offen sc1
    v_accvgpr_read_b32 v116, a204
    v_accvgpr_read_b32 v117, a205
    v_accvgpr_read_b32 v118, a206
    v_accvgpr_read_b32 v119, a207
    v_cvt_pk_bf16_f32 v114, v116, v117
    v_cvt_pk_bf16_f32 v115, v118, v119
    v_accvgpr_read_b32 v116, a236
    v_accvgpr_read_b32 v117, a237
    v_accvgpr_read_b32 v118, a238
    v_accvgpr_read_b32 v119, a239
    v_cvt_pk_bf16_f32 v112, v116, v117
    v_cvt_pk_bf16_f32 v113, v118, v119
    s_add_u32 s54, s52, 15360
    buffer_store_dwordx4 v[112:115], v18, s[8:11], s54 offen sc1
    s_branch W_DONE
W_thv:
    s_mov_b64 s[12:13], s[28:29]
    s_mov_b32 s14, 4718592
    s_mov_b32 s63, 8192
    v_and_b32 v1, 63, v0
    v_lshrrev_b32 v2, 4, v1
    v_lshlrev_b32 v18, 4, v1
    s_lshr_b32 s54, s3, 1
    s_lshl_b32 s54, s54, 12
    v_add_u32 v8, s54, v18
    v_bfe_u32 v3, v1, 2, 2
    v_and_b32 v4, 3, v1
    v_and_b32 v5, 1, v2
    v_lshl_add_u32 v5, v5, 2, v3
    v_lshlrev_b32 v6, 12, v2
    v_lshl_add_u32 v6, v3, 9, v6
    v_lshl_add_u32 v6, v4, 3, v6
    v_add_u32 v6, 16384, v6
    s_and_b32 s54, s3, 1
    s_mul_i32 s54, s54, 8
    s_add_u32 s55, s54, 0
    v_xor_b32 v7, s55, v5
    v_lshl_add_u32 v10, v7, 5, v6
    s_add_u32 s55, s54, 1
    v_xor_b32 v7, s55, v5
    v_lshl_add_u32 v11, v7, 5, v6
    s_add_u32 s55, s54, 2
    v_xor_b32 v7, s55, v5
    v_lshl_add_u32 v12, v7, 5, v6
    s_add_u32 s55, s54, 3
    v_xor_b32 v7, s55, v5
    v_lshl_add_u32 v13, v7, 5, v6
    s_add_u32 s55, s54, 4
    v_xor_b32 v7, s55, v5
    v_lshl_add_u32 v14, v7, 5, v6
    s_add_u32 s55, s54, 5
    v_xor_b32 v7, s55, v5
    v_lshl_add_u32 v15, v7, 5, v6
    s_add_u32 s55, s54, 6
    v_xor_b32 v7, s55, v5
    v_lshl_add_u32 v16, v7, 5, v6
    s_add_u32 s55, s54, 7
    v_xor_b32 v7, s55, v5
    v_lshl_add_u32 v17, v7, 5, v6
    s_and_b32 s54, s3, 1
    s_lshl_b32 s54, s54, 1
    s_lshr_b32 s55, s3, 1
    s_lshl_b32 s55, s55, 2
    s_or_b32 s54, s54, s55
    v_lshrrev_b32 v3, 5, v1
    v_or_b32 v4, s54, v3
    v_lshlrev_b32 v4, 1, v4
    v_and_b32 v5, 31, v1
    v_xor_b32 v4, v4, v5
    v_mul_lo_u32 v3, v3, s63
    v_lshl_add_u32 v19, v4, 4, v3
    s_mul_i32 s64, s60, 294912
    s_add_u32 s64, s64, 0
    s_mul_i32 s54, s62, 147456
    s_add_u32 s64, s64, s54
    s_lshl_b32 s65, s61, 9
    s_mul_i32 s54, s3, 36864
    s_add_u32 s54, s54, s64
    s_add_u32 s40, s54, 0
    s_add_u32 s41, s54, 18432
    s_and_b32 s54, s3, 1
    s_lshl_b32 s54, s54, 1
    s_lshr_b32 s55, s3, 1
    s_mul_i32 s55, s55, 8
    s_add_u32 s54, s54, s55
    s_add_u32 s55, s54, 0
    s_mul_i32 s55, s55, s63
    s_add_u32 s44, s55, s65
    s_add_u32 s55, s54, 4
    s_mul_i32 s55, s55, s63
    s_add_u32 s45, s55, s65
    s_add_u32 s55, s54, 16
    s_mul_i32 s55, s55, s63
    s_add_u32 s46, s55, s65
    s_add_u32 s55, s54, 20
    s_mul_i32 s55, s55, s63
    s_add_u32 s47, s55, s65
    s_lshl_b32 s50, s63, 5
    s_lshl_b32 s48, s3, 11
    s_and_b32 s54, s3, 1
    s_lshl_b32 s54, s54, 10
    s_lshr_b32 s55, s3, 1
    s_lshl_b32 s55, s55, 12
    s_add_u32 s49, s54, s55
    s_add_u32 s49, s49, 16384
    s_add_u32 m0, s48, 0
    s_nop 0
    buffer_load_dwordx4 v18, s[8:11], s40 offen  lds
    s_add_u32 s40, s40, 1024
    s_add_u32 m0, s48, 1024
    s_nop 0
    buffer_load_dwordx4 v18, s[8:11], s41 offen  lds
    s_add_u32 s41, s41, 1024
    s_add_u32 s48, s48, 32768
    s_and_b32 s48, s48, 0x1ffff
    s_add_u32 m0, s49, 0
    s_nop 0
    buffer_load_dwordx4 v19, s[12:15], s44 offen lds
    s_add_u32 s44, s44, s50
    s_add_u32 m0, s49, 2048
    s_nop 0
    buffer_load_dwordx4 v19, s[12:15], s45 offen lds
    s_add_u32 s45, s45, s50
    s_add_u32 m0, s49, 8192
    s_nop 0
    buffer_load_dwordx4 v19, s[12:15], s46 offen lds
    s_add_u32 s46, s46, s50
    s_add_u32 m0, s49, 10240
    s_nop 0
    buffer_load_dwordx4 v19, s[12:15], s47 offen lds
    s_add_u32 s47, s47, s50
    s_add_u32 s49, s49, 32768
    s_and_b32 s49, s49, 0x1ffff
    s_add_u32 m0, s48, 0
    s_nop 0
    buffer_load_dwordx4 v18, s[8:11], s40 offen  lds
    s_add_u32 s40, s40, 1024
    s_add_u32 m0, s48, 1024
    s_nop 0
    buffer_load_dwordx4 v18, s[8:11], s41 offen  lds
    s_add_u32 s41, s41, 1024
    s_add_u32 s48, s48, 32768
    s_and_b32 s48, s48, 0x1ffff
    s_add_u32 m0, s49, 0
    s_nop 0
    buffer_load_dwordx4 v19, s[12:15], s44 offen lds
    s_add_u32 s44, s44, s50
    s_add_u32 m0, s49, 2048
    s_nop 0
    buffer_load_dwordx4 v19, s[12:15], s45 offen lds
    s_add_u32 s45, s45, s50
    s_add_u32 m0, s49, 8192
    s_nop 0
    buffer_load_dwordx4 v19, s[12:15], s46 offen lds
    s_add_u32 s46, s46, s50
    s_add_u32 m0, s49, 10240
    s_nop 0
    buffer_load_dwordx4 v19, s[12:15], s47 offen lds
    s_add_u32 s47, s47, s50
    s_add_u32 s49, s49, 32768
    s_and_b32 s49, s49, 0x1ffff
    s_add_u32 m0, s48, 0
    s_nop 0
    buffer_load_dwordx4 v18, s[8:11], s40 offen  lds
    s_add_u32 s40, s40, 1024
    s_add_u32 m0, s48, 1024
    s_nop 0
    buffer_load_dwordx4 v18, s[8:11], s41 offen  lds
    s_add_u32 s41, s41, 1024
    s_add_u32 s48, s48, 32768
    s_and_b32 s48, s48, 0x1ffff
    s_add_u32 m0, s49, 0
    s_nop 0
    buffer_load_dwordx4 v19, s[12:15], s44 offen lds
    s_add_u32 s44, s44, s50
    s_add_u32 m0, s49, 2048
    s_nop 0
    buffer_load_dwordx4 v19, s[12:15], s45 offen lds
    s_add_u32 s45, s45, s50
    s_add_u32 m0, s49, 8192
    s_nop 0
    buffer_load_dwordx4 v19, s[12:15], s46 offen lds
    s_add_u32 s46, s46, s50
    s_add_u32 m0, s49, 10240
    s_nop 0
    buffer_load_dwordx4 v19, s[12:15], s47 offen lds
    s_add_u32 s47, s47, s50
    s_add_u32 s49, s49, 32768
    s_and_b32 s49, s49, 0x1ffff
    s_add_u32 m0, s48, 0
    s_nop 0
    buffer_load_dwordx4 v18, s[8:11], s40 offen  lds
    s_add_u32 s40, s40, 1024
    s_add_u32 m0, s48, 1024
    s_nop 0
    buffer_load_dwordx4 v18, s[8:11], s41 offen  lds
    s_add_u32 s41, s41, 1024
    s_add_u32 s48, s48, 32768
    s_and_b32 s48, s48, 0x1ffff
    s_add_u32 m0, s49, 0
    s_nop 0
    buffer_load_dwordx4 v19, s[12:15], s44 offen lds
    s_add_u32 s44, s44, s50
    s_add_u32 m0, s49, 2048
    s_nop 0
    buffer_load_dwordx4 v19, s[12:15], s45 offen lds
    s_add_u32 s45, s45, s50
    s_add_u32 m0, s49, 8192
    s_nop 0
    buffer_load_dwordx4 v19, s[12:15], s46 offen lds
    s_add_u32 s46, s46, s50
    s_add_u32 m0, s49, 10240
    s_nop 0
    buffer_load_dwordx4 v19, s[12:15], s47 offen lds
    s_add_u32 s47, s47, s50
    s_add_u32 s49, s49, 32768
    s_and_b32 s49, s49, 0x1ffff
    v_accvgpr_write_b32 a0, 0
    v_accvgpr_write_b32 a1, 0
    v_accvgpr_write_b32 a2, 0
    v_accvgpr_write_b32 a3, 0
    v_accvgpr_write_b32 a4, 0
    v_accvgpr_write_b32 a5, 0
    v_accvgpr_write_b32 a6, 0
    v_accvgpr_write_b32 a7, 0
    v_accvgpr_write_b32 a8, 0
    v_accvgpr_write_b32 a9, 0
    v_accvgpr_write_b32 a10, 0
    v_accvgpr_write_b32 a11, 0
    v_accvgpr_write_b32 a12, 0
    v_accvgpr_write_b32 a13, 0
    v_accvgpr_write_b32 a14, 0
    v_accvgpr_write_b32 a15, 0
    v_accvgpr_write_b32 a32, 0
    v_accvgpr_write_b32 a33, 0
    v_accvgpr_write_b32 a34, 0
    v_accvgpr_write_b32 a35, 0
    v_accvgpr_write_b32 a36, 0
    v_accvgpr_write_b32 a37, 0
    v_accvgpr_write_b32 a38, 0
    v_accvgpr_write_b32 a39, 0
    v_accvgpr_write_b32 a40, 0
    v_accvgpr_write_b32 a41, 0
    v_accvgpr_write_b32 a42, 0
    v_accvgpr_write_b32 a43, 0
    v_accvgpr_write_b32 a44, 0
    v_accvgpr_write_b32 a45, 0
    v_accvgpr_write_b32 a46, 0
    v_accvgpr_write_b32 a47, 0
    v_accvgpr_write_b32 a64, 0
    v_accvgpr_write_b32 a65, 0
    v_accvgpr_write_b32 a66, 0
    v_accvgpr_write_b32 a67, 0
    v_accvgpr_write_b32 a68, 0
    v_accvgpr_write_b32 a69, 0
    v_accvgpr_write_b32 a70, 0
    v_accvgpr_write_b32 a71, 0
    v_accvgpr_write_b32 a72, 0
    v_accvgpr_write_b32 a73, 0
    v_accvgpr_write_b32 a74, 0
    v_accvgpr_write_b32 a75, 0
    v_accvgpr_write_b32 a76, 0
    v_accvgpr_write_b32 a77, 0
    v_accvgpr_write_b32 a78, 0
    v_accvgpr_write_b32 a79, 0
    v_accvgpr_write_b32 a96, 0
    v_accvgpr_write_b32 a97, 0
    v_accvgpr_write_b32 a98, 0
    v_accvgpr_write_b32 a99, 0
    v_accvgpr_write_b32 a100, 0
    v_accvgpr_write_b32 a101, 0
    v_accvgpr_write_b32 a102, 0
    v_accvgpr_write_b32 a103, 0
    v_accvgpr_write_b32 a104, 0
    v_accvgpr_write_b32 a105, 0
    v_accvgpr_write_b32 a106, 0
    v_accvgpr_write_b32 a107, 0
    v_accvgpr_write_b32 a108, 0
    v_accvgpr_write_b32 a109, 0
    v_accvgpr_write_b32 a110, 0
    v_accvgpr_write_b32 a111, 0
    v_accvgpr_write_b32 a128, 0
    v_accvgpr_write_b32 a129, 0
    v_accvgpr_write_b32 a130, 0
    v_accvgpr_write_b32 a131, 0
    v_accvgpr_write_b32 a132, 0
    v_accvgpr_write_b32 a133, 0
    v_accvgpr_write_b32 a134, 0
    v_accvgpr_write_b32 a135, 0
    v_accvgpr_write_b32 a136, 0
    v_accvgpr_write_b32 a137, 0
    v_accvgpr_write_b32 a138, 0
    v_accvgpr_write_b32 a139, 0
    v_accvgpr_write_b32 a140, 0
    v_accvgpr_write_b32 a141, 0
    v_accvgpr_write_b32 a142, 0
    v_accvgpr_write_b32 a143, 0
    v_accvgpr_write_b32 a160, 0
    v_accvgpr_write_b32 a161, 0
    v_accvgpr_write_b32 a162, 0
    v_accvgpr_write_b32 a163, 0
    v_accvgpr_write_b32 a164, 0
    v_accvgpr_write_b32 a165, 0
    v_accvgpr_write_b32 a166, 0
    v_accvgpr_write_b32 a167, 0
    v_accvgpr_write_b32 a168, 0
    v_accvgpr_write_b32 a169, 0
    v_accvgpr_write_b32 a170, 0
    v_accvgpr_write_b32 a171, 0
    v_accvgpr_write_b32 a172, 0
    v_accvgpr_write_b32 a173, 0
    v_accvgpr_write_b32 a174, 0
    v_accvgpr_write_b32 a175, 0
    v_accvgpr_write_b32 a192, 0
    v_accvgpr_write_b32 a193, 0
    v_accvgpr_write_b32 a194, 0
    v_accvgpr_write_b32 a195, 0
    v_accvgpr_write_b32 a196, 0
    v_accvgpr_write_b32 a197, 0
    v_accvgpr_write_b32 a198, 0
    v_accvgpr_write_b32 a199, 0
    v_accvgpr_write_b32 a200, 0
    v_accvgpr_write_b32 a201, 0
    v_accvgpr_write_b32 a202, 0
    v_accvgpr_write_b32 a203, 0
    v_accvgpr_write_b32 a204, 0
    v_accvgpr_write_b32 a205, 0
    v_accvgpr_write_b32 a206, 0
    v_accvgpr_write_b32 a207, 0
    v_accvgpr_write_b32 a224, 0
    v_accvgpr_write_b32 a225, 0
    v_accvgpr_write_b32 a226, 0
    v_accvgpr_write_b32 a227, 0
    v_accvgpr_write_b32 a228, 0
    v_accvgpr_write_b32 a229, 0
    v_accvgpr_write_b32 a230, 0
    v_accvgpr_write_b32 a231, 0
    v_accvgpr_write_b32 a232, 0
    v_accvgpr_write_b32 a233, 0
    v_accvgpr_write_b32 a234, 0
    v_accvgpr_write_b32 a235, 0
    v_accvgpr_write_b32 a236, 0
    v_accvgpr_write_b32 a237, 0
    v_accvgpr_write_b32 a238, 0
    v_accvgpr_write_b32 a239, 0
    s_waitcnt vmcnt(18)
    s_barrier
    ds_read_b64_tr_b16 v[96:97], v10 offset:0
    ds_read_b64_tr_b16 v[98:99], v10 offset:2048
    ds_read_b128 v[64:67], v8 offset:0
    ds_read_b64_tr_b16 v[100:101], v11 offset:0
    ds_read_b64_tr_b16 v[102:103], v11 offset:2048
    ds_read_b128 v[68:71], v8 offset:1024
    ds_read_b64_tr_b16 v[104:105], v12 offset:0
    ds_read_b64_tr_b16 v[106:107], v12 offset:2048
    ds_read_b128 v[72:75], v8 offset:2048
    ds_read_b64_tr_b16 v[108:109], v13 offset:0
    ds_read_b64_tr_b16 v[110:111], v13 offset:2048
    ds_read_b128 v[76:79], v8 offset:3072
    ds_read_b64_tr_b16 v[112:113], v14 offset:0
    ds_read_b64_tr_b16 v[114:115], v14 offset:2048
    ds_read_b64_tr_b16 v[116:117], v15 offset:0
    ds_read_b64_tr_b16 v[118:119], v15 offset:2048
    ds_read_b64_tr_b16 v[120:121], v16 offset:0
    ds_read_b64_tr_b16 v[122:123], v16 offset:2048
    ds_read_b64_tr_b16 v[124:125], v17 offset:0
    ds_read_b64_tr_b16 v[126:127], v17 offset:2048
    s_mov_b32 s51, 7
Gvh_loop:
    s_waitcnt vmcnt(12) lgkmcnt(0)
    s_barrier
    v_mfma_f32_16x16x32_bf16 a[0:3], v[64:67], v[96:99], a[0:3]
    ds_read_b64_tr_b16 v[160:161], v10 offset:32768
    v_mfma_f32_16x16x32_bf16 a[4:7], v[68:71], v[96:99], a[4:7]
    ds_read_b64_tr_b16 v[162:163], v10 offset:34816
    v_mfma_f32_16x16x32_bf16 a[8:11], v[72:75], v[96:99], a[8:11]
    ds_read_b128 v[128:131], v8 offset:32768
    s_add_u32 m0, s48, 0
    s_nop 0
    buffer_load_dwordx4 v18, s[8:11], s40 offen  lds
    s_add_u32 s40, s40, 1024
    v_mfma_f32_16x16x32_bf16 a[12:15], v[76:79], v[96:99], a[12:15]
    ds_read_b64_tr_b16 v[164:165], v11 offset:32768
    v_mfma_f32_16x16x32_bf16 a[32:35], v[64:67], v[100:103], a[32:35]
    ds_read_b64_tr_b16 v[166:167], v11 offset:34816
    v_mfma_f32_16x16x32_bf16 a[36:39], v[68:71], v[100:103], a[36:39]
    ds_read_b128 v[132:135], v8 offset:33792
    v_mfma_f32_16x16x32_bf16 a[40:43], v[72:75], v[100:103], a[40:43]
    ds_read_b64_tr_b16 v[168:169], v12 offset:32768
    s_add_u32 m0, s48, 1024
    s_nop 0
    buffer_load_dwordx4 v18, s[8:11], s41 offen  lds
    s_add_u32 s41, s41, 1024
    s_add_u32 s48, s48, 32768
    s_and_b32 s48, s48, 0x1ffff
    v_mfma_f32_16x16x32_bf16 a[44:47], v[76:79], v[100:103], a[44:47]
    ds_read_b64_tr_b16 v[170:171], v12 offset:34816
    v_mfma_f32_16x16x32_bf16 a[64:67], v[64:67], v[104:107], a[64:67]
    ds_read_b128 v[136:139], v8 offset:34816
    v_mfma_f32_16x16x32_bf16 a[68:71], v[68:71], v[104:107], a[68:71]
    ds_read_b64_tr_b16 v[172:173], v13 offset:32768
    v_mfma_f32_16x16x32_bf16 a[72:75], v[72:75], v[104:107], a[72:75]
    ds_read_b64_tr_b16 v[174:175], v13 offset:34816
    s_add_u32 m0, s49, 0
    s_nop 0
    buffer_load_dwordx4 v19, s[12:15], s44 offen lds
    s_add_u32 s44, s44, s50
    v_mfma_f32_16x16x32_bf16 a[76:79], v[76:79], v[104:107], a[76:79]
    ds_read_b128 v[140:143], v8 offset:35840
    v_mfma_f32_16x16x32_bf16 a[96:99], v[64:67], v[108:111], a[96:99]
    ds_read_b64_tr_b16 v[176:177], v14 offset:32768
    v_mfma_f32_16x16x32_bf16 a[100:103], v[68:71], v[108:111], a[100:103]
    ds_read_b64_tr_b16 v[178:179], v14 offset:34816
    v_mfma_f32_16x16x32_bf16 a[104:107], v[72:75], v[108:111], a[104:107]
    ds_read_b64_tr_b16 v[180:181], v15 offset:32768
    s_add_u32 m0, s49, 2048
    s_nop 0
    buffer_load_dwordx4 v19, s[12:15], s45 offen lds
    s_add_u32 s45, s45, s50
    v_mfma_f32_16x16x32_bf16 a[108:111], v[76:79], v[108:111], a[108:111]
    ds_read_b64_tr_b16 v[182:183], v15 offset:34816
    v_mfma_f32_16x16x32_bf16 a[128:131], v[64:67], v[112:115], a[128:131]
    ds_read_b64_tr_b16 v[184:185], v16 offset:32768
    v_mfma_f32_16x16x32_bf16 a[132:135], v[68:71], v[112:115], a[132:135]
    ds_read_b64_tr_b16 v[186:187], v16 offset:34816
    v_mfma_f32_16x16x32_bf16 a[136:139], v[72:75], v[112:115], a[136:139]
    ds_read_b64_tr_b16 v[188:189], v17 offset:32768
    s_add_u32 m0, s49, 8192
    s_nop 0
    buffer_load_dwordx4 v19, s[12:15], s46 offen lds
    s_add_u32 s46, s46, s50
    v_mfma_f32_16x16x32_bf16 a[140:143], v[76:79], v[112:115], a[140:143]
    ds_read_b64_tr_b16 v[190:191], v17 offset:34816
    v_mfma_f32_16x16x32_bf16 a[160:163], v[64:67], v[116:119], a[160:163]
    v_mfma_f32_16x16x32_bf16 a[164:167], v[68:71], v[116:119], a[164:167]
    v_mfma_f32_16x16x32_bf16 a[168:171], v[72:75], v[116:119], a[168:171]
    s_add_u32 m0, s49, 10240
    s_nop 0
    buffer_load_dwordx4 v19, s[12:15], s47 offen lds
    s_add_u32 s47, s47, s50
    s_add_u32 s49, s49, 32768
    s_and_b32 s49, s49, 0x1ffff
    v_mfma_f32_16x16x32_bf16 a[172:175], v[76:79], v[116:119], a[172:175]
    v_mfma_f32_16x16x32_bf16 a[192:195], v[64:67], v[120:123], a[192:195]
    v_mfma_f32_16x16x32_bf16 a[196:199], v[68:71], v[120:123], a[196:199]
    v_mfma_f32_16x16x32_bf16 a[200:203], v[72:75], v[120:123], a[200:203]
    v_mfma_f32_16x16x32_bf16 a[204:207], v[76:79], v[120:123], a[204:207]
    v_mfma_f32_16x16x32_bf16 a[224:227], v[64:67], v[124:127], a[224:227]
    v_mfma_f32_16x16x32_bf16 a[228:231], v[68:71], v[124:127], a[228:231]
    v_mfma_f32_16x16x32_bf16 a[232:235], v[72:75], v[124:127], a[232:235]
    v_mfma_f32_16x16x32_bf16 a[236:239], v[76:79], v[124:127], a[236:239]
    v_xor_b32 v8, 0x10000, v8
    v_xor_b32 v10, 0x10000, v10
    v_xor_b32 v11, 0x10000, v11
    v_xor_b32 v12, 0x10000, v12
    v_xor_b32 v13, 0x10000, v13
    v_xor_b32 v14, 0x10000, v14
    v_xor_b32 v15, 0x10000, v15
    v_xor_b32 v16, 0x10000, v16
    v_xor_b32 v17, 0x10000, v17
    s_waitcnt vmcnt(12) lgkmcnt(0)
    s_barrier
    v_mfma_f32_16x16x32_bf16 a[0:3], v[128:131], v[160:163], a[0:3]
    ds_read_b64_tr_b16 v[96:97], v10 offset:0
    v_mfma_f32_16x16x32_bf16 a[4:7], v[132:135], v[160:163], a[4:7]
    ds_read_b64_tr_b16 v[98:99], v10 offset:2048
    v_mfma_f32_16x16x32_bf16 a[8:11], v[136:139], v[160:163], a[8:11]
    ds_read_b128 v[64:67], v8 offset:0
    s_add_u32 m0, s48, 0
    s_nop 0
    buffer_load_dwordx4 v18, s[8:11], s40 offen  lds
    s_add_u32 s40, s40, 1024
    v_mfma_f32_16x16x32_bf16 a[12:15], v[140:143], v[160:163], a[12:15]
    ds_read_b64_tr_b16 v[100:101], v11 offset:0
    v_mfma_f32_16x16x32_bf16 a[32:35], v[128:131], v[164:167], a[32:35]
    ds_read_b64_tr_b16 v[102:103], v11 offset:2048
    v_mfma_f32_16x16x32_bf16 a[36:39], v[132:135], v[164:167], a[36:39]
    ds_read_b128 v[68:71], v8 offset:1024
    v_mfma_f32_16x16x32_bf16 a[40:43], v[136:139], v[164:167], a[40:43]
    ds_read_b64_tr_b16 v[104:105], v12 offset:0
    s_add_u32 m0, s48, 1024
    s_nop 0
    buffer_load_dwordx4 v18, s[8:11], s41 offen  lds
    s_add_u32 s41, s41, 1024
    s_add_u32 s48, s48, 32768
    s_and_b32 s48, s48, 0x1ffff
    v_mfma_f32_16x16x32_bf16 a[44:47], v[140:143], v[164:167], a[44:47]
    ds_read_b64_tr_b16 v[106:107], v12 offset:2048
    v_mfma_f32_16x16x32_bf16 a[64:67], v[128:131], v[168:171], a[64:67]
    ds_read_b128 v[72:75], v8 offset:2048
    v_mfma_f32_16x16x32_bf16 a[68:71], v[132:135], v[168:171], a[68:71]
    ds_read_b64_tr_b16 v[108:109], v13 offset:0
    v_mfma_f32_16x16x32_bf16 a[72:75], v[136:139], v[168:171], a[72:75]
    ds_read_b64_tr_b16 v[110:111], v13 offset:2048
    s_add_u32 m0, s49, 0
    s_nop 0
    buffer_load_dwordx4 v19, s[12:15], s44 offen lds
    s_add_u32 s44, s44, s50
    v_mfma_f32_16x16x32_bf16 a[76:79], v[140:143], v[168:171], a[76:79]
    ds_read_b128 v[76:79], v8 offset:3072
    v_mfma_f32_16x16x32_bf16 a[96:99], v[128:131], v[172:175], a[96:99]
    ds_read_b64_tr_b16 v[112:113], v14 offset:0
    v_mfma_f32_16x16x32_bf16 a[100:103], v[132:135], v[172:175], a[100:103]
    ds_read_b64_tr_b16 v[114:115], v14 offset:2048
    v_mfma_f32_16x16x32_bf16 a[104:107], v[136:139], v[172:175], a[104:107]
    ds_read_b64_tr_b16 v[116:117], v15 offset:0
    s_add_u32 m0, s49, 2048
    s_nop 0
    buffer_load_dwordx4 v19, s[12:15], s45 offen lds
    s_add_u32 s45, s45, s50
    v_mfma_f32_16x16x32_bf16 a[108:111], v[140:143], v[172:175], a[108:111]
    ds_read_b64_tr_b16 v[118:119], v15 offset:2048
    v_mfma_f32_16x16x32_bf16 a[128:131], v[128:131], v[176:179], a[128:131]
    ds_read_b64_tr_b16 v[120:121], v16 offset:0
    v_mfma_f32_16x16x32_bf16 a[132:135], v[132:135], v[176:179], a[132:135]
    ds_read_b64_tr_b16 v[122:123], v16 offset:2048
    v_mfma_f32_16x16x32_bf16 a[136:139], v[136:139], v[176:179], a[136:139]
    ds_read_b64_tr_b16 v[124:125], v17 offset:0
    s_add_u32 m0, s49, 8192
    s_nop 0
    buffer_load_dwordx4 v19, s[12:15], s46 offen lds
    s_add_u32 s46, s46, s50
    v_mfma_f32_16x16x32_bf16 a[140:143], v[140:143], v[176:179], a[140:143]
    ds_read_b64_tr_b16 v[126:127], v17 offset:2048
    v_mfma_f32_16x16x32_bf16 a[160:163], v[128:131], v[180:183], a[160:163]
    v_mfma_f32_16x16x32_bf16 a[164:167], v[132:135], v[180:183], a[164:167]
    v_mfma_f32_16x16x32_bf16 a[168:171], v[136:139], v[180:183], a[168:171]
    s_add_u32 m0, s49, 10240
    s_nop 0
    buffer_load_dwordx4 v19, s[12:15], s47 offen lds
    s_add_u32 s47, s47, s50
    s_add_u32 s49, s49, 32768
    s_and_b32 s49, s49, 0x1ffff
    v_mfma_f32_16x16x32_bf16 a[172:175], v[140:143], v[180:183], a[172:175]
    v_mfma_f32_16x16x32_bf16 a[192:195], v[128:131], v[184:187], a[192:195]
    v_mfma_f32_16x16x32_bf16 a[196:199], v[132:135], v[184:187], a[196:199]
    v_mfma_f32_16x16x32_bf16 a[200:203], v[136:139], v[184:187], a[200:203]
    v_mfma_f32_16x16x32_bf16 a[204:207], v[140:143], v[184:187], a[204:207]
    v_mfma_f32_16x16x32_bf16 a[224:227], v[128:131], v[188:191], a[224:227]
    v_mfma_f32_16x16x32_bf16 a[228:231], v[132:135], v[188:191], a[228:231]
    v_mfma_f32_16x16x32_bf16 a[232:235], v[136:139], v[188:191], a[232:235]
    v_mfma_f32_16x16x32_bf16 a[236:239], v[140:143], v[188:191], a[236:239]
    s_sub_u32 s51, s51, 1
    s_cmp_lg_u32 s51, 0
    s_cbranch_scc1 Gvh_loop
    s_waitcnt vmcnt(12) lgkmcnt(0)
    s_barrier
    v_mfma_f32_16x16x32_bf16 a[0:3], v[64:67], v[96:99], a[0:3]
    ds_read_b64_tr_b16 v[160:161], v10 offset:32768
    v_mfma_f32_16x16x32_bf16 a[4:7], v[68:71], v[96:99], a[4:7]
    ds_read_b64_tr_b16 v[162:163], v10 offset:34816
    v_mfma_f32_16x16x32_bf16 a[8:11], v[72:75], v[96:99], a[8:11]
    ds_read_b128 v[128:131], v8 offset:32768
    v_mfma_f32_16x16x32_bf16 a[12:15], v[76:79], v[96:99], a[12:15]
    ds_read_b64_tr_b16 v[164:165], v11 offset:32768
    v_mfma_f32_16x16x32_bf16 a[32:35], v[64:67], v[100:103], a[32:35]
    ds_read_b64_tr_b16 v[166:167], v11 offset:34816
    v_mfma_f32_16x16x32_bf16 a[36:39], v[68:71], v[100:103], a[36:39]
    ds_read_b128 v[132:135], v8 offset:33792
    v_mfma_f32_16x16x32_bf16 a[40:43], v[72:75], v[100:103], a[40:43]
    ds_read_b64_tr_b16 v[168:169], v12 offset:32768
    v_mfma_f32_16x16x32_bf16 a[44:47], v[76:79], v[100:103], a[44:47]
    ds_read_b64_tr_b16 v[170:171], v12 offset:34816
    v_mfma_f32_16x16x32_bf16 a[64:67], v[64:67], v[104:107], a[64:67]
    ds_read_b128 v[136:139], v8 offset:34816
    v_mfma_f32_16x16x32_bf16 a[68:71], v[68:71], v[104:107], a[68:71]
    ds_read_b64_tr_b16 v[172:173], v13 offset:32768
    v_mfma_f32_16x16x32_bf16 a[72:75], v[72:75], v[104:107], a[72:75]
    ds_read_b64_tr_b16 v[174:175], v13 offset:34816
    v_mfma_f32_16x16x32_bf16 a[76:79], v[76:79], v[104:107], a[76:79]
    ds_read_b128 v[140:143], v8 offset:35840
    v_mfma_f32_16x16x32_bf16 a[96:99], v[64:67], v[108:111], a[96:99]
    ds_read_b64_tr_b16 v[176:177], v14 offset:32768
    v_mfma_f32_16x16x32_bf16 a[100:103], v[68:71], v[108:111], a[100:103]
    ds_read_b64_tr_b16 v[178:179], v14 offset:34816
    v_mfma_f32_16x16x32_bf16 a[104:107], v[72:75], v[108:111], a[104:107]
    ds_read_b64_tr_b16 v[180:181], v15 offset:32768
    v_mfma_f32_16x16x32_bf16 a[108:111], v[76:79], v[108:111], a[108:111]
    ds_read_b64_tr_b16 v[182:183], v15 offset:34816
    v_mfma_f32_16x16x32_bf16 a[128:131], v[64:67], v[112:115], a[128:131]
    ds_read_b64_tr_b16 v[184:185], v16 offset:32768
    v_mfma_f32_16x16x32_bf16 a[132:135], v[68:71], v[112:115], a[132:135]
    ds_read_b64_tr_b16 v[186:187], v16 offset:34816
    v_mfma_f32_16x16x32_bf16 a[136:139], v[72:75], v[112:115], a[136:139]
    ds_read_b64_tr_b16 v[188:189], v17 offset:32768
    v_mfma_f32_16x16x32_bf16 a[140:143], v[76:79], v[112:115], a[140:143]
    ds_read_b64_tr_b16 v[190:191], v17 offset:34816
    v_mfma_f32_16x16x32_bf16 a[160:163], v[64:67], v[116:119], a[160:163]
    v_mfma_f32_16x16x32_bf16 a[164:167], v[68:71], v[116:119], a[164:167]
    v_mfma_f32_16x16x32_bf16 a[168:171], v[72:75], v[116:119], a[168:171]
    v_mfma_f32_16x16x32_bf16 a[172:175], v[76:79], v[116:119], a[172:175]
    v_mfma_f32_16x16x32_bf16 a[192:195], v[64:67], v[120:123], a[192:195]
    v_mfma_f32_16x16x32_bf16 a[196:199], v[68:71], v[120:123], a[196:199]
    v_mfma_f32_16x16x32_bf16 a[200:203], v[72:75], v[120:123], a[200:203]
    v_mfma_f32_16x16x32_bf16 a[204:207], v[76:79], v[120:123], a[204:207]
    v_mfma_f32_16x16x32_bf16 a[224:227], v[64:67], v[124:127], a[224:227]
    v_mfma_f32_16x16x32_bf16 a[228:231], v[68:71], v[124:127], a[228:231]
    v_mfma_f32_16x16x32_bf16 a[232:235], v[72:75], v[124:127], a[232:235]
    v_mfma_f32_16x16x32_bf16 a[236:239], v[76:79], v[124:127], a[236:239]
    v_xor_b32 v8, 0x10000, v8
    v_xor_b32 v10, 0x10000, v10
    v_xor_b32 v11, 0x10000, v11
    v_xor_b32 v12, 0x10000, v12
    v_xor_b32 v13, 0x10000, v13
    v_xor_b32 v14, 0x10000, v14
    v_xor_b32 v15, 0x10000, v15
    v_xor_b32 v16, 0x10000, v16
    v_xor_b32 v17, 0x10000, v17
    s_waitcnt vmcnt(6) lgkmcnt(0)
    s_barrier
    v_mfma_f32_16x16x32_bf16 a[0:3], v[128:131], v[160:163], a[0:3]
    ds_read_b64_tr_b16 v[96:97], v10 offset:0
    v_mfma_f32_16x16x32_bf16 a[4:7], v[132:135], v[160:163], a[4:7]
    ds_read_b64_tr_b16 v[98:99], v10 offset:2048
    v_mfma_f32_16x16x32_bf16 a[8:11], v[136:139], v[160:163], a[8:11]
    ds_read_b128 v[64:67], v8 offset:0
    v_mfma_f32_16x16x32_bf16 a[12:15], v[140:143], v[160:163], a[12:15]
    ds_read_b64_tr_b16 v[100:101], v11 offset:0
    v_mfma_f32_16x16x32_bf16 a[32:35], v[128:131], v[164:167], a[32:35]
    ds_read_b64_tr_b16 v[102:103], v11 offset:2048
    v_mfma_f32_16x16x32_bf16 a[36:39], v[132:135], v[164:167], a[36:39]
    ds_read_b128 v[68:71], v8 offset:1024
    v_mfma_f32_16x16x32_bf16 a[40:43], v[136:139], v[164:167], a[40:43]
    ds_read_b64_tr_b16 v[104:105], v12 offset:0
    v_mfma_f32_16x16x32_bf16 a[44:47], v[140:143], v[164:167], a[44:47]
    ds_read_b64_tr_b16 v[106:107], v12 offset:2048
    v_mfma_f32_16x16x32_bf16 a[64:67], v[128:131], v[168:171], a[64:67]
    ds_read_b128 v[72:75], v8 offset:2048
    v_mfma_f32_16x16x32_bf16 a[68:71], v[132:135], v[168:171], a[68:71]
    ds_read_b64_tr_b16 v[108:109], v13 offset:0
    v_mfma_f32_16x16x32_bf16 a[72:75], v[136:139], v[168:171], a[72:75]
    ds_read_b64_tr_b16 v[110:111], v13 offset:2048
    v_mfma_f32_16x16x32_bf16 a[76:79], v[140:143], v[168:171], a[76:79]
    ds_read_b128 v[76:79], v8 offset:3072
    v_mfma_f32_16x16x32_bf16 a[96:99], v[128:131], v[172:175], a[96:99]
    ds_read_b64_tr_b16 v[112:113], v14 offset:0
    v_mfma_f32_16x16x32_bf16 a[100:103], v[132:135], v[172:175], a[100:103]
    ds_read_b64_tr_b16 v[114:115], v14 offset:2048
    v_mfma_f32_16x16x32_bf16 a[104:107], v[136:139], v[172:175], a[104:107]
    ds_read_b64_tr_b16 v[116:117], v15 offset:0
    v_mfma_f32_16x16x32_bf16 a[108:111], v[140:143], v[172:175], a[108:111]
    ds_read_b64_tr_b16 v[118:119], v15 offset:2048
    v_mfma_f32_16x16x32_bf16 a[128:131], v[128:131], v[176:179], a[128:131]
    ds_read_b64_tr_b16 v[120:121], v16 offset:0
    v_mfma_f32_16x16x32_bf16 a[132:135], v[132:135], v[176:179], a[132:135]
    ds_read_b64_tr_b16 v[122:123], v16 offset:2048
    v_mfma_f32_16x16x32_bf16 a[136:139], v[136:139], v[176:179], a[136:139]
    ds_read_b64_tr_b16 v[124:125], v17 offset:0
    v_mfma_f32_16x16x32_bf16 a[140:143], v[140:143], v[176:179], a[140:143]
    ds_read_b64_tr_b16 v[126:127], v17 offset:2048
    v_mfma_f32_16x16x32_bf16 a[160:163], v[128:131], v[180:183], a[160:163]
    v_mfma_f32_16x16x32_bf16 a[164:167], v[132:135], v[180:183], a[164:167]
    v_mfma_f32_16x16x32_bf16 a[168:171], v[136:139], v[180:183], a[168:171]
    v_mfma_f32_16x16x32_bf16 a[172:175], v[140:143], v[180:183], a[172:175]
    v_mfma_f32_16x16x32_bf16 a[192:195], v[128:131], v[184:187], a[192:195]
    v_mfma_f32_16x16x32_bf16 a[196:199], v[132:135], v[184:187], a[196:199]
    v_mfma_f32_16x16x32_bf16 a[200:203], v[136:139], v[184:187], a[200:203]
    v_mfma_f32_16x16x32_bf16 a[204:207], v[140:143], v[184:187], a[204:207]
    v_mfma_f32_16x16x32_bf16 a[224:227], v[128:131], v[188:191], a[224:227]
    v_mfma_f32_16x16x32_bf16 a[228:231], v[132:135], v[188:191], a[228:231]
    v_mfma_f32_16x16x32_bf16 a[232:235], v[136:139], v[188:191], a[232:235]
    v_mfma_f32_16x16x32_bf16 a[236:239], v[140:143], v[188:191], a[236:239]
    s_waitcnt vmcnt(0) lgkmcnt(0)
    s_barrier
    v_mfma_f32_16x16x32_bf16 a[0:3], v[64:67], v[96:99], a[0:3]
    ds_read_b64_tr_b16 v[160:161], v10 offset:32768
    v_mfma_f32_16x16x32_bf16 a[4:7], v[68:71], v[96:99], a[4:7]
    ds_read_b64_tr_b16 v[162:163], v10 offset:34816
    v_mfma_f32_16x16x32_bf16 a[8:11], v[72:75], v[96:99], a[8:11]
    ds_read_b128 v[128:131], v8 offset:32768
    v_mfma_f32_16x16x32_bf16 a[12:15], v[76:79], v[96:99], a[12:15]
    ds_read_b64_tr_b16 v[164:165], v11 offset:32768
    v_mfma_f32_16x16x32_bf16 a[32:35], v[64:67], v[100:103], a[32:35]
    ds_read_b64_tr_b16 v[166:167], v11 offset:34816
    v_mfma_f32_16x16x32_bf16 a[36:39], v[68:71], v[100:103], a[36:39]
    ds_read_b128 v[132:135], v8 offset:33792
    v_mfma_f32_16x16x32_bf16 a[40:43], v[72:75], v[100:103], a[40:43]
    ds_read_b64_tr_b16 v[168:169], v12 offset:32768
    v_mfma_f32_16x16x32_bf16 a[44:47], v[76:79], v[100:103], a[44:47]
    ds_read_b64_tr_b16 v[170:171], v12 offset:34816
    v_mfma_f32_16x16x32_bf16 a[64:67], v[64:67], v[104:107], a[64:67]
    ds_read_b128 v[136:139], v8 offset:34816
    v_mfma_f32_16x16x32_bf16 a[68:71], v[68:71], v[104:107], a[68:71]
    ds_read_b64_tr_b16 v[172:173], v13 offset:32768
    v_mfma_f32_16x16x32_bf16 a[72:75], v[72:75], v[104:107], a[72:75]
    ds_read_b64_tr_b16 v[174:175], v13 offset:34816
    v_mfma_f32_16x16x32_bf16 a[76:79], v[76:79], v[104:107], a[76:79]
    ds_read_b128 v[140:143], v8 offset:35840
    v_mfma_f32_16x16x32_bf16 a[96:99], v[64:67], v[108:111], a[96:99]
    ds_read_b64_tr_b16 v[176:177], v14 offset:32768
    v_mfma_f32_16x16x32_bf16 a[100:103], v[68:71], v[108:111], a[100:103]
    ds_read_b64_tr_b16 v[178:179], v14 offset:34816
    v_mfma_f32_16x16x32_bf16 a[104:107], v[72:75], v[108:111], a[104:107]
    ds_read_b64_tr_b16 v[180:181], v15 offset:32768
    v_mfma_f32_16x16x32_bf16 a[108:111], v[76:79], v[108:111], a[108:111]
    ds_read_b64_tr_b16 v[182:183], v15 offset:34816
    v_mfma_f32_16x16x32_bf16 a[128:131], v[64:67], v[112:115], a[128:131]
    ds_read_b64_tr_b16 v[184:185], v16 offset:32768
    v_mfma_f32_16x16x32_bf16 a[132:135], v[68:71], v[112:115], a[132:135]
    ds_read_b64_tr_b16 v[186:187], v16 offset:34816
    v_mfma_f32_16x16x32_bf16 a[136:139], v[72:75], v[112:115], a[136:139]
    ds_read_b64_tr_b16 v[188:189], v17 offset:32768
    v_mfma_f32_16x16x32_bf16 a[140:143], v[76:79], v[112:115], a[140:143]
    ds_read_b64_tr_b16 v[190:191], v17 offset:34816
    v_mfma_f32_16x16x32_bf16 a[160:163], v[64:67], v[116:119], a[160:163]
    v_mfma_f32_16x16x32_bf16 a[164:167], v[68:71], v[116:119], a[164:167]
    v_mfma_f32_16x16x32_bf16 a[168:171], v[72:75], v[116:119], a[168:171]
    v_mfma_f32_16x16x32_bf16 a[172:175], v[76:79], v[116:119], a[172:175]
    v_mfma_f32_16x16x32_bf16 a[192:195], v[64:67], v[120:123], a[192:195]
    v_mfma_f32_16x16x32_bf16 a[196:199], v[68:71], v[120:123], a[196:199]
    v_mfma_f32_16x16x32_bf16 a[200:203], v[72:75], v[120:123], a[200:203]
    v_mfma_f32_16x16x32_bf16 a[204:207], v[76:79], v[120:123], a[204:207]
    v_mfma_f32_16x16x32_bf16 a[224:227], v[64:67], v[124:127], a[224:227]
    v_mfma_f32_16x16x32_bf16 a[228:231], v[68:71], v[124:127], a[228:231]
    v_mfma_f32_16x16x32_bf16 a[232:235], v[72:75], v[124:127], a[232:235]
    v_mfma_f32_16x16x32_bf16 a[236:239], v[76:79], v[124:127], a[236:239]
    s_waitcnt lgkmcnt(0)
    s_barrier
    v_mfma_f32_16x16x32_bf16 a[0:3], v[128:131], v[160:163], a[0:3]
    v_mfma_f32_16x16x32_bf16 a[4:7], v[132:135], v[160:163], a[4:7]
    v_mfma_f32_16x16x32_bf16 a[8:11], v[136:139], v[160:163], a[8:11]
    v_mfma_f32_16x16x32_bf16 a[12:15], v[140:143], v[160:163], a[12:15]
    v_mfma_f32_16x16x32_bf16 a[32:35], v[128:131], v[164:167], a[32:35]
    v_mfma_f32_16x16x32_bf16 a[36:39], v[132:135], v[164:167], a[36:39]
    v_mfma_f32_16x16x32_bf16 a[40:43], v[136:139], v[164:167], a[40:43]
    v_mfma_f32_16x16x32_bf16 a[44:47], v[140:143], v[164:167], a[44:47]
    v_mfma_f32_16x16x32_bf16 a[64:67], v[128:131], v[168:171], a[64:67]
    v_mfma_f32_16x16x32_bf16 a[68:71], v[132:135], v[168:171], a[68:71]
    v_mfma_f32_16x16x32_bf16 a[72:75], v[136:139], v[168:171], a[72:75]
    v_mfma_f32_16x16x32_bf16 a[76:79], v[140:143], v[168:171], a[76:79]
    v_mfma_f32_16x16x32_bf16 a[96:99], v[128:131], v[172:175], a[96:99]
    v_mfma_f32_16x16x32_bf16 a[100:103], v[132:135], v[172:175], a[100:103]
    v_mfma_f32_16x16x32_bf16 a[104:107], v[136:139], v[172:175], a[104:107]
    v_mfma_f32_16x16x32_bf16 a[108:111], v[140:143], v[172:175], a[108:111]
    v_mfma_f32_16x16x32_bf16 a[128:131], v[128:131], v[176:179], a[128:131]
    v_mfma_f32_16x16x32_bf16 a[132:135], v[132:135], v[176:179], a[132:135]
    v_mfma_f32_16x16x32_bf16 a[136:139], v[136:139], v[176:179], a[136:139]
    v_mfma_f32_16x16x32_bf16 a[140:143], v[140:143], v[176:179], a[140:143]
    v_mfma_f32_16x16x32_bf16 a[160:163], v[128:131], v[180:183], a[160:163]
    v_mfma_f32_16x16x32_bf16 a[164:167], v[132:135], v[180:183], a[164:167]
    v_mfma_f32_16x16x32_bf16 a[168:171], v[136:139], v[180:183], a[168:171]
    v_mfma_f32_16x16x32_bf16 a[172:175], v[140:143], v[180:183], a[172:175]
    v_mfma_f32_16x16x32_bf16 a[192:195], v[128:131], v[184:187], a[192:195]
    v_mfma_f32_16x16x32_bf16 a[196:199], v[132:135], v[184:187], a[196:199]
    v_mfma_f32_16x16x32_bf16 a[200:203], v[136:139], v[184:187], a[200:203]
    v_mfma_f32_16x16x32_bf16 a[204:207], v[140:143], v[184:187], a[204:207]
    v_mfma_f32_16x16x32_bf16 a[224:227], v[128:131], v[188:191], a[224:227]
    v_mfma_f32_16x16x32_bf16 a[228:231], v[132:135], v[188:191], a[228:231]
    v_mfma_f32_16x16x32_bf16 a[232:235], v[136:139], v[188:191], a[232:235]
    v_mfma_f32_16x16x32_bf16 a[236:239], v[140:143], v[188:191], a[236:239]
    s_lshl_b32 s54, s61, 1
    s_and_b32 s55, s3, 1
    s_add_u32 s54, s54, s55
    s_lshl_b32 s52, s54, 19
    s_lshl_b32 s54, s60, 1
    s_add_u32 s54, s54, s62
    s_lshl_b32 s54, s54, 1
    s_lshr_b32 s55, s3, 1
    s_add_u32 s54, s54, s55
    s_lshl_b32 s54, s54, 14
    s_add_u32 s52, s52, s54
    s_add_u32 s52, s52, 35913728
    v_accvgpr_read_b32 v68, a0
    v_accvgpr_read_b32 v69, a1
    v_accvgpr_read_b32 v70, a2
    v_accvgpr_read_b32 v71, a3
    v_cvt_pk_bf16_f32 v64, v68, v69
    v_cvt_pk_bf16_f32 v65, v70, v71
    v_accvgpr_read_b32 v68, a36
    v_accvgpr_read_b32 v69, a37
    v_accvgpr_read_b32 v70, a38
    v_accvgpr_read_b32 v71, a39
    v_cvt_pk_bf16_f32 v66, v68, v69
    v_cvt_pk_bf16_f32 v67, v70, v71
    s_add_u32 s54, s52, 0
    buffer_store_dwordx4 v[64:67], v18, s[8:11], s54 offen sc1
    v_accvgpr_read_b32 v84, a32
    v_accvgpr_read_b32 v85, a33
    v_accvgpr_read_b32 v86, a34
    v_accvgpr_read_b32 v87, a35
    v_cvt_pk_bf16_f32 v80, v84, v85
    v_cvt_pk_bf16_f32 v81, v86, v87
    v_accvgpr_read_b32 v84, a4
    v_accvgpr_read_b32 v85, a5
    v_accvgpr_read_b32 v86, a6
    v_accvgpr_read_b32 v87, a7
    v_cvt_pk_bf16_f32 v82, v84, v85
    v_cvt_pk_bf16_f32 v83, v86, v87
    s_add_u32 s54, s52, 1024
    buffer_store_dwordx4 v[80:83], v18, s[8:11], s54 offen sc1
    v_accvgpr_read_b32 v100, a64
    v_accvgpr_read_b32 v101, a65
    v_accvgpr_read_b32 v102, a66
    v_accvgpr_read_b32 v103, a67
    v_cvt_pk_bf16_f32 v96, v100, v101
    v_cvt_pk_bf16_f32 v97, v102, v103
    v_accvgpr_read_b32 v100, a100
    v_accvgpr_read_b32 v101, a101
    v_accvgpr_read_b32 v102, a102
    v_accvgpr_read_b32 v103, a103
    v_cvt_pk_bf16_f32 v98, v100, v101
    v_cvt_pk_bf16_f32 v99, v102, v103
    s_add_u32 s54, s52, 2048
    buffer_store_dwordx4 v[96:99], v18, s[8:11], s54 offen sc1
    v_accvgpr_read_b32 v116, a96
    v_accvgpr_read_b32 v117, a97
    v_accvgpr_read_b32 v118, a98
    v_accvgpr_read_b32 v119, a99
    v_cvt_pk_bf16_f32 v112, v116, v117
    v_cvt_pk_bf16_f32 v113, v118, v119
    v_accvgpr_read_b32 v116, a68
    v_accvgpr_read_b32 v117, a69
    v_accvgpr_read_b32 v118, a70
    v_accvgpr_read_b32 v119, a71
    v_cvt_pk_bf16_f32 v114, v116, v117
    v_cvt_pk_bf16_f32 v115, v118, v119
    s_add_u32 s54, s52, 3072
    buffer_store_dwordx4 v[112:115], v18, s[8:11], s54 offen sc1
    v_accvgpr_read_b32 v68, a128
    v_accvgpr_read_b32 v69, a129
    v_accvgpr_read_b32 v70, a130
    v_accvgpr_read_b32 v71, a131
    v_cvt_pk_bf16_f32 v64, v68, v69
    v_cvt_pk_bf16_f32 v65, v70, v71
    v_accvgpr_read_b32 v68, a164
    v_accvgpr_read_b32 v69, a165
    v_accvgpr_read_b32 v70, a166
    v_accvgpr_read_b32 v71, a167
    v_cvt_pk_bf16_f32 v66, v68, v69
    v_cvt_pk_bf16_f32 v67, v70, v71
    s_add_u32 s54, s52, 4096
    buffer_store_dwordx4 v[64:67], v18, s[8:11], s54 offen sc1
    v_accvgpr_read_b32 v84, a160
    v_accvgpr_read_b32 v85, a161
    v_accvgpr_read_b32 v86, a162
    v_accvgpr_read_b32 v87, a163
    v_cvt_pk_bf16_f32 v80, v84, v85
    v_cvt_pk_bf16_f32 v81, v86, v87
    v_accvgpr_read_b32 v84, a132
    v_accvgpr_read_b32 v85, a133
    v_accvgpr_read_b32 v86, a134
    v_accvgpr_read_b32 v87, a135
    v_cvt_pk_bf16_f32 v82, v84, v85
    v_cvt_pk_bf16_f32 v83, v86, v87
    s_add_u32 s54, s52, 5120
    buffer_store_dwordx4 v[80:83], v18, s[8:11], s54 offen sc1
    v_accvgpr_read_b32 v100, a192
    v_accvgpr_read_b32 v101, a193
    v_accvgpr_read_b32 v102, a194
    v_accvgpr_read_b32 v103, a195
    v_cvt_pk_bf16_f32 v96, v100, v101
    v_cvt_pk_bf16_f32 v97, v102, v103
    v_accvgpr_read_b32 v100, a228
    v_accvgpr_read_b32 v101, a229
    v_accvgpr_read_b32 v102, a230
    v_accvgpr_read_b32 v103, a231
    v_cvt_pk_bf16_f32 v98, v100, v101
    v_cvt_pk_bf16_f32 v99, v102, v103
    s_add_u32 s54, s52, 6144
    buffer_store_dwordx4 v[96:99], v18, s[8:11], s54 offen sc1
    v_accvgpr_read_b32 v116, a224
    v_accvgpr_read_b32 v117, a225
    v_accvgpr_read_b32 v118, a226
    v_accvgpr_read_b32 v119, a227
    v_cvt_pk_bf16_f32 v112, v116, v117
    v_cvt_pk_bf16_f32 v113, v118, v119
    v_accvgpr_read_b32 v116, a196
    v_accvgpr_read_b32 v117, a197
    v_accvgpr_read_b32 v118, a198
    v_accvgpr_read_b32 v119, a199
    v_cvt_pk_bf16_f32 v114, v116, v117
    v_cvt_pk_bf16_f32 v115, v118, v119
    s_add_u32 s54, s52, 7168
    buffer_store_dwordx4 v[112:115], v18, s[8:11], s54 offen sc1
    v_accvgpr_read_b32 v68, a8
    v_accvgpr_read_b32 v69, a9
    v_accvgpr_read_b32 v70, a10
    v_accvgpr_read_b32 v71, a11
    v_cvt_pk_bf16_f32 v64, v68, v69
    v_cvt_pk_bf16_f32 v65, v70, v71
    v_accvgpr_read_b32 v68, a44
    v_accvgpr_read_b32 v69, a45
    v_accvgpr_read_b32 v70, a46
    v_accvgpr_read_b32 v71, a47
    v_cvt_pk_bf16_f32 v66, v68, v69
    v_cvt_pk_bf16_f32 v67, v70, v71
    s_add_u32 s54, s52, 8192
    buffer_store_dwordx4 v[64:67], v18, s[8:11], s54 offen sc1
    v_accvgpr_read_b32 v84, a40
    v_accvgpr_read_b32 v85, a41
    v_accvgpr_read_b32 v86, a42
    v_accvgpr_read_b32 v87, a43
    v_cvt_pk_bf16_f32 v80, v84, v85
    v_cvt_pk_bf16_f32 v81, v86, v87
    v_accvgpr_read_b32 v84, a12
    v_accvgpr_read_b32 v85, a13
    v_accvgpr_read_b32 v86, a14
    v_accvgpr_read_b32 v87, a15
    v_cvt_pk_bf16_f32 v82, v84, v85
    v_cvt_pk_bf16_f32 v83, v86, v87
    s_add_u32 s54, s52, 9216
    buffer_store_dwordx4 v[80:83], v18, s[8:11], s54 offen sc1
    v_accvgpr_read_b32 v100, a72
    v_accvgpr_read_b32 v101, a73
    v_accvgpr_read_b32 v102, a74
    v_accvgpr_read_b32 v103, a75
    v_cvt_pk_bf16_f32 v96, v100, v101
    v_cvt_pk_bf16_f32 v97, v102, v103
    v_accvgpr_read_b32 v100, a108
    v_accvgpr_read_b32 v101, a109
    v_accvgpr_read_b32 v102, a110
    v_accvgpr_read_b32 v103, a111
    v_cvt_pk_bf16_f32 v98, v100, v101
    v_cvt_pk_bf16_f32 v99, v102, v103
    s_add_u32 s54, s52, 10240
    buffer_store_dwordx4 v[96:99], v18, s[8:11], s54 offen sc1
    v_accvgpr_read_b32 v116, a104
    v_accvgpr_read_b32 v117, a105
    v_accvgpr_read_b32 v118, a106
    v_accvgpr_read_b32 v119, a107
    v_cvt_pk_bf16_f32 v112, v116, v117
    v_cvt_pk_bf16_f32 v113, v118, v119
    v_accvgpr_read_b32 v116, a76
    v_accvgpr_read_b32 v117, a77
    v_accvgpr_read_b32 v118, a78
    v_accvgpr_read_b32 v119, a79
    v_cvt_pk_bf16_f32 v114, v116, v117
    v_cvt_pk_bf16_f32 v115, v118, v119
    s_add_u32 s54, s52, 11264
    buffer_store_dwordx4 v[112:115], v18, s[8:11], s54 offen sc1
    v_accvgpr_read_b32 v68, a136
    v_accvgpr_read_b32 v69, a137
    v_accvgpr_read_b32 v70, a138
    v_accvgpr_read_b32 v71, a139
    v_cvt_pk_bf16_f32 v64, v68, v69
    v_cvt_pk_bf16_f32 v65, v70, v71
    v_accvgpr_read_b32 v68, a172
    v_accvgpr_read_b32 v69, a173
    v_accvgpr_read_b32 v70, a174
    v_accvgpr_read_b32 v71, a175
    v_cvt_pk_bf16_f32 v66, v68, v69
    v_cvt_pk_bf16_f32 v67, v70, v71
    s_add_u32 s54, s52, 12288
    buffer_store_dwordx4 v[64:67], v18, s[8:11], s54 offen sc1
    v_accvgpr_read_b32 v84, a168
    v_accvgpr_read_b32 v85, a169
    v_accvgpr_read_b32 v86, a170
    v_accvgpr_read_b32 v87, a171
    v_cvt_pk_bf16_f32 v80, v84, v85
    v_cvt_pk_bf16_f32 v81, v86, v87
    v_accvgpr_read_b32 v84, a140
    v_accvgpr_read_b32 v85, a141
    v_accvgpr_read_b32 v86, a142
    v_accvgpr_read_b32 v87, a143
    v_cvt_pk_bf16_f32 v82, v84, v85
    v_cvt_pk_bf16_f32 v83, v86, v87
    s_add_u32 s54, s52, 13312
    buffer_store_dwordx4 v[80:83], v18, s[8:11], s54 offen sc1
    v_accvgpr_read_b32 v100, a200
    v_accvgpr_read_b32 v101, a201
    v_accvgpr_read_b32 v102, a202
    v_accvgpr_read_b32 v103, a203
    v_cvt_pk_bf16_f32 v96, v100, v101
    v_cvt_pk_bf16_f32 v97, v102, v103
    v_accvgpr_read_b32 v100, a236
    v_accvgpr_read_b32 v101, a237
    v_accvgpr_read_b32 v102, a238
    v_accvgpr_read_b32 v103, a239
    v_cvt_pk_bf16_f32 v98, v100, v101
    v_cvt_pk_bf16_f32 v99, v102, v103
    s_add_u32 s54, s52, 14336
    buffer_store_dwordx4 v[96:99], v18, s[8:11], s54 offen sc1
    v_accvgpr_read_b32 v116, a232
    v_accvgpr_read_b32 v117, a233
    v_accvgpr_read_b32 v118, a234
    v_accvgpr_read_b32 v119, a235
    v_cvt_pk_bf16_f32 v112, v116, v117
    v_cvt_pk_bf16_f32 v113, v118, v119
    v_accvgpr_read_b32 v116, a204
    v_accvgpr_read_b32 v117, a205
    v_accvgpr_read_b32 v118, a206
    v_accvgpr_read_b32 v119, a207
    v_cvt_pk_bf16_f32 v114, v116, v117
    v_cvt_pk_bf16_f32 v115, v118, v119
    s_add_u32 s54, s52, 15360
    buffer_store_dwordx4 v[112:115], v18, s[8:11], s54 offen sc1
    s_branch W_DONE
W_tfull:
    s_cmp_eq_u32 s94, 0
    s_cbranch_scc1 W_tk
    s_cmp_eq_u32 s94, 1
    s_cbranch_scc1 W_tv
    s_cmp_eq_u32 s94, 2
    s_cbranch_scc1 W_tq
    s_cmp_eq_u32 s94, 3
    s_cbranch_scc1 W_th
    s_mov_b64 s[12:13], s[32:33]
    s_mov_b32 s14, 5308416
    s_mov_b32 s63, 1152
    v_and_b32 v1, 63, v0
    v_lshrrev_b32 v2, 4, v1
    v_lshlrev_b32 v18, 4, v1
    s_lshr_b32 s54, s3, 1
    s_lshl_b32 s54, s54, 13
    v_add_u32 v8, s54, v18
    v_bfe_u32 v3, v1, 2, 2
    v_and_b32 v4, 3, v1
    v_and_b32 v5, 1, v2
    v_lshl_add_u32 v5, v5, 2, v3
    v_lshlrev_b32 v6, 12, v2
    v_lshl_add_u32 v6, v3, 9, v6
    v_lshl_add_u32 v6, v4, 3, v6
    v_add_u32 v6, 16384, v6
    s_and_b32 s54, s3, 1
    s_mul_i32 s54, s54, 6
    s_add_u32 s55, s54, 0
    v_xor_b32 v7, s55, v5
    v_lshl_add_u32 v10, v7, 5, v6
    s_add_u32 s55, s54, 1
    v_xor_b32 v7, s55, v5
    v_lshl_add_u32 v11, v7, 5, v6
    s_add_u32 s55, s54, 2
    v_xor_b32 v7, s55, v5
    v_lshl_add_u32 v12, v7, 5, v6
    s_add_u32 s55, s54, 3
    v_xor_b32 v7, s55, v5
    v_lshl_add_u32 v13, v7, 5, v6
    s_add_u32 s55, s54, 4
    v_xor_b32 v7, s55, v5
    v_lshl_add_u32 v14, v7, 5, v6
    s_add_u32 s55, s54, 5
    v_xor_b32 v7, s55, v5
    v_lshl_add_u32 v15, v7, 5, v6
    s_and_b32 s54, s3, 1
    s_lshl_b32 s54, s54, 1
    s_lshr_b32 s55, s3, 1
    s_lshl_b32 s55, s55, 2
    s_or_b32 s54, s54, s55
    v_lshrrev_b32 v3, 5, v1
    v_or_b32 v4, s54, v3
    v_lshlrev_b32 v4, 1, v4
    v_and_b32 v5, 31, v1
    v_xor_b32 v4, v4, v5
    v_mul_lo_u32 v3, v3, s63
    v_lshl_add_u32 v19, v4, 4, v3
    s_mul_i32 s64, s60, 2359296
    s_mul_i32 s54, s62, 24576
    s_add_u32 s64, s64, s54
    s_add_u32 s64, s64, 52690944
    s_mul_i32 s65, s62, 884736
    s_mul_i32 s54, s61, 384
    s_add_u32 s65, s65, s54
    s_mul_i32 s54, s3, 589824
    s_add_u32 s54, s54, s64
    s_add_u32 s40, s54, 0
    s_add_u32 s41, s54, 147456
    s_add_u32 s42, s54, 294912
    s_add_u32 s43, s54, 442368
    s_and_b32 s54, s3, 1
    s_lshl_b32 s54, s54, 1
    s_lshr_b32 s55, s3, 1
    s_mul_i32 s55, s55, 4
    s_add_u32 s54, s54, s55
    s_add_u32 s55, s54, 0
    s_mul_i32 s55, s55, s63
    s_add_u32 s44, s55, s65
    s_add_u32 s55, s54, 16
    s_mul_i32 s55, s55, s63
    s_add_u32 s45, s55, s65
    s_add_u32 s55, s54, 8
    s_mul_i32 s55, s55, s63
    s_add_u32 s46, s55, s65
    s_add_u32 s55, s54, 24
    s_mul_i32 s55, s55, s63
    s_add_u32 s47, s55, s65
    s_lshl_b32 s50, s63, 5
    s_lshl_b32 s48, s3, 12
    s_and_b32 s54, s3, 1
    s_lshl_b32 s54, s54, 10
    s_lshr_b32 s55, s3, 1
    s_lshl_b32 s55, s55, 12
    s_add_u32 s49, s54, s55
    s_add_u32 s49, s49, 16384
    s_add_u32 m0, s48, 0
    s_nop 0
    buffer_load_dwordx4 v18, s[8:11], s40 offen  lds
    s_add_u32 s40, s40, 1024
    s_add_u32 m0, s48, 1024
    s_nop 0
    buffer_load_dwordx4 v18, s[8:11], s41 offen  lds
    s_add_u32 s41, s41, 1024
    s_add_u32 m0, s48, 2048
    s_nop 0
    buffer_load_dwordx4 v18, s[8:11], s42 offen  lds
    s_add_u32 s42, s42, 1024
    s_add_u32 m0, s48, 3072
    s_nop 0
    buffer_load_dwordx4 v18, s[8:11], s43 offen  lds
    s_add_u32 s43, s43, 1024
    s_add_u32 s48, s48, 32768
    s_and_b32 s48, s48, 0x1ffff
    s_add_u32 m0, s49, 0
    s_nop 0
    buffer_load_dwordx4 v19, s[12:15], s44 offen lds
    s_add_u32 s44, s44, s50
    s_add_u32 m0, s49, 2048
    s_nop 0
    buffer_load_dwordx4 v19, s[12:15], s45 offen lds
    s_add_u32 s45, s45, s50
    s_add_u32 m0, s49, 8192
    s_nop 0
    buffer_load_dwordx4 v19, s[12:15], s46 offen lds
    s_add_u32 s46, s46, s50
    s_add_u32 m0, s49, 10240
    s_nop 0
    buffer_load_dwordx4 v19, s[12:15], s47 offen lds
    s_add_u32 s47, s47, s50
    s_add_u32 s49, s49, 32768
    s_and_b32 s49, s49, 0x1ffff
    s_add_u32 m0, s48, 0
    s_nop 0
    buffer_load_dwordx4 v18, s[8:11], s40 offen  lds
    s_add_u32 s40, s40, 1024
    s_add_u32 m0, s48, 1024
    s_nop 0
    buffer_load_dwordx4 v18, s[8:11], s41 offen  lds
    s_add_u32 s41, s41, 1024
    s_add_u32 m0, s48, 2048
    s_nop 0
    buffer_load_dwordx4 v18, s[8:11], s42 offen  lds
    s_add_u32 s42, s42, 1024
    s_add_u32 m0, s48, 3072
    s_nop 0
    buffer_load_dwordx4 v18, s[8:11], s43 offen  lds
    s_add_u32 s43, s43, 1024
    s_add_u32 s48, s48, 32768
    s_and_b32 s48, s48, 0x1ffff
    s_add_u32 m0, s49, 0
    s_nop 0
    buffer_load_dwordx4 v19, s[12:15], s44 offen lds
    s_add_u32 s44, s44, s50
    s_add_u32 m0, s49, 2048
    s_nop 0
    buffer_load_dwordx4 v19, s[12:15], s45 offen lds
    s_add_u32 s45, s45, s50
    s_add_u32 m0, s49, 8192
    s_nop 0
    buffer_load_dwordx4 v19, s[12:15], s46 offen lds
    s_add_u32 s46, s46, s50
    s_add_u32 m0, s49, 10240
    s_nop 0
    buffer_load_dwordx4 v19, s[12:15], s47 offen lds
    s_add_u32 s47, s47, s50
    s_add_u32 s49, s49, 32768
    s_and_b32 s49, s49, 0x1ffff
    s_add_u32 m0, s48, 0
    s_nop 0
    buffer_load_dwordx4 v18, s[8:11], s40 offen  lds
    s_add_u32 s40, s40, 1024
    s_add_u32 m0, s48, 1024
    s_nop 0
    buffer_load_dwordx4 v18, s[8:11], s41 offen  lds
    s_add_u32 s41, s41, 1024
    s_add_u32 m0, s48, 2048
    s_nop 0
    buffer_load_dwordx4 v18, s[8:11], s42 offen  lds
    s_add_u32 s42, s42, 1024
    s_add_u32 m0, s48, 3072
    s_nop 0
    buffer_load_dwordx4 v18, s[8:11], s43 offen  lds
    s_add_u32 s43, s43, 1024
    s_add_u32 s48, s48, 32768
    s_and_b32 s48, s48, 0x1ffff
    s_add_u32 m0, s49, 0
    s_nop 0
    buffer_load_dwordx4 v19, s[12:15], s44 offen lds
    s_add_u32 s44, s44, s50
    s_add_u32 m0, s49, 2048
    s_nop 0
    buffer_load_dwordx4 v19, s[12:15], s45 offen lds
    s_add_u32 s45, s45, s50
    s_add_u32 m0, s49, 8192
    s_nop 0
    buffer_load_dwordx4 v19, s[12:15], s46 offen lds
    s_add_u32 s46, s46, s50
    s_add_u32 m0, s49, 10240
    s_nop 0
    buffer_load_dwordx4 v19, s[12:15], s47 offen lds
    s_add_u32 s47, s47, s50
    s_add_u32 s49, s49, 32768
    s_and_b32 s49, s49, 0x1ffff
    s_add_u32 m0, s48, 0
    s_nop 0
    buffer_load_dwordx4 v18, s[8:11], s40 offen  lds
    s_add_u32 s40, s40, 1024
    s_add_u32 m0, s48, 1024
    s_nop 0
    buffer_load_dwordx4 v18, s[8:11], s41 offen  lds
    s_add_u32 s41, s41, 1024
    s_add_u32 m0, s48, 2048
    s_nop 0
    buffer_load_dwordx4 v18, s[8:11], s42 offen  lds
    s_add_u32 s42, s42, 1024
    s_add_u32 m0, s48, 3072
    s_nop 0
    buffer_load_dwordx4 v18, s[8:11], s43 offen  lds
    s_add_u32 s43, s43, 1024
    s_add_u32 s48, s48, 32768
    s_and_b32 s48, s48, 0x1ffff
    s_add_u32 m0, s49, 0
    s_nop 0
    buffer_load_dwordx4 v19, s[12:15], s44 offen lds
    s_add_u32 s44, s44, s50
    s_add_u32 m0, s49, 2048
    s_nop 0
    buffer_load_dwordx4 v19, s[12:15], s45 offen lds
    s_add_u32 s45, s45, s50
    s_add_u32 m0, s49, 8192
    s_nop 0
    buffer_load_dwordx4 v19, s[12:15], s46 offen lds
    s_add_u32 s46, s46, s50
    s_add_u32 m0, s49, 10240
    s_nop 0
    buffer_load_dwordx4 v19, s[12:15], s47 offen lds
    s_add_u32 s47, s47, s50
    s_add_u32 s49, s49, 32768
    s_and_b32 s49, s49, 0x1ffff
    v_accvgpr_write_b32 a0, 0
    v_accvgpr_write_b32 a1, 0
    v_accvgpr_write_b32 a2, 0
    v_accvgpr_write_b32 a3, 0
    v_accvgpr_write_b32 a4, 0
    v_accvgpr_write_b32 a5, 0
    v_accvgpr_write_b32 a6, 0
    v_accvgpr_write_b32 a7, 0
    v_accvgpr_write_b32 a8, 0
    v_accvgpr_write_b32 a9, 0
    v_accvgpr_write_b32 a10, 0
    v_accvgpr_write_b32 a11, 0
    v_accvgpr_write_b32 a12, 0
    v_accvgpr_write_b32 a13, 0
    v_accvgpr_write_b32 a14, 0
    v_accvgpr_write_b32 a15, 0
    v_accvgpr_write_b32 a16, 0
    v_accvgpr_write_b32 a17, 0
    v_accvgpr_write_b32 a18, 0
    v_accvgpr_write_b32 a19, 0
    v_accvgpr_write_b32 a20, 0
    v_accvgpr_write_b32 a21, 0
    v_accvgpr_write_b32 a22, 0
    v_accvgpr_write_b32 a23, 0
    v_accvgpr_write_b32 a24, 0
    v_accvgpr_write_b32 a25, 0
    v_accvgpr_write_b32 a26, 0
    v_accvgpr_write_b32 a27, 0
    v_accvgpr_write_b32 a28, 0
    v_accvgpr_write_b32 a29, 0
    v_accvgpr_write_b32 a30, 0
    v_accvgpr_write_b32 a31, 0
    v_accvgpr_write_b32 a32, 0
    v_accvgpr_write_b32 a33, 0
    v_accvgpr_write_b32 a34, 0
    v_accvgpr_write_b32 a35, 0
    v_accvgpr_write_b32 a36, 0
    v_accvgpr_write_b32 a37, 0
    v_accvgpr_write_b32 a38, 0
    v_accvgpr_write_b32 a39, 0
    v_accvgpr_write_b32 a40, 0
    v_accvgpr_write_b32 a41, 0
    v_accvgpr_write_b32 a42, 0
    v_accvgpr_write_b32 a43, 0
    v_accvgpr_write_b32 a44, 0
    v_accvgpr_write_b32 a45, 0
    v_accvgpr_write_b32 a46, 0
    v_accvgpr_write_b32 a47, 0
    v_accvgpr_write_b32 a48, 0
    v_accvgpr_write_b32 a49, 0
    v_accvgpr_write_b32 a50, 0
    v_accvgpr_write_b32 a51, 0
    v_accvgpr_write_b32 a52, 0
    v_accvgpr_write_b32 a53, 0
    v_accvgpr_write_b32 a54, 0
    v_accvgpr_write_b32 a55, 0
    v_accvgpr_write_b32 a56, 0
    v_accvgpr_write_b32 a57, 0
    v_accvgpr_write_b32 a58, 0
    v_accvgpr_write_b32 a59, 0
    v_accvgpr_write_b32 a60, 0
    v_accvgpr_write_b32 a61, 0
    v_accvgpr_write_b32 a62, 0
    v_accvgpr_write_b32 a63, 0
    v_accvgpr_write_b32 a64, 0
    v_accvgpr_write_b32 a65, 0
    v_accvgpr_write_b32 a66, 0
    v_accvgpr_write_b32 a67, 0
    v_accvgpr_write_b32 a68, 0
    v_accvgpr_write_b32 a69, 0
    v_accvgpr_write_b32 a70, 0
    v_accvgpr_write_b32 a71, 0
    v_accvgpr_write_b32 a72, 0
    v_accvgpr_write_b32 a73, 0
    v_accvgpr_write_b32 a74, 0
    v_accvgpr_write_b32 a75, 0
    v_accvgpr_write_b32 a76, 0
    v_accvgpr_write_b32 a77, 0
    v_accvgpr_write_b32 a78, 0
    v_accvgpr_write_b32 a79, 0
    v_accvgpr_write_b32 a80, 0
    v_accvgpr_write_b32 a81, 0
    v_accvgpr_write_b32 a82, 0
    v_accvgpr_write_b32 a83, 0
    v_accvgpr_write_b32 a84, 0
    v_accvgpr_write_b32 a85, 0
    v_accvgpr_write_b32 a86, 0
    v_accvgpr_write_b32 a87, 0
    v_accvgpr_write_b32 a88, 0
    v_accvgpr_write_b32 a89, 0
    v_accvgpr_write_b32 a90, 0
    v_accvgpr_write_b32 a91, 0
    v_accvgpr_write_b32 a92, 0
    v_accvgpr_write_b32 a93, 0
    v_accvgpr_write_b32 a94, 0
    v_accvgpr_write_b32 a95, 0
    v_accvgpr_write_b32 a96, 0
    v_accvgpr_write_b32 a97, 0
    v_accvgpr_write_b32 a98, 0
    v_accvgpr_write_b32 a99, 0
    v_accvgpr_write_b32 a100, 0
    v_accvgpr_write_b32 a101, 0
    v_accvgpr_write_b32 a102, 0
    v_accvgpr_write_b32 a103, 0
    v_accvgpr_write_b32 a104, 0
    v_accvgpr_write_b32 a105, 0
    v_accvgpr_write_b32 a106, 0
    v_accvgpr_write_b32 a107, 0
    v_accvgpr_write_b32 a108, 0
    v_accvgpr_write_b32 a109, 0
    v_accvgpr_write_b32 a110, 0
    v_accvgpr_write_b32 a111, 0
    v_accvgpr_write_b32 a112, 0
    v_accvgpr_write_b32 a113, 0
    v_accvgpr_write_b32 a114, 0
    v_accvgpr_write_b32 a115, 0
    v_accvgpr_write_b32 a116, 0
    v_accvgpr_write_b32 a117, 0
    v_accvgpr_write_b32 a118, 0
    v_accvgpr_write_b32 a119, 0
    v_accvgpr_write_b32 a120, 0
    v_accvgpr_write_b32 a121, 0
    v_accvgpr_write_b32 a122, 0
    v_accvgpr_write_b32 a123, 0
    v_accvgpr_write_b32 a124, 0
    v_accvgpr_write_b32 a125, 0
    v_accvgpr_write_b32 a126, 0
    v_accvgpr_write_b32 a127, 0
    v_accvgpr_write_b32 a128, 0
    v_accvgpr_write_b32 a129, 0
    v_accvgpr_write_b32 a130, 0
    v_accvgpr_write_b32 a131, 0
    v_accvgpr_write_b32 a132, 0
    v_accvgpr_write_b32 a133, 0
    v_accvgpr_write_b32 a134, 0
    v_accvgpr_write_b32 a135, 0
    v_accvgpr_write_b32 a136, 0
    v_accvgpr_write_b32 a137, 0
    v_accvgpr_write_b32 a138, 0
    v_accvgpr_write_b32 a139, 0
    v_accvgpr_write_b32 a140, 0
    v_accvgpr_write_b32 a141, 0
    v_accvgpr_write_b32 a142, 0
    v_accvgpr_write_b32 a143, 0
    v_accvgpr_write_b32 a144, 0
    v_accvgpr_write_b32 a145, 0
    v_accvgpr_write_b32 a146, 0
    v_accvgpr_write_b32 a147, 0
    v_accvgpr_write_b32 a148, 0
    v_accvgpr_write_b32 a149, 0
    v_accvgpr_write_b32 a150, 0
    v_accvgpr_write_b32 a151, 0
    v_accvgpr_write_b32 a152, 0
    v_accvgpr_write_b32 a153, 0
    v_accvgpr_write_b32 a154, 0
    v_accvgpr_write_b32 a155, 0
    v_accvgpr_write_b32 a156, 0
    v_accvgpr_write_b32 a157, 0
    v_accvgpr_write_b32 a158, 0
    v_accvgpr_write_b32 a159, 0
    v_accvgpr_write_b32 a160, 0
    v_accvgpr_write_b32 a161, 0
    v_accvgpr_write_b32 a162, 0
    v_accvgpr_write_b32 a163, 0
    v_accvgpr_write_b32 a164, 0
    v_accvgpr_write_b32 a165, 0
    v_accvgpr_write_b32 a166, 0
    v_accvgpr_write_b32 a167, 0
    v_accvgpr_write_b32 a168, 0
    v_accvgpr_write_b32 a169, 0
    v_accvgpr_write_b32 a170, 0
    v_accvgpr_write_b32 a171, 0
    v_accvgpr_write_b32 a172, 0
    v_accvgpr_write_b32 a173, 0
    v_accvgpr_write_b32 a174, 0
    v_accvgpr_write_b32 a175, 0
    v_accvgpr_write_b32 a176, 0
    v_accvgpr_write_b32 a177, 0
    v_accvgpr_write_b32 a178, 0
    v_accvgpr_write_b32 a179, 0
    v_accvgpr_write_b32 a180, 0
    v_accvgpr_write_b32 a181, 0
    v_accvgpr_write_b32 a182, 0
    v_accvgpr_write_b32 a183, 0
    v_accvgpr_write_b32 a184, 0
    v_accvgpr_write_b32 a185, 0
    v_accvgpr_write_b32 a186, 0
    v_accvgpr_write_b32 a187, 0
    v_accvgpr_write_b32 a188, 0
    v_accvgpr_write_b32 a189, 0
    v_accvgpr_write_b32 a190, 0
    v_accvgpr_write_b32 a191, 0
    s_waitcnt vmcnt(24)
    s_barrier
    ds_read_b64_tr_b16 v[96:97], v10 offset:0
    ds_read_b64_tr_b16 v[98:99], v10 offset:2048
    ds_read_b128 v[64:67], v8 offset:0
    ds_read_b64_tr_b16 v[100:101], v11 offset:0
    ds_read_b64_tr_b16 v[102:103], v11 offset:2048
    ds_read_b128 v[68:71], v8 offset:1024
    ds_read_b64_tr_b16 v[104:105], v12 offset:0
    ds_read_b64_tr_b16 v[106:107], v12 offset:2048
    ds_read_b128 v[72:75], v8 offset:2048
    ds_read_b64_tr_b16 v[108:109], v13 offset:0
    ds_read_b64_tr_b16 v[110:111], v13 offset:2048
    ds_read_b128 v[76:79], v8 offset:3072
    ds_read_b64_tr_b16 v[112:113], v14 offset:0
    ds_read_b64_tr_b16 v[114:115], v14 offset:2048
    ds_read_b128 v[80:83], v8 offset:4096
    ds_read_b64_tr_b16 v[116:117], v15 offset:0
    ds_read_b64_tr_b16 v[118:119], v15 offset:2048
    ds_read_b128 v[84:87], v8 offset:5120
    ds_read_b128 v[88:91], v8 offset:6144
    ds_read_b128 v[92:95], v8 offset:7168
    s_mov_b32 s51, 10
Gf_loop:
    s_waitcnt vmcnt(16) lgkmcnt(0)
    s_barrier
    v_mfma_f32_16x16x32_bf16 a[0:3], v[96:99], v[64:67], a[0:3]
    ds_read_b64_tr_b16 v[160:161], v10 offset:32768
    v_mfma_f32_16x16x32_bf16 a[4:7], v[96:99], v[68:71], a[4:7]
    ds_read_b64_tr_b16 v[162:163], v10 offset:34816
    v_mfma_f32_16x16x32_bf16 a[8:11], v[96:99], v[72:75], a[8:11]
    ds_read_b128 v[128:131], v8 offset:32768
    s_add_u32 m0, s48, 0
    s_nop 0
    buffer_load_dwordx4 v18, s[8:11], s40 offen  lds
    s_add_u32 s40, s40, 1024
    v_mfma_f32_16x16x32_bf16 a[12:15], v[96:99], v[76:79], a[12:15]
    ds_read_b64_tr_b16 v[164:165], v11 offset:32768
    v_mfma_f32_16x16x32_bf16 a[16:19], v[96:99], v[80:83], a[16:19]
    ds_read_b64_tr_b16 v[166:167], v11 offset:34816
    v_mfma_f32_16x16x32_bf16 a[20:23], v[96:99], v[84:87], a[20:23]
    ds_read_b128 v[132:135], v8 offset:33792
    v_mfma_f32_16x16x32_bf16 a[24:27], v[96:99], v[88:91], a[24:27]
    ds_read_b64_tr_b16 v[168:169], v12 offset:32768
    v_mfma_f32_16x16x32_bf16 a[28:31], v[96:99], v[92:95], a[28:31]
    ds_read_b64_tr_b16 v[170:171], v12 offset:34816
    s_add_u32 m0, s48, 1024
    s_nop 0
    buffer_load_dwordx4 v18, s[8:11], s41 offen  lds
    s_add_u32 s41, s41, 1024
    v_mfma_f32_16x16x32_bf16 a[32:35], v[100:103], v[64:67], a[32:35]
    ds_read_b128 v[136:139], v8 offset:34816
    v_mfma_f32_16x16x32_bf16 a[36:39], v[100:103], v[68:71], a[36:39]
    ds_read_b64_tr_b16 v[172:173], v13 offset:32768
    v_mfma_f32_16x16x32_bf16 a[40:43], v[100:103], v[72:75], a[40:43]
    ds_read_b64_tr_b16 v[174:175], v13 offset:34816
    v_mfma_f32_16x16x32_bf16 a[44:47], v[100:103], v[76:79], a[44:47]
    ds_read_b128 v[140:143], v8 offset:35840
    v_mfma_f32_16x16x32_bf16 a[48:51], v[100:103], v[80:83], a[48:51]
    ds_read_b64_tr_b16 v[176:177], v14 offset:32768
    s_add_u32 m0, s48, 2048
    s_nop 0
    buffer_load_dwordx4 v18, s[8:11], s42 offen  lds
    s_add_u32 s42, s42, 1024
    v_mfma_f32_16x16x32_bf16 a[52:55], v[100:103], v[84:87], a[52:55]
    ds_read_b64_tr_b16 v[178:179], v14 offset:34816
    v_mfma_f32_16x16x32_bf16 a[56:59], v[100:103], v[88:91], a[56:59]
    ds_read_b128 v[144:147], v8 offset:36864
    v_mfma_f32_16x16x32_bf16 a[60:63], v[100:103], v[92:95], a[60:63]
    ds_read_b64_tr_b16 v[180:181], v15 offset:32768
    v_mfma_f32_16x16x32_bf16 a[64:67], v[104:107], v[64:67], a[64:67]
    ds_read_b64_tr_b16 v[182:183], v15 offset:34816
    v_mfma_f32_16x16x32_bf16 a[68:71], v[104:107], v[68:71], a[68:71]
    ds_read_b128 v[148:151], v8 offset:37888
    s_add_u32 m0, s48, 3072
    s_nop 0
    buffer_load_dwordx4 v18, s[8:11], s43 offen  lds
    s_add_u32 s43, s43, 1024
    s_add_u32 s48, s48, 32768
    s_and_b32 s48, s48, 0x1ffff
    v_mfma_f32_16x16x32_bf16 a[72:75], v[104:107], v[72:75], a[72:75]
    ds_read_b128 v[152:155], v8 offset:38912
    v_mfma_f32_16x16x32_bf16 a[76:79], v[104:107], v[76:79], a[76:79]
    ds_read_b128 v[156:159], v8 offset:39936
    v_mfma_f32_16x16x32_bf16 a[80:83], v[104:107], v[80:83], a[80:83]
    v_mfma_f32_16x16x32_bf16 a[84:87], v[104:107], v[84:87], a[84:87]
    v_mfma_f32_16x16x32_bf16 a[88:91], v[104:107], v[88:91], a[88:91]
    s_add_u32 m0, s49, 0
    s_nop 0
    buffer_load_dwordx4 v19, s[12:15], s44 offen lds
    s_add_u32 s44, s44, s50
    v_mfma_f32_16x16x32_bf16 a[92:95], v[104:107], v[92:95], a[92:95]
    v_mfma_f32_16x16x32_bf16 a[96:99], v[108:111], v[64:67], a[96:99]
    v_mfma_f32_16x16x32_bf16 a[100:103], v[108:111], v[68:71], a[100:103]
    v_mfma_f32_16x16x32_bf16 a[104:107], v[108:111], v[72:75], a[104:107]
    v_mfma_f32_16x16x32_bf16 a[108:111], v[108:111], v[76:79], a[108:111]
    s_add_u32 m0, s49, 2048
    s_nop 0
    buffer_load_dwordx4 v19, s[12:15], s45 offen lds
    s_add_u32 s45, s45, s50
    v_mfma_f32_16x16x32_bf16 a[112:115], v[108:111], v[80:83], a[112:115]
    v_mfma_f32_16x16x32_bf16 a[116:119], v[108:111], v[84:87], a[116:119]
    v_mfma_f32_16x16x32_bf16 a[120:123], v[108:111], v[88:91], a[120:123]
    v_mfma_f32_16x16x32_bf16 a[124:127], v[108:111], v[92:95], a[124:127]
    v_mfma_f32_16x16x32_bf16 a[128:131], v[112:115], v[64:67], a[128:131]
    s_add_u32 m0, s49, 8192
    s_nop 0
    buffer_load_dwordx4 v19, s[12:15], s46 offen lds
    s_add_u32 s46, s46, s50
    v_mfma_f32_16x16x32_bf16 a[132:135], v[112:115], v[68:71], a[132:135]
    v_mfma_f32_16x16x32_bf16 a[136:139], v[112:115], v[72:75], a[136:139]
    v_mfma_f32_16x16x32_bf16 a[140:143], v[112:115], v[76:79], a[140:143]
    v_mfma_f32_16x16x32_bf16 a[144:147], v[112:115], v[80:83], a[144:147]
    v_mfma_f32_16x16x32_bf16 a[148:151], v[112:115], v[84:87], a[148:151]
    s_add_u32 m0, s49, 10240
    s_nop 0
    buffer_load_dwordx4 v19, s[12:15], s47 offen lds
    s_add_u32 s47, s47, s50
    s_add_u32 s49, s49, 32768
    s_and_b32 s49, s49, 0x1ffff
    v_mfma_f32_16x16x32_bf16 a[152:155], v[112:115], v[88:91], a[152:155]
    v_mfma_f32_16x16x32_bf16 a[156:159], v[112:115], v[92:95], a[156:159]
    v_mfma_f32_16x16x32_bf16 a[160:163], v[116:119], v[64:67], a[160:163]
    v_mfma_f32_16x16x32_bf16 a[164:167], v[116:119], v[68:71], a[164:167]
    v_mfma_f32_16x16x32_bf16 a[168:171], v[116:119], v[72:75], a[168:171]
    v_mfma_f32_16x16x32_bf16 a[172:175], v[116:119], v[76:79], a[172:175]
    v_mfma_f32_16x16x32_bf16 a[176:179], v[116:119], v[80:83], a[176:179]
    v_mfma_f32_16x16x32_bf16 a[180:183], v[116:119], v[84:87], a[180:183]
    v_mfma_f32_16x16x32_bf16 a[184:187], v[116:119], v[88:91], a[184:187]
    v_mfma_f32_16x16x32_bf16 a[188:191], v[116:119], v[92:95], a[188:191]
    v_xor_b32 v8, 0x10000, v8
    v_xor_b32 v10, 0x10000, v10
    v_xor_b32 v11, 0x10000, v11
    v_xor_b32 v12, 0x10000, v12
    v_xor_b32 v13, 0x10000, v13
    v_xor_b32 v14, 0x10000, v14
    v_xor_b32 v15, 0x10000, v15
    s_waitcnt vmcnt(16) lgkmcnt(0)
    s_barrier
    v_mfma_f32_16x16x32_bf16 a[0:3], v[160:163], v[128:131], a[0:3]
    ds_read_b64_tr_b16 v[96:97], v10 offset:0
    v_mfma_f32_16x16x32_bf16 a[4:7], v[160:163], v[132:135], a[4:7]
    ds_read_b64_tr_b16 v[98:99], v10 offset:2048
    v_mfma_f32_16x16x32_bf16 a[8:11], v[160:163], v[136:139], a[8:11]
    ds_read_b128 v[64:67], v8 offset:0
    s_add_u32 m0, s48, 0
    s_nop 0
    buffer_load_dwordx4 v18, s[8:11], s40 offen  lds
    s_add_u32 s40, s40, 1024
    v_mfma_f32_16x16x32_bf16 a[12:15], v[160:163], v[140:143], a[12:15]
    ds_read_b64_tr_b16 v[100:101], v11 offset:0
    v_mfma_f32_16x16x32_bf16 a[16:19], v[160:163], v[144:147], a[16:19]
    ds_read_b64_tr_b16 v[102:103], v11 offset:2048
    v_mfma_f32_16x16x32_bf16 a[20:23], v[160:163], v[148:151], a[20:23]
    ds_read_b128 v[68:71], v8 offset:1024
    v_mfma_f32_16x16x32_bf16 a[24:27], v[160:163], v[152:155], a[24:27]
    ds_read_b64_tr_b16 v[104:105], v12 offset:0
    v_mfma_f32_16x16x32_bf16 a[28:31], v[160:163], v[156:159], a[28:31]
    ds_read_b64_tr_b16 v[106:107], v12 offset:2048
    s_add_u32 m0, s48, 1024
    s_nop 0
    buffer_load_dwordx4 v18, s[8:11], s41 offen  lds
    s_add_u32 s41, s41, 1024
    v_mfma_f32_16x16x32_bf16 a[32:35], v[164:167], v[128:131], a[32:35]
    ds_read_b128 v[72:75], v8 offset:2048
    v_mfma_f32_16x16x32_bf16 a[36:39], v[164:167], v[132:135], a[36:39]
    ds_read_b64_tr_b16 v[108:109], v13 offset:0
    v_mfma_f32_16x16x32_bf16 a[40:43], v[164:167], v[136:139], a[40:43]
    ds_read_b64_tr_b16 v[110:111], v13 offset:2048
    v_mfma_f32_16x16x32_bf16 a[44:47], v[164:167], v[140:143], a[44:47]
    ds_read_b128 v[76:79], v8 offset:3072
    v_mfma_f32_16x16x32_bf16 a[48:51], v[164:167], v[144:147], a[48:51]
    ds_read_b64_tr_b16 v[112:113], v14 offset:0
    s_add_u32 m0, s48, 2048
    s_nop 0
    buffer_load_dwordx4 v18, s[8:11], s42 offen  lds
    s_add_u32 s42, s42, 1024
    v_mfma_f32_16x16x32_bf16 a[52:55], v[164:167], v[148:151], a[52:55]
    ds_read_b64_tr_b16 v[114:115], v14 offset:2048
    v_mfma_f32_16x16x32_bf16 a[56:59], v[164:167], v[152:155], a[56:59]
    ds_read_b128 v[80:83], v8 offset:4096
    v_mfma_f32_16x16x32_bf16 a[60:63], v[164:167], v[156:159], a[60:63]
    ds_read_b64_tr_b16 v[116:117], v15 offset:0
    v_mfma_f32_16x16x32_bf16 a[64:67], v[168:171], v[128:131], a[64:67]
    ds_read_b64_tr_b16 v[118:119], v15 offset:2048
    v_mfma_f32_16x16x32_bf16 a[68:71], v[168:171], v[132:135], a[68:71]
    ds_read_b128 v[84:87], v8 offset:5120
    s_add_u32 m0, s48, 3072
    s_nop 0
    buffer_load_dwordx4 v18, s[8:11], s43 offen  lds
    s_add_u32 s43, s43, 1024
    s_add_u32 s48, s48, 32768
    s_and_b32 s48, s48, 0x1ffff
    v_mfma_f32_16x16x32_bf16 a[72:75], v[168:171], v[136:139], a[72:75]
    ds_read_b128 v[88:91], v8 offset:6144
    v_mfma_f32_16x16x32_bf16 a[76:79], v[168:171], v[140:143], a[76:79]
    ds_read_b128 v[92:95], v8 offset:7168
    v_mfma_f32_16x16x32_bf16 a[80:83], v[168:171], v[144:147], a[80:83]
    v_mfma_f32_16x16x32_bf16 a[84:87], v[168:171], v[148:151], a[84:87]
    v_mfma_f32_16x16x32_bf16 a[88:91], v[168:171], v[152:155], a[88:91]
    s_add_u32 m0, s49, 0
    s_nop 0
    buffer_load_dwordx4 v19, s[12:15], s44 offen lds
    s_add_u32 s44, s44, s50
    v_mfma_f32_16x16x32_bf16 a[92:95], v[168:171], v[156:159], a[92:95]
    v_mfma_f32_16x16x32_bf16 a[96:99], v[172:175], v[128:131], a[96:99]
    v_mfma_f32_16x16x32_bf16 a[100:103], v[172:175], v[132:135], a[100:103]
    v_mfma_f32_16x16x32_bf16 a[104:107], v[172:175], v[136:139], a[104:107]
    v_mfma_f32_16x16x32_bf16 a[108:111], v[172:175], v[140:143], a[108:111]
    s_add_u32 m0, s49, 2048
    s_nop 0
    buffer_load_dwordx4 v19, s[12:15], s45 offen lds
    s_add_u32 s45, s45, s50
    v_mfma_f32_16x16x32_bf16 a[112:115], v[172:175], v[144:147], a[112:115]
    v_mfma_f32_16x16x32_bf16 a[116:119], v[172:175], v[148:151], a[116:119]
    v_mfma_f32_16x16x32_bf16 a[120:123], v[172:175], v[152:155], a[120:123]
    v_mfma_f32_16x16x32_bf16 a[124:127], v[172:175], v[156:159], a[124:127]
    v_mfma_f32_16x16x32_bf16 a[128:131], v[176:179], v[128:131], a[128:131]
    s_add_u32 m0, s49, 8192
    s_nop 0
    buffer_load_dwordx4 v19, s[12:15], s46 offen lds
    s_add_u32 s46, s46, s50
    v_mfma_f32_16x16x32_bf16 a[132:135], v[176:179], v[132:135], a[132:135]
    v_mfma_f32_16x16x32_bf16 a[136:139], v[176:179], v[136:139], a[136:139]
    v_mfma_f32_16x16x32_bf16 a[140:143], v[176:179], v[140:143], a[140:143]
    v_mfma_f32_16x16x32_bf16 a[144:147], v[176:179], v[144:147], a[144:147]
    v_mfma_f32_16x16x32_bf16 a[148:151], v[176:179], v[148:151], a[148:151]
    s_add_u32 m0, s49, 10240
    s_nop 0
    buffer_load_dwordx4 v19, s[12:15], s47 offen lds
    s_add_u32 s47, s47, s50
    s_add_u32 s49, s49, 32768
    s_and_b32 s49, s49, 0x1ffff
    v_mfma_f32_16x16x32_bf16 a[152:155], v[176:179], v[152:155], a[152:155]
    v_mfma_f32_16x16x32_bf16 a[156:159], v[176:179], v[156:159], a[156:159]
    v_mfma_f32_16x16x32_bf16 a[160:163], v[180:183], v[128:131], a[160:163]
    v_mfma_f32_16x16x32_bf16 a[164:167], v[180:183], v[132:135], a[164:167]
    v_mfma_f32_16x16x32_bf16 a[168:171], v[180:183], v[136:139], a[168:171]
    v_mfma_f32_16x16x32_bf16 a[172:175], v[180:183], v[140:143], a[172:175]
    v_mfma_f32_16x16x32_bf16 a[176:179], v[180:183], v[144:147], a[176:179]
    v_mfma_f32_16x16x32_bf16 a[180:183], v[180:183], v[148:151], a[180:183]
    v_mfma_f32_16x16x32_bf16 a[184:187], v[180:183], v[152:155], a[184:187]
    v_mfma_f32_16x16x32_bf16 a[188:191], v[180:183], v[156:159], a[188:191]
    s_sub_u32 s51, s51, 1
    s_cmp_lg_u32 s51, 0
    s_cbranch_scc1 Gf_loop
    s_waitcnt vmcnt(16) lgkmcnt(0)
    s_barrier
    v_mfma_f32_16x16x32_bf16 a[0:3], v[96:99], v[64:67], a[0:3]
    ds_read_b64_tr_b16 v[160:161], v10 offset:32768
    v_mfma_f32_16x16x32_bf16 a[4:7], v[96:99], v[68:71], a[4:7]
    ds_read_b64_tr_b16 v[162:163], v10 offset:34816
    v_mfma_f32_16x16x32_bf16 a[8:11], v[96:99], v[72:75], a[8:11]
    ds_read_b128 v[128:131], v8 offset:32768
    v_mfma_f32_16x16x32_bf16 a[12:15], v[96:99], v[76:79], a[12:15]
    ds_read_b64_tr_b16 v[164:165], v11 offset:32768
    v_mfma_f32_16x16x32_bf16 a[16:19], v[96:99], v[80:83], a[16:19]
    ds_read_b64_tr_b16 v[166:167], v11 offset:34816
    v_mfma_f32_16x16x32_bf16 a[20:23], v[96:99], v[84:87], a[20:23]
    ds_read_b128 v[132:135], v8 offset:33792
    v_mfma_f32_16x16x32_bf16 a[24:27], v[96:99], v[88:91], a[24:27]
    ds_read_b64_tr_b16 v[168:169], v12 offset:32768
    v_mfma_f32_16x16x32_bf16 a[28:31], v[96:99], v[92:95], a[28:31]
    ds_read_b64_tr_b16 v[170:171], v12 offset:34816
    v_mfma_f32_16x16x32_bf16 a[32:35], v[100:103], v[64:67], a[32:35]
    ds_read_b128 v[136:139], v8 offset:34816
    v_mfma_f32_16x16x32_bf16 a[36:39], v[100:103], v[68:71], a[36:39]
    ds_read_b64_tr_b16 v[172:173], v13 offset:32768
    v_mfma_f32_16x16x32_bf16 a[40:43], v[100:103], v[72:75], a[40:43]
    ds_read_b64_tr_b16 v[174:175], v13 offset:34816
    v_mfma_f32_16x16x32_bf16 a[44:47], v[100:103], v[76:79], a[44:47]
    ds_read_b128 v[140:143], v8 offset:35840
    v_mfma_f32_16x16x32_bf16 a[48:51], v[100:103], v[80:83], a[48:51]
    ds_read_b64_tr_b16 v[176:177], v14 offset:32768
    v_mfma_f32_16x16x32_bf16 a[52:55], v[100:103], v[84:87], a[52:55]
    ds_read_b64_tr_b16 v[178:179], v14 offset:34816
    v_mfma_f32_16x16x32_bf16 a[56:59], v[100:103], v[88:91], a[56:59]
    ds_read_b128 v[144:147], v8 offset:36864
    v_mfma_f32_16x16x32_bf16 a[60:63], v[100:103], v[92:95], a[60:63]
    ds_read_b64_tr_b16 v[180:181], v15 offset:32768
    v_mfma_f32_16x16x32_bf16 a[64:67], v[104:107], v[64:67], a[64:67]
    ds_read_b64_tr_b16 v[182:183], v15 offset:34816
    v_mfma_f32_16x16x32_bf16 a[68:71], v[104:107], v[68:71], a[68:71]
    ds_read_b128 v[148:151], v8 offset:37888
    v_mfma_f32_16x16x32_bf16 a[72:75], v[104:107], v[72:75], a[72:75]
    ds_read_b128 v[152:155], v8 offset:38912
    v_mfma_f32_16x16x32_bf16 a[76:79], v[104:107], v[76:79], a[76:79]
    ds_read_b128 v[156:159], v8 offset:39936
    v_mfma_f32_16x16x32_bf16 a[80:83], v[104:107], v[80:83], a[80:83]
    v_mfma_f32_16x16x32_bf16 a[84:87], v[104:107], v[84:87], a[84:87]
    v_mfma_f32_16x16x32_bf16 a[88:91], v[104:107], v[88:91], a[88:91]
    v_mfma_f32_16x16x32_bf16 a[92:95], v[104:107], v[92:95], a[92:95]
    v_mfma_f32_16x16x32_bf16 a[96:99], v[108:111], v[64:67], a[96:99]
    v_mfma_f32_16x16x32_bf16 a[100:103], v[108:111], v[68:71], a[100:103]
    v_mfma_f32_16x16x32_bf16 a[104:107], v[108:111], v[72:75], a[104:107]
    v_mfma_f32_16x16x32_bf16 a[108:111], v[108:111], v[76:79], a[108:111]
    v_mfma_f32_16x16x32_bf16 a[112:115], v[108:111], v[80:83], a[112:115]
    v_mfma_f32_16x16x32_bf16 a[116:119], v[108:111], v[84:87], a[116:119]
    v_mfma_f32_16x16x32_bf16 a[120:123], v[108:111], v[88:91], a[120:123]
    v_mfma_f32_16x16x32_bf16 a[124:127], v[108:111], v[92:95], a[124:127]
    v_mfma_f32_16x16x32_bf16 a[128:131], v[112:115], v[64:67], a[128:131]
    v_mfma_f32_16x16x32_bf16 a[132:135], v[112:115], v[68:71], a[132:135]
    v_mfma_f32_16x16x32_bf16 a[136:139], v[112:115], v[72:75], a[136:139]
    v_mfma_f32_16x16x32_bf16 a[140:143], v[112:115], v[76:79], a[140:143]
    v_mfma_f32_16x16x32_bf16 a[144:147], v[112:115], v[80:83], a[144:147]
    v_mfma_f32_16x16x32_bf16 a[148:151], v[112:115], v[84:87], a[148:151]
    v_mfma_f32_16x16x32_bf16 a[152:155], v[112:115], v[88:91], a[152:155]
    v_mfma_f32_16x16x32_bf16 a[156:159], v[112:115], v[92:95], a[156:159]
    v_mfma_f32_16x16x32_bf16 a[160:163], v[116:119], v[64:67], a[160:163]
    v_mfma_f32_16x16x32_bf16 a[164:167], v[116:119], v[68:71], a[164:167]
    v_mfma_f32_16x16x32_bf16 a[168:171], v[116:119], v[72:75], a[168:171]
    v_mfma_f32_16x16x32_bf16 a[172:175], v[116:119], v[76:79], a[172:175]
    v_mfma_f32_16x16x32_bf16 a[176:179], v[116:119], v[80:83], a[176:179]
    v_mfma_f32_16x16x32_bf16 a[180:183], v[116:119], v[84:87], a[180:183]
    v_mfma_f32_16x16x32_bf16 a[184:187], v[116:119], v[88:91], a[184:187]
    v_mfma_f32_16x16x32_bf16 a[188:191], v[116:119], v[92:95], a[188:191]
    v_xor_b32 v8, 0x10000, v8
    v_xor_b32 v10, 0x10000, v10
    v_xor_b32 v11, 0x10000, v11
    v_xor_b32 v12, 0x10000, v12
    v_xor_b32 v13, 0x10000, v13
    v_xor_b32 v14, 0x10000, v14
    v_xor_b32 v15, 0x10000, v15
    s_waitcnt vmcnt(8) lgkmcnt(0)
    s_barrier
    v_mfma_f32_16x16x32_bf16 a[0:3], v[160:163], v[128:131], a[0:3]
    ds_read_b64_tr_b16 v[96:97], v10 offset:0
    v_mfma_f32_16x16x32_bf16 a[4:7], v[160:163], v[132:135], a[4:7]
    ds_read_b64_tr_b16 v[98:99], v10 offset:2048
    v_mfma_f32_16x16x32_bf16 a[8:11], v[160:163], v[136:139], a[8:11]
    ds_read_b128 v[64:67], v8 offset:0
    v_mfma_f32_16x16x32_bf16 a[12:15], v[160:163], v[140:143], a[12:15]
    ds_read_b64_tr_b16 v[100:101], v11 offset:0
    v_mfma_f32_16x16x32_bf16 a[16:19], v[160:163], v[144:147], a[16:19]
    ds_read_b64_tr_b16 v[102:103], v11 offset:2048
    v_mfma_f32_16x16x32_bf16 a[20:23], v[160:163], v[148:151], a[20:23]
    ds_read_b128 v[68:71], v8 offset:1024
    v_mfma_f32_16x16x32_bf16 a[24:27], v[160:163], v[152:155], a[24:27]
    ds_read_b64_tr_b16 v[104:105], v12 offset:0
    v_mfma_f32_16x16x32_bf16 a[28:31], v[160:163], v[156:159], a[28:31]
    ds_read_b64_tr_b16 v[106:107], v12 offset:2048
    v_mfma_f32_16x16x32_bf16 a[32:35], v[164:167], v[128:131], a[32:35]
    ds_read_b128 v[72:75], v8 offset:2048
    v_mfma_f32_16x16x32_bf16 a[36:39], v[164:167], v[132:135], a[36:39]
    ds_read_b64_tr_b16 v[108:109], v13 offset:0
    v_mfma_f32_16x16x32_bf16 a[40:43], v[164:167], v[136:139], a[40:43]
    ds_read_b64_tr_b16 v[110:111], v13 offset:2048
    v_mfma_f32_16x16x32_bf16 a[44:47], v[164:167], v[140:143], a[44:47]
    ds_read_b128 v[76:79], v8 offset:3072
    v_mfma_f32_16x16x32_bf16 a[48:51], v[164:167], v[144:147], a[48:51]
    ds_read_b64_tr_b16 v[112:113], v14 offset:0
    v_mfma_f32_16x16x32_bf16 a[52:55], v[164:167], v[148:151], a[52:55]
    ds_read_b64_tr_b16 v[114:115], v14 offset:2048
    v_mfma_f32_16x16x32_bf16 a[56:59], v[164:167], v[152:155], a[56:59]
    ds_read_b128 v[80:83], v8 offset:4096
    v_mfma_f32_16x16x32_bf16 a[60:63], v[164:167], v[156:159], a[60:63]
    ds_read_b64_tr_b16 v[116:117], v15 offset:0
    v_mfma_f32_16x16x32_bf16 a[64:67], v[168:171], v[128:131], a[64:67]
    ds_read_b64_tr_b16 v[118:119], v15 offset:2048
    v_mfma_f32_16x16x32_bf16 a[68:71], v[168:171], v[132:135], a[68:71]
    ds_read_b128 v[84:87], v8 offset:5120
    v_mfma_f32_16x16x32_bf16 a[72:75], v[168:171], v[136:139], a[72:75]
    ds_read_b128 v[88:91], v8 offset:6144
    v_mfma_f32_16x16x32_bf16 a[76:79], v[168:171], v[140:143], a[76:79]
    ds_read_b128 v[92:95], v8 offset:7168
    v_mfma_f32_16x16x32_bf16 a[80:83], v[168:171], v[144:147], a[80:83]
    v_mfma_f32_16x16x32_bf16 a[84:87], v[168:171], v[148:151], a[84:87]
    v_mfma_f32_16x16x32_bf16 a[88:91], v[168:171], v[152:155], a[88:91]
    v_mfma_f32_16x16x32_bf16 a[92:95], v[168:171], v[156:159], a[92:95]
    v_mfma_f32_16x16x32_bf16 a[96:99], v[172:175], v[128:131], a[96:99]
    v_mfma_f32_16x16x32_bf16 a[100:103], v[172:175], v[132:135], a[100:103]
    v_mfma_f32_16x16x32_bf16 a[104:107], v[172:175], v[136:139], a[104:107]
    v_mfma_f32_16x16x32_bf16 a[108:111], v[172:175], v[140:143], a[108:111]
    v_mfma_f32_16x16x32_bf16 a[112:115], v[172:175], v[144:147], a[112:115]
    v_mfma_f32_16x16x32_bf16 a[116:119], v[172:175], v[148:151], a[116:119]
    v_mfma_f32_16x16x32_bf16 a[120:123], v[172:175], v[152:155], a[120:123]
    v_mfma_f32_16x16x32_bf16 a[124:127], v[172:175], v[156:159], a[124:127]
    v_mfma_f32_16x16x32_bf16 a[128:131], v[176:179], v[128:131], a[128:131]
    v_mfma_f32_16x16x32_bf16 a[132:135], v[176:179], v[132:135], a[132:135]
    v_mfma_f32_16x16x32_bf16 a[136:139], v[176:179], v[136:139], a[136:139]
    v_mfma_f32_16x16x32_bf16 a[140:143], v[176:179], v[140:143], a[140:143]
    v_mfma_f32_16x16x32_bf16 a[144:147], v[176:179], v[144:147], a[144:147]
    v_mfma_f32_16x16x32_bf16 a[148:151], v[176:179], v[148:151], a[148:151]
    v_mfma_f32_16x16x32_bf16 a[152:155], v[176:179], v[152:155], a[152:155]
    v_mfma_f32_16x16x32_bf16 a[156:159], v[176:179], v[156:159], a[156:159]
    v_mfma_f32_16x16x32_bf16 a[160:163], v[180:183], v[128:131], a[160:163]
    v_mfma_f32_16x16x32_bf16 a[164:167], v[180:183], v[132:135], a[164:167]
    v_mfma_f32_16x16x32_bf16 a[168:171], v[180:183], v[136:139], a[168:171]
    v_mfma_f32_16x16x32_bf16 a[172:175], v[180:183], v[140:143], a[172:175]
    v_mfma_f32_16x16x32_bf16 a[176:179], v[180:183], v[144:147], a[176:179]
    v_mfma_f32_16x16x32_bf16 a[180:183], v[180:183], v[148:151], a[180:183]
    v_mfma_f32_16x16x32_bf16 a[184:187], v[180:183], v[152:155], a[184:187]
    v_mfma_f32_16x16x32_bf16 a[188:191], v[180:183], v[156:159], a[188:191]
    s_waitcnt vmcnt(0) lgkmcnt(0)
    s_barrier
    v_mfma_f32_16x16x32_bf16 a[0:3], v[96:99], v[64:67], a[0:3]
    ds_read_b64_tr_b16 v[160:161], v10 offset:32768
    v_mfma_f32_16x16x32_bf16 a[4:7], v[96:99], v[68:71], a[4:7]
    ds_read_b64_tr_b16 v[162:163], v10 offset:34816
    v_mfma_f32_16x16x32_bf16 a[8:11], v[96:99], v[72:75], a[8:11]
    ds_read_b128 v[128:131], v8 offset:32768
    v_mfma_f32_16x16x32_bf16 a[12:15], v[96:99], v[76:79], a[12:15]
    ds_read_b64_tr_b16 v[164:165], v11 offset:32768
    v_mfma_f32_16x16x32_bf16 a[16:19], v[96:99], v[80:83], a[16:19]
    ds_read_b64_tr_b16 v[166:167], v11 offset:34816
    v_mfma_f32_16x16x32_bf16 a[20:23], v[96:99], v[84:87], a[20:23]
    ds_read_b128 v[132:135], v8 offset:33792
    v_mfma_f32_16x16x32_bf16 a[24:27], v[96:99], v[88:91], a[24:27]
    ds_read_b64_tr_b16 v[168:169], v12 offset:32768
    v_mfma_f32_16x16x32_bf16 a[28:31], v[96:99], v[92:95], a[28:31]
    ds_read_b64_tr_b16 v[170:171], v12 offset:34816
    v_mfma_f32_16x16x32_bf16 a[32:35], v[100:103], v[64:67], a[32:35]
    ds_read_b128 v[136:139], v8 offset:34816
    v_mfma_f32_16x16x32_bf16 a[36:39], v[100:103], v[68:71], a[36:39]
    ds_read_b64_tr_b16 v[172:173], v13 offset:32768
    v_mfma_f32_16x16x32_bf16 a[40:43], v[100:103], v[72:75], a[40:43]
    ds_read_b64_tr_b16 v[174:175], v13 offset:34816
    v_mfma_f32_16x16x32_bf16 a[44:47], v[100:103], v[76:79], a[44:47]
    ds_read_b128 v[140:143], v8 offset:35840
    v_mfma_f32_16x16x32_bf16 a[48:51], v[100:103], v[80:83], a[48:51]
    ds_read_b64_tr_b16 v[176:177], v14 offset:32768
    v_mfma_f32_16x16x32_bf16 a[52:55], v[100:103], v[84:87], a[52:55]
    ds_read_b64_tr_b16 v[178:179], v14 offset:34816
    v_mfma_f32_16x16x32_bf16 a[56:59], v[100:103], v[88:91], a[56:59]
    ds_read_b128 v[144:147], v8 offset:36864
    v_mfma_f32_16x16x32_bf16 a[60:63], v[100:103], v[92:95], a[60:63]
    ds_read_b64_tr_b16 v[180:181], v15 offset:32768
    v_mfma_f32_16x16x32_bf16 a[64:67], v[104:107], v[64:67], a[64:67]
    ds_read_b64_tr_b16 v[182:183], v15 offset:34816
    v_mfma_f32_16x16x32_bf16 a[68:71], v[104:107], v[68:71], a[68:71]
    ds_read_b128 v[148:151], v8 offset:37888
    v_mfma_f32_16x16x32_bf16 a[72:75], v[104:107], v[72:75], a[72:75]
    ds_read_b128 v[152:155], v8 offset:38912
    v_mfma_f32_16x16x32_bf16 a[76:79], v[104:107], v[76:79], a[76:79]
    ds_read_b128 v[156:159], v8 offset:39936
    v_mfma_f32_16x16x32_bf16 a[80:83], v[104:107], v[80:83], a[80:83]
    v_mfma_f32_16x16x32_bf16 a[84:87], v[104:107], v[84:87], a[84:87]
    v_mfma_f32_16x16x32_bf16 a[88:91], v[104:107], v[88:91], a[88:91]
    v_mfma_f32_16x16x32_bf16 a[92:95], v[104:107], v[92:95], a[92:95]
    v_mfma_f32_16x16x32_bf16 a[96:99], v[108:111], v[64:67], a[96:99]
    v_mfma_f32_16x16x32_bf16 a[100:103], v[108:111], v[68:71], a[100:103]
    v_mfma_f32_16x16x32_bf16 a[104:107], v[108:111], v[72:75], a[104:107]
    v_mfma_f32_16x16x32_bf16 a[108:111], v[108:111], v[76:79], a[108:111]
    v_mfma_f32_16x16x32_bf16 a[112:115], v[108:111], v[80:83], a[112:115]
    v_mfma_f32_16x16x32_bf16 a[116:119], v[108:111], v[84:87], a[116:119]
    v_mfma_f32_16x16x32_bf16 a[120:123], v[108:111], v[88:91], a[120:123]
    v_mfma_f32_16x16x32_bf16 a[124:127], v[108:111], v[92:95], a[124:127]
    v_mfma_f32_16x16x32_bf16 a[128:131], v[112:115], v[64:67], a[128:131]
    v_mfma_f32_16x16x32_bf16 a[132:135], v[112:115], v[68:71], a[132:135]
    v_mfma_f32_16x16x32_bf16 a[136:139], v[112:115], v[72:75], a[136:139]
    v_mfma_f32_16x16x32_bf16 a[140:143], v[112:115], v[76:79], a[140:143]
    v_mfma_f32_16x16x32_bf16 a[144:147], v[112:115], v[80:83], a[144:147]
    v_mfma_f32_16x16x32_bf16 a[148:151], v[112:115], v[84:87], a[148:151]
    v_mfma_f32_16x16x32_bf16 a[152:155], v[112:115], v[88:91], a[152:155]
    v_mfma_f32_16x16x32_bf16 a[156:159], v[112:115], v[92:95], a[156:159]
    v_mfma_f32_16x16x32_bf16 a[160:163], v[116:119], v[64:67], a[160:163]
    v_mfma_f32_16x16x32_bf16 a[164:167], v[116:119], v[68:71], a[164:167]
    v_mfma_f32_16x16x32_bf16 a[168:171], v[116:119], v[72:75], a[168:171]
    v_mfma_f32_16x16x32_bf16 a[172:175], v[116:119], v[76:79], a[172:175]
    v_mfma_f32_16x16x32_bf16 a[176:179], v[116:119], v[80:83], a[176:179]
    v_mfma_f32_16x16x32_bf16 a[180:183], v[116:119], v[84:87], a[180:183]
    v_mfma_f32_16x16x32_bf16 a[184:187], v[116:119], v[88:91], a[184:187]
    v_mfma_f32_16x16x32_bf16 a[188:191], v[116:119], v[92:95], a[188:191]
    s_waitcnt lgkmcnt(0)
    s_barrier
    v_mfma_f32_16x16x32_bf16 a[0:3], v[160:163], v[128:131], a[0:3]
    v_mfma_f32_16x16x32_bf16 a[4:7], v[160:163], v[132:135], a[4:7]
    v_mfma_f32_16x16x32_bf16 a[8:11], v[160:163], v[136:139], a[8:11]
    v_mfma_f32_16x16x32_bf16 a[12:15], v[160:163], v[140:143], a[12:15]
    v_mfma_f32_16x16x32_bf16 a[16:19], v[160:163], v[144:147], a[16:19]
    v_mfma_f32_16x16x32_bf16 a[20:23], v[160:163], v[148:151], a[20:23]
    v_mfma_f32_16x16x32_bf16 a[24:27], v[160:163], v[152:155], a[24:27]
    v_mfma_f32_16x16x32_bf16 a[28:31], v[160:163], v[156:159], a[28:31]
    v_mfma_f32_16x16x32_bf16 a[32:35], v[164:167], v[128:131], a[32:35]
    v_mfma_f32_16x16x32_bf16 a[36:39], v[164:167], v[132:135], a[36:39]
    v_mfma_f32_16x16x32_bf16 a[40:43], v[164:167], v[136:139], a[40:43]
    v_mfma_f32_16x16x32_bf16 a[44:47], v[164:167], v[140:143], a[44:47]
    v_mfma_f32_16x16x32_bf16 a[48:51], v[164:167], v[144:147], a[48:51]
    v_mfma_f32_16x16x32_bf16 a[52:55], v[164:167], v[148:151], a[52:55]
    v_mfma_f32_16x16x32_bf16 a[56:59], v[164:167], v[152:155], a[56:59]
    v_mfma_f32_16x16x32_bf16 a[60:63], v[164:167], v[156:159], a[60:63]
    v_mfma_f32_16x16x32_bf16 a[64:67], v[168:171], v[128:131], a[64:67]
    v_mfma_f32_16x16x32_bf16 a[68:71], v[168:171], v[132:135], a[68:71]
    v_mfma_f32_16x16x32_bf16 a[72:75], v[168:171], v[136:139], a[72:75]
    v_mfma_f32_16x16x32_bf16 a[76:79], v[168:171], v[140:143], a[76:79]
    v_mfma_f32_16x16x32_bf16 a[80:83], v[168:171], v[144:147], a[80:83]
    v_mfma_f32_16x16x32_bf16 a[84:87], v[168:171], v[148:151], a[84:87]
    v_mfma_f32_16x16x32_bf16 a[88:91], v[168:171], v[152:155], a[88:91]
    v_mfma_f32_16x16x32_bf16 a[92:95], v[168:171], v[156:159], a[92:95]
    v_mfma_f32_16x16x32_bf16 a[96:99], v[172:175], v[128:131], a[96:99]
    v_mfma_f32_16x16x32_bf16 a[100:103], v[172:175], v[132:135], a[100:103]
    v_mfma_f32_16x16x32_bf16 a[104:107], v[172:175], v[136:139], a[104:107]
    v_mfma_f32_16x16x32_bf16 a[108:111], v[172:175], v[140:143], a[108:111]
    v_mfma_f32_16x16x32_bf16 a[112:115], v[172:175], v[144:147], a[112:115]
    v_mfma_f32_16x16x32_bf16 a[116:119], v[172:175], v[148:151], a[116:119]
    v_mfma_f32_16x16x32_bf16 a[120:123], v[172:175], v[152:155], a[120:123]
    v_mfma_f32_16x16x32_bf16 a[124:127], v[172:175], v[156:159], a[124:127]
    v_mfma_f32_16x16x32_bf16 a[128:131], v[176:179], v[128:131], a[128:131]
    v_mfma_f32_16x16x32_bf16 a[132:135], v[176:179], v[132:135], a[132:135]
    v_mfma_f32_16x16x32_bf16 a[136:139], v[176:179], v[136:139], a[136:139]
    v_mfma_f32_16x16x32_bf16 a[140:143], v[176:179], v[140:143], a[140:143]
    v_mfma_f32_16x16x32_bf16 a[144:147], v[176:179], v[144:147], a[144:147]
    v_mfma_f32_16x16x32_bf16 a[148:151], v[176:179], v[148:151], a[148:151]
    v_mfma_f32_16x16x32_bf16 a[152:155], v[176:179], v[152:155], a[152:155]
    v_mfma_f32_16x16x32_bf16 a[156:159], v[176:179], v[156:159], a[156:159]
    v_mfma_f32_16x16x32_bf16 a[160:163], v[180:183], v[128:131], a[160:163]
    v_mfma_f32_16x16x32_bf16 a[164:167], v[180:183], v[132:135], a[164:167]
    v_mfma_f32_16x16x32_bf16 a[168:171], v[180:183], v[136:139], a[168:171]
    v_mfma_f32_16x16x32_bf16 a[172:175], v[180:183], v[140:143], a[172:175]
    v_mfma_f32_16x16x32_bf16 a[176:179], v[180:183], v[144:147], a[176:179]
    v_mfma_f32_16x16x32_bf16 a[180:183], v[180:183], v[148:151], a[180:183]
    v_mfma_f32_16x16x32_bf16 a[184:187], v[180:183], v[152:155], a[184:187]
    v_mfma_f32_16x16x32_bf16 a[188:191], v[180:183], v[156:159], a[188:191]
    v_xor_b32 v8, 0x10000, v8
    v_xor_b32 v10, 0x10000, v10
    v_xor_b32 v11, 0x10000, v11
    v_xor_b32 v12, 0x10000, v12
    v_xor_b32 v13, 0x10000, v13
    v_xor_b32 v14, 0x10000, v14
    v_xor_b32 v15, 0x10000, v15
    s_mul_i32 s52, s62, 4718592
    s_lshl_b32 s54, s60, 1
    s_lshr_b32 s55, s3, 1
    s_add_u32 s54, s54, s55
    s_mul_i32 s54, s54, 294912
    s_add_u32 s52, s52, s54
    s_lshl_b32 s54, s61, 1
    s_and_b32 s55, s3, 1
    s_add_u32 s54, s54, s55
    s_mul_i32 s54, s54, 6144
    s_add_u32 s52, s52, s54
    s_add_u32 s52, s52, 71565312
    s_add_u32 s54, s52, 0
    buffer_store_dwordx4 a[0:3], v18, s[8:11], s54 offen sc1
    s_add_u32 s54, s52, 1024
    buffer_store_dwordx4 a[32:35], v18, s[8:11], s54 offen sc1
    s_add_u32 s54, s52, 2048
    buffer_store_dwordx4 a[64:67], v18, s[8:11], s54 offen sc1
    s_add_u32 s54, s52, 3072
    buffer_store_dwordx4 a[96:99], v18, s[8:11], s54 offen sc1
    s_add_u32 s54, s52, 4096
    buffer_store_dwordx4 a[128:131], v18, s[8:11], s54 offen sc1
    s_add_u32 s54, s52, 5120
    buffer_store_dwordx4 a[160:163], v18, s[8:11], s54 offen sc1
    s_add_u32 s54, s52, 36864
    buffer_store_dwordx4 a[4:7], v18, s[8:11], s54 offen sc1
    s_add_u32 s54, s52, 37888
    buffer_store_dwordx4 a[36:39], v18, s[8:11], s54 offen sc1
    s_add_u32 s54, s52, 38912
    buffer_store_dwordx4 a[68:71], v18, s[8:11], s54 offen sc1
    s_add_u32 s54, s52, 39936
    buffer_store_dwordx4 a[100:103], v18, s[8:11], s54 offen sc1
    s_add_u32 s54, s52, 40960
    buffer_store_dwordx4 a[132:135], v18, s[8:11], s54 offen sc1
    s_add_u32 s54, s52, 41984
    buffer_store_dwordx4 a[164:167], v18, s[8:11], s54 offen sc1
    s_add_u32 s54, s52, 73728
    buffer_store_dwordx4 a[8:11], v18, s[8:11], s54 offen sc1
    s_add_u32 s54, s52, 74752
    buffer_store_dwordx4 a[40:43], v18, s[8:11], s54 offen sc1
    s_add_u32 s54, s52, 75776
    buffer_store_dwordx4 a[72:75], v18, s[8:11], s54 offen sc1
    s_add_u32 s54, s52, 76800
    buffer_store_dwordx4 a[104:107], v18, s[8:11], s54 offen sc1
    s_add_u32 s54, s52, 77824
    buffer_store_dwordx4 a[136:139], v18, s[8:11], s54 offen sc1
    s_add_u32 s54, s52, 78848
    buffer_store_dwordx4 a[168:171], v18, s[8:11], s54 offen sc1
    s_add_u32 s54, s52, 110592
    buffer_store_dwordx4 a[12:15], v18, s[8:11], s54 offen sc1
    s_add_u32 s54, s52, 111616
    buffer_store_dwordx4 a[44:47], v18, s[8:11], s54 offen sc1
    s_add_u32 s54, s52, 112640
    buffer_store_dwordx4 a[76:79], v18, s[8:11], s54 offen sc1
    s_add_u32 s54, s52, 113664
    buffer_store_dwordx4 a[108:111], v18, s[8:11], s54 offen sc1
    s_add_u32 s54, s52, 114688
    buffer_store_dwordx4 a[140:143], v18, s[8:11], s54 offen sc1
    s_add_u32 s54, s52, 115712
    buffer_store_dwordx4 a[172:175], v18, s[8:11], s54 offen sc1
    s_add_u32 s54, s52, 147456
    buffer_store_dwordx4 a[16:19], v18, s[8:11], s54 offen sc1
    s_add_u32 s54, s52, 148480
    buffer_store_dwordx4 a[48:51], v18, s[8:11], s54 offen sc1
    s_add_u32 s54, s52, 149504
    buffer_store_dwordx4 a[80:83], v18, s[8:11], s54 offen sc1
    s_add_u32 s54, s52, 150528
    buffer_store_dwordx4 a[112:115], v18, s[8:11], s54 offen sc1
    s_add_u32 s54, s52, 151552
    buffer_store_dwordx4 a[144:147], v18, s[8:11], s54 offen sc1
    s_add_u32 s54, s52, 152576
    buffer_store_dwordx4 a[176:179], v18, s[8:11], s54 offen sc1
    s_add_u32 s54, s52, 184320
    buffer_store_dwordx4 a[20:23], v18, s[8:11], s54 offen sc1
    s_add_u32 s54, s52, 185344
    buffer_store_dwordx4 a[52:55], v18, s[8:11], s54 offen sc1
    s_add_u32 s54, s52, 186368
    buffer_store_dwordx4 a[84:87], v18, s[8:11], s54 offen sc1
    s_add_u32 s54, s52, 187392
    buffer_store_dwordx4 a[116:119], v18, s[8:11], s54 offen sc1
    s_add_u32 s54, s52, 188416
    buffer_store_dwordx4 a[148:151], v18, s[8:11], s54 offen sc1
    s_add_u32 s54, s52, 189440
    buffer_store_dwordx4 a[180:183], v18, s[8:11], s54 offen sc1
    s_add_u32 s54, s52, 221184
    buffer_store_dwordx4 a[24:27], v18, s[8:11], s54 offen sc1
    s_add_u32 s54, s52, 222208
    buffer_store_dwordx4 a[56:59], v18, s[8:11], s54 offen sc1
    s_add_u32 s54, s52, 223232
    buffer_store_dwordx4 a[88:91], v18, s[8:11], s54 offen sc1
    s_add_u32 s54, s52, 224256
    buffer_store_dwordx4 a[120:123], v18, s[8:11], s54 offen sc1
    s_add_u32 s54, s52, 225280
    buffer_store_dwordx4 a[152:155], v18, s[8:11], s54 offen sc1
    s_add_u32 s54, s52, 226304
    buffer_store_dwordx4 a[184:187], v18, s[8:11], s54 offen sc1
    s_add_u32 s54, s52, 258048
    buffer_store_dwordx4 a[28:31], v18, s[8:11], s54 offen sc1
    s_add_u32 s54, s52, 259072
    buffer_store_dwordx4 a[60:63], v18, s[8:11], s54 offen sc1
    s_add_u32 s54, s52, 260096
    buffer_store_dwordx4 a[92:95], v18, s[8:11], s54 offen sc1
    s_add_u32 s54, s52, 261120
    buffer_store_dwordx4 a[124:127], v18, s[8:11], s54 offen sc1
    s_add_u32 s54, s52, 262144
    buffer_store_dwordx4 a[156:159], v18, s[8:11], s54 offen sc1
    s_add_u32 s54, s52, 263168
    buffer_store_dwordx4 a[188:191], v18, s[8:11], s54 offen sc1
    s_branch W_DONE
W_tk:
    s_mov_b64 s[12:13], s[26:27]
    s_mov_b32 s14, 4718592
    s_mov_b32 s63, 8192
    v_and_b32 v1, 63, v0
    v_lshrrev_b32 v2, 4, v1
    v_lshlrev_b32 v18, 4, v1
    s_lshr_b32 s54, s3, 1
    s_lshl_b32 s54, s54, 13
    v_add_u32 v8, s54, v18
    v_bfe_u32 v3, v1, 2, 2
    v_and_b32 v4, 3, v1
    v_and_b32 v5, 1, v2
    v_lshl_add_u32 v5, v5, 2, v3
    v_lshlrev_b32 v6, 12, v2
    v_lshl_add_u32 v6, v3, 9, v6
    v_lshl_add_u32 v6, v4, 3, v6
    v_add_u32 v6, 16384, v6
    s_and_b32 s54, s3, 1
    s_mul_i32 s54, s54, 8
    s_add_u32 s55, s54, 0
    v_xor_b32 v7, s55, v5
    v_lshl_add_u32 v10, v7, 5, v6
    s_add_u32 s55, s54, 1
    v_xor_b32 v7, s55, v5
    v_lshl_add_u32 v11, v7, 5, v6
    s_add_u32 s55, s54, 2
    v_xor_b32 v7, s55, v5
    v_lshl_add_u32 v12, v7, 5, v6
    s_add_u32 s55, s54, 3
    v_xor_b32 v7, s55, v5
    v_lshl_add_u32 v13, v7, 5, v6
    s_add_u32 s55, s54, 4
    v_xor_b32 v7, s55, v5
    v_lshl_add_u32 v14, v7, 5, v6
    s_add_u32 s55, s54, 5
    v_xor_b32 v7, s55, v5
    v_lshl_add_u32 v15, v7, 5, v6
    s_add_u32 s55, s54, 6
    v_xor_b32 v7, s55, v5
    v_lshl_add_u32 v16, v7, 5, v6
    s_add_u32 s55, s54, 7
    v_xor_b32 v7, s55, v5
    v_lshl_add_u32 v17, v7, 5, v6
    s_and_b32 s54, s3, 1
    s_lshl_b32 s54, s54, 1
    s_lshr_b32 s55, s3, 1
    s_lshl_b32 s55, s55, 2
    s_or_b32 s54, s54, s55
    v_lshrrev_b32 v3, 5, v1
    v_or_b32 v4, s54, v3
    v_lshlrev_b32 v4, 1, v4
    v_and_b32 v5, 31, v1
    v_xor_b32 v4, v4, v5
    v_mul_lo_u32 v3, v3, s63
    v_lshl_add_u32 v19, v4, 4, v3
    s_mul_i32 s64, s60, 294912
    s_add_u32 s64, s64, 0
    s_lshl_b32 s65, s61, 9
    s_mul_i32 s54, s3, 73728
    s_add_u32 s54, s54, s64
    s_add_u32 s40, s54, 0
    s_add_u32 s41, s54, 18432
    s_add_u32 s42, s54, 36864
    s_add_u32 s43, s54, 55296
    s_and_b32 s54, s3, 1
    s_lshl_b32 s54, s54, 1
    s_lshr_b32 s55, s3, 1
    s_mul_i32 s55, s55, 8
    s_add_u32 s54, s54, s55
    s_add_u32 s55, s54, 0
    s_mul_i32 s55, s55, s63
    s_add_u32 s44, s55, s65
    s_add_u32 s55, s54, 4
    s_mul_i32 s55, s55, s63
    s_add_u32 s45, s55, s65
    s_add_u32 s55, s54, 16
    s_mul_i32 s55, s55, s63
    s_add_u32 s46, s55, s65
    s_add_u32 s55, s54, 20
    s_mul_i32 s55, s55, s63
    s_add_u32 s47, s55, s65
    s_lshl_b32 s50, s63, 5
    s_lshl_b32 s48, s3, 12
    s_and_b32 s54, s3, 1
    s_lshl_b32 s54, s54, 10
    s_lshr_b32 s55, s3, 1
    s_lshl_b32 s55, s55, 12
    s_add_u32 s49, s54, s55
    s_add_u32 s49, s49, 16384
    s_add_u32 m0, s48, 0
    s_nop 0
    buffer_load_dwordx4 v18, s[8:11], s40 offen  lds
    s_add_u32 s40, s40, 1024
    s_add_u32 m0, s48, 1024
    s_nop 0
    buffer_load_dwordx4 v18, s[8:11], s41 offen  lds
    s_add_u32 s41, s41, 1024
    s_add_u32 m0, s48, 2048
    s_nop 0
    buffer_load_dwordx4 v18, s[8:11], s42 offen  lds
    s_add_u32 s42, s42, 1024
    s_add_u32 m0, s48, 3072
    s_nop 0
    buffer_load_dwordx4 v18, s[8:11], s43 offen  lds
    s_add_u32 s43, s43, 1024
    s_add_u32 s48, s48, 32768
    s_and_b32 s48, s48, 0x1ffff
    s_add_u32 m0, s49, 0
    s_nop 0
    buffer_load_dwordx4 v19, s[12:15], s44 offen lds
    s_add_u32 s44, s44, s50
    s_add_u32 m0, s49, 2048
    s_nop 0
    buffer_load_dwordx4 v19, s[12:15], s45 offen lds
    s_add_u32 s45, s45, s50
    s_add_u32 m0, s49, 8192
    s_nop 0
    buffer_load_dwordx4 v19, s[12:15], s46 offen lds
    s_add_u32 s46, s46, s50
    s_add_u32 m0, s49, 10240
    s_nop 0
    buffer_load_dwordx4 v19, s[12:15], s47 offen lds
    s_add_u32 s47, s47, s50
    s_add_u32 s49, s49, 32768
    s_and_b32 s49, s49, 0x1ffff
    s_add_u32 m0, s48, 0
    s_nop 0
    buffer_load_dwordx4 v18, s[8:11], s40 offen  lds
    s_add_u32 s40, s40, 1024
    s_add_u32 m0, s48, 1024
    s_nop 0
    buffer_load_dwordx4 v18, s[8:11], s41 offen  lds
    s_add_u32 s41, s41, 1024
    s_add_u32 m0, s48, 2048
    s_nop 0
    buffer_load_dwordx4 v18, s[8:11], s42 offen  lds
    s_add_u32 s42, s42, 1024
    s_add_u32 m0, s48, 3072
    s_nop 0
    buffer_load_dwordx4 v18, s[8:11], s43 offen  lds
    s_add_u32 s43, s43, 1024
    s_add_u32 s48, s48, 32768
    s_and_b32 s48, s48, 0x1ffff
    s_add_u32 m0, s49, 0
    s_nop 0
    buffer_load_dwordx4 v19, s[12:15], s44 offen lds
    s_add_u32 s44, s44, s50
    s_add_u32 m0, s49, 2048
    s_nop 0
    buffer_load_dwordx4 v19, s[12:15], s45 offen lds
    s_add_u32 s45, s45, s50
    s_add_u32 m0, s49, 8192
    s_nop 0
    buffer_load_dwordx4 v19, s[12:15], s46 offen lds
    s_add_u32 s46, s46, s50
    s_add_u32 m0, s49, 10240
    s_nop 0
    buffer_load_dwordx4 v19, s[12:15], s47 offen lds
    s_add_u32 s47, s47, s50
    s_add_u32 s49, s49, 32768
    s_and_b32 s49, s49, 0x1ffff
    s_add_u32 m0, s48, 0
    s_nop 0
    buffer_load_dwordx4 v18, s[8:11], s40 offen  lds
    s_add_u32 s40, s40, 1024
    s_add_u32 m0, s48, 1024
    s_nop 0
    buffer_load_dwordx4 v18, s[8:11], s41 offen  lds
    s_add_u32 s41, s41, 1024
    s_add_u32 m0, s48, 2048
    s_nop 0
    buffer_load_dwordx4 v18, s[8:11], s42 offen  lds
    s_add_u32 s42, s42, 1024
    s_add_u32 m0, s48, 3072
    s_nop 0
    buffer_load_dwordx4 v18, s[8:11], s43 offen  lds
    s_add_u32 s43, s43, 1024
    s_add_u32 s48, s48, 32768
    s_and_b32 s48, s48, 0x1ffff
    s_add_u32 m0, s49, 0
    s_nop 0
    buffer_load_dwordx4 v19, s[12:15], s44 offen lds
    s_add_u32 s44, s44, s50
    s_add_u32 m0, s49, 2048
    s_nop 0
    buffer_load_dwordx4 v19, s[12:15], s45 offen lds
    s_add_u32 s45, s45, s50
    s_add_u32 m0, s49, 8192
    s_nop 0
    buffer_load_dwordx4 v19, s[12:15], s46 offen lds
    s_add_u32 s46, s46, s50
    s_add_u32 m0, s49, 10240
    s_nop 0
    buffer_load_dwordx4 v19, s[12:15], s47 offen lds
    s_add_u32 s47, s47, s50
    s_add_u32 s49, s49, 32768
    s_and_b32 s49, s49, 0x1ffff
    s_add_u32 m0, s48, 0
    s_nop 0
    buffer_load_dwordx4 v18, s[8:11], s40 offen  lds
    s_add_u32 s40, s40, 1024
    s_add_u32 m0, s48, 1024
    s_nop 0
    buffer_load_dwordx4 v18, s[8:11], s41 offen  lds
    s_add_u32 s41, s41, 1024
    s_add_u32 m0, s48, 2048
    s_nop 0
    buffer_load_dwordx4 v18, s[8:11], s42 offen  lds
    s_add_u32 s42, s42, 1024
    s_add_u32 m0, s48, 3072
    s_nop 0
    buffer_load_dwordx4 v18, s[8:11], s43 offen  lds
    s_add_u32 s43, s43, 1024
    s_add_u32 s48, s48, 32768
    s_and_b32 s48, s48, 0x1ffff
    s_add_u32 m0, s49, 0
    s_nop 0
    buffer_load_dwordx4 v19, s[12:15], s44 offen lds
    s_add_u32 s44, s44, s50
    s_add_u32 m0, s49, 2048
    s_nop 0
    buffer_load_dwordx4 v19, s[12:15], s45 offen lds
    s_add_u32 s45, s45, s50
    s_add_u32 m0, s49, 8192
    s_nop 0
    buffer_load_dwordx4 v19, s[12:15], s46 offen lds
    s_add_u32 s46, s46, s50
    s_add_u32 m0, s49, 10240
    s_nop 0
    buffer_load_dwordx4 v19, s[12:15], s47 offen lds
    s_add_u32 s47, s47, s50
    s_add_u32 s49, s49, 32768
    s_and_b32 s49, s49, 0x1ffff
    v_accvgpr_write_b32 a0, 0
    v_accvgpr_write_b32 a1, 0
    v_accvgpr_write_b32 a2, 0
    v_accvgpr_write_b32 a3, 0
    v_accvgpr_write_b32 a4, 0
    v_accvgpr_write_b32 a5, 0
    v_accvgpr_write_b32 a6, 0
    v_accvgpr_write_b32 a7, 0
    v_accvgpr_write_b32 a8, 0
    v_accvgpr_write_b32 a9, 0
    v_accvgpr_write_b32 a10, 0
    v_accvgpr_write_b32 a11, 0
    v_accvgpr_write_b32 a12, 0
    v_accvgpr_write_b32 a13, 0
    v_accvgpr_write_b32 a14, 0
    v_accvgpr_write_b32 a15, 0
    v_accvgpr_write_b32 a16, 0
    v_accvgpr_write_b32 a17, 0
    v_accvgpr_write_b32 a18, 0
    v_accvgpr_write_b32 a19, 0
    v_accvgpr_write_b32 a20, 0
    v_accvgpr_write_b32 a21, 0
    v_accvgpr_write_b32 a22, 0
    v_accvgpr_write_b32 a23, 0
    v_accvgpr_write_b32 a24, 0
    v_accvgpr_write_b32 a25, 0
    v_accvgpr_write_b32 a26, 0
    v_accvgpr_write_b32 a27, 0
    v_accvgpr_write_b32 a28, 0
    v_accvgpr_write_b32 a29, 0
    v_accvgpr_write_b32 a30, 0
    v_accvgpr_write_b32 a31, 0
    v_accvgpr_write_b32 a32, 0
    v_accvgpr_write_b32 a33, 0
    v_accvgpr_write_b32 a34, 0
    v_accvgpr_write_b32 a35, 0
    v_accvgpr_write_b32 a36, 0
    v_accvgpr_write_b32 a37, 0
    v_accvgpr_write_b32 a38, 0
    v_accvgpr_write_b32 a39, 0
    v_accvgpr_write_b32 a40, 0
    v_accvgpr_write_b32 a41, 0
    v_accvgpr_write_b32 a42, 0
    v_accvgpr_write_b32 a43, 0
    v_accvgpr_write_b32 a44, 0
    v_accvgpr_write_b32 a45, 0
    v_accvgpr_write_b32 a46, 0
    v_accvgpr_write_b32 a47, 0
    v_accvgpr_write_b32 a48, 0
    v_accvgpr_write_b32 a49, 0
    v_accvgpr_write_b32 a50, 0
    v_accvgpr_write_b32 a51, 0
    v_accvgpr_write_b32 a52, 0
    v_accvgpr_write_b32 a53, 0
    v_accvgpr_write_b32 a54, 0
    v_accvgpr_write_b32 a55, 0
    v_accvgpr_write_b32 a56, 0
    v_accvgpr_write_b32 a57, 0
    v_accvgpr_write_b32 a58, 0
    v_accvgpr_write_b32 a59, 0
    v_accvgpr_write_b32 a60, 0
    v_accvgpr_write_b32 a61, 0
    v_accvgpr_write_b32 a62, 0
    v_accvgpr_write_b32 a63, 0
    v_accvgpr_write_b32 a64, 0
    v_accvgpr_write_b32 a65, 0
    v_accvgpr_write_b32 a66, 0
    v_accvgpr_write_b32 a67, 0
    v_accvgpr_write_b32 a68, 0
    v_accvgpr_write_b32 a69, 0
    v_accvgpr_write_b32 a70, 0
    v_accvgpr_write_b32 a71, 0
    v_accvgpr_write_b32 a72, 0
    v_accvgpr_write_b32 a73, 0
    v_accvgpr_write_b32 a74, 0
    v_accvgpr_write_b32 a75, 0
    v_accvgpr_write_b32 a76, 0
    v_accvgpr_write_b32 a77, 0
    v_accvgpr_write_b32 a78, 0
    v_accvgpr_write_b32 a79, 0
    v_accvgpr_write_b32 a80, 0
    v_accvgpr_write_b32 a81, 0
    v_accvgpr_write_b32 a82, 0
    v_accvgpr_write_b32 a83, 0
    v_accvgpr_write_b32 a84, 0
    v_accvgpr_write_b32 a85, 0
    v_accvgpr_write_b32 a86, 0
    v_accvgpr_write_b32 a87, 0
    v_accvgpr_write_b32 a88, 0
    v_accvgpr_write_b32 a89, 0
    v_accvgpr_write_b32 a90, 0
    v_accvgpr_write_b32 a91, 0
    v_accvgpr_write_b32 a92, 0
    v_accvgpr_write_b32 a93, 0
    v_accvgpr_write_b32 a94, 0
    v_accvgpr_write_b32 a95, 0
    v_accvgpr_write_b32 a96, 0
    v_accvgpr_write_b32 a97, 0
    v_accvgpr_write_b32 a98, 0
    v_accvgpr_write_b32 a99, 0
    v_accvgpr_write_b32 a100, 0
    v_accvgpr_write_b32 a101, 0
    v_accvgpr_write_b32 a102, 0
    v_accvgpr_write_b32 a103, 0
    v_accvgpr_write_b32 a104, 0
    v_accvgpr_write_b32 a105, 0
    v_accvgpr_write_b32 a106, 0
    v_accvgpr_write_b32 a107, 0
    v_accvgpr_write_b32 a108, 0
    v_accvgpr_write_b32 a109, 0
    v_accvgpr_write_b32 a110, 0
    v_accvgpr_write_b32 a111, 0
    v_accvgpr_write_b32 a112, 0
    v_accvgpr_write_b32 a113, 0
    v_accvgpr_write_b32 a114, 0
    v_accvgpr_write_b32 a115, 0
    v_accvgpr_write_b32 a116, 0
    v_accvgpr_write_b32 a117, 0
    v_accvgpr_write_b32 a118, 0
    v_accvgpr_write_b32 a119, 0
    v_accvgpr_write_b32 a120, 0
    v_accvgpr_write_b32 a121, 0
    v_accvgpr_write_b32 a122, 0
    v_accvgpr_write_b32 a123, 0
    v_accvgpr_write_b32 a124, 0
    v_accvgpr_write_b32 a125, 0
    v_accvgpr_write_b32 a126, 0
    v_accvgpr_write_b32 a127, 0
    v_accvgpr_write_b32 a128, 0
    v_accvgpr_write_b32 a129, 0
    v_accvgpr_write_b32 a130, 0
    v_accvgpr_write_b32 a131, 0
    v_accvgpr_write_b32 a132, 0
    v_accvgpr_write_b32 a133, 0
    v_accvgpr_write_b32 a134, 0
    v_accvgpr_write_b32 a135, 0
    v_accvgpr_write_b32 a136, 0
    v_accvgpr_write_b32 a137, 0
    v_accvgpr_write_b32 a138, 0
    v_accvgpr_write_b32 a139, 0
    v_accvgpr_write_b32 a140, 0
    v_accvgpr_write_b32 a141, 0
    v_accvgpr_write_b32 a142, 0
    v_accvgpr_write_b32 a143, 0
    v_accvgpr_write_b32 a144, 0
    v_accvgpr_write_b32 a145, 0
    v_accvgpr_write_b32 a146, 0
    v_accvgpr_write_b32 a147, 0
    v_accvgpr_write_b32 a148, 0
    v_accvgpr_write_b32 a149, 0
    v_accvgpr_write_b32 a150, 0
    v_accvgpr_write_b32 a151, 0
    v_accvgpr_write_b32 a152, 0
    v_accvgpr_write_b32 a153, 0
    v_accvgpr_write_b32 a154, 0
    v_accvgpr_write_b32 a155, 0
    v_accvgpr_write_b32 a156, 0
    v_accvgpr_write_b32 a157, 0
    v_accvgpr_write_b32 a158, 0
    v_accvgpr_write_b32 a159, 0
    v_accvgpr_write_b32 a160, 0
    v_accvgpr_write_b32 a161, 0
    v_accvgpr_write_b32 a162, 0
    v_accvgpr_write_b32 a163, 0
    v_accvgpr_write_b32 a164, 0
    v_accvgpr_write_b32 a165, 0
    v_accvgpr_write_b32 a166, 0
    v_accvgpr_write_b32 a167, 0
    v_accvgpr_write_b32 a168, 0
    v_accvgpr_write_b32 a169, 0
    v_accvgpr_write_b32 a170, 0
    v_accvgpr_write_b32 a171, 0
    v_accvgpr_write_b32 a172, 0
    v_accvgpr_write_b32 a173, 0
    v_accvgpr_write_b32 a174, 0
    v_accvgpr_write_b32 a175, 0
    v_accvgpr_write_b32 a176, 0
    v_accvgpr_write_b32 a177, 0
    v_accvgpr_write_b32 a178, 0
    v_accvgpr_write_b32 a179, 0
    v_accvgpr_write_b32 a180, 0
    v_accvgpr_write_b32 a181, 0
    v_accvgpr_write_b32 a182, 0
    v_accvgpr_write_b32 a183, 0
    v_accvgpr_write_b32 a184, 0
    v_accvgpr_write_b32 a185, 0
    v_accvgpr_write_b32 a186, 0
    v_accvgpr_write_b32 a187, 0
    v_accvgpr_write_b32 a188, 0
    v_accvgpr_write_b32 a189, 0
    v_accvgpr_write_b32 a190, 0
    v_accvgpr_write_b32 a191, 0
    v_accvgpr_write_b32 a192, 0
    v_accvgpr_write_b32 a193, 0
    v_accvgpr_write_b32 a194, 0
    v_accvgpr_write_b32 a195, 0
    v_accvgpr_write_b32 a196, 0
    v_accvgpr_write_b32 a197, 0
    v_accvgpr_write_b32 a198, 0
    v_accvgpr_write_b32 a199, 0
    v_accvgpr_write_b32 a200, 0
    v_accvgpr_write_b32 a201, 0
    v_accvgpr_write_b32 a202, 0
    v_accvgpr_write_b32 a203, 0
    v_accvgpr_write_b32 a204, 0
    v_accvgpr_write_b32 a205, 0
    v_accvgpr_write_b32 a206, 0
    v_accvgpr_write_b32 a207, 0
    v_accvgpr_write_b32 a208, 0
    v_accvgpr_write_b32 a209, 0
    v_accvgpr_write_b32 a210, 0
    v_accvgpr_write_b32 a211, 0
    v_accvgpr_write_b32 a212, 0
    v_accvgpr_write_b32 a213, 0
    v_accvgpr_write_b32 a214, 0
    v_accvgpr_write_b32 a215, 0
    v_accvgpr_write_b32 a216, 0
    v_accvgpr_write_b32 a217, 0
    v_accvgpr_write_b32 a218, 0
    v_accvgpr_write_b32 a219, 0
    v_accvgpr_write_b32 a220, 0
    v_accvgpr_write_b32 a221, 0
    v_accvgpr_write_b32 a222, 0
    v_accvgpr_write_b32 a223, 0
    v_accvgpr_write_b32 a224, 0
    v_accvgpr_write_b32 a225, 0
    v_accvgpr_write_b32 a226, 0
    v_accvgpr_write_b32 a227, 0
    v_accvgpr_write_b32 a228, 0
    v_accvgpr_write_b32 a229, 0
    v_accvgpr_write_b32 a230, 0
    v_accvgpr_write_b32 a231, 0
    v_accvgpr_write_b32 a232, 0
    v_accvgpr_write_b32 a233, 0
    v_accvgpr_write_b32 a234, 0
    v_accvgpr_write_b32 a235, 0
    v_accvgpr_write_b32 a236, 0
    v_accvgpr_write_b32 a237, 0
    v_accvgpr_write_b32 a238, 0
    v_accvgpr_write_b32 a239, 0
    v_accvgpr_write_b32 a240, 0
    v_accvgpr_write_b32 a241, 0
    v_accvgpr_write_b32 a242, 0
    v_accvgpr_write_b32 a243, 0
    v_accvgpr_write_b32 a244, 0
    v_accvgpr_write_b32 a245, 0
    v_accvgpr_write_b32 a246, 0
    v_accvgpr_write_b32 a247, 0
    v_accvgpr_write_b32 a248, 0
    v_accvgpr_write_b32 a249, 0
    v_accvgpr_write_b32 a250, 0
    v_accvgpr_write_b32 a251, 0
    v_accvgpr_write_b32 a252, 0
    v_accvgpr_write_b32 a253, 0
    v_accvgpr_write_b32 a254, 0
    v_accvgpr_write_b32 a255, 0
    s_waitcnt vmcnt(24)
    s_barrier
    ds_read_b64_tr_b16 v[96:97], v10 offset:0
    ds_read_b64_tr_b16 v[98:99], v10 offset:2048
    ds_read_b128 v[64:67], v8 offset:0
    ds_read_b64_tr_b16 v[100:101], v11 offset:0
    ds_read_b64_tr_b16 v[102:103], v11 offset:2048
    ds_read_b128 v[68:71], v8 offset:1024
    ds_read_b64_tr_b16 v[104:105], v12 offset:0
    ds_read_b64_tr_b16 v[106:107], v12 offset:2048
    ds_read_b128 v[72:75], v8 offset:2048
    ds_read_b64_tr_b16 v[108:109], v13 offset:0
    ds_read_b64_tr_b16 v[110:111], v13 offset:2048
    ds_read_b128 v[76:79], v8 offset:3072
    ds_read_b64_tr_b16 v[112:113], v14 offset:0
    ds_read_b64_tr_b16 v[114:115], v14 offset:2048
    ds_read_b128 v[80:83], v8 offset:4096
    ds_read_b64_tr_b16 v[116:117], v15 offset:0
    ds_read_b64_tr_b16 v[118:119], v15 offset:2048
    ds_read_b128 v[84:87], v8 offset:5120
    ds_read_b64_tr_b16 v[120:121], v16 offset:0
    ds_read_b64_tr_b16 v[122:123], v16 offset:2048
    ds_read_b128 v[88:91], v8 offset:6144
    ds_read_b64_tr_b16 v[124:125], v17 offset:0
    ds_read_b64_tr_b16 v[126:127], v17 offset:2048
    ds_read_b128 v[92:95], v8 offset:7168
    s_mov_b32 s51, 7
Gk_loop:
    s_waitcnt vmcnt(16) lgkmcnt(0)
    s_barrier
    v_mfma_f32_16x16x32_bf16 a[0:3], v[96:99], v[64:67], a[0:3]
    ds_read_b64_tr_b16 v[160:161], v10 offset:32768
    v_mfma_f32_16x16x32_bf16 a[4:7], v[96:99], v[68:71], a[4:7]
    ds_read_b64_tr_b16 v[162:163], v10 offset:34816
    v_mfma_f32_16x16x32_bf16 a[8:11], v[96:99], v[72:75], a[8:11]
    ds_read_b128 v[128:131], v8 offset:32768
    s_add_u32 m0, s48, 0
    s_nop 0
    buffer_load_dwordx4 v18, s[8:11], s40 offen  lds
    s_add_u32 s40, s40, 1024
    v_mfma_f32_16x16x32_bf16 a[12:15], v[96:99], v[76:79], a[12:15]
    ds_read_b64_tr_b16 v[164:165], v11 offset:32768
    v_mfma_f32_16x16x32_bf16 a[16:19], v[96:99], v[80:83], a[16:19]
    ds_read_b64_tr_b16 v[166:167], v11 offset:34816
    v_mfma_f32_16x16x32_bf16 a[20:23], v[96:99], v[84:87], a[20:23]
    ds_read_b128 v[132:135], v8 offset:33792
    v_mfma_f32_16x16x32_bf16 a[24:27], v[96:99], v[88:91], a[24:27]
    ds_read_b64_tr_b16 v[168:169], v12 offset:32768
    v_mfma_f32_16x16x32_bf16 a[28:31], v[96:99], v[92:95], a[28:31]
    ds_read_b64_tr_b16 v[170:171], v12 offset:34816
    v_mfma_f32_16x16x32_bf16 a[32:35], v[100:103], v[64:67], a[32:35]
    ds_read_b128 v[136:139], v8 offset:34816
    v_mfma_f32_16x16x32_bf16 a[36:39], v[100:103], v[68:71], a[36:39]
    ds_read_b64_tr_b16 v[172:173], v13 offset:32768
    s_add_u32 m0, s48, 1024
    s_nop 0
    buffer_load_dwordx4 v18, s[8:11], s41 offen  lds
    s_add_u32 s41, s41, 1024
    v_mfma_f32_16x16x32_bf16 a[40:43], v[100:103], v[72:75], a[40:43]
    ds_read_b64_tr_b16 v[174:175], v13 offset:34816
    v_mfma_f32_16x16x32_bf16 a[44:47], v[100:103], v[76:79], a[44:47]
    ds_read_b128 v[140:143], v8 offset:35840
    v_mfma_f32_16x16x32_bf16 a[48:51], v[100:103], v[80:83], a[48:51]
    ds_read_b64_tr_b16 v[176:177], v14 offset:32768
    v_mfma_f32_16x16x32_bf16 a[52:55], v[100:103], v[84:87], a[52:55]
    ds_read_b64_tr_b16 v[178:179], v14 offset:34816
    v_mfma_f32_16x16x32_bf16 a[56:59], v[100:103], v[88:91], a[56:59]
    ds_read_b128 v[144:147], v8 offset:36864
    v_mfma_f32_16x16x32_bf16 a[60:63], v[100:103], v[92:95], a[60:63]
    ds_read_b64_tr_b16 v[180:181], v15 offset:32768
    v_mfma_f32_16x16x32_bf16 a[64:67], v[104:107], v[64:67], a[64:67]
    ds_read_b64_tr_b16 v[182:183], v15 offset:34816
    s_add_u32 m0, s48, 2048
    s_nop 0
    buffer_load_dwordx4 v18, s[8:11], s42 offen  lds
    s_add_u32 s42, s42, 1024
    v_mfma_f32_16x16x32_bf16 a[68:71], v[104:107], v[68:71], a[68:71]
    ds_read_b128 v[148:151], v8 offset:37888
    v_mfma_f32_16x16x32_bf16 a[72:75], v[104:107], v[72:75], a[72:75]
    ds_read_b64_tr_b16 v[184:185], v16 offset:32768
    v_mfma_f32_16x16x32_bf16 a[76:79], v[104:107], v[76:79], a[76:79]
    ds_read_b64_tr_b16 v[186:187], v16 offset:34816
    v_mfma_f32_16x16x32_bf16 a[80:83], v[104:107], v[80:83], a[80:83]
    ds_read_b128 v[152:155], v8 offset:38912
    v_mfma_f32_16x16x32_bf16 a[84:87], v[104:107], v[84:87], a[84:87]
    ds_read_b64_tr_b16 v[188:189], v17 offset:32768
    v_mfma_f32_16x16x32_bf16 a[88:91], v[104:107], v[88:91], a[88:91]
    ds_read_b64_tr_b16 v[190:191], v17 offset:34816
    v_mfma_f32_16x16x32_bf16 a[92:95], v[104:107], v[92:95], a[92:95]
    ds_read_b128 v[156:159], v8 offset:39936
    s_add_u32 m0, s48, 3072
    s_nop 0
    buffer_load_dwordx4 v18, s[8:11], s43 offen  lds
    s_add_u32 s43, s43, 1024
    s_add_u32 s48, s48, 32768
    s_and_b32 s48, s48, 0x1ffff
    v_mfma_f32_16x16x32_bf16 a[96:99], v[108:111], v[64:67], a[96:99]
    v_mfma_f32_16x16x32_bf16 a[100:103], v[108:111], v[68:71], a[100:103]
    v_mfma_f32_16x16x32_bf16 a[104:107], v[108:111], v[72:75], a[104:107]
    v_mfma_f32_16x16x32_bf16 a[108:111], v[108:111], v[76:79], a[108:111]
    v_mfma_f32_16x16x32_bf16 a[112:115], v[108:111], v[80:83], a[112:115]
    v_mfma_f32_16x16x32_bf16 a[116:119], v[108:111], v[84:87], a[116:119]
    v_mfma_f32_16x16x32_bf16 a[120:123], v[108:111], v[88:91], a[120:123]
    s_add_u32 m0, s49, 0
    s_nop 0
    buffer_load_dwordx4 v19, s[12:15], s44 offen lds
    s_add_u32 s44, s44, s50
    v_mfma_f32_16x16x32_bf16 a[124:127], v[108:111], v[92:95], a[124:127]
    v_mfma_f32_16x16x32_bf16 a[128:131], v[112:115], v[64:67], a[128:131]
    v_mfma_f32_16x16x32_bf16 a[132:135], v[112:115], v[68:71], a[132:135]
    v_mfma_f32_16x16x32_bf16 a[136:139], v[112:115], v[72:75], a[136:139]
    v_mfma_f32_16x16x32_bf16 a[140:143], v[112:115], v[76:79], a[140:143]
    v_mfma_f32_16x16x32_bf16 a[144:147], v[112:115], v[80:83], a[144:147]
    v_mfma_f32_16x16x32_bf16 a[148:151], v[112:115], v[84:87], a[148:151]
    s_add_u32 m0, s49, 2048
    s_nop 0
    buffer_load_dwordx4 v19, s[12:15], s45 offen lds
    s_add_u32 s45, s45, s50
    v_mfma_f32_16x16x32_bf16 a[152:155], v[112:115], v[88:91], a[152:155]
    v_mfma_f32_16x16x32_bf16 a[156:159], v[112:115], v[92:95], a[156:159]
    v_mfma_f32_16x16x32_bf16 a[160:163], v[116:119], v[64:67], a[160:163]
    v_mfma_f32_16x16x32_bf16 a[164:167], v[116:119], v[68:71], a[164:167]
    v_mfma_f32_16x16x32_bf16 a[168:171], v[116:119], v[72:75], a[168:171]
    v_mfma_f32_16x16x32_bf16 a[172:175], v[116:119], v[76:79], a[172:175]
    v_mfma_f32_16x16x32_bf16 a[176:179], v[116:119], v[80:83], a[176:179]
    s_add_u32 m0, s49, 8192
    s_nop 0
    buffer_load_dwordx4 v19, s[12:15], s46 offen lds
    s_add_u32 s46, s46, s50
    v_mfma_f32_16x16x32_bf16 a[180:183], v[116:119], v[84:87], a[180:183]
    v_mfma_f32_16x16x32_bf16 a[184:187], v[116:119], v[88:91], a[184:187]
    v_mfma_f32_16x16x32_bf16 a[188:191], v[116:119], v[92:95], a[188:191]
    v_mfma_f32_16x16x32_bf16 a[192:195], v[120:123], v[64:67], a[192:195]
    v_mfma_f32_16x16x32_bf16 a[196:199], v[120:123], v[68:71], a[196:199]
    v_mfma_f32_16x16x32_bf16 a[200:203], v[120:123], v[72:75], a[200:203]
    v_mfma_f32_16x16x32_bf16 a[204:207], v[120:123], v[76:79], a[204:207]
    s_add_u32 m0, s49, 10240
    s_nop 0
    buffer_load_dwordx4 v19, s[12:15], s47 offen lds
    s_add_u32 s47, s47, s50
    s_add_u32 s49, s49, 32768
    s_and_b32 s49, s49, 0x1ffff
    v_mfma_f32_16x16x32_bf16 a[208:211], v[120:123], v[80:83], a[208:211]
    v_mfma_f32_16x16x32_bf16 a[212:215], v[120:123], v[84:87], a[212:215]
    v_mfma_f32_16x16x32_bf16 a[216:219], v[120:123], v[88:91], a[216:219]
    v_mfma_f32_16x16x32_bf16 a[220:223], v[120:123], v[92:95], a[220:223]
    v_mfma_f32_16x16x32_bf16 a[224:227], v[124:127], v[64:67], a[224:227]
    v_mfma_f32_16x16x32_bf16 a[228:231], v[124:127], v[68:71], a[228:231]
    v_mfma_f32_16x16x32_bf16 a[232:235], v[124:127], v[72:75], a[232:235]
    v_mfma_f32_16x16x32_bf16 a[236:239], v[124:127], v[76:79], a[236:239]
    v_mfma_f32_16x16x32_bf16 a[240:243], v[124:127], v[80:83], a[240:243]
    v_mfma_f32_16x16x32_bf16 a[244:247], v[124:127], v[84:87], a[244:247]
    v_mfma_f32_16x16x32_bf16 a[248:251], v[124:127], v[88:91], a[248:251]
    v_mfma_f32_16x16x32_bf16 a[252:255], v[124:127], v[92:95], a[252:255]
    v_xor_b32 v8, 0x10000, v8
    v_xor_b32 v10, 0x10000, v10
    v_xor_b32 v11, 0x10000, v11
    v_xor_b32 v12, 0x10000, v12
    v_xor_b32 v13, 0x10000, v13
    v_xor_b32 v14, 0x10000, v14
    v_xor_b32 v15, 0x10000, v15
    v_xor_b32 v16, 0x10000, v16
    v_xor_b32 v17, 0x10000, v17
    s_waitcnt vmcnt(16) lgkmcnt(0)
    s_barrier
    v_mfma_f32_16x16x32_bf16 a[0:3], v[160:163], v[128:131], a[0:3]
    ds_read_b64_tr_b16 v[96:97], v10 offset:0
    v_mfma_f32_16x16x32_bf16 a[4:7], v[160:163], v[132:135], a[4:7]
    ds_read_b64_tr_b16 v[98:99], v10 offset:2048
    v_mfma_f32_16x16x32_bf16 a[8:11], v[160:163], v[136:139], a[8:11]
    ds_read_b128 v[64:67], v8 offset:0
    s_add_u32 m0, s48, 0
    s_nop 0
    buffer_load_dwordx4 v18, s[8:11], s40 offen  lds
    s_add_u32 s40, s40, 1024
    v_mfma_f32_16x16x32_bf16 a[12:15], v[160:163], v[140:143], a[12:15]
    ds_read_b64_tr_b16 v[100:101], v11 offset:0
    v_mfma_f32_16x16x32_bf16 a[16:19], v[160:163], v[144:147], a[16:19]
    ds_read_b64_tr_b16 v[102:103], v11 offset:2048
    v_mfma_f32_16x16x32_bf16 a[20:23], v[160:163], v[148:151], a[20:23]
    ds_read_b128 v[68:71], v8 offset:1024
    v_mfma_f32_16x16x32_bf16 a[24:27], v[160:163], v[152:155], a[24:27]
    ds_read_b64_tr_b16 v[104:105], v12 offset:0
    v_mfma_f32_16x16x32_bf16 a[28:31], v[160:163], v[156:159], a[28:31]
    ds_read_b64_tr_b16 v[106:107], v12 offset:2048
    v_mfma_f32_16x16x32_bf16 a[32:35], v[164:167], v[128:131], a[32:35]
    ds_read_b128 v[72:75], v8 offset:2048
    v_mfma_f32_16x16x32_bf16 a[36:39], v[164:167], v[132:135], a[36:39]
    ds_read_b64_tr_b16 v[108:109], v13 offset:0
    s_add_u32 m0, s48, 1024
    s_nop 0
    buffer_load_dwordx4 v18, s[8:11], s41 offen  lds
    s_add_u32 s41, s41, 1024
    v_mfma_f32_16x16x32_bf16 a[40:43], v[164:167], v[136:139], a[40:43]
    ds_read_b64_tr_b16 v[110:111], v13 offset:2048
    v_mfma_f32_16x16x32_bf16 a[44:47], v[164:167], v[140:143], a[44:47]
    ds_read_b128 v[76:79], v8 offset:3072
    v_mfma_f32_16x16x32_bf16 a[48:51], v[164:167], v[144:147], a[48:51]
    ds_read_b64_tr_b16 v[112:113], v14 offset:0
    v_mfma_f32_16x16x32_bf16 a[52:55], v[164:167], v[148:151], a[52:55]
    ds_read_b64_tr_b16 v[114:115], v14 offset:2048
    v_mfma_f32_16x16x32_bf16 a[56:59], v[164:167], v[152:155], a[56:59]
    ds_read_b128 v[80:83], v8 offset:4096
    v_mfma_f32_16x16x32_bf16 a[60:63], v[164:167], v[156:159], a[60:63]
    ds_read_b64_tr_b16 v[116:117], v15 offset:0
    v_mfma_f32_16x16x32_bf16 a[64:67], v[168:171], v[128:131], a[64:67]
    ds_read_b64_tr_b16 v[118:119], v15 offset:2048
    s_add_u32 m0, s48, 2048
    s_nop 0
    buffer_load_dwordx4 v18, s[8:11], s42 offen  lds
    s_add_u32 s42, s42, 1024
    v_mfma_f32_16x16x32_bf16 a[68:71], v[168:171], v[132:135], a[68:71]
    ds_read_b128 v[84:87], v8 offset:5120
    v_mfma_f32_16x16x32_bf16 a[72:75], v[168:171], v[136:139], a[72:75]
    ds_read_b64_tr_b16 v[120:121], v16 offset:0
    v_mfma_f32_16x16x32_bf16 a[76:79], v[168:171], v[140:143], a[76:79]
    ds_read_b64_tr_b16 v[122:123], v16 offset:2048
    v_mfma_f32_16x16x32_bf16 a[80:83], v[168:171], v[144:147], a[80:83]
    ds_read_b128 v[88:91], v8 offset:6144
    v_mfma_f32_16x16x32_bf16 a[84:87], v[168:171], v[148:151], a[84:87]
    ds_read_b64_tr_b16 v[124:125], v17 offset:0
    v_mfma_f32_16x16x32_bf16 a[88:91], v[168:171], v[152:155], a[88:91]
    ds_read_b64_tr_b16 v[126:127], v17 offset:2048
    v_mfma_f32_16x16x32_bf16 a[92:95], v[168:171], v[156:159], a[92:95]
    ds_read_b128 v[92:95], v8 offset:7168
    s_add_u32 m0, s48, 3072
    s_nop 0
    buffer_load_dwordx4 v18, s[8:11], s43 offen  lds
    s_add_u32 s43, s43, 1024
    s_add_u32 s48, s48, 32768
    s_and_b32 s48, s48, 0x1ffff
    v_mfma_f32_16x16x32_bf16 a[96:99], v[172:175], v[128:131], a[96:99]
    v_mfma_f32_16x16x32_bf16 a[100:103], v[172:175], v[132:135], a[100:103]
    v_mfma_f32_16x16x32_bf16 a[104:107], v[172:175], v[136:139], a[104:107]
    v_mfma_f32_16x16x32_bf16 a[108:111], v[172:175], v[140:143], a[108:111]
    v_mfma_f32_16x16x32_bf16 a[112:115], v[172:175], v[144:147], a[112:115]
    v_mfma_f32_16x16x32_bf16 a[116:119], v[172:175], v[148:151], a[116:119]
    v_mfma_f32_16x16x32_bf16 a[120:123], v[172:175], v[152:155], a[120:123]
    s_add_u32 m0, s49, 0
    s_nop 0
    buffer_load_dwordx4 v19, s[12:15], s44 offen lds
    s_add_u32 s44, s44, s50
    v_mfma_f32_16x16x32_bf16 a[124:127], v[172:175], v[156:159], a[124:127]
    v_mfma_f32_16x16x32_bf16 a[128:131], v[176:179], v[128:131], a[128:131]
    v_mfma_f32_16x16x32_bf16 a[132:135], v[176:179], v[132:135], a[132:135]
    v_mfma_f32_16x16x32_bf16 a[136:139], v[176:179], v[136:139], a[136:139]
    v_mfma_f32_16x16x32_bf16 a[140:143], v[176:179], v[140:143], a[140:143]
    v_mfma_f32_16x16x32_bf16 a[144:147], v[176:179], v[144:147], a[144:147]
    v_mfma_f32_16x16x32_bf16 a[148:151], v[176:179], v[148:151], a[148:151]
    s_add_u32 m0, s49, 2048
    s_nop 0
    buffer_load_dwordx4 v19, s[12:15], s45 offen lds
    s_add_u32 s45, s45, s50
    v_mfma_f32_16x16x32_bf16 a[152:155], v[176:179], v[152:155], a[152:155]
    v_mfma_f32_16x16x32_bf16 a[156:159], v[176:179], v[156:159], a[156:159]
    v_mfma_f32_16x16x32_bf16 a[160:163], v[180:183], v[128:131], a[160:163]
    v_mfma_f32_16x16x32_bf16 a[164:167], v[180:183], v[132:135], a[164:167]
    v_mfma_f32_16x16x32_bf16 a[168:171], v[180:183], v[136:139], a[168:171]
    v_mfma_f32_16x16x32_bf16 a[172:175], v[180:183], v[140:143], a[172:175]
    v_mfma_f32_16x16x32_bf16 a[176:179], v[180:183], v[144:147], a[176:179]
    s_add_u32 m0, s49, 8192
    s_nop 0
    buffer_load_dwordx4 v19, s[12:15], s46 offen lds
    s_add_u32 s46, s46, s50
    v_mfma_f32_16x16x32_bf16 a[180:183], v[180:183], v[148:151], a[180:183]
    v_mfma_f32_16x16x32_bf16 a[184:187], v[180:183], v[152:155], a[184:187]
    v_mfma_f32_16x16x32_bf16 a[188:191], v[180:183], v[156:159], a[188:191]
    v_mfma_f32_16x16x32_bf16 a[192:195], v[184:187], v[128:131], a[192:195]
    v_mfma_f32_16x16x32_bf16 a[196:199], v[184:187], v[132:135], a[196:199]
    v_mfma_f32_16x16x32_bf16 a[200:203], v[184:187], v[136:139], a[200:203]
    v_mfma_f32_16x16x32_bf16 a[204:207], v[184:187], v[140:143], a[204:207]
    s_add_u32 m0, s49, 10240
    s_nop 0
    buffer_load_dwordx4 v19, s[12:15], s47 offen lds
    s_add_u32 s47, s47, s50
    s_add_u32 s49, s49, 32768
    s_and_b32 s49, s49, 0x1ffff
    v_mfma_f32_16x16x32_bf16 a[208:211], v[184:187], v[144:147], a[208:211]
    v_mfma_f32_16x16x32_bf16 a[212:215], v[184:187], v[148:151], a[212:215]
    v_mfma_f32_16x16x32_bf16 a[216:219], v[184:187], v[152:155], a[216:219]
    v_mfma_f32_16x16x32_bf16 a[220:223], v[184:187], v[156:159], a[220:223]
    v_mfma_f32_16x16x32_bf16 a[224:227], v[188:191], v[128:131], a[224:227]
    v_mfma_f32_16x16x32_bf16 a[228:231], v[188:191], v[132:135], a[228:231]
    v_mfma_f32_16x16x32_bf16 a[232:235], v[188:191], v[136:139], a[232:235]
    v_mfma_f32_16x16x32_bf16 a[236:239], v[188:191], v[140:143], a[236:239]
    v_mfma_f32_16x16x32_bf16 a[240:243], v[188:191], v[144:147], a[240:243]
    v_mfma_f32_16x16x32_bf16 a[244:247], v[188:191], v[148:151], a[244:247]
    v_mfma_f32_16x16x32_bf16 a[248:251], v[188:191], v[152:155], a[248:251]
    v_mfma_f32_16x16x32_bf16 a[252:255], v[188:191], v[156:159], a[252:255]
    s_sub_u32 s51, s51, 1
    s_cmp_lg_u32 s51, 0
    s_cbranch_scc1 Gk_loop
    s_waitcnt vmcnt(16) lgkmcnt(0)
    s_barrier
    v_mfma_f32_16x16x32_bf16 a[0:3], v[96:99], v[64:67], a[0:3]
    ds_read_b64_tr_b16 v[160:161], v10 offset:32768
    v_mfma_f32_16x16x32_bf16 a[4:7], v[96:99], v[68:71], a[4:7]
    ds_read_b64_tr_b16 v[162:163], v10 offset:34816
    v_mfma_f32_16x16x32_bf16 a[8:11], v[96:99], v[72:75], a[8:11]
    ds_read_b128 v[128:131], v8 offset:32768
    v_mfma_f32_16x16x32_bf16 a[12:15], v[96:99], v[76:79], a[12:15]
    ds_read_b64_tr_b16 v[164:165], v11 offset:32768
    v_mfma_f32_16x16x32_bf16 a[16:19], v[96:99], v[80:83], a[16:19]
    ds_read_b64_tr_b16 v[166:167], v11 offset:34816
    v_mfma_f32_16x16x32_bf16 a[20:23], v[96:99], v[84:87], a[20:23]
    ds_read_b128 v[132:135], v8 offset:33792
    v_mfma_f32_16x16x32_bf16 a[24:27], v[96:99], v[88:91], a[24:27]
    ds_read_b64_tr_b16 v[168:169], v12 offset:32768
    v_mfma_f32_16x16x32_bf16 a[28:31], v[96:99], v[92:95], a[28:31]
    ds_read_b64_tr_b16 v[170:171], v12 offset:34816
    v_mfma_f32_16x16x32_bf16 a[32:35], v[100:103], v[64:67], a[32:35]
    ds_read_b128 v[136:139], v8 offset:34816
    v_mfma_f32_16x16x32_bf16 a[36:39], v[100:103], v[68:71], a[36:39]
    ds_read_b64_tr_b16 v[172:173], v13 offset:32768
    v_mfma_f32_16x16x32_bf16 a[40:43], v[100:103], v[72:75], a[40:43]
    ds_read_b64_tr_b16 v[174:175], v13 offset:34816
    v_mfma_f32_16x16x32_bf16 a[44:47], v[100:103], v[76:79], a[44:47]
    ds_read_b128 v[140:143], v8 offset:35840
    v_mfma_f32_16x16x32_bf16 a[48:51], v[100:103], v[80:83], a[48:51]
    ds_read_b64_tr_b16 v[176:177], v14 offset:32768
    v_mfma_f32_16x16x32_bf16 a[52:55], v[100:103], v[84:87], a[52:55]
    ds_read_b64_tr_b16 v[178:179], v14 offset:34816
    v_mfma_f32_16x16x32_bf16 a[56:59], v[100:103], v[88:91], a[56:59]
    ds_read_b128 v[144:147], v8 offset:36864
    v_mfma_f32_16x16x32_bf16 a[60:63], v[100:103], v[92:95], a[60:63]
    ds_read_b64_tr_b16 v[180:181], v15 offset:32768
    v_mfma_f32_16x16x32_bf16 a[64:67], v[104:107], v[64:67], a[64:67]
    ds_read_b64_tr_b16 v[182:183], v15 offset:34816
    v_mfma_f32_16x16x32_bf16 a[68:71], v[104:107], v[68:71], a[68:71]
    ds_read_b128 v[148:151], v8 offset:37888
    v_mfma_f32_16x16x32_bf16 a[72:75], v[104:107], v[72:75], a[72:75]
    ds_read_b64_tr_b16 v[184:185], v16 offset:32768
    v_mfma_f32_16x16x32_bf16 a[76:79], v[104:107], v[76:79], a[76:79]
    ds_read_b64_tr_b16 v[186:187], v16 offset:34816
    v_mfma_f32_16x16x32_bf16 a[80:83], v[104:107], v[80:83], a[80:83]
    ds_read_b128 v[152:155], v8 offset:38912
    v_mfma_f32_16x16x32_bf16 a[84:87], v[104:107], v[84:87], a[84:87]
    ds_read_b64_tr_b16 v[188:189], v17 offset:32768
    v_mfma_f32_16x16x32_bf16 a[88:91], v[104:107], v[88:91], a[88:91]
    ds_read_b64_tr_b16 v[190:191], v17 offset:34816
    v_mfma_f32_16x16x32_bf16 a[92:95], v[104:107], v[92:95], a[92:95]
    ds_read_b128 v[156:159], v8 offset:39936
    v_mfma_f32_16x16x32_bf16 a[96:99], v[108:111], v[64:67], a[96:99]
    v_mfma_f32_16x16x32_bf16 a[100:103], v[108:111], v[68:71], a[100:103]
    v_mfma_f32_16x16x32_bf16 a[104:107], v[108:111], v[72:75], a[104:107]
    v_mfma_f32_16x16x32_bf16 a[108:111], v[108:111], v[76:79], a[108:111]
    v_mfma_f32_16x16x32_bf16 a[112:115], v[108:111], v[80:83], a[112:115]
    v_mfma_f32_16x16x32_bf16 a[116:119], v[108:111], v[84:87], a[116:119]
    v_mfma_f32_16x16x32_bf16 a[120:123], v[108:111], v[88:91], a[120:123]
    v_mfma_f32_16x16x32_bf16 a[124:127], v[108:111], v[92:95], a[124:127]
    v_mfma_f32_16x16x32_bf16 a[128:131], v[112:115], v[64:67], a[128:131]
    v_mfma_f32_16x16x32_bf16 a[132:135], v[112:115], v[68:71], a[132:135]
    v_mfma_f32_16x16x32_bf16 a[136:139], v[112:115], v[72:75], a[136:139]
    v_mfma_f32_16x16x32_bf16 a[140:143], v[112:115], v[76:79], a[140:143]
    v_mfma_f32_16x16x32_bf16 a[144:147], v[112:115], v[80:83], a[144:147]
    v_mfma_f32_16x16x32_bf16 a[148:151], v[112:115], v[84:87], a[148:151]
    v_mfma_f32_16x16x32_bf16 a[152:155], v[112:115], v[88:91], a[152:155]
    v_mfma_f32_16x16x32_bf16 a[156:159], v[112:115], v[92:95], a[156:159]
    v_mfma_f32_16x16x32_bf16 a[160:163], v[116:119], v[64:67], a[160:163]
    v_mfma_f32_16x16x32_bf16 a[164:167], v[116:119], v[68:71], a[164:167]
    v_mfma_f32_16x16x32_bf16 a[168:171], v[116:119], v[72:75], a[168:171]
    v_mfma_f32_16x16x32_bf16 a[172:175], v[116:119], v[76:79], a[172:175]
    v_mfma_f32_16x16x32_bf16 a[176:179], v[116:119], v[80:83], a[176:179]
    v_mfma_f32_16x16x32_bf16 a[180:183], v[116:119], v[84:87], a[180:183]
    v_mfma_f32_16x16x32_bf16 a[184:187], v[116:119], v[88:91], a[184:187]
    v_mfma_f32_16x16x32_bf16 a[188:191], v[116:119], v[92:95], a[188:191]
    v_mfma_f32_16x16x32_bf16 a[192:195], v[120:123], v[64:67], a[192:195]
    v_mfma_f32_16x16x32_bf16 a[196:199], v[120:123], v[68:71], a[196:199]
    v_mfma_f32_16x16x32_bf16 a[200:203], v[120:123], v[72:75], a[200:203]
    v_mfma_f32_16x16x32_bf16 a[204:207], v[120:123], v[76:79], a[204:207]
    v_mfma_f32_16x16x32_bf16 a[208:211], v[120:123], v[80:83], a[208:211]
    v_mfma_f32_16x16x32_bf16 a[212:215], v[120:123], v[84:87], a[212:215]
    v_mfma_f32_16x16x32_bf16 a[216:219], v[120:123], v[88:91], a[216:219]
    v_mfma_f32_16x16x32_bf16 a[220:223], v[120:123], v[92:95], a[220:223]
    v_mfma_f32_16x16x32_bf16 a[224:227], v[124:127], v[64:67], a[224:227]
    v_mfma_f32_16x16x32_bf16 a[228:231], v[124:127], v[68:71], a[228:231]
    v_mfma_f32_16x16x32_bf16 a[232:235], v[124:127], v[72:75], a[232:235]
    v_mfma_f32_16x16x32_bf16 a[236:239], v[124:127], v[76:79], a[236:239]
    v_mfma_f32_16x16x32_bf16 a[240:243], v[124:127], v[80:83], a[240:243]
    v_mfma_f32_16x16x32_bf16 a[244:247], v[124:127], v[84:87], a[244:247]
    v_mfma_f32_16x16x32_bf16 a[248:251], v[124:127], v[88:91], a[248:251]
    v_mfma_f32_16x16x32_bf16 a[252:255], v[124:127], v[92:95], a[252:255]
    v_xor_b32 v8, 0x10000, v8
    v_xor_b32 v10, 0x10000, v10
    v_xor_b32 v11, 0x10000, v11
    v_xor_b32 v12, 0x10000, v12
    v_xor_b32 v13, 0x10000, v13
    v_xor_b32 v14, 0x10000, v14
    v_xor_b32 v15, 0x10000, v15
    v_xor_b32 v16, 0x10000, v16
    v_xor_b32 v17, 0x10000, v17
    s_waitcnt vmcnt(8) lgkmcnt(0)
    s_barrier
    v_mfma_f32_16x16x32_bf16 a[0:3], v[160:163], v[128:131], a[0:3]
    ds_read_b64_tr_b16 v[96:97], v10 offset:0
    v_mfma_f32_16x16x32_bf16 a[4:7], v[160:163], v[132:135], a[4:7]
    ds_read_b64_tr_b16 v[98:99], v10 offset:2048
    v_mfma_f32_16x16x32_bf16 a[8:11], v[160:163], v[136:139], a[8:11]
    ds_read_b128 v[64:67], v8 offset:0
    v_mfma_f32_16x16x32_bf16 a[12:15], v[160:163], v[140:143], a[12:15]
    ds_read_b64_tr_b16 v[100:101], v11 offset:0
    v_mfma_f32_16x16x32_bf16 a[16:19], v[160:163], v[144:147], a[16:19]
    ds_read_b64_tr_b16 v[102:103], v11 offset:2048
    v_mfma_f32_16x16x32_bf16 a[20:23], v[160:163], v[148:151], a[20:23]
    ds_read_b128 v[68:71], v8 offset:1024
    v_mfma_f32_16x16x32_bf16 a[24:27], v[160:163], v[152:155], a[24:27]
    ds_read_b64_tr_b16 v[104:105], v12 offset:0
    v_mfma_f32_16x16x32_bf16 a[28:31], v[160:163], v[156:159], a[28:31]
    ds_read_b64_tr_b16 v[106:107], v12 offset:2048
    v_mfma_f32_16x16x32_bf16 a[32:35], v[164:167], v[128:131], a[32:35]
    ds_read_b128 v[72:75], v8 offset:2048
    v_mfma_f32_16x16x32_bf16 a[36:39], v[164:167], v[132:135], a[36:39]
    ds_read_b64_tr_b16 v[108:109], v13 offset:0
    v_mfma_f32_16x16x32_bf16 a[40:43], v[164:167], v[136:139], a[40:43]
    ds_read_b64_tr_b16 v[110:111], v13 offset:2048
    v_mfma_f32_16x16x32_bf16 a[44:47], v[164:167], v[140:143], a[44:47]
    ds_read_b128 v[76:79], v8 offset:3072
    v_mfma_f32_16x16x32_bf16 a[48:51], v[164:167], v[144:147], a[48:51]
    ds_read_b64_tr_b16 v[112:113], v14 offset:0
    v_mfma_f32_16x16x32_bf16 a[52:55], v[164:167], v[148:151], a[52:55]
    ds_read_b64_tr_b16 v[114:115], v14 offset:2048
    v_mfma_f32_16x16x32_bf16 a[56:59], v[164:167], v[152:155], a[56:59]
    ds_read_b128 v[80:83], v8 offset:4096
    v_mfma_f32_16x16x32_bf16 a[60:63], v[164:167], v[156:159], a[60:63]
    ds_read_b64_tr_b16 v[116:117], v15 offset:0
    v_mfma_f32_16x16x32_bf16 a[64:67], v[168:171], v[128:131], a[64:67]
    ds_read_b64_tr_b16 v[118:119], v15 offset:2048
    v_mfma_f32_16x16x32_bf16 a[68:71], v[168:171], v[132:135], a[68:71]
    ds_read_b128 v[84:87], v8 offset:5120
    v_mfma_f32_16x16x32_bf16 a[72:75], v[168:171], v[136:139], a[72:75]
    ds_read_b64_tr_b16 v[120:121], v16 offset:0
    v_mfma_f32_16x16x32_bf16 a[76:79], v[168:171], v[140:143], a[76:79]
    ds_read_b64_tr_b16 v[122:123], v16 offset:2048
    v_mfma_f32_16x16x32_bf16 a[80:83], v[168:171], v[144:147], a[80:83]
    ds_read_b128 v[88:91], v8 offset:6144
    v_mfma_f32_16x16x32_bf16 a[84:87], v[168:171], v[148:151], a[84:87]
    ds_read_b64_tr_b16 v[124:125], v17 offset:0
    v_mfma_f32_16x16x32_bf16 a[88:91], v[168:171], v[152:155], a[88:91]
    ds_read_b64_tr_b16 v[126:127], v17 offset:2048
    v_mfma_f32_16x16x32_bf16 a[92:95], v[168:171], v[156:159], a[92:95]
    ds_read_b128 v[92:95], v8 offset:7168
    v_mfma_f32_16x16x32_bf16 a[96:99], v[172:175], v[128:131], a[96:99]
    v_mfma_f32_16x16x32_bf16 a[100:103], v[172:175], v[132:135], a[100:103]
    v_mfma_f32_16x16x32_bf16 a[104:107], v[172:175], v[136:139], a[104:107]
    v_mfma_f32_16x16x32_bf16 a[108:111], v[172:175], v[140:143], a[108:111]
    v_mfma_f32_16x16x32_bf16 a[112:115], v[172:175], v[144:147], a[112:115]
    v_mfma_f32_16x16x32_bf16 a[116:119], v[172:175], v[148:151], a[116:119]
    v_mfma_f32_16x16x32_bf16 a[120:123], v[172:175], v[152:155], a[120:123]
    v_mfma_f32_16x16x32_bf16 a[124:127], v[172:175], v[156:159], a[124:127]
    v_mfma_f32_16x16x32_bf16 a[128:131], v[176:179], v[128:131], a[128:131]
    v_mfma_f32_16x16x32_bf16 a[132:135], v[176:179], v[132:135], a[132:135]
    v_mfma_f32_16x16x32_bf16 a[136:139], v[176:179], v[136:139], a[136:139]
    v_mfma_f32_16x16x32_bf16 a[140:143], v[176:179], v[140:143], a[140:143]
    v_mfma_f32_16x16x32_bf16 a[144:147], v[176:179], v[144:147], a[144:147]
    v_mfma_f32_16x16x32_bf16 a[148:151], v[176:179], v[148:151], a[148:151]
    v_mfma_f32_16x16x32_bf16 a[152:155], v[176:179], v[152:155], a[152:155]
    v_mfma_f32_16x16x32_bf16 a[156:159], v[176:179], v[156:159], a[156:159]
    v_mfma_f32_16x16x32_bf16 a[160:163], v[180:183], v[128:131], a[160:163]
    v_mfma_f32_16x16x32_bf16 a[164:167], v[180:183], v[132:135], a[164:167]
    v_mfma_f32_16x16x32_bf16 a[168:171], v[180:183], v[136:139], a[168:171]
    v_mfma_f32_16x16x32_bf16 a[172:175], v[180:183], v[140:143], a[172:175]
    v_mfma_f32_16x16x32_bf16 a[176:179], v[180:183], v[144:147], a[176:179]
    v_mfma_f32_16x16x32_bf16 a[180:183], v[180:183], v[148:151], a[180:183]
    v_mfma_f32_16x16x32_bf16 a[184:187], v[180:183], v[152:155], a[184:187]
    v_mfma_f32_16x16x32_bf16 a[188:191], v[180:183], v[156:159], a[188:191]
    v_mfma_f32_16x16x32_bf16 a[192:195], v[184:187], v[128:131], a[192:195]
    v_mfma_f32_16x16x32_bf16 a[196:199], v[184:187], v[132:135], a[196:199]
    v_mfma_f32_16x16x32_bf16 a[200:203], v[184:187], v[136:139], a[200:203]
    v_mfma_f32_16x16x32_bf16 a[204:207], v[184:187], v[140:143], a[204:207]
    v_mfma_f32_16x16x32_bf16 a[208:211], v[184:187], v[144:147], a[208:211]
    v_mfma_f32_16x16x32_bf16 a[212:215], v[184:187], v[148:151], a[212:215]
    v_mfma_f32_16x16x32_bf16 a[216:219], v[184:187], v[152:155], a[216:219]
    v_mfma_f32_16x16x32_bf16 a[220:223], v[184:187], v[156:159], a[220:223]
    v_mfma_f32_16x16x32_bf16 a[224:227], v[188:191], v[128:131], a[224:227]
    v_mfma_f32_16x16x32_bf16 a[228:231], v[188:191], v[132:135], a[228:231]
    v_mfma_f32_16x16x32_bf16 a[232:235], v[188:191], v[136:139], a[232:235]
    v_mfma_f32_16x16x32_bf16 a[236:239], v[188:191], v[140:143], a[236:239]
    v_mfma_f32_16x16x32_bf16 a[240:243], v[188:191], v[144:147], a[240:243]
    v_mfma_f32_16x16x32_bf16 a[244:247], v[188:191], v[148:151], a[244:247]
    v_mfma_f32_16x16x32_bf16 a[248:251], v[188:191], v[152:155], a[248:251]
    v_mfma_f32_16x16x32_bf16 a[252:255], v[188:191], v[156:159], a[252:255]
    s_waitcnt vmcnt(0) lgkmcnt(0)
    s_barrier
    v_mfma_f32_16x16x32_bf16 a[0:3], v[96:99], v[64:67], a[0:3]
    ds_read_b64_tr_b16 v[160:161], v10 offset:32768
    v_mfma_f32_16x16x32_bf16 a[4:7], v[96:99], v[68:71], a[4:7]
    ds_read_b64_tr_b16 v[162:163], v10 offset:34816
    v_mfma_f32_16x16x32_bf16 a[8:11], v[96:99], v[72:75], a[8:11]
    ds_read_b128 v[128:131], v8 offset:32768
    v_mfma_f32_16x16x32_bf16 a[12:15], v[96:99], v[76:79], a[12:15]
    ds_read_b64_tr_b16 v[164:165], v11 offset:32768
    v_mfma_f32_16x16x32_bf16 a[16:19], v[96:99], v[80:83], a[16:19]
    ds_read_b64_tr_b16 v[166:167], v11 offset:34816
    v_mfma_f32_16x16x32_bf16 a[20:23], v[96:99], v[84:87], a[20:23]
    ds_read_b128 v[132:135], v8 offset:33792
    v_mfma_f32_16x16x32_bf16 a[24:27], v[96:99], v[88:91], a[24:27]
    ds_read_b64_tr_b16 v[168:169], v12 offset:32768
    v_mfma_f32_16x16x32_bf16 a[28:31], v[96:99], v[92:95], a[28:31]
    ds_read_b64_tr_b16 v[170:171], v12 offset:34816
    v_mfma_f32_16x16x32_bf16 a[32:35], v[100:103], v[64:67], a[32:35]
    ds_read_b128 v[136:139], v8 offset:34816
    v_mfma_f32_16x16x32_bf16 a[36:39], v[100:103], v[68:71], a[36:39]
    ds_read_b64_tr_b16 v[172:173], v13 offset:32768
    v_mfma_f32_16x16x32_bf16 a[40:43], v[100:103], v[72:75], a[40:43]
    ds_read_b64_tr_b16 v[174:175], v13 offset:34816
    v_mfma_f32_16x16x32_bf16 a[44:47], v[100:103], v[76:79], a[44:47]
    ds_read_b128 v[140:143], v8 offset:35840
    v_mfma_f32_16x16x32_bf16 a[48:51], v[100:103], v[80:83], a[48:51]
    ds_read_b64_tr_b16 v[176:177], v14 offset:32768
    v_mfma_f32_16x16x32_bf16 a[52:55], v[100:103], v[84:87], a[52:55]
    ds_read_b64_tr_b16 v[178:179], v14 offset:34816
    v_mfma_f32_16x16x32_bf16 a[56:59], v[100:103], v[88:91], a[56:59]
    ds_read_b128 v[144:147], v8 offset:36864
    v_mfma_f32_16x16x32_bf16 a[60:63], v[100:103], v[92:95], a[60:63]
    ds_read_b64_tr_b16 v[180:181], v15 offset:32768
    v_mfma_f32_16x16x32_bf16 a[64:67], v[104:107], v[64:67], a[64:67]
    ds_read_b64_tr_b16 v[182:183], v15 offset:34816
    v_mfma_f32_16x16x32_bf16 a[68:71], v[104:107], v[68:71], a[68:71]
    ds_read_b128 v[148:151], v8 offset:37888
    v_mfma_f32_16x16x32_bf16 a[72:75], v[104:107], v[72:75], a[72:75]
    ds_read_b64_tr_b16 v[184:185], v16 offset:32768
    v_mfma_f32_16x16x32_bf16 a[76:79], v[104:107], v[76:79], a[76:79]
    ds_read_b64_tr_b16 v[186:187], v16 offset:34816
    v_mfma_f32_16x16x32_bf16 a[80:83], v[104:107], v[80:83], a[80:83]
    ds_read_b128 v[152:155], v8 offset:38912
    v_mfma_f32_16x16x32_bf16 a[84:87], v[104:107], v[84:87], a[84:87]
    ds_read_b64_tr_b16 v[188:189], v17 offset:32768
    v_mfma_f32_16x16x32_bf16 a[88:91], v[104:107], v[88:91], a[88:91]
    ds_read_b64_tr_b16 v[190:191], v17 offset:34816
    v_mfma_f32_16x16x32_bf16 a[92:95], v[104:107], v[92:95], a[92:95]
    ds_read_b128 v[156:159], v8 offset:39936
    v_mfma_f32_16x16x32_bf16 a[96:99], v[108:111], v[64:67], a[96:99]
    v_mfma_f32_16x16x32_bf16 a[100:103], v[108:111], v[68:71], a[100:103]
    v_mfma_f32_16x16x32_bf16 a[104:107], v[108:111], v[72:75], a[104:107]
    v_mfma_f32_16x16x32_bf16 a[108:111], v[108:111], v[76:79], a[108:111]
    v_mfma_f32_16x16x32_bf16 a[112:115], v[108:111], v[80:83], a[112:115]
    v_mfma_f32_16x16x32_bf16 a[116:119], v[108:111], v[84:87], a[116:119]
    v_mfma_f32_16x16x32_bf16 a[120:123], v[108:111], v[88:91], a[120:123]
    v_mfma_f32_16x16x32_bf16 a[124:127], v[108:111], v[92:95], a[124:127]
    v_mfma_f32_16x16x32_bf16 a[128:131], v[112:115], v[64:67], a[128:131]
    v_mfma_f32_16x16x32_bf16 a[132:135], v[112:115], v[68:71], a[132:135]
    v_mfma_f32_16x16x32_bf16 a[136:139], v[112:115], v[72:75], a[136:139]
    v_mfma_f32_16x16x32_bf16 a[140:143], v[112:115], v[76:79], a[140:143]
    v_mfma_f32_16x16x32_bf16 a[144:147], v[112:115], v[80:83], a[144:147]
    v_mfma_f32_16x16x32_bf16 a[148:151], v[112:115], v[84:87], a[148:151]
    v_mfma_f32_16x16x32_bf16 a[152:155], v[112:115], v[88:91], a[152:155]
    v_mfma_f32_16x16x32_bf16 a[156:159], v[112:115], v[92:95], a[156:159]
    v_mfma_f32_16x16x32_bf16 a[160:163], v[116:119], v[64:67], a[160:163]
    v_mfma_f32_16x16x32_bf16 a[164:167], v[116:119], v[68:71], a[164:167]
    v_mfma_f32_16x16x32_bf16 a[168:171], v[116:119], v[72:75], a[168:171]
    v_mfma_f32_16x16x32_bf16 a[172:175], v[116:119], v[76:79], a[172:175]
    v_mfma_f32_16x16x32_bf16 a[176:179], v[116:119], v[80:83], a[176:179]
    v_mfma_f32_16x16x32_bf16 a[180:183], v[116:119], v[84:87], a[180:183]
    v_mfma_f32_16x16x32_bf16 a[184:187], v[116:119], v[88:91], a[184:187]
    v_mfma_f32_16x16x32_bf16 a[188:191], v[116:119], v[92:95], a[188:191]
    v_mfma_f32_16x16x32_bf16 a[192:195], v[120:123], v[64:67], a[192:195]
    v_mfma_f32_16x16x32_bf16 a[196:199], v[120:123], v[68:71], a[196:199]
    v_mfma_f32_16x16x32_bf16 a[200:203], v[120:123], v[72:75], a[200:203]
    v_mfma_f32_16x16x32_bf16 a[204:207], v[120:123], v[76:79], a[204:207]
    v_mfma_f32_16x16x32_bf16 a[208:211], v[120:123], v[80:83], a[208:211]
    v_mfma_f32_16x16x32_bf16 a[212:215], v[120:123], v[84:87], a[212:215]
    v_mfma_f32_16x16x32_bf16 a[216:219], v[120:123], v[88:91], a[216:219]
    v_mfma_f32_16x16x32_bf16 a[220:223], v[120:123], v[92:95], a[220:223]
    v_mfma_f32_16x16x32_bf16 a[224:227], v[124:127], v[64:67], a[224:227]
    v_mfma_f32_16x16x32_bf16 a[228:231], v[124:127], v[68:71], a[228:231]
    v_mfma_f32_16x16x32_bf16 a[232:235], v[124:127], v[72:75], a[232:235]
    v_mfma_f32_16x16x32_bf16 a[236:239], v[124:127], v[76:79], a[236:239]
    v_mfma_f32_16x16x32_bf16 a[240:243], v[124:127], v[80:83], a[240:243]
    v_mfma_f32_16x16x32_bf16 a[244:247], v[124:127], v[84:87], a[244:247]
    v_mfma_f32_16x16x32_bf16 a[248:251], v[124:127], v[88:91], a[248:251]
    v_mfma_f32_16x16x32_bf16 a[252:255], v[124:127], v[92:95], a[252:255]
    s_waitcnt lgkmcnt(0)
    s_barrier
    v_mfma_f32_16x16x32_bf16 a[0:3], v[160:163], v[128:131], a[0:3]
    v_mfma_f32_16x16x32_bf16 a[4:7], v[160:163], v[132:135], a[4:7]
    v_mfma_f32_16x16x32_bf16 a[8:11], v[160:163], v[136:139], a[8:11]
    v_mfma_f32_16x16x32_bf16 a[12:15], v[160:163], v[140:143], a[12:15]
    v_mfma_f32_16x16x32_bf16 a[16:19], v[160:163], v[144:147], a[16:19]
    v_mfma_f32_16x16x32_bf16 a[20:23], v[160:163], v[148:151], a[20:23]
    v_mfma_f32_16x16x32_bf16 a[24:27], v[160:163], v[152:155], a[24:27]
    v_mfma_f32_16x16x32_bf16 a[28:31], v[160:163], v[156:159], a[28:31]
    v_mfma_f32_16x16x32_bf16 a[32:35], v[164:167], v[128:131], a[32:35]
    v_mfma_f32_16x16x32_bf16 a[36:39], v[164:167], v[132:135], a[36:39]
    v_mfma_f32_16x16x32_bf16 a[40:43], v[164:167], v[136:139], a[40:43]
    v_mfma_f32_16x16x32_bf16 a[44:47], v[164:167], v[140:143], a[44:47]
    v_mfma_f32_16x16x32_bf16 a[48:51], v[164:167], v[144:147], a[48:51]
    v_mfma_f32_16x16x32_bf16 a[52:55], v[164:167], v[148:151], a[52:55]
    v_mfma_f32_16x16x32_bf16 a[56:59], v[164:167], v[152:155], a[56:59]
    v_mfma_f32_16x16x32_bf16 a[60:63], v[164:167], v[156:159], a[60:63]
    v_mfma_f32_16x16x32_bf16 a[64:67], v[168:171], v[128:131], a[64:67]
    v_mfma_f32_16x16x32_bf16 a[68:71], v[168:171], v[132:135], a[68:71]
    v_mfma_f32_16x16x32_bf16 a[72:75], v[168:171], v[136:139], a[72:75]
    v_mfma_f32_16x16x32_bf16 a[76:79], v[168:171], v[140:143], a[76:79]
    v_mfma_f32_16x16x32_bf16 a[80:83], v[168:171], v[144:147], a[80:83]
    v_mfma_f32_16x16x32_bf16 a[84:87], v[168:171], v[148:151], a[84:87]
    v_mfma_f32_16x16x32_bf16 a[88:91], v[168:171], v[152:155], a[88:91]
    v_mfma_f32_16x16x32_bf16 a[92:95], v[168:171], v[156:159], a[92:95]
    v_mfma_f32_16x16x32_bf16 a[96:99], v[172:175], v[128:131], a[96:99]
    v_mfma_f32_16x16x32_bf16 a[100:103], v[172:175], v[132:135], a[100:103]
    v_mfma_f32_16x16x32_bf16 a[104:107], v[172:175], v[136:139], a[104:107]
    v_mfma_f32_16x16x32_bf16 a[108:111], v[172:175], v[140:143], a[108:111]
    v_mfma_f32_16x16x32_bf16 a[112:115], v[172:175], v[144:147], a[112:115]
    v_mfma_f32_16x16x32_bf16 a[116:119], v[172:175], v[148:151], a[116:119]
    v_mfma_f32_16x16x32_bf16 a[120:123], v[172:175], v[152:155], a[120:123]
    v_mfma_f32_16x16x32_bf16 a[124:127], v[172:175], v[156:159], a[124:127]
    v_mfma_f32_16x16x32_bf16 a[128:131], v[176:179], v[128:131], a[128:131]
    v_mfma_f32_16x16x32_bf16 a[132:135], v[176:179], v[132:135], a[132:135]
    v_mfma_f32_16x16x32_bf16 a[136:139], v[176:179], v[136:139], a[136:139]
    v_mfma_f32_16x16x32_bf16 a[140:143], v[176:179], v[140:143], a[140:143]
    v_mfma_f32_16x16x32_bf16 a[144:147], v[176:179], v[144:147], a[144:147]
    v_mfma_f32_16x16x32_bf16 a[148:151], v[176:179], v[148:151], a[148:151]
    v_mfma_f32_16x16x32_bf16 a[152:155], v[176:179], v[152:155], a[152:155]
    v_mfma_f32_16x16x32_bf16 a[156:159], v[176:179], v[156:159], a[156:159]
    v_mfma_f32_16x16x32_bf16 a[160:163], v[180:183], v[128:131], a[160:163]
    v_mfma_f32_16x16x32_bf16 a[164:167], v[180:183], v[132:135], a[164:167]
    v_mfma_f32_16x16x32_bf16 a[168:171], v[180:183], v[136:139], a[168:171]
    v_mfma_f32_16x16x32_bf16 a[172:175], v[180:183], v[140:143], a[172:175]
    v_mfma_f32_16x16x32_bf16 a[176:179], v[180:183], v[144:147], a[176:179]
    v_mfma_f32_16x16x32_bf16 a[180:183], v[180:183], v[148:151], a[180:183]
    v_mfma_f32_16x16x32_bf16 a[184:187], v[180:183], v[152:155], a[184:187]
    v_mfma_f32_16x16x32_bf16 a[188:191], v[180:183], v[156:159], a[188:191]
    v_mfma_f32_16x16x32_bf16 a[192:195], v[184:187], v[128:131], a[192:195]
    v_mfma_f32_16x16x32_bf16 a[196:199], v[184:187], v[132:135], a[196:199]
    v_mfma_f32_16x16x32_bf16 a[200:203], v[184:187], v[136:139], a[200:203]
    v_mfma_f32_16x16x32_bf16 a[204:207], v[184:187], v[140:143], a[204:207]
    v_mfma_f32_16x16x32_bf16 a[208:211], v[184:187], v[144:147], a[208:211]
    v_mfma_f32_16x16x32_bf16 a[212:215], v[184:187], v[148:151], a[212:215]
    v_mfma_f32_16x16x32_bf16 a[216:219], v[184:187], v[152:155], a[216:219]
    v_mfma_f32_16x16x32_bf16 a[220:223], v[184:187], v[156:159], a[220:223]
    v_mfma_f32_16x16x32_bf16 a[224:227], v[188:191], v[128:131], a[224:227]
    v_mfma_f32_16x16x32_bf16 a[228:231], v[188:191], v[132:135], a[228:231]
    v_mfma_f32_16x16x32_bf16 a[232:235], v[188:191], v[136:139], a[232:235]
    v_mfma_f32_16x16x32_bf16 a[236:239], v[188:191], v[140:143], a[236:239]
    v_mfma_f32_16x16x32_bf16 a[240:243], v[188:191], v[144:147], a[240:243]
    v_mfma_f32_16x16x32_bf16 a[244:247], v[188:191], v[148:151], a[244:247]
    v_mfma_f32_16x16x32_bf16 a[248:251], v[188:191], v[152:155], a[248:251]
    v_mfma_f32_16x16x32_bf16 a[252:255], v[188:191], v[156:159], a[252:255]
    s_lshl_b32 s54, s61, 1
    s_and_b32 s55, s3, 1
    s_add_u32 s54, s54, s55
    s_lshl_b32 s52, s54, 19
    s_lshl_b32 s54, s60, 1
    s_lshr_b32 s55, s3, 1
    s_add_u32 s54, s54, s55
    s_lshl_b32 s54, s54, 15
    s_add_u32 s52, s52, s54
    s_add_u32 s52, s52, 19136512
    v_accvgpr_read_b32 v68, a0
    v_accvgpr_read_b32 v69, a1
    v_accvgpr_read_b32 v70, a2
    v_accvgpr_read_b32 v71, a3
    v_cvt_pk_bf16_f32 v64, v68, v69
    v_cvt_pk_bf16_f32 v65, v70, v71
    v_accvgpr_read_b32 v68, a32
    v_accvgpr_read_b32 v69, a33
    v_accvgpr_read_b32 v70, a34
    v_accvgpr_read_b32 v71, a35
    v_cvt_pk_bf16_f32 v66, v68, v69
    v_cvt_pk_bf16_f32 v67, v70, v71
    s_add_u32 s54, s52, 0
    buffer_store_dwordx4 v[64:67], v18, s[8:11], s54 offen sc1
    v_accvgpr_read_b32 v84, a64
    v_accvgpr_read_b32 v85, a65
    v_accvgpr_read_b32 v86, a66
    v_accvgpr_read_b32 v87, a67
    v_cvt_pk_bf16_f32 v80, v84, v85
    v_cvt_pk_bf16_f32 v81, v86, v87
    v_accvgpr_read_b32 v84, a96
    v_accvgpr_read_b32 v85, a97
    v_accvgpr_read_b32 v86, a98
    v_accvgpr_read_b32 v87, a99
    v_cvt_pk_bf16_f32 v82, v84, v85
    v_cvt_pk_bf16_f32 v83, v86, v87
    s_add_u32 s54, s52, 2048
    buffer_store_dwordx4 v[80:83], v18, s[8:11], s54 offen sc1
    v_accvgpr_read_b32 v100, a128
    v_accvgpr_read_b32 v101, a129
    v_accvgpr_read_b32 v102, a130
    v_accvgpr_read_b32 v103, a131
    v_cvt_pk_bf16_f32 v96, v100, v101
    v_cvt_pk_bf16_f32 v97, v102, v103
    v_accvgpr_read_b32 v100, a160
    v_accvgpr_read_b32 v101, a161
    v_accvgpr_read_b32 v102, a162
    v_accvgpr_read_b32 v103, a163
    v_cvt_pk_bf16_f32 v98, v100, v101
    v_cvt_pk_bf16_f32 v99, v102, v103
    s_add_u32 s54, s52, 4096
    buffer_store_dwordx4 v[96:99], v18, s[8:11], s54 offen sc1
    v_accvgpr_read_b32 v116, a192
    v_accvgpr_read_b32 v117, a193
    v_accvgpr_read_b32 v118, a194
    v_accvgpr_read_b32 v119, a195
    v_cvt_pk_bf16_f32 v112, v116, v117
    v_cvt_pk_bf16_f32 v113, v118, v119
    v_accvgpr_read_b32 v116, a224
    v_accvgpr_read_b32 v117, a225
    v_accvgpr_read_b32 v118, a226
    v_accvgpr_read_b32 v119, a227
    v_cvt_pk_bf16_f32 v114, v116, v117
    v_cvt_pk_bf16_f32 v115, v118, v119
    s_add_u32 s54, s52, 6144
    buffer_store_dwordx4 v[112:115], v18, s[8:11], s54 offen sc1
    v_accvgpr_read_b32 v68, a4
    v_accvgpr_read_b32 v69, a5
    v_accvgpr_read_b32 v70, a6
    v_accvgpr_read_b32 v71, a7
    v_cvt_pk_bf16_f32 v66, v68, v69
    v_cvt_pk_bf16_f32 v67, v70, v71
    v_accvgpr_read_b32 v68, a36
    v_accvgpr_read_b32 v69, a37
    v_accvgpr_read_b32 v70, a38
    v_accvgpr_read_b32 v71, a39
    v_cvt_pk_bf16_f32 v64, v68, v69
    v_cvt_pk_bf16_f32 v65, v70, v71
    s_add_u32 s54, s52, 1024
    buffer_store_dwordx4 v[64:67], v18, s[8:11], s54 offen sc1
    v_accvgpr_read_b32 v84, a68
    v_accvgpr_read_b32 v85, a69
    v_accvgpr_read_b32 v86, a70
    v_accvgpr_read_b32 v87, a71
    v_cvt_pk_bf16_f32 v82, v84, v85
    v_cvt_pk_bf16_f32 v83, v86, v87
    v_accvgpr_read_b32 v84, a100
    v_accvgpr_read_b32 v85, a101
    v_accvgpr_read_b32 v86, a102
    v_accvgpr_read_b32 v87, a103
    v_cvt_pk_bf16_f32 v80, v84, v85
    v_cvt_pk_bf16_f32 v81, v86, v87
    s_add_u32 s54, s52, 3072
    buffer_store_dwordx4 v[80:83], v18, s[8:11], s54 offen sc1
    v_accvgpr_read_b32 v100, a132
    v_accvgpr_read_b32 v101, a133
    v_accvgpr_read_b32 v102, a134
    v_accvgpr_read_b32 v103, a135
    v_cvt_pk_bf16_f32 v98, v100, v101
    v_cvt_pk_bf16_f32 v99, v102, v103
    v_accvgpr_read_b32 v100, a164
    v_accvgpr_read_b32 v101, a165
    v_accvgpr_read_b32 v102, a166
    v_accvgpr_read_b32 v103, a167
    v_cvt_pk_bf16_f32 v96, v100, v101
    v_cvt_pk_bf16_f32 v97, v102, v103
    s_add_u32 s54, s52, 5120
    buffer_store_dwordx4 v[96:99], v18, s[8:11], s54 offen sc1
    v_accvgpr_read_b32 v116, a196
    v_accvgpr_read_b32 v117, a197
    v_accvgpr_read_b32 v118, a198
    v_accvgpr_read_b32 v119, a199
    v_cvt_pk_bf16_f32 v114, v116, v117
    v_cvt_pk_bf16_f32 v115, v118, v119
    v_accvgpr_read_b32 v116, a228
    v_accvgpr_read_b32 v117, a229
    v_accvgpr_read_b32 v118, a230
    v_accvgpr_read_b32 v119, a231
    v_cvt_pk_bf16_f32 v112, v116, v117
    v_cvt_pk_bf16_f32 v113, v118, v119
    s_add_u32 s54, s52, 7168
    buffer_store_dwordx4 v[112:115], v18, s[8:11], s54 offen sc1
    v_accvgpr_read_b32 v68, a8
    v_accvgpr_read_b32 v69, a9
    v_accvgpr_read_b32 v70, a10
    v_accvgpr_read_b32 v71, a11
    v_cvt_pk_bf16_f32 v64, v68, v69
    v_cvt_pk_bf16_f32 v65, v70, v71
    v_accvgpr_read_b32 v68, a40
    v_accvgpr_read_b32 v69, a41
    v_accvgpr_read_b32 v70, a42
    v_accvgpr_read_b32 v71, a43
    v_cvt_pk_bf16_f32 v66, v68, v69
    v_cvt_pk_bf16_f32 v67, v70, v71
    s_add_u32 s54, s52, 8192
    buffer_store_dwordx4 v[64:67], v18, s[8:11], s54 offen sc1
    v_accvgpr_read_b32 v84, a72
    v_accvgpr_read_b32 v85, a73
    v_accvgpr_read_b32 v86, a74
    v_accvgpr_read_b32 v87, a75
    v_cvt_pk_bf16_f32 v80, v84, v85
    v_cvt_pk_bf16_f32 v81, v86, v87
    v_accvgpr_read_b32 v84, a104
    v_accvgpr_read_b32 v85, a105
    v_accvgpr_read_b32 v86, a106
    v_accvgpr_read_b32 v87, a107
    v_cvt_pk_bf16_f32 v82, v84, v85
    v_cvt_pk_bf16_f32 v83, v86, v87
    s_add_u32 s54, s52, 10240
    buffer_store_dwordx4 v[80:83], v18, s[8:11], s54 offen sc1
    v_accvgpr_read_b32 v100, a136
    v_accvgpr_read_b32 v101, a137
    v_accvgpr_read_b32 v102, a138
    v_accvgpr_read_b32 v103, a139
    v_cvt_pk_bf16_f32 v96, v100, v101
    v_cvt_pk_bf16_f32 v97, v102, v103
    v_accvgpr_read_b32 v100, a168
    v_accvgpr_read_b32 v101, a169
    v_accvgpr_read_b32 v102, a170
    v_accvgpr_read_b32 v103, a171
    v_cvt_pk_bf16_f32 v98, v100, v101
    v_cvt_pk_bf16_f32 v99, v102, v103
    s_add_u32 s54, s52, 12288
    buffer_store_dwordx4 v[96:99], v18, s[8:11], s54 offen sc1
    v_accvgpr_read_b32 v116, a200
    v_accvgpr_read_b32 v117, a201
    v_accvgpr_read_b32 v118, a202
    v_accvgpr_read_b32 v119, a203
    v_cvt_pk_bf16_f32 v112, v116, v117
    v_cvt_pk_bf16_f32 v113, v118, v119
    v_accvgpr_read_b32 v116, a232
    v_accvgpr_read_b32 v117, a233
    v_accvgpr_read_b32 v118, a234
    v_accvgpr_read_b32 v119, a235
    v_cvt_pk_bf16_f32 v114, v116, v117
    v_cvt_pk_bf16_f32 v115, v118, v119
    s_add_u32 s54, s52, 14336
    buffer_store_dwordx4 v[112:115], v18, s[8:11], s54 offen sc1
    v_accvgpr_read_b32 v68, a12
    v_accvgpr_read_b32 v69, a13
    v_accvgpr_read_b32 v70, a14
    v_accvgpr_read_b32 v71, a15
    v_cvt_pk_bf16_f32 v66, v68, v69
    v_cvt_pk_bf16_f32 v67, v70, v71
    v_accvgpr_read_b32 v68, a44
    v_accvgpr_read_b32 v69, a45
    v_accvgpr_read_b32 v70, a46
    v_accvgpr_read_b32 v71, a47
    v_cvt_pk_bf16_f32 v64, v68, v69
    v_cvt_pk_bf16_f32 v65, v70, v71
    s_add_u32 s54, s52, 9216
    buffer_store_dwordx4 v[64:67], v18, s[8:11], s54 offen sc1
    v_accvgpr_read_b32 v84, a76
    v_accvgpr_read_b32 v85, a77
    v_accvgpr_read_b32 v86, a78
    v_accvgpr_read_b32 v87, a79
    v_cvt_pk_bf16_f32 v82, v84, v85
    v_cvt_pk_bf16_f32 v83, v86, v87
    v_accvgpr_read_b32 v84, a108
    v_accvgpr_read_b32 v85, a109
    v_accvgpr_read_b32 v86, a110
    v_accvgpr_read_b32 v87, a111
    v_cvt_pk_bf16_f32 v80, v84, v85
    v_cvt_pk_bf16_f32 v81, v86, v87
    s_add_u32 s54, s52, 11264
    buffer_store_dwordx4 v[80:83], v18, s[8:11], s54 offen sc1
    v_accvgpr_read_b32 v100, a140
    v_accvgpr_read_b32 v101, a141
    v_accvgpr_read_b32 v102, a142
    v_accvgpr_read_b32 v103, a143
    v_cvt_pk_bf16_f32 v98, v100, v101
    v_cvt_pk_bf16_f32 v99, v102, v103
    v_accvgpr_read_b32 v100, a172
    v_accvgpr_read_b32 v101, a173
    v_accvgpr_read_b32 v102, a174
    v_accvgpr_read_b32 v103, a175
    v_cvt_pk_bf16_f32 v96, v100, v101
    v_cvt_pk_bf16_f32 v97, v102, v103
    s_add_u32 s54, s52, 13312
    buffer_store_dwordx4 v[96:99], v18, s[8:11], s54 offen sc1
    v_accvgpr_read_b32 v116, a204
    v_accvgpr_read_b32 v117, a205
    v_accvgpr_read_b32 v118, a206
    v_accvgpr_read_b32 v119, a207
    v_cvt_pk_bf16_f32 v114, v116, v117
    v_cvt_pk_bf16_f32 v115, v118, v119
    v_accvgpr_read_b32 v116, a236
    v_accvgpr_read_b32 v117, a237
    v_accvgpr_read_b32 v118, a238
    v_accvgpr_read_b32 v119, a239
    v_cvt_pk_bf16_f32 v112, v116, v117
    v_cvt_pk_bf16_f32 v113, v118, v119
    s_add_u32 s54, s52, 15360
    buffer_store_dwordx4 v[112:115], v18, s[8:11], s54 offen sc1
    v_accvgpr_read_b32 v68, a16
    v_accvgpr_read_b32 v69, a17
    v_accvgpr_read_b32 v70, a18
    v_accvgpr_read_b32 v71, a19
    v_cvt_pk_bf16_f32 v64, v68, v69
    v_cvt_pk_bf16_f32 v65, v70, v71
    v_accvgpr_read_b32 v68, a48
    v_accvgpr_read_b32 v69, a49
    v_accvgpr_read_b32 v70, a50
    v_accvgpr_read_b32 v71, a51
    v_cvt_pk_bf16_f32 v66, v68, v69
    v_cvt_pk_bf16_f32 v67, v70, v71
    s_add_u32 s54, s52, 16384
    buffer_store_dwordx4 v[64:67], v18, s[8:11], s54 offen sc1
    v_accvgpr_read_b32 v84, a80
    v_accvgpr_read_b32 v85, a81
    v_accvgpr_read_b32 v86, a82
    v_accvgpr_read_b32 v87, a83
    v_cvt_pk_bf16_f32 v80, v84, v85
    v_cvt_pk_bf16_f32 v81, v86, v87
    v_accvgpr_read_b32 v84, a112
    v_accvgpr_read_b32 v85, a113
    v_accvgpr_read_b32 v86, a114
    v_accvgpr_read_b32 v87, a115
    v_cvt_pk_bf16_f32 v82, v84, v85
    v_cvt_pk_bf16_f32 v83, v86, v87
    s_add_u32 s54, s52, 18432
    buffer_store_dwordx4 v[80:83], v18, s[8:11], s54 offen sc1
    v_accvgpr_read_b32 v100, a144
    v_accvgpr_read_b32 v101, a145
    v_accvgpr_read_b32 v102, a146
    v_accvgpr_read_b32 v103, a147
    v_cvt_pk_bf16_f32 v96, v100, v101
    v_cvt_pk_bf16_f32 v97, v102, v103
    v_accvgpr_read_b32 v100, a176
    v_accvgpr_read_b32 v101, a177
    v_accvgpr_read_b32 v102, a178
    v_accvgpr_read_b32 v103, a179
    v_cvt_pk_bf16_f32 v98, v100, v101
    v_cvt_pk_bf16_f32 v99, v102, v103
    s_add_u32 s54, s52, 20480
    buffer_store_dwordx4 v[96:99], v18, s[8:11], s54 offen sc1
    v_accvgpr_read_b32 v116, a208
    v_accvgpr_read_b32 v117, a209
    v_accvgpr_read_b32 v118, a210
    v_accvgpr_read_b32 v119, a211
    v_cvt_pk_bf16_f32 v112, v116, v117
    v_cvt_pk_bf16_f32 v113, v118, v119
    v_accvgpr_read_b32 v116, a240
    v_accvgpr_read_b32 v117, a241
    v_accvgpr_read_b32 v118, a242
    v_accvgpr_read_b32 v119, a243
    v_cvt_pk_bf16_f32 v114, v116, v117
    v_cvt_pk_bf16_f32 v115, v118, v119
    s_add_u32 s54, s52, 22528
    buffer_store_dwordx4 v[112:115], v18, s[8:11], s54 offen sc1
    v_accvgpr_read_b32 v68, a20
    v_accvgpr_read_b32 v69, a21
    v_accvgpr_read_b32 v70, a22
    v_accvgpr_read_b32 v71, a23
    v_cvt_pk_bf16_f32 v66, v68, v69
    v_cvt_pk_bf16_f32 v67, v70, v71
    v_accvgpr_read_b32 v68, a52
    v_accvgpr_read_b32 v69, a53
    v_accvgpr_read_b32 v70, a54
    v_accvgpr_read_b32 v71, a55
    v_cvt_pk_bf16_f32 v64, v68, v69
    v_cvt_pk_bf16_f32 v65, v70, v71
    s_add_u32 s54, s52, 17408
    buffer_store_dwordx4 v[64:67], v18, s[8:11], s54 offen sc1
    v_accvgpr_read_b32 v84, a84
    v_accvgpr_read_b32 v85, a85
    v_accvgpr_read_b32 v86, a86
    v_accvgpr_read_b32 v87, a87
    v_cvt_pk_bf16_f32 v82, v84, v85
    v_cvt_pk_bf16_f32 v83, v86, v87
    v_accvgpr_read_b32 v84, a116
    v_accvgpr_read_b32 v85, a117
    v_accvgpr_read_b32 v86, a118
    v_accvgpr_read_b32 v87, a119
    v_cvt_pk_bf16_f32 v80, v84, v85
    v_cvt_pk_bf16_f32 v81, v86, v87
    s_add_u32 s54, s52, 19456
    buffer_store_dwordx4 v[80:83], v18, s[8:11], s54 offen sc1
    v_accvgpr_read_b32 v100, a148
    v_accvgpr_read_b32 v101, a149
    v_accvgpr_read_b32 v102, a150
    v_accvgpr_read_b32 v103, a151
    v_cvt_pk_bf16_f32 v98, v100, v101
    v_cvt_pk_bf16_f32 v99, v102, v103
    v_accvgpr_read_b32 v100, a180
    v_accvgpr_read_b32 v101, a181
    v_accvgpr_read_b32 v102, a182
    v_accvgpr_read_b32 v103, a183
    v_cvt_pk_bf16_f32 v96, v100, v101
    v_cvt_pk_bf16_f32 v97, v102, v103
    s_add_u32 s54, s52, 21504
    buffer_store_dwordx4 v[96:99], v18, s[8:11], s54 offen sc1
    v_accvgpr_read_b32 v116, a212
    v_accvgpr_read_b32 v117, a213
    v_accvgpr_read_b32 v118, a214
    v_accvgpr_read_b32 v119, a215
    v_cvt_pk_bf16_f32 v114, v116, v117
    v_cvt_pk_bf16_f32 v115, v118, v119
    v_accvgpr_read_b32 v116, a244
    v_accvgpr_read_b32 v117, a245
    v_accvgpr_read_b32 v118, a246
    v_accvgpr_read_b32 v119, a247
    v_cvt_pk_bf16_f32 v112, v116, v117
    v_cvt_pk_bf16_f32 v113, v118, v119
    s_add_u32 s54, s52, 23552
    buffer_store_dwordx4 v[112:115], v18, s[8:11], s54 offen sc1
    v_accvgpr_read_b32 v68, a24
    v_accvgpr_read_b32 v69, a25
    v_accvgpr_read_b32 v70, a26
    v_accvgpr_read_b32 v71, a27
    v_cvt_pk_bf16_f32 v64, v68, v69
    v_cvt_pk_bf16_f32 v65, v70, v71
    v_accvgpr_read_b32 v68, a56
    v_accvgpr_read_b32 v69, a57
    v_accvgpr_read_b32 v70, a58
    v_accvgpr_read_b32 v71, a59
    v_cvt_pk_bf16_f32 v66, v68, v69
    v_cvt_pk_bf16_f32 v67, v70, v71
    s_add_u32 s54, s52, 24576
    buffer_store_dwordx4 v[64:67], v18, s[8:11], s54 offen sc1
    v_accvgpr_read_b32 v84, a88
    v_accvgpr_read_b32 v85, a89
    v_accvgpr_read_b32 v86, a90
    v_accvgpr_read_b32 v87, a91
    v_cvt_pk_bf16_f32 v80, v84, v85
    v_cvt_pk_bf16_f32 v81, v86, v87
    v_accvgpr_read_b32 v84, a120
    v_accvgpr_read_b32 v85, a121
    v_accvgpr_read_b32 v86, a122
    v_accvgpr_read_b32 v87, a123
    v_cvt_pk_bf16_f32 v82, v84, v85
    v_cvt_pk_bf16_f32 v83, v86, v87
    s_add_u32 s54, s52, 26624
    buffer_store_dwordx4 v[80:83], v18, s[8:11], s54 offen sc1
    v_accvgpr_read_b32 v100, a152
    v_accvgpr_read_b32 v101, a153
    v_accvgpr_read_b32 v102, a154
    v_accvgpr_read_b32 v103, a155
    v_cvt_pk_bf16_f32 v96, v100, v101
    v_cvt_pk_bf16_f32 v97, v102, v103
    v_accvgpr_read_b32 v100, a184
    v_accvgpr_read_b32 v101, a185
    v_accvgpr_read_b32 v102, a186
    v_accvgpr_read_b32 v103, a187
    v_cvt_pk_bf16_f32 v98, v100, v101
    v_cvt_pk_bf16_f32 v99, v102, v103
    s_add_u32 s54, s52, 28672
    buffer_store_dwordx4 v[96:99], v18, s[8:11], s54 offen sc1
    v_accvgpr_read_b32 v116, a216
    v_accvgpr_read_b32 v117, a217
    v_accvgpr_read_b32 v118, a218
    v_accvgpr_read_b32 v119, a219
    v_cvt_pk_bf16_f32 v112, v116, v117
    v_cvt_pk_bf16_f32 v113, v118, v119
    v_accvgpr_read_b32 v116, a248
    v_accvgpr_read_b32 v117, a249
    v_accvgpr_read_b32 v118, a250
    v_accvgpr_read_b32 v119, a251
    v_cvt_pk_bf16_f32 v114, v116, v117
    v_cvt_pk_bf16_f32 v115, v118, v119
    s_add_u32 s54, s52, 30720
    buffer_store_dwordx4 v[112:115], v18, s[8:11], s54 offen sc1
    v_accvgpr_read_b32 v68, a28
    v_accvgpr_read_b32 v69, a29
    v_accvgpr_read_b32 v70, a30
    v_accvgpr_read_b32 v71, a31
    v_cvt_pk_bf16_f32 v66, v68, v69
    v_cvt_pk_bf16_f32 v67, v70, v71
    v_accvgpr_read_b32 v68, a60
    v_accvgpr_read_b32 v69, a61
    v_accvgpr_read_b32 v70, a62
    v_accvgpr_read_b32 v71, a63
    v_cvt_pk_bf16_f32 v64, v68, v69
    v_cvt_pk_bf16_f32 v65, v70, v71
    s_add_u32 s54, s52, 25600
    buffer_store_dwordx4 v[64:67], v18, s[8:11], s54 offen sc1
    v_accvgpr_read_b32 v84, a92
    v_accvgpr_read_b32 v85, a93
    v_accvgpr_read_b32 v86, a94
    v_accvgpr_read_b32 v87, a95
    v_cvt_pk_bf16_f32 v82, v84, v85
    v_cvt_pk_bf16_f32 v83, v86, v87
    v_accvgpr_read_b32 v84, a124
    v_accvgpr_read_b32 v85, a125
    v_accvgpr_read_b32 v86, a126
    v_accvgpr_read_b32 v87, a127
    v_cvt_pk_bf16_f32 v80, v84, v85
    v_cvt_pk_bf16_f32 v81, v86, v87
    s_add_u32 s54, s52, 27648
    buffer_store_dwordx4 v[80:83], v18, s[8:11], s54 offen sc1
    v_accvgpr_read_b32 v100, a156
    v_accvgpr_read_b32 v101, a157
    v_accvgpr_read_b32 v102, a158
    v_accvgpr_read_b32 v103, a159
    v_cvt_pk_bf16_f32 v98, v100, v101
    v_cvt_pk_bf16_f32 v99, v102, v103
    v_accvgpr_read_b32 v100, a188
    v_accvgpr_read_b32 v101, a189
    v_accvgpr_read_b32 v102, a190
    v_accvgpr_read_b32 v103, a191
    v_cvt_pk_bf16_f32 v96, v100, v101
    v_cvt_pk_bf16_f32 v97, v102, v103
    s_add_u32 s54, s52, 29696
    buffer_store_dwordx4 v[96:99], v18, s[8:11], s54 offen sc1
    v_accvgpr_read_b32 v116, a220
    v_accvgpr_read_b32 v117, a221
    v_accvgpr_read_b32 v118, a222
    v_accvgpr_read_b32 v119, a223
    v_cvt_pk_bf16_f32 v114, v116, v117
    v_cvt_pk_bf16_f32 v115, v118, v119
    v_accvgpr_read_b32 v116, a252
    v_accvgpr_read_b32 v117, a253
    v_accvgpr_read_b32 v118, a254
    v_accvgpr_read_b32 v119, a255
    v_cvt_pk_bf16_f32 v112, v116, v117
    v_cvt_pk_bf16_f32 v113, v118, v119
    s_add_u32 s54, s52, 31744
    buffer_store_dwordx4 v[112:115], v18, s[8:11], s54 offen sc1
    s_branch W_DONE
W_tv:
    s_mov_b64 s[12:13], s[28:29]
    s_mov_b32 s14, 4718592
    s_mov_b32 s63, 8192
    v_and_b32 v1, 63, v0
    v_lshrrev_b32 v2, 4, v1
    v_lshlrev_b32 v18, 4, v1
    s_lshr_b32 s54, s3, 1
    s_lshl_b32 s54, s54, 13
    v_add_u32 v8, s54, v18
    v_bfe_u32 v3, v1, 2, 2
    v_and_b32 v4, 3, v1
    v_and_b32 v5, 1, v2
    v_lshl_add_u32 v5, v5, 2, v3
    v_lshlrev_b32 v6, 12, v2
    v_lshl_add_u32 v6, v3, 9, v6
    v_lshl_add_u32 v6, v4, 3, v6
    v_add_u32 v6, 16384, v6
    s_and_b32 s54, s3, 1
    s_mul_i32 s54, s54, 8
    s_add_u32 s55, s54, 0
    v_xor_b32 v7, s55, v5
    v_lshl_add_u32 v10, v7, 5, v6
    s_add_u32 s55, s54, 1
    v_xor_b32 v7, s55, v5
    v_lshl_add_u32 v11, v7, 5, v6
    s_add_u32 s55, s54, 2
    v_xor_b32 v7, s55, v5
    v_lshl_add_u32 v12, v7, 5, v6
    s_add_u32 s55, s54, 3
    v_xor_b32 v7, s55, v5
    v_lshl_add_u32 v13, v7, 5, v6
    s_add_u32 s55, s54, 4
    v_xor_b32 v7, s55, v5
    v_lshl_add_u32 v14, v7, 5, v6
    s_add_u32 s55, s54, 5
    v_xor_b32 v7, s55, v5
    v_lshl_add_u32 v15, v7, 5, v6
    s_add_u32 s55, s54, 6
    v_xor_b32 v7, s55, v5
    v_lshl_add_u32 v16, v7, 5, v6
    s_add_u32 s55, s54, 7
    v_xor_b32 v7, s55, v5
    v_lshl_add_u32 v17, v7, 5, v6
    s_and_b32 s54, s3, 1
    s_lshl_b32 s54, s54, 1
    s_lshr_b32 s55, s3, 1
    s_lshl_b32 s55, s55, 2
    s_or_b32 s54, s54, s55
    v_lshrrev_b32 v3, 5, v1
    v_or_b32 v4, s54, v3
    v_lshlrev_b32 v4, 1, v4
    v_and_b32 v5, 31, v1
    v_xor_b32 v4, v4, v5
    v_mul_lo_u32 v3, v3, s63
    v_lshl_add_u32 v19, v4, 4, v3
    s_mul_i32 s64, s60, 294912
    s_add_u32 s64, s64, 0
    s_lshl_b32 s65, s61, 9
    s_mul_i32 s54, s3, 73728
    s_add_u32 s54, s54, s64
    s_add_u32 s40, s54, 0
    s_add_u32 s41, s54, 18432
    s_add_u32 s42, s54, 36864
    s_add_u32 s43, s54, 55296
    s_and_b32 s54, s3, 1
    s_lshl_b32 s54, s54, 1
    s_lshr_b32 s55, s3, 1
    s_mul_i32 s55, s55, 8
    s_add_u32 s54, s54, s55
    s_add_u32 s55, s54, 0
    s_mul_i32 s55, s55, s63
    s_add_u32 s44, s55, s65
    s_add_u32 s55, s54, 4
    s_mul_i32 s55, s55, s63
    s_add_u32 s45, s55, s65
    s_add_u32 s55, s54, 16
    s_mul_i32 s55, s55, s63
    s_add_u32 s46, s55, s65
    s_add_u32 s55, s54, 20
    s_mul_i32 s55, s55, s63
    s_add_u32 s47, s55, s65
    s_lshl_b32 s50, s63, 5
    s_lshl_b32 s48, s3, 12
    s_and_b32 s54, s3, 1
    s_lshl_b32 s54, s54, 10
    s_lshr_b32 s55, s3, 1
    s_lshl_b32 s55, s55, 12
    s_add_u32 s49, s54, s55
    s_add_u32 s49, s49, 16384
    s_add_u32 m0, s48, 0
    s_nop 0
    buffer_load_dwordx4 v18, s[8:11], s40 offen  lds
    s_add_u32 s40, s40, 1024
    s_add_u32 m0, s48, 1024
    s_nop 0
    buffer_load_dwordx4 v18, s[8:11], s41 offen  lds
    s_add_u32 s41, s41, 1024
    s_add_u32 m0, s48, 2048
    s_nop 0
    buffer_load_dwordx4 v18, s[8:11], s42 offen  lds
    s_add_u32 s42, s42, 1024
    s_add_u32 m0, s48, 3072
    s_nop 0
    buffer_load_dwordx4 v18, s[8:11], s43 offen  lds
    s_add_u32 s43, s43, 1024
    s_add_u32 s48, s48, 32768
    s_and_b32 s48, s48, 0x1ffff
    s_add_u32 m0, s49, 0
    s_nop 0
    buffer_load_dwordx4 v19, s[12:15], s44 offen lds
    s_add_u32 s44, s44, s50
    s_add_u32 m0, s49, 2048
    s_nop 0
    buffer_load_dwordx4 v19, s[12:15], s45 offen lds
    s_add_u32 s45, s45, s50
    s_add_u32 m0, s49, 8192
    s_nop 0
    buffer_load_dwordx4 v19, s[12:15], s46 offen lds
    s_add_u32 s46, s46, s50
    s_add_u32 m0, s49, 10240
    s_nop 0
    buffer_load_dwordx4 v19, s[12:15], s47 offen lds
    s_add_u32 s47, s47, s50
    s_add_u32 s49, s49, 32768
    s_and_b32 s49, s49, 0x1ffff
    s_add_u32 m0, s48, 0
    s_nop 0
    buffer_load_dwordx4 v18, s[8:11], s40 offen  lds
    s_add_u32 s40, s40, 1024
    s_add_u32 m0, s48, 1024
    s_nop 0
    buffer_load_dwordx4 v18, s[8:11], s41 offen  lds
    s_add_u32 s41, s41, 1024
    s_add_u32 m0, s48, 2048
    s_nop 0
    buffer_load_dwordx4 v18, s[8:11], s42 offen  lds
    s_add_u32 s42, s42, 1024
    s_add_u32 m0, s48, 3072
    s_nop 0
    buffer_load_dwordx4 v18, s[8:11], s43 offen  lds
    s_add_u32 s43, s43, 1024
    s_add_u32 s48, s48, 32768
    s_and_b32 s48, s48, 0x1ffff
    s_add_u32 m0, s49, 0
    s_nop 0
    buffer_load_dwordx4 v19, s[12:15], s44 offen lds
    s_add_u32 s44, s44, s50
    s_add_u32 m0, s49, 2048
    s_nop 0
    buffer_load_dwordx4 v19, s[12:15], s45 offen lds
    s_add_u32 s45, s45, s50
    s_add_u32 m0, s49, 8192
    s_nop 0
    buffer_load_dwordx4 v19, s[12:15], s46 offen lds
    s_add_u32 s46, s46, s50
    s_add_u32 m0, s49, 10240
    s_nop 0
    buffer_load_dwordx4 v19, s[12:15], s47 offen lds
    s_add_u32 s47, s47, s50
    s_add_u32 s49, s49, 32768
    s_and_b32 s49, s49, 0x1ffff
    s_add_u32 m0, s48, 0
    s_nop 0
    buffer_load_dwordx4 v18, s[8:11], s40 offen  lds
    s_add_u32 s40, s40, 1024
    s_add_u32 m0, s48, 1024
    s_nop 0
    buffer_load_dwordx4 v18, s[8:11], s41 offen  lds
    s_add_u32 s41, s41, 1024
    s_add_u32 m0, s48, 2048
    s_nop 0
    buffer_load_dwordx4 v18, s[8:11], s42 offen  lds
    s_add_u32 s42, s42, 1024
    s_add_u32 m0, s48, 3072
    s_nop 0
    buffer_load_dwordx4 v18, s[8:11], s43 offen  lds
    s_add_u32 s43, s43, 1024
    s_add_u32 s48, s48, 32768
    s_and_b32 s48, s48, 0x1ffff
    s_add_u32 m0, s49, 0
    s_nop 0
    buffer_load_dwordx4 v19, s[12:15], s44 offen lds
    s_add_u32 s44, s44, s50
    s_add_u32 m0, s49, 2048
    s_nop 0
    buffer_load_dwordx4 v19, s[12:15], s45 offen lds
    s_add_u32 s45, s45, s50
    s_add_u32 m0, s49, 8192
    s_nop 0
    buffer_load_dwordx4 v19, s[12:15], s46 offen lds
    s_add_u32 s46, s46, s50
    s_add_u32 m0, s49, 10240
    s_nop 0
    buffer_load_dwordx4 v19, s[12:15], s47 offen lds
    s_add_u32 s47, s47, s50
    s_add_u32 s49, s49, 32768
    s_and_b32 s49, s49, 0x1ffff
    s_add_u32 m0, s48, 0
    s_nop 0
    buffer_load_dwordx4 v18, s[8:11], s40 offen  lds
    s_add_u32 s40, s40, 1024
    s_add_u32 m0, s48, 1024
    s_nop 0
    buffer_load_dwordx4 v18, s[8:11], s41 offen  lds
    s_add_u32 s41, s41, 1024
    s_add_u32 m0, s48, 2048
    s_nop 0
    buffer_load_dwordx4 v18, s[8:11], s42 offen  lds
    s_add_u32 s42, s42, 1024
    s_add_u32 m0, s48, 3072
    s_nop 0
    buffer_load_dwordx4 v18, s[8:11], s43 offen  lds
    s_add_u32 s43, s43, 1024
    s_add_u32 s48, s48, 32768
    s_and_b32 s48, s48, 0x1ffff
    s_add_u32 m0, s49, 0
    s_nop 0
    buffer_load_dwordx4 v19, s[12:15], s44 offen lds
    s_add_u32 s44, s44, s50
    s_add_u32 m0, s49, 2048
    s_nop 0
    buffer_load_dwordx4 v19, s[12:15], s45 offen lds
    s_add_u32 s45, s45, s50
    s_add_u32 m0, s49, 8192
    s_nop 0
    buffer_load_dwordx4 v19, s[12:15], s46 offen lds
    s_add_u32 s46, s46, s50
    s_add_u32 m0, s49, 10240
    s_nop 0
    buffer_load_dwordx4 v19, s[12:15], s47 offen lds
    s_add_u32 s47, s47, s50
    s_add_u32 s49, s49, 32768
    s_and_b32 s49, s49, 0x1ffff
    v_accvgpr_write_b32 a0, 0
    v_accvgpr_write_b32 a1, 0
    v_accvgpr_write_b32 a2, 0
    v_accvgpr_write_b32 a3, 0
    v_accvgpr_write_b32 a4, 0
    v_accvgpr_write_b32 a5, 0
    v_accvgpr_write_b32 a6, 0
    v_accvgpr_write_b32 a7, 0
    v_accvgpr_write_b32 a8, 0
    v_accvgpr_write_b32 a9, 0
    v_accvgpr_write_b32 a10, 0
    v_accvgpr_write_b32 a11, 0
    v_accvgpr_write_b32 a12, 0
    v_accvgpr_write_b32 a13, 0
    v_accvgpr_write_b32 a14, 0
    v_accvgpr_write_b32 a15, 0
    v_accvgpr_write_b32 a16, 0
    v_accvgpr_write_b32 a17, 0
    v_accvgpr_write_b32 a18, 0
    v_accvgpr_write_b32 a19, 0
    v_accvgpr_write_b32 a20, 0
    v_accvgpr_write_b32 a21, 0
    v_accvgpr_write_b32 a22, 0
    v_accvgpr_write_b32 a23, 0
    v_accvgpr_write_b32 a24, 0
    v_accvgpr_write_b32 a25, 0
    v_accvgpr_write_b32 a26, 0
    v_accvgpr_write_b32 a27, 0
    v_accvgpr_write_b32 a28, 0
    v_accvgpr_write_b32 a29, 0
    v_accvgpr_write_b32 a30, 0
    v_accvgpr_write_b32 a31, 0
    v_accvgpr_write_b32 a32, 0
    v_accvgpr_write_b32 a33, 0
    v_accvgpr_write_b32 a34, 0
    v_accvgpr_write_b32 a35, 0
    v_accvgpr_write_b32 a36, 0
    v_accvgpr_write_b32 a37, 0
    v_accvgpr_write_b32 a38, 0
    v_accvgpr_write_b32 a39, 0
    v_accvgpr_write_b32 a40, 0
    v_accvgpr_write_b32 a41, 0
    v_accvgpr_write_b32 a42, 0
    v_accvgpr_write_b32 a43, 0
    v_accvgpr_write_b32 a44, 0
    v_accvgpr_write_b32 a45, 0
    v_accvgpr_write_b32 a46, 0
    v_accvgpr_write_b32 a47, 0
    v_accvgpr_write_b32 a48, 0
    v_accvgpr_write_b32 a49, 0
    v_accvgpr_write_b32 a50, 0
    v_accvgpr_write_b32 a51, 0
    v_accvgpr_write_b32 a52, 0
    v_accvgpr_write_b32 a53, 0
    v_accvgpr_write_b32 a54, 0
    v_accvgpr_write_b32 a55, 0
    v_accvgpr_write_b32 a56, 0
    v_accvgpr_write_b32 a57, 0
    v_accvgpr_write_b32 a58, 0
    v_accvgpr_write_b32 a59, 0
    v_accvgpr_write_b32 a60, 0
    v_accvgpr_write_b32 a61, 0
    v_accvgpr_write_b32 a62, 0
    v_accvgpr_write_b32 a63, 0
    v_accvgpr_write_b32 a64, 0
    v_accvgpr_write_b32 a65, 0
    v_accvgpr_write_b32 a66, 0
    v_accvgpr_write_b32 a67, 0
    v_accvgpr_write_b32 a68, 0
    v_accvgpr_write_b32 a69, 0
    v_accvgpr_write_b32 a70, 0
    v_accvgpr_write_b32 a71, 0
    v_accvgpr_write_b32 a72, 0
    v_accvgpr_write_b32 a73, 0
    v_accvgpr_write_b32 a74, 0
    v_accvgpr_write_b32 a75, 0
    v_accvgpr_write_b32 a76, 0
    v_accvgpr_write_b32 a77, 0
    v_accvgpr_write_b32 a78, 0
    v_accvgpr_write_b32 a79, 0
    v_accvgpr_write_b32 a80, 0
    v_accvgpr_write_b32 a81, 0
    v_accvgpr_write_b32 a82, 0
    v_accvgpr_write_b32 a83, 0
    v_accvgpr_write_b32 a84, 0
    v_accvgpr_write_b32 a85, 0
    v_accvgpr_write_b32 a86, 0
    v_accvgpr_write_b32 a87, 0
    v_accvgpr_write_b32 a88, 0
    v_accvgpr_write_b32 a89, 0
    v_accvgpr_write_b32 a90, 0
    v_accvgpr_write_b32 a91, 0
    v_accvgpr_write_b32 a92, 0
    v_accvgpr_write_b32 a93, 0
    v_accvgpr_write_b32 a94, 0
    v_accvgpr_write_b32 a95, 0
    v_accvgpr_write_b32 a96, 0
    v_accvgpr_write_b32 a97, 0
    v_accvgpr_write_b32 a98, 0
    v_accvgpr_write_b32 a99, 0
    v_accvgpr_write_b32 a100, 0
    v_accvgpr_write_b32 a101, 0
    v_accvgpr_write_b32 a102, 0
    v_accvgpr_write_b32 a103, 0
    v_accvgpr_write_b32 a104, 0
    v_accvgpr_write_b32 a105, 0
    v_accvgpr_write_b32 a106, 0
    v_accvgpr_write_b32 a107, 0
    v_accvgpr_write_b32 a108, 0
    v_accvgpr_write_b32 a109, 0
    v_accvgpr_write_b32 a110, 0
    v_accvgpr_write_b32 a111, 0
    v_accvgpr_write_b32 a112, 0
    v_accvgpr_write_b32 a113, 0
    v_accvgpr_write_b32 a114, 0
    v_accvgpr_write_b32 a115, 0
    v_accvgpr_write_b32 a116, 0
    v_accvgpr_write_b32 a117, 0
    v_accvgpr_write_b32 a118, 0
    v_accvgpr_write_b32 a119, 0
    v_accvgpr_write_b32 a120, 0
    v_accvgpr_write_b32 a121, 0
    v_accvgpr_write_b32 a122, 0
    v_accvgpr_write_b32 a123, 0
    v_accvgpr_write_b32 a124, 0
    v_accvgpr_write_b32 a125, 0
    v_accvgpr_write_b32 a126, 0
    v_accvgpr_write_b32 a127, 0
    v_accvgpr_write_b32 a128, 0
    v_accvgpr_write_b32 a129, 0
    v_accvgpr_write_b32 a130, 0
    v_accvgpr_write_b32 a131, 0
    v_accvgpr_write_b32 a132, 0
    v_accvgpr_write_b32 a133, 0
    v_accvgpr_write_b32 a134, 0
    v_accvgpr_write_b32 a135, 0
    v_accvgpr_write_b32 a136, 0
    v_accvgpr_write_b32 a137, 0
    v_accvgpr_write_b32 a138, 0
    v_accvgpr_write_b32 a139, 0
    v_accvgpr_write_b32 a140, 0
    v_accvgpr_write_b32 a141, 0
    v_accvgpr_write_b32 a142, 0
    v_accvgpr_write_b32 a143, 0
    v_accvgpr_write_b32 a144, 0
    v_accvgpr_write_b32 a145, 0
    v_accvgpr_write_b32 a146, 0
    v_accvgpr_write_b32 a147, 0
    v_accvgpr_write_b32 a148, 0
    v_accvgpr_write_b32 a149, 0
    v_accvgpr_write_b32 a150, 0
    v_accvgpr_write_b32 a151, 0
    v_accvgpr_write_b32 a152, 0
    v_accvgpr_write_b32 a153, 0
    v_accvgpr_write_b32 a154, 0
    v_accvgpr_write_b32 a155, 0
    v_accvgpr_write_b32 a156, 0
    v_accvgpr_write_b32 a157, 0
    v_accvgpr_write_b32 a158, 0
    v_accvgpr_write_b32 a159, 0
    v_accvgpr_write_b32 a160, 0
    v_accvgpr_write_b32 a161, 0
    v_accvgpr_write_b32 a162, 0
    v_accvgpr_write_b32 a163, 0
    v_accvgpr_write_b32 a164, 0
    v_accvgpr_write_b32 a165, 0
    v_accvgpr_write_b32 a166, 0
    v_accvgpr_write_b32 a167, 0
    v_accvgpr_write_b32 a168, 0
    v_accvgpr_write_b32 a169, 0
    v_accvgpr_write_b32 a170, 0
    v_accvgpr_write_b32 a171, 0
    v_accvgpr_write_b32 a172, 0
    v_accvgpr_write_b32 a173, 0
    v_accvgpr_write_b32 a174, 0
    v_accvgpr_write_b32 a175, 0
    v_accvgpr_write_b32 a176, 0
    v_accvgpr_write_b32 a177, 0
    v_accvgpr_write_b32 a178, 0
    v_accvgpr_write_b32 a179, 0
    v_accvgpr_write_b32 a180, 0
    v_accvgpr_write_b32 a181, 0
    v_accvgpr_write_b32 a182, 0
    v_accvgpr_write_b32 a183, 0
    v_accvgpr_write_b32 a184, 0
    v_accvgpr_write_b32 a185, 0
    v_accvgpr_write_b32 a186, 0
    v_accvgpr_write_b32 a187, 0
    v_accvgpr_write_b32 a188, 0
    v_accvgpr_write_b32 a189, 0
    v_accvgpr_write_b32 a190, 0
    v_accvgpr_write_b32 a191, 0
    v_accvgpr_write_b32 a192, 0
    v_accvgpr_write_b32 a193, 0
    v_accvgpr_write_b32 a194, 0
    v_accvgpr_write_b32 a195, 0
    v_accvgpr_write_b32 a196, 0
    v_accvgpr_write_b32 a197, 0
    v_accvgpr_write_b32 a198, 0
    v_accvgpr_write_b32 a199, 0
    v_accvgpr_write_b32 a200, 0
    v_accvgpr_write_b32 a201, 0
    v_accvgpr_write_b32 a202, 0
    v_accvgpr_write_b32 a203, 0
    v_accvgpr_write_b32 a204, 0
    v_accvgpr_write_b32 a205, 0
    v_accvgpr_write_b32 a206, 0
    v_accvgpr_write_b32 a207, 0
    v_accvgpr_write_b32 a208, 0
    v_accvgpr_write_b32 a209, 0
    v_accvgpr_write_b32 a210, 0
    v_accvgpr_write_b32 a211, 0
    v_accvgpr_write_b32 a212, 0
    v_accvgpr_write_b32 a213, 0
    v_accvgpr_write_b32 a214, 0
    v_accvgpr_write_b32 a215, 0
    v_accvgpr_write_b32 a216, 0
    v_accvgpr_write_b32 a217, 0
    v_accvgpr_write_b32 a218, 0
    v_accvgpr_write_b32 a219, 0
    v_accvgpr_write_b32 a220, 0
    v_accvgpr_write_b32 a221, 0
    v_accvgpr_write_b32 a222, 0
    v_accvgpr_write_b32 a223, 0
    v_accvgpr_write_b32 a224, 0
    v_accvgpr_write_b32 a225, 0
    v_accvgpr_write_b32 a226, 0
    v_accvgpr_write_b32 a227, 0
    v_accvgpr_write_b32 a228, 0
    v_accvgpr_write_b32 a229, 0
    v_accvgpr_write_b32 a230, 0
    v_accvgpr_write_b32 a231, 0
    v_accvgpr_write_b32 a232, 0
    v_accvgpr_write_b32 a233, 0
    v_accvgpr_write_b32 a234, 0
    v_accvgpr_write_b32 a235, 0
    v_accvgpr_write_b32 a236, 0
    v_accvgpr_write_b32 a237, 0
    v_accvgpr_write_b32 a238, 0
    v_accvgpr_write_b32 a239, 0
    v_accvgpr_write_b32 a240, 0
    v_accvgpr_write_b32 a241, 0
    v_accvgpr_write_b32 a242, 0
    v_accvgpr_write_b32 a243, 0
    v_accvgpr_write_b32 a244, 0
    v_accvgpr_write_b32 a245, 0
    v_accvgpr_write_b32 a246, 0
    v_accvgpr_write_b32 a247, 0
    v_accvgpr_write_b32 a248, 0
    v_accvgpr_write_b32 a249, 0
    v_accvgpr_write_b32 a250, 0
    v_accvgpr_write_b32 a251, 0
    v_accvgpr_write_b32 a252, 0
    v_accvgpr_write_b32 a253, 0
    v_accvgpr_write_b32 a254, 0
    v_accvgpr_write_b32 a255, 0
    s_waitcnt vmcnt(24)
    s_barrier
    ds_read_b64_tr_b16 v[96:97], v10 offset:0
    ds_read_b64_tr_b16 v[98:99], v10 offset:2048
    ds_read_b128 v[64:67], v8 offset:0
    ds_read_b64_tr_b16 v[100:101], v11 offset:0
    ds_read_b64_tr_b16 v[102:103], v11 offset:2048
    ds_read_b128 v[68:71], v8 offset:1024
    ds_read_b64_tr_b16 v[104:105], v12 offset:0
    ds_read_b64_tr_b16 v[106:107], v12 offset:2048
    ds_read_b128 v[72:75], v8 offset:2048
    ds_read_b64_tr_b16 v[108:109], v13 offset:0
    ds_read_b64_tr_b16 v[110:111], v13 offset:2048
    ds_read_b128 v[76:79], v8 offset:3072
    ds_read_b64_tr_b16 v[112:113], v14 offset:0
    ds_read_b64_tr_b16 v[114:115], v14 offset:2048
    ds_read_b128 v[80:83], v8 offset:4096
    ds_read_b64_tr_b16 v[116:117], v15 offset:0
    ds_read_b64_tr_b16 v[118:119], v15 offset:2048
    ds_read_b128 v[84:87], v8 offset:5120
    ds_read_b64_tr_b16 v[120:121], v16 offset:0
    ds_read_b64_tr_b16 v[122:123], v16 offset:2048
    ds_read_b128 v[88:91], v8 offset:6144
    ds_read_b64_tr_b16 v[124:125], v17 offset:0
    ds_read_b64_tr_b16 v[126:127], v17 offset:2048
    ds_read_b128 v[92:95], v8 offset:7168
    s_mov_b32 s51, 7
Gv_loop:
    s_waitcnt vmcnt(16) lgkmcnt(0)
    s_barrier
    v_mfma_f32_16x16x32_bf16 a[0:3], v[64:67], v[96:99], a[0:3]
    ds_read_b64_tr_b16 v[160:161], v10 offset:32768
    v_mfma_f32_16x16x32_bf16 a[4:7], v[68:71], v[96:99], a[4:7]
    ds_read_b64_tr_b16 v[162:163], v10 offset:34816
    v_mfma_f32_16x16x32_bf16 a[8:11], v[72:75], v[96:99], a[8:11]
    ds_read_b128 v[128:131], v8 offset:32768
    s_add_u32 m0, s48, 0
    s_nop 0
    buffer_load_dwordx4 v18, s[8:11], s40 offen  lds
    s_add_u32 s40, s40, 1024
    v_mfma_f32_16x16x32_bf16 a[12:15], v[76:79], v[96:99], a[12:15]
    ds_read_b64_tr_b16 v[164:165], v11 offset:32768
    v_mfma_f32_16x16x32_bf16 a[16:19], v[80:83], v[96:99], a[16:19]
    ds_read_b64_tr_b16 v[166:167], v11 offset:34816
    v_mfma_f32_16x16x32_bf16 a[20:23], v[84:87], v[96:99], a[20:23]
    ds_read_b128 v[132:135], v8 offset:33792
    v_mfma_f32_16x16x32_bf16 a[24:27], v[88:91], v[96:99], a[24:27]
    ds_read_b64_tr_b16 v[168:169], v12 offset:32768
    v_mfma_f32_16x16x32_bf16 a[28:31], v[92:95], v[96:99], a[28:31]
    ds_read_b64_tr_b16 v[170:171], v12 offset:34816
    v_mfma_f32_16x16x32_bf16 a[32:35], v[64:67], v[100:103], a[32:35]
    ds_read_b128 v[136:139], v8 offset:34816
    v_mfma_f32_16x16x32_bf16 a[36:39], v[68:71], v[100:103], a[36:39]
    ds_read_b64_tr_b16 v[172:173], v13 offset:32768
    s_add_u32 m0, s48, 1024
    s_nop 0
    buffer_load_dwordx4 v18, s[8:11], s41 offen  lds
    s_add_u32 s41, s41, 1024
    v_mfma_f32_16x16x32_bf16 a[40:43], v[72:75], v[100:103], a[40:43]
    ds_read_b64_tr_b16 v[174:175], v13 offset:34816
    v_mfma_f32_16x16x32_bf16 a[44:47], v[76:79], v[100:103], a[44:47]
    ds_read_b128 v[140:143], v8 offset:35840
    v_mfma_f32_16x16x32_bf16 a[48:51], v[80:83], v[100:103], a[48:51]
    ds_read_b64_tr_b16 v[176:177], v14 offset:32768
    v_mfma_f32_16x16x32_bf16 a[52:55], v[84:87], v[100:103], a[52:55]
    ds_read_b64_tr_b16 v[178:179], v14 offset:34816
    v_mfma_f32_16x16x32_bf16 a[56:59], v[88:91], v[100:103], a[56:59]
    ds_read_b128 v[144:147], v8 offset:36864
    v_mfma_f32_16x16x32_bf16 a[60:63], v[92:95], v[100:103], a[60:63]
    ds_read_b64_tr_b16 v[180:181], v15 offset:32768
    v_mfma_f32_16x16x32_bf16 a[64:67], v[64:67], v[104:107], a[64:67]
    ds_read_b64_tr_b16 v[182:183], v15 offset:34816
    s_add_u32 m0, s48, 2048
    s_nop 0
    buffer_load_dwordx4 v18, s[8:11], s42 offen  lds
    s_add_u32 s42, s42, 1024
    v_mfma_f32_16x16x32_bf16 a[68:71], v[68:71], v[104:107], a[68:71]
    ds_read_b128 v[148:151], v8 offset:37888
    v_mfma_f32_16x16x32_bf16 a[72:75], v[72:75], v[104:107], a[72:75]
    ds_read_b64_tr_b16 v[184:185], v16 offset:32768
    v_mfma_f32_16x16x32_bf16 a[76:79], v[76:79], v[104:107], a[76:79]
    ds_read_b64_tr_b16 v[186:187], v16 offset:34816
    v_mfma_f32_16x16x32_bf16 a[80:83], v[80:83], v[104:107], a[80:83]
    ds_read_b128 v[152:155], v8 offset:38912
    v_mfma_f32_16x16x32_bf16 a[84:87], v[84:87], v[104:107], a[84:87]
    ds_read_b64_tr_b16 v[188:189], v17 offset:32768
    v_mfma_f32_16x16x32_bf16 a[88:91], v[88:91], v[104:107], a[88:91]
    ds_read_b64_tr_b16 v[190:191], v17 offset:34816
    v_mfma_f32_16x16x32_bf16 a[92:95], v[92:95], v[104:107], a[92:95]
    ds_read_b128 v[156:159], v8 offset:39936
    s_add_u32 m0, s48, 3072
    s_nop 0
    buffer_load_dwordx4 v18, s[8:11], s43 offen  lds
    s_add_u32 s43, s43, 1024
    s_add_u32 s48, s48, 32768
    s_and_b32 s48, s48, 0x1ffff
    v_mfma_f32_16x16x32_bf16 a[96:99], v[64:67], v[108:111], a[96:99]
    v_mfma_f32_16x16x32_bf16 a[100:103], v[68:71], v[108:111], a[100:103]
    v_mfma_f32_16x16x32_bf16 a[104:107], v[72:75], v[108:111], a[104:107]
    v_mfma_f32_16x16x32_bf16 a[108:111], v[76:79], v[108:111], a[108:111]
    v_mfma_f32_16x16x32_bf16 a[112:115], v[80:83], v[108:111], a[112:115]
    v_mfma_f32_16x16x32_bf16 a[116:119], v[84:87], v[108:111], a[116:119]
    v_mfma_f32_16x16x32_bf16 a[120:123], v[88:91], v[108:111], a[120:123]
    s_add_u32 m0, s49, 0
    s_nop 0
    buffer_load_dwordx4 v19, s[12:15], s44 offen lds
    s_add_u32 s44, s44, s50
    v_mfma_f32_16x16x32_bf16 a[124:127], v[92:95], v[108:111], a[124:127]
    v_mfma_f32_16x16x32_bf16 a[128:131], v[64:67], v[112:115], a[128:131]
    v_mfma_f32_16x16x32_bf16 a[132:135], v[68:71], v[112:115], a[132:135]
    v_mfma_f32_16x16x32_bf16 a[136:139], v[72:75], v[112:115], a[136:139]
    v_mfma_f32_16x16x32_bf16 a[140:143], v[76:79], v[112:115], a[140:143]
    v_mfma_f32_16x16x32_bf16 a[144:147], v[80:83], v[112:115], a[144:147]
    v_mfma_f32_16x16x32_bf16 a[148:151], v[84:87], v[112:115], a[148:151]
    s_add_u32 m0, s49, 2048
    s_nop 0
    buffer_load_dwordx4 v19, s[12:15], s45 offen lds
    s_add_u32 s45, s45, s50
    v_mfma_f32_16x16x32_bf16 a[152:155], v[88:91], v[112:115], a[152:155]
    v_mfma_f32_16x16x32_bf16 a[156:159], v[92:95], v[112:115], a[156:159]
    v_mfma_f32_16x16x32_bf16 a[160:163], v[64:67], v[116:119], a[160:163]
    v_mfma_f32_16x16x32_bf16 a[164:167], v[68:71], v[116:119], a[164:167]
    v_mfma_f32_16x16x32_bf16 a[168:171], v[72:75], v[116:119], a[168:171]
    v_mfma_f32_16x16x32_bf16 a[172:175], v[76:79], v[116:119], a[172:175]
    v_mfma_f32_16x16x32_bf16 a[176:179], v[80:83], v[116:119], a[176:179]
    s_add_u32 m0, s49, 8192
    s_nop 0
    buffer_load_dwordx4 v19, s[12:15], s46 offen lds
    s_add_u32 s46, s46, s50
    v_mfma_f32_16x16x32_bf16 a[180:183], v[84:87], v[116:119], a[180:183]
    v_mfma_f32_16x16x32_bf16 a[184:187], v[88:91], v[116:119], a[184:187]
    v_mfma_f32_16x16x32_bf16 a[188:191], v[92:95], v[116:119], a[188:191]
    v_mfma_f32_16x16x32_bf16 a[192:195], v[64:67], v[120:123], a[192:195]
    v_mfma_f32_16x16x32_bf16 a[196:199], v[68:71], v[120:123], a[196:199]
    v_mfma_f32_16x16x32_bf16 a[200:203], v[72:75], v[120:123], a[200:203]
    v_mfma_f32_16x16x32_bf16 a[204:207], v[76:79], v[120:123], a[204:207]
    s_add_u32 m0, s49, 10240
    s_nop 0
    buffer_load_dwordx4 v19, s[12:15], s47 offen lds
    s_add_u32 s47, s47, s50
    s_add_u32 s49, s49, 32768
    s_and_b32 s49, s49, 0x1ffff
    v_mfma_f32_16x16x32_bf16 a[208:211], v[80:83], v[120:123], a[208:211]
    v_mfma_f32_16x16x32_bf16 a[212:215], v[84:87], v[120:123], a[212:215]
    v_mfma_f32_16x16x32_bf16 a[216:219], v[88:91], v[120:123], a[216:219]
    v_mfma_f32_16x16x32_bf16 a[220:223], v[92:95], v[120:123], a[220:223]
    v_mfma_f32_16x16x32_bf16 a[224:227], v[64:67], v[124:127], a[224:227]
    v_mfma_f32_16x16x32_bf16 a[228:231], v[68:71], v[124:127], a[228:231]
    v_mfma_f32_16x16x32_bf16 a[232:235], v[72:75], v[124:127], a[232:235]
    v_mfma_f32_16x16x32_bf16 a[236:239], v[76:79], v[124:127], a[236:239]
    v_mfma_f32_16x16x32_bf16 a[240:243], v[80:83], v[124:127], a[240:243]
    v_mfma_f32_16x16x32_bf16 a[244:247], v[84:87], v[124:127], a[244:247]
    v_mfma_f32_16x16x32_bf16 a[248:251], v[88:91], v[124:127], a[248:251]
    v_mfma_f32_16x16x32_bf16 a[252:255], v[92:95], v[124:127], a[252:255]
    v_xor_b32 v8, 0x10000, v8
    v_xor_b32 v10, 0x10000, v10
    v_xor_b32 v11, 0x10000, v11
    v_xor_b32 v12, 0x10000, v12
    v_xor_b32 v13, 0x10000, v13
    v_xor_b32 v14, 0x10000, v14
    v_xor_b32 v15, 0x10000, v15
    v_xor_b32 v16, 0x10000, v16
    v_xor_b32 v17, 0x10000, v17
    s_waitcnt vmcnt(16) lgkmcnt(0)
    s_barrier
    v_mfma_f32_16x16x32_bf16 a[0:3], v[128:131], v[160:163], a[0:3]
    ds_read_b64_tr_b16 v[96:97], v10 offset:0
    v_mfma_f32_16x16x32_bf16 a[4:7], v[132:135], v[160:163], a[4:7]
    ds_read_b64_tr_b16 v[98:99], v10 offset:2048
    v_mfma_f32_16x16x32_bf16 a[8:11], v[136:139], v[160:163], a[8:11]
    ds_read_b128 v[64:67], v8 offset:0
    s_add_u32 m0, s48, 0
    s_nop 0
    buffer_load_dwordx4 v18, s[8:11], s40 offen  lds
    s_add_u32 s40, s40, 1024
    v_mfma_f32_16x16x32_bf16 a[12:15], v[140:143], v[160:163], a[12:15]
    ds_read_b64_tr_b16 v[100:101], v11 offset:0
    v_mfma_f32_16x16x32_bf16 a[16:19], v[144:147], v[160:163], a[16:19]
    ds_read_b64_tr_b16 v[102:103], v11 offset:2048
    v_mfma_f32_16x16x32_bf16 a[20:23], v[148:151], v[160:163], a[20:23]
    ds_read_b128 v[68:71], v8 offset:1024
    v_mfma_f32_16x16x32_bf16 a[24:27], v[152:155], v[160:163], a[24:27]
    ds_read_b64_tr_b16 v[104:105], v12 offset:0
    v_mfma_f32_16x16x32_bf16 a[28:31], v[156:159], v[160:163], a[28:31]
    ds_read_b64_tr_b16 v[106:107], v12 offset:2048
    v_mfma_f32_16x16x32_bf16 a[32:35], v[128:131], v[164:167], a[32:35]
    ds_read_b128 v[72:75], v8 offset:2048
    v_mfma_f32_16x16x32_bf16 a[36:39], v[132:135], v[164:167], a[36:39]
    ds_read_b64_tr_b16 v[108:109], v13 offset:0
    s_add_u32 m0, s48, 1024
    s_nop 0
    buffer_load_dwordx4 v18, s[8:11], s41 offen  lds
    s_add_u32 s41, s41, 1024
    v_mfma_f32_16x16x32_bf16 a[40:43], v[136:139], v[164:167], a[40:43]
    ds_read_b64_tr_b16 v[110:111], v13 offset:2048
    v_mfma_f32_16x16x32_bf16 a[44:47], v[140:143], v[164:167], a[44:47]
    ds_read_b128 v[76:79], v8 offset:3072
    v_mfma_f32_16x16x32_bf16 a[48:51], v[144:147], v[164:167], a[48:51]
    ds_read_b64_tr_b16 v[112:113], v14 offset:0
    v_mfma_f32_16x16x32_bf16 a[52:55], v[148:151], v[164:167], a[52:55]
    ds_read_b64_tr_b16 v[114:115], v14 offset:2048
    v_mfma_f32_16x16x32_bf16 a[56:59], v[152:155], v[164:167], a[56:59]
    ds_read_b128 v[80:83], v8 offset:4096
    v_mfma_f32_16x16x32_bf16 a[60:63], v[156:159], v[164:167], a[60:63]
    ds_read_b64_tr_b16 v[116:117], v15 offset:0
    v_mfma_f32_16x16x32_bf16 a[64:67], v[128:131], v[168:171], a[64:67]
    ds_read_b64_tr_b16 v[118:119], v15 offset:2048
    s_add_u32 m0, s48, 2048
    s_nop 0
    buffer_load_dwordx4 v18, s[8:11], s42 offen  lds
    s_add_u32 s42, s42, 1024
    v_mfma_f32_16x16x32_bf16 a[68:71], v[132:135], v[168:171], a[68:71]
    ds_read_b128 v[84:87], v8 offset:5120
    v_mfma_f32_16x16x32_bf16 a[72:75], v[136:139], v[168:171], a[72:75]
    ds_read_b64_tr_b16 v[120:121], v16 offset:0
    v_mfma_f32_16x16x32_bf16 a[76:79], v[140:143], v[168:171], a[76:79]
    ds_read_b64_tr_b16 v[122:123], v16 offset:2048
    v_mfma_f32_16x16x32_bf16 a[80:83], v[144:147], v[168:171], a[80:83]
    ds_read_b128 v[88:91], v8 offset:6144
    v_mfma_f32_16x16x32_bf16 a[84:87], v[148:151], v[168:171], a[84:87]
    ds_read_b64_tr_b16 v[124:125], v17 offset:0
    v_mfma_f32_16x16x32_bf16 a[88:91], v[152:155], v[168:171], a[88:91]
    ds_read_b64_tr_b16 v[126:127], v17 offset:2048
    v_mfma_f32_16x16x32_bf16 a[92:95], v[156:159], v[168:171], a[92:95]
    ds_read_b128 v[92:95], v8 offset:7168
    s_add_u32 m0, s48, 3072
    s_nop 0
    buffer_load_dwordx4 v18, s[8:11], s43 offen  lds
    s_add_u32 s43, s43, 1024
    s_add_u32 s48, s48, 32768
    s_and_b32 s48, s48, 0x1ffff
    v_mfma_f32_16x16x32_bf16 a[96:99], v[128:131], v[172:175], a[96:99]
    v_mfma_f32_16x16x32_bf16 a[100:103], v[132:135], v[172:175], a[100:103]
    v_mfma_f32_16x16x32_bf16 a[104:107], v[136:139], v[172:175], a[104:107]
    v_mfma_f32_16x16x32_bf16 a[108:111], v[140:143], v[172:175], a[108:111]
    v_mfma_f32_16x16x32_bf16 a[112:115], v[144:147], v[172:175], a[112:115]
    v_mfma_f32_16x16x32_bf16 a[116:119], v[148:151], v[172:175], a[116:119]
    v_mfma_f32_16x16x32_bf16 a[120:123], v[152:155], v[172:175], a[120:123]
    s_add_u32 m0, s49, 0
    s_nop 0
    buffer_load_dwordx4 v19, s[12:15], s44 offen lds
    s_add_u32 s44, s44, s50
    v_mfma_f32_16x16x32_bf16 a[124:127], v[156:159], v[172:175], a[124:127]
    v_mfma_f32_16x16x32_bf16 a[128:131], v[128:131], v[176:179], a[128:131]
    v_mfma_f32_16x16x32_bf16 a[132:135], v[132:135], v[176:179], a[132:135]
    v_mfma_f32_16x16x32_bf16 a[136:139], v[136:139], v[176:179], a[136:139]
    v_mfma_f32_16x16x32_bf16 a[140:143], v[140:143], v[176:179], a[140:143]
    v_mfma_f32_16x16x32_bf16 a[144:147], v[144:147], v[176:179], a[144:147]
    v_mfma_f32_16x16x32_bf16 a[148:151], v[148:151], v[176:179], a[148:151]
    s_add_u32 m0, s49, 2048
    s_nop 0
    buffer_load_dwordx4 v19, s[12:15], s45 offen lds
    s_add_u32 s45, s45, s50
    v_mfma_f32_16x16x32_bf16 a[152:155], v[152:155], v[176:179], a[152:155]
    v_mfma_f32_16x16x32_bf16 a[156:159], v[156:159], v[176:179], a[156:159]
    v_mfma_f32_16x16x32_bf16 a[160:163], v[128:131], v[180:183], a[160:163]
    v_mfma_f32_16x16x32_bf16 a[164:167], v[132:135], v[180:183], a[164:167]
    v_mfma_f32_16x16x32_bf16 a[168:171], v[136:139], v[180:183], a[168:171]
    v_mfma_f32_16x16x32_bf16 a[172:175], v[140:143], v[180:183], a[172:175]
    v_mfma_f32_16x16x32_bf16 a[176:179], v[144:147], v[180:183], a[176:179]
    s_add_u32 m0, s49, 8192
    s_nop 0
    buffer_load_dwordx4 v19, s[12:15], s46 offen lds
    s_add_u32 s46, s46, s50
    v_mfma_f32_16x16x32_bf16 a[180:183], v[148:151], v[180:183], a[180:183]
    v_mfma_f32_16x16x32_bf16 a[184:187], v[152:155], v[180:183], a[184:187]
    v_mfma_f32_16x16x32_bf16 a[188:191], v[156:159], v[180:183], a[188:191]
    v_mfma_f32_16x16x32_bf16 a[192:195], v[128:131], v[184:187], a[192:195]
    v_mfma_f32_16x16x32_bf16 a[196:199], v[132:135], v[184:187], a[196:199]
    v_mfma_f32_16x16x32_bf16 a[200:203], v[136:139], v[184:187], a[200:203]
    v_mfma_f32_16x16x32_bf16 a[204:207], v[140:143], v[184:187], a[204:207]
    s_add_u32 m0, s49, 10240
    s_nop 0
    buffer_load_dwordx4 v19, s[12:15], s47 offen lds
    s_add_u32 s47, s47, s50
    s_add_u32 s49, s49, 32768
    s_and_b32 s49, s49, 0x1ffff
    v_mfma_f32_16x16x32_bf16 a[208:211], v[144:147], v[184:187], a[208:211]
    v_mfma_f32_16x16x32_bf16 a[212:215], v[148:151], v[184:187], a[212:215]
    v_mfma_f32_16x16x32_bf16 a[216:219], v[152:155], v[184:187], a[216:219]
    v_mfma_f32_16x16x32_bf16 a[220:223], v[156:159], v[184:187], a[220:223]
    v_mfma_f32_16x16x32_bf16 a[224:227], v[128:131], v[188:191], a[224:227]
    v_mfma_f32_16x16x32_bf16 a[228:231], v[132:135], v[188:191], a[228:231]
    v_mfma_f32_16x16x32_bf16 a[232:235], v[136:139], v[188:191], a[232:235]
    v_mfma_f32_16x16x32_bf16 a[236:239], v[140:143], v[188:191], a[236:239]
    v_mfma_f32_16x16x32_bf16 a[240:243], v[144:147], v[188:191], a[240:243]
    v_mfma_f32_16x16x32_bf16 a[244:247], v[148:151], v[188:191], a[244:247]
    v_mfma_f32_16x16x32_bf16 a[248:251], v[152:155], v[188:191], a[248:251]
    v_mfma_f32_16x16x32_bf16 a[252:255], v[156:159], v[188:191], a[252:255]
    s_sub_u32 s51, s51, 1
    s_cmp_lg_u32 s51, 0
    s_cbranch_scc1 Gv_loop
    s_waitcnt vmcnt(16) lgkmcnt(0)
    s_barrier
    v_mfma_f32_16x16x32_bf16 a[0:3], v[64:67], v[96:99], a[0:3]
    ds_read_b64_tr_b16 v[160:161], v10 offset:32768
    v_mfma_f32_16x16x32_bf16 a[4:7], v[68:71], v[96:99], a[4:7]
    ds_read_b64_tr_b16 v[162:163], v10 offset:34816
    v_mfma_f32_16x16x32_bf16 a[8:11], v[72:75], v[96:99], a[8:11]
    ds_read_b128 v[128:131], v8 offset:32768
    v_mfma_f32_16x16x32_bf16 a[12:15], v[76:79], v[96:99], a[12:15]
    ds_read_b64_tr_b16 v[164:165], v11 offset:32768
    v_mfma_f32_16x16x32_bf16 a[16:19], v[80:83], v[96:99], a[16:19]
    ds_read_b64_tr_b16 v[166:167], v11 offset:34816
    v_mfma_f32_16x16x32_bf16 a[20:23], v[84:87], v[96:99], a[20:23]
    ds_read_b128 v[132:135], v8 offset:33792
    v_mfma_f32_16x16x32_bf16 a[24:27], v[88:91], v[96:99], a[24:27]
    ds_read_b64_tr_b16 v[168:169], v12 offset:32768
    v_mfma_f32_16x16x32_bf16 a[28:31], v[92:95], v[96:99], a[28:31]
    ds_read_b64_tr_b16 v[170:171], v12 offset:34816
    v_mfma_f32_16x16x32_bf16 a[32:35], v[64:67], v[100:103], a[32:35]
    ds_read_b128 v[136:139], v8 offset:34816
    v_mfma_f32_16x16x32_bf16 a[36:39], v[68:71], v[100:103], a[36:39]
    ds_read_b64_tr_b16 v[172:173], v13 offset:32768
    v_mfma_f32_16x16x32_bf16 a[40:43], v[72:75], v[100:103], a[40:43]
    ds_read_b64_tr_b16 v[174:175], v13 offset:34816
    v_mfma_f32_16x16x32_bf16 a[44:47], v[76:79], v[100:103], a[44:47]
    ds_read_b128 v[140:143], v8 offset:35840
    v_mfma_f32_16x16x32_bf16 a[48:51], v[80:83], v[100:103], a[48:51]
    ds_read_b64_tr_b16 v[176:177], v14 offset:32768
    v_mfma_f32_16x16x32_bf16 a[52:55], v[84:87], v[100:103], a[52:55]
    ds_read_b64_tr_b16 v[178:179], v14 offset:34816
    v_mfma_f32_16x16x32_bf16 a[56:59], v[88:91], v[100:103], a[56:59]
    ds_read_b128 v[144:147], v8 offset:36864
    v_mfma_f32_16x16x32_bf16 a[60:63], v[92:95], v[100:103], a[60:63]
    ds_read_b64_tr_b16 v[180:181], v15 offset:32768
    v_mfma_f32_16x16x32_bf16 a[64:67], v[64:67], v[104:107], a[64:67]
    ds_read_b64_tr_b16 v[182:183], v15 offset:34816
    v_mfma_f32_16x16x32_bf16 a[68:71], v[68:71], v[104:107], a[68:71]
    ds_read_b128 v[148:151], v8 offset:37888
    v_mfma_f32_16x16x32_bf16 a[72:75], v[72:75], v[104:107], a[72:75]
    ds_read_b64_tr_b16 v[184:185], v16 offset:32768
    v_mfma_f32_16x16x32_bf16 a[76:79], v[76:79], v[104:107], a[76:79]
    ds_read_b64_tr_b16 v[186:187], v16 offset:34816
    v_mfma_f32_16x16x32_bf16 a[80:83], v[80:83], v[104:107], a[80:83]
    ds_read_b128 v[152:155], v8 offset:38912
    v_mfma_f32_16x16x32_bf16 a[84:87], v[84:87], v[104:107], a[84:87]
    ds_read_b64_tr_b16 v[188:189], v17 offset:32768
    v_mfma_f32_16x16x32_bf16 a[88:91], v[88:91], v[104:107], a[88:91]
    ds_read_b64_tr_b16 v[190:191], v17 offset:34816
    v_mfma_f32_16x16x32_bf16 a[92:95], v[92:95], v[104:107], a[92:95]
    ds_read_b128 v[156:159], v8 offset:39936
    v_mfma_f32_16x16x32_bf16 a[96:99], v[64:67], v[108:111], a[96:99]
    v_mfma_f32_16x16x32_bf16 a[100:103], v[68:71], v[108:111], a[100:103]
    v_mfma_f32_16x16x32_bf16 a[104:107], v[72:75], v[108:111], a[104:107]
    v_mfma_f32_16x16x32_bf16 a[108:111], v[76:79], v[108:111], a[108:111]
    v_mfma_f32_16x16x32_bf16 a[112:115], v[80:83], v[108:111], a[112:115]
    v_mfma_f32_16x16x32_bf16 a[116:119], v[84:87], v[108:111], a[116:119]
    v_mfma_f32_16x16x32_bf16 a[120:123], v[88:91], v[108:111], a[120:123]
    v_mfma_f32_16x16x32_bf16 a[124:127], v[92:95], v[108:111], a[124:127]
    v_mfma_f32_16x16x32_bf16 a[128:131], v[64:67], v[112:115], a[128:131]
    v_mfma_f32_16x16x32_bf16 a[132:135], v[68:71], v[112:115], a[132:135]
    v_mfma_f32_16x16x32_bf16 a[136:139], v[72:75], v[112:115], a[136:139]
    v_mfma_f32_16x16x32_bf16 a[140:143], v[76:79], v[112:115], a[140:143]
    v_mfma_f32_16x16x32_bf16 a[144:147], v[80:83], v[112:115], a[144:147]
    v_mfma_f32_16x16x32_bf16 a[148:151], v[84:87], v[112:115], a[148:151]
    v_mfma_f32_16x16x32_bf16 a[152:155], v[88:91], v[112:115], a[152:155]
    v_mfma_f32_16x16x32_bf16 a[156:159], v[92:95], v[112:115], a[156:159]
    v_mfma_f32_16x16x32_bf16 a[160:163], v[64:67], v[116:119], a[160:163]
    v_mfma_f32_16x16x32_bf16 a[164:167], v[68:71], v[116:119], a[164:167]
    v_mfma_f32_16x16x32_bf16 a[168:171], v[72:75], v[116:119], a[168:171]
    v_mfma_f32_16x16x32_bf16 a[172:175], v[76:79], v[116:119], a[172:175]
    v_mfma_f32_16x16x32_bf16 a[176:179], v[80:83], v[116:119], a[176:179]
    v_mfma_f32_16x16x32_bf16 a[180:183], v[84:87], v[116:119], a[180:183]
    v_mfma_f32_16x16x32_bf16 a[184:187], v[88:91], v[116:119], a[184:187]
    v_mfma_f32_16x16x32_bf16 a[188:191], v[92:95], v[116:119], a[188:191]
    v_mfma_f32_16x16x32_bf16 a[192:195], v[64:67], v[120:123], a[192:195]
    v_mfma_f32_16x16x32_bf16 a[196:199], v[68:71], v[120:123], a[196:199]
    v_mfma_f32_16x16x32_bf16 a[200:203], v[72:75], v[120:123], a[200:203]
    v_mfma_f32_16x16x32_bf16 a[204:207], v[76:79], v[120:123], a[204:207]
    v_mfma_f32_16x16x32_bf16 a[208:211], v[80:83], v[120:123], a[208:211]
    v_mfma_f32_16x16x32_bf16 a[212:215], v[84:87], v[120:123], a[212:215]
    v_mfma_f32_16x16x32_bf16 a[216:219], v[88:91], v[120:123], a[216:219]
    v_mfma_f32_16x16x32_bf16 a[220:223], v[92:95], v[120:123], a[220:223]
    v_mfma_f32_16x16x32_bf16 a[224:227], v[64:67], v[124:127], a[224:227]
    v_mfma_f32_16x16x32_bf16 a[228:231], v[68:71], v[124:127], a[228:231]
    v_mfma_f32_16x16x32_bf16 a[232:235], v[72:75], v[124:127], a[232:235]
    v_mfma_f32_16x16x32_bf16 a[236:239], v[76:79], v[124:127], a[236:239]
    v_mfma_f32_16x16x32_bf16 a[240:243], v[80:83], v[124:127], a[240:243]
    v_mfma_f32_16x16x32_bf16 a[244:247], v[84:87], v[124:127], a[244:247]
    v_mfma_f32_16x16x32_bf16 a[248:251], v[88:91], v[124:127], a[248:251]
    v_mfma_f32_16x16x32_bf16 a[252:255], v[92:95], v[124:127], a[252:255]
    v_xor_b32 v8, 0x10000, v8
    v_xor_b32 v10, 0x10000, v10
    v_xor_b32 v11, 0x10000, v11
    v_xor_b32 v12, 0x10000, v12
    v_xor_b32 v13, 0x10000, v13
    v_xor_b32 v14, 0x10000, v14
    v_xor_b32 v15, 0x10000, v15
    v_xor_b32 v16, 0x10000, v16
    v_xor_b32 v17, 0x10000, v17
    s_waitcnt vmcnt(8) lgkmcnt(0)
    s_barrier
    v_mfma_f32_16x16x32_bf16 a[0:3], v[128:131], v[160:163], a[0:3]
    ds_read_b64_tr_b16 v[96:97], v10 offset:0
    v_mfma_f32_16x16x32_bf16 a[4:7], v[132:135], v[160:163], a[4:7]
    ds_read_b64_tr_b16 v[98:99], v10 offset:2048
    v_mfma_f32_16x16x32_bf16 a[8:11], v[136:139], v[160:163], a[8:11]
    ds_read_b128 v[64:67], v8 offset:0
    v_mfma_f32_16x16x32_bf16 a[12:15], v[140:143], v[160:163], a[12:15]
    ds_read_b64_tr_b16 v[100:101], v11 offset:0
    v_mfma_f32_16x16x32_bf16 a[16:19], v[144:147], v[160:163], a[16:19]
    ds_read_b64_tr_b16 v[102:103], v11 offset:2048
    v_mfma_f32_16x16x32_bf16 a[20:23], v[148:151], v[160:163], a[20:23]
    ds_read_b128 v[68:71], v8 offset:1024
    v_mfma_f32_16x16x32_bf16 a[24:27], v[152:155], v[160:163], a[24:27]
    ds_read_b64_tr_b16 v[104:105], v12 offset:0
    v_mfma_f32_16x16x32_bf16 a[28:31], v[156:159], v[160:163], a[28:31]
    ds_read_b64_tr_b16 v[106:107], v12 offset:2048
    v_mfma_f32_16x16x32_bf16 a[32:35], v[128:131], v[164:167], a[32:35]
    ds_read_b128 v[72:75], v8 offset:2048
    v_mfma_f32_16x16x32_bf16 a[36:39], v[132:135], v[164:167], a[36:39]
    ds_read_b64_tr_b16 v[108:109], v13 offset:0
    v_mfma_f32_16x16x32_bf16 a[40:43], v[136:139], v[164:167], a[40:43]
    ds_read_b64_tr_b16 v[110:111], v13 offset:2048
    v_mfma_f32_16x16x32_bf16 a[44:47], v[140:143], v[164:167], a[44:47]
    ds_read_b128 v[76:79], v8 offset:3072
    v_mfma_f32_16x16x32_bf16 a[48:51], v[144:147], v[164:167], a[48:51]
    ds_read_b64_tr_b16 v[112:113], v14 offset:0
    v_mfma_f32_16x16x32_bf16 a[52:55], v[148:151], v[164:167], a[52:55]
    ds_read_b64_tr_b16 v[114:115], v14 offset:2048
    v_mfma_f32_16x16x32_bf16 a[56:59], v[152:155], v[164:167], a[56:59]
    ds_read_b128 v[80:83], v8 offset:4096
    v_mfma_f32_16x16x32_bf16 a[60:63], v[156:159], v[164:167], a[60:63]
    ds_read_b64_tr_b16 v[116:117], v15 offset:0
    v_mfma_f32_16x16x32_bf16 a[64:67], v[128:131], v[168:171], a[64:67]
    ds_read_b64_tr_b16 v[118:119], v15 offset:2048
    v_mfma_f32_16x16x32_bf16 a[68:71], v[132:135], v[168:171], a[68:71]
    ds_read_b128 v[84:87], v8 offset:5120
    v_mfma_f32_16x16x32_bf16 a[72:75], v[136:139], v[168:171], a[72:75]
    ds_read_b64_tr_b16 v[120:121], v16 offset:0
    v_mfma_f32_16x16x32_bf16 a[76:79], v[140:143], v[168:171], a[76:79]
    ds_read_b64_tr_b16 v[122:123], v16 offset:2048
    v_mfma_f32_16x16x32_bf16 a[80:83], v[144:147], v[168:171], a[80:83]
    ds_read_b128 v[88:91], v8 offset:6144
    v_mfma_f32_16x16x32_bf16 a[84:87], v[148:151], v[168:171], a[84:87]
    ds_read_b64_tr_b16 v[124:125], v17 offset:0
    v_mfma_f32_16x16x32_bf16 a[88:91], v[152:155], v[168:171], a[88:91]
    ds_read_b64_tr_b16 v[126:127], v17 offset:2048
    v_mfma_f32_16x16x32_bf16 a[92:95], v[156:159], v[168:171], a[92:95]
    ds_read_b128 v[92:95], v8 offset:7168
    v_mfma_f32_16x16x32_bf16 a[96:99], v[128:131], v[172:175], a[96:99]
    v_mfma_f32_16x16x32_bf16 a[100:103], v[132:135], v[172:175], a[100:103]
    v_mfma_f32_16x16x32_bf16 a[104:107], v[136:139], v[172:175], a[104:107]
    v_mfma_f32_16x16x32_bf16 a[108:111], v[140:143], v[172:175], a[108:111]
    v_mfma_f32_16x16x32_bf16 a[112:115], v[144:147], v[172:175], a[112:115]
    v_mfma_f32_16x16x32_bf16 a[116:119], v[148:151], v[172:175], a[116:119]
    v_mfma_f32_16x16x32_bf16 a[120:123], v[152:155], v[172:175], a[120:123]
    v_mfma_f32_16x16x32_bf16 a[124:127], v[156:159], v[172:175], a[124:127]
    v_mfma_f32_16x16x32_bf16 a[128:131], v[128:131], v[176:179], a[128:131]
    v_mfma_f32_16x16x32_bf16 a[132:135], v[132:135], v[176:179], a[132:135]
    v_mfma_f32_16x16x32_bf16 a[136:139], v[136:139], v[176:179], a[136:139]
    v_mfma_f32_16x16x32_bf16 a[140:143], v[140:143], v[176:179], a[140:143]
    v_mfma_f32_16x16x32_bf16 a[144:147], v[144:147], v[176:179], a[144:147]
    v_mfma_f32_16x16x32_bf16 a[148:151], v[148:151], v[176:179], a[148:151]
    v_mfma_f32_16x16x32_bf16 a[152:155], v[152:155], v[176:179], a[152:155]
    v_mfma_f32_16x16x32_bf16 a[156:159], v[156:159], v[176:179], a[156:159]
    v_mfma_f32_16x16x32_bf16 a[160:163], v[128:131], v[180:183], a[160:163]
    v_mfma_f32_16x16x32_bf16 a[164:167], v[132:135], v[180:183], a[164:167]
    v_mfma_f32_16x16x32_bf16 a[168:171], v[136:139], v[180:183], a[168:171]
    v_mfma_f32_16x16x32_bf16 a[172:175], v[140:143], v[180:183], a[172:175]
    v_mfma_f32_16x16x32_bf16 a[176:179], v[144:147], v[180:183], a[176:179]
    v_mfma_f32_16x16x32_bf16 a[180:183], v[148:151], v[180:183], a[180:183]
    v_mfma_f32_16x16x32_bf16 a[184:187], v[152:155], v[180:183], a[184:187]
    v_mfma_f32_16x16x32_bf16 a[188:191], v[156:159], v[180:183], a[188:191]
    v_mfma_f32_16x16x32_bf16 a[192:195], v[128:131], v[184:187], a[192:195]
    v_mfma_f32_16x16x32_bf16 a[196:199], v[132:135], v[184:187], a[196:199]
    v_mfma_f32_16x16x32_bf16 a[200:203], v[136:139], v[184:187], a[200:203]
    v_mfma_f32_16x16x32_bf16 a[204:207], v[140:143], v[184:187], a[204:207]
    v_mfma_f32_16x16x32_bf16 a[208:211], v[144:147], v[184:187], a[208:211]
    v_mfma_f32_16x16x32_bf16 a[212:215], v[148:151], v[184:187], a[212:215]
    v_mfma_f32_16x16x32_bf16 a[216:219], v[152:155], v[184:187], a[216:219]
    v_mfma_f32_16x16x32_bf16 a[220:223], v[156:159], v[184:187], a[220:223]
    v_mfma_f32_16x16x32_bf16 a[224:227], v[128:131], v[188:191], a[224:227]
    v_mfma_f32_16x16x32_bf16 a[228:231], v[132:135], v[188:191], a[228:231]
    v_mfma_f32_16x16x32_bf16 a[232:235], v[136:139], v[188:191], a[232:235]
    v_mfma_f32_16x16x32_bf16 a[236:239], v[140:143], v[188:191], a[236:239]
    v_mfma_f32_16x16x32_bf16 a[240:243], v[144:147], v[188:191], a[240:243]
    v_mfma_f32_16x16x32_bf16 a[244:247], v[148:151], v[188:191], a[244:247]
    v_mfma_f32_16x16x32_bf16 a[248:251], v[152:155], v[188:191], a[248:251]
    v_mfma_f32_16x16x32_bf16 a[252:255], v[156:159], v[188:191], a[252:255]
    s_waitcnt vmcnt(0) lgkmcnt(0)
    s_barrier
    v_mfma_f32_16x16x32_bf16 a[0:3], v[64:67], v[96:99], a[0:3]
    ds_read_b64_tr_b16 v[160:161], v10 offset:32768
    v_mfma_f32_16x16x32_bf16 a[4:7], v[68:71], v[96:99], a[4:7]
    ds_read_b64_tr_b16 v[162:163], v10 offset:34816
    v_mfma_f32_16x16x32_bf16 a[8:11], v[72:75], v[96:99], a[8:11]
    ds_read_b128 v[128:131], v8 offset:32768
    v_mfma_f32_16x16x32_bf16 a[12:15], v[76:79], v[96:99], a[12:15]
    ds_read_b64_tr_b16 v[164:165], v11 offset:32768
    v_mfma_f32_16x16x32_bf16 a[16:19], v[80:83], v[96:99], a[16:19]
    ds_read_b64_tr_b16 v[166:167], v11 offset:34816
    v_mfma_f32_16x16x32_bf16 a[20:23], v[84:87], v[96:99], a[20:23]
    ds_read_b128 v[132:135], v8 offset:33792
    v_mfma_f32_16x16x32_bf16 a[24:27], v[88:91], v[96:99], a[24:27]
    ds_read_b64_tr_b16 v[168:169], v12 offset:32768
    v_mfma_f32_16x16x32_bf16 a[28:31], v[92:95], v[96:99], a[28:31]
    ds_read_b64_tr_b16 v[170:171], v12 offset:34816
    v_mfma_f32_16x16x32_bf16 a[32:35], v[64:67], v[100:103], a[32:35]
    ds_read_b128 v[136:139], v8 offset:34816
    v_mfma_f32_16x16x32_bf16 a[36:39], v[68:71], v[100:103], a[36:39]
    ds_read_b64_tr_b16 v[172:173], v13 offset:32768
    v_mfma_f32_16x16x32_bf16 a[40:43], v[72:75], v[100:103], a[40:43]
    ds_read_b64_tr_b16 v[174:175], v13 offset:34816
    v_mfma_f32_16x16x32_bf16 a[44:47], v[76:79], v[100:103], a[44:47]
    ds_read_b128 v[140:143], v8 offset:35840
    v_mfma_f32_16x16x32_bf16 a[48:51], v[80:83], v[100:103], a[48:51]
    ds_read_b64_tr_b16 v[176:177], v14 offset:32768
    v_mfma_f32_16x16x32_bf16 a[52:55], v[84:87], v[100:103], a[52:55]
    ds_read_b64_tr_b16 v[178:179], v14 offset:34816
    v_mfma_f32_16x16x32_bf16 a[56:59], v[88:91], v[100:103], a[56:59]
    ds_read_b128 v[144:147], v8 offset:36864
    v_mfma_f32_16x16x32_bf16 a[60:63], v[92:95], v[100:103], a[60:63]
    ds_read_b64_tr_b16 v[180:181], v15 offset:32768
    v_mfma_f32_16x16x32_bf16 a[64:67], v[64:67], v[104:107], a[64:67]
    ds_read_b64_tr_b16 v[182:183], v15 offset:34816
    v_mfma_f32_16x16x32_bf16 a[68:71], v[68:71], v[104:107], a[68:71]
    ds_read_b128 v[148:151], v8 offset:37888
    v_mfma_f32_16x16x32_bf16 a[72:75], v[72:75], v[104:107], a[72:75]
    ds_read_b64_tr_b16 v[184:185], v16 offset:32768
    v_mfma_f32_16x16x32_bf16 a[76:79], v[76:79], v[104:107], a[76:79]
    ds_read_b64_tr_b16 v[186:187], v16 offset:34816
    v_mfma_f32_16x16x32_bf16 a[80:83], v[80:83], v[104:107], a[80:83]
    ds_read_b128 v[152:155], v8 offset:38912
    v_mfma_f32_16x16x32_bf16 a[84:87], v[84:87], v[104:107], a[84:87]
    ds_read_b64_tr_b16 v[188:189], v17 offset:32768
    v_mfma_f32_16x16x32_bf16 a[88:91], v[88:91], v[104:107], a[88:91]
    ds_read_b64_tr_b16 v[190:191], v17 offset:34816
    v_mfma_f32_16x16x32_bf16 a[92:95], v[92:95], v[104:107], a[92:95]
    ds_read_b128 v[156:159], v8 offset:39936
    v_mfma_f32_16x16x32_bf16 a[96:99], v[64:67], v[108:111], a[96:99]
    v_mfma_f32_16x16x32_bf16 a[100:103], v[68:71], v[108:111], a[100:103]
    v_mfma_f32_16x16x32_bf16 a[104:107], v[72:75], v[108:111], a[104:107]
    v_mfma_f32_16x16x32_bf16 a[108:111], v[76:79], v[108:111], a[108:111]
    v_mfma_f32_16x16x32_bf16 a[112:115], v[80:83], v[108:111], a[112:115]
    v_mfma_f32_16x16x32_bf16 a[116:119], v[84:87], v[108:111], a[116:119]
    v_mfma_f32_16x16x32_bf16 a[120:123], v[88:91], v[108:111], a[120:123]
    v_mfma_f32_16x16x32_bf16 a[124:127], v[92:95], v[108:111], a[124:127]
    v_mfma_f32_16x16x32_bf16 a[128:131], v[64:67], v[112:115], a[128:131]
    v_mfma_f32_16x16x32_bf16 a[132:135], v[68:71], v[112:115], a[132:135]
    v_mfma_f32_16x16x32_bf16 a[136:139], v[72:75], v[112:115], a[136:139]
    v_mfma_f32_16x16x32_bf16 a[140:143], v[76:79], v[112:115], a[140:143]
    v_mfma_f32_16x16x32_bf16 a[144:147], v[80:83], v[112:115], a[144:147]
    v_mfma_f32_16x16x32_bf16 a[148:151], v[84:87], v[112:115], a[148:151]
    v_mfma_f32_16x16x32_bf16 a[152:155], v[88:91], v[112:115], a[152:155]
    v_mfma_f32_16x16x32_bf16 a[156:159], v[92:95], v[112:115], a[156:159]
    v_mfma_f32_16x16x32_bf16 a[160:163], v[64:67], v[116:119], a[160:163]
    v_mfma_f32_16x16x32_bf16 a[164:167], v[68:71], v[116:119], a[164:167]
    v_mfma_f32_16x16x32_bf16 a[168:171], v[72:75], v[116:119], a[168:171]
    v_mfma_f32_16x16x32_bf16 a[172:175], v[76:79], v[116:119], a[172:175]
    v_mfma_f32_16x16x32_bf16 a[176:179], v[80:83], v[116:119], a[176:179]
    v_mfma_f32_16x16x32_bf16 a[180:183], v[84:87], v[116:119], a[180:183]
    v_mfma_f32_16x16x32_bf16 a[184:187], v[88:91], v[116:119], a[184:187]
    v_mfma_f32_16x16x32_bf16 a[188:191], v[92:95], v[116:119], a[188:191]
    v_mfma_f32_16x16x32_bf16 a[192:195], v[64:67], v[120:123], a[192:195]
    v_mfma_f32_16x16x32_bf16 a[196:199], v[68:71], v[120:123], a[196:199]
    v_mfma_f32_16x16x32_bf16 a[200:203], v[72:75], v[120:123], a[200:203]
    v_mfma_f32_16x16x32_bf16 a[204:207], v[76:79], v[120:123], a[204:207]
    v_mfma_f32_16x16x32_bf16 a[208:211], v[80:83], v[120:123], a[208:211]
    v_mfma_f32_16x16x32_bf16 a[212:215], v[84:87], v[120:123], a[212:215]
    v_mfma_f32_16x16x32_bf16 a[216:219], v[88:91], v[120:123], a[216:219]
    v_mfma_f32_16x16x32_bf16 a[220:223], v[92:95], v[120:123], a[220:223]
    v_mfma_f32_16x16x32_bf16 a[224:227], v[64:67], v[124:127], a[224:227]
    v_mfma_f32_16x16x32_bf16 a[228:231], v[68:71], v[124:127], a[228:231]
    v_mfma_f32_16x16x32_bf16 a[232:235], v[72:75], v[124:127], a[232:235]
    v_mfma_f32_16x16x32_bf16 a[236:239], v[76:79], v[124:127], a[236:239]
    v_mfma_f32_16x16x32_bf16 a[240:243], v[80:83], v[124:127], a[240:243]
    v_mfma_f32_16x16x32_bf16 a[244:247], v[84:87], v[124:127], a[244:247]
    v_mfma_f32_16x16x32_bf16 a[248:251], v[88:91], v[124:127], a[248:251]
    v_mfma_f32_16x16x32_bf16 a[252:255], v[92:95], v[124:127], a[252:255]
    s_waitcnt lgkmcnt(0)
    s_barrier
    v_mfma_f32_16x16x32_bf16 a[0:3], v[128:131], v[160:163], a[0:3]
    v_mfma_f32_16x16x32_bf16 a[4:7], v[132:135], v[160:163], a[4:7]
    v_mfma_f32_16x16x32_bf16 a[8:11], v[136:139], v[160:163], a[8:11]
    v_mfma_f32_16x16x32_bf16 a[12:15], v[140:143], v[160:163], a[12:15]
    v_mfma_f32_16x16x32_bf16 a[16:19], v[144:147], v[160:163], a[16:19]
    v_mfma_f32_16x16x32_bf16 a[20:23], v[148:151], v[160:163], a[20:23]
    v_mfma_f32_16x16x32_bf16 a[24:27], v[152:155], v[160:163], a[24:27]
    v_mfma_f32_16x16x32_bf16 a[28:31], v[156:159], v[160:163], a[28:31]
    v_mfma_f32_16x16x32_bf16 a[32:35], v[128:131], v[164:167], a[32:35]
    v_mfma_f32_16x16x32_bf16 a[36:39], v[132:135], v[164:167], a[36:39]
    v_mfma_f32_16x16x32_bf16 a[40:43], v[136:139], v[164:167], a[40:43]
    v_mfma_f32_16x16x32_bf16 a[44:47], v[140:143], v[164:167], a[44:47]
    v_mfma_f32_16x16x32_bf16 a[48:51], v[144:147], v[164:167], a[48:51]
    v_mfma_f32_16x16x32_bf16 a[52:55], v[148:151], v[164:167], a[52:55]
    v_mfma_f32_16x16x32_bf16 a[56:59], v[152:155], v[164:167], a[56:59]
    v_mfma_f32_16x16x32_bf16 a[60:63], v[156:159], v[164:167], a[60:63]
    v_mfma_f32_16x16x32_bf16 a[64:67], v[128:131], v[168:171], a[64:67]
    v_mfma_f32_16x16x32_bf16 a[68:71], v[132:135], v[168:171], a[68:71]
    v_mfma_f32_16x16x32_bf16 a[72:75], v[136:139], v[168:171], a[72:75]
    v_mfma_f32_16x16x32_bf16 a[76:79], v[140:143], v[168:171], a[76:79]
    v_mfma_f32_16x16x32_bf16 a[80:83], v[144:147], v[168:171], a[80:83]
    v_mfma_f32_16x16x32_bf16 a[84:87], v[148:151], v[168:171], a[84:87]
    v_mfma_f32_16x16x32_bf16 a[88:91], v[152:155], v[168:171], a[88:91]
    v_mfma_f32_16x16x32_bf16 a[92:95], v[156:159], v[168:171], a[92:95]
    v_mfma_f32_16x16x32_bf16 a[96:99], v[128:131], v[172:175], a[96:99]
    v_mfma_f32_16x16x32_bf16 a[100:103], v[132:135], v[172:175], a[100:103]
    v_mfma_f32_16x16x32_bf16 a[104:107], v[136:139], v[172:175], a[104:107]
    v_mfma_f32_16x16x32_bf16 a[108:111], v[140:143], v[172:175], a[108:111]
    v_mfma_f32_16x16x32_bf16 a[112:115], v[144:147], v[172:175], a[112:115]
    v_mfma_f32_16x16x32_bf16 a[116:119], v[148:151], v[172:175], a[116:119]
    v_mfma_f32_16x16x32_bf16 a[120:123], v[152:155], v[172:175], a[120:123]
    v_mfma_f32_16x16x32_bf16 a[124:127], v[156:159], v[172:175], a[124:127]
    v_mfma_f32_16x16x32_bf16 a[128:131], v[128:131], v[176:179], a[128:131]
    v_mfma_f32_16x16x32_bf16 a[132:135], v[132:135], v[176:179], a[132:135]
    v_mfma_f32_16x16x32_bf16 a[136:139], v[136:139], v[176:179], a[136:139]
    v_mfma_f32_16x16x32_bf16 a[140:143], v[140:143], v[176:179], a[140:143]
    v_mfma_f32_16x16x32_bf16 a[144:147], v[144:147], v[176:179], a[144:147]
    v_mfma_f32_16x16x32_bf16 a[148:151], v[148:151], v[176:179], a[148:151]
    v_mfma_f32_16x16x32_bf16 a[152:155], v[152:155], v[176:179], a[152:155]
    v_mfma_f32_16x16x32_bf16 a[156:159], v[156:159], v[176:179], a[156:159]
    v_mfma_f32_16x16x32_bf16 a[160:163], v[128:131], v[180:183], a[160:163]
    v_mfma_f32_16x16x32_bf16 a[164:167], v[132:135], v[180:183], a[164:167]
    v_mfma_f32_16x16x32_bf16 a[168:171], v[136:139], v[180:183], a[168:171]
    v_mfma_f32_16x16x32_bf16 a[172:175], v[140:143], v[180:183], a[172:175]
    v_mfma_f32_16x16x32_bf16 a[176:179], v[144:147], v[180:183], a[176:179]
    v_mfma_f32_16x16x32_bf16 a[180:183], v[148:151], v[180:183], a[180:183]
    v_mfma_f32_16x16x32_bf16 a[184:187], v[152:155], v[180:183], a[184:187]
    v_mfma_f32_16x16x32_bf16 a[188:191], v[156:159], v[180:183], a[188:191]
    v_mfma_f32_16x16x32_bf16 a[192:195], v[128:131], v[184:187], a[192:195]
    v_mfma_f32_16x16x32_bf16 a[196:199], v[132:135], v[184:187], a[196:199]
    v_mfma_f32_16x16x32_bf16 a[200:203], v[136:139], v[184:187], a[200:203]
    v_mfma_f32_16x16x32_bf16 a[204:207], v[140:143], v[184:187], a[204:207]
    v_mfma_f32_16x16x32_bf16 a[208:211], v[144:147], v[184:187], a[208:211]
    v_mfma_f32_16x16x32_bf16 a[212:215], v[148:151], v[184:187], a[212:215]
    v_mfma_f32_16x16x32_bf16 a[216:219], v[152:155], v[184:187], a[216:219]
    v_mfma_f32_16x16x32_bf16 a[220:223], v[156:159], v[184:187], a[220:223]
    v_mfma_f32_16x16x32_bf16 a[224:227], v[128:131], v[188:191], a[224:227]
    v_mfma_f32_16x16x32_bf16 a[228:231], v[132:135], v[188:191], a[228:231]
    v_mfma_f32_16x16x32_bf16 a[232:235], v[136:139], v[188:191], a[232:235]
    v_mfma_f32_16x16x32_bf16 a[236:239], v[140:143], v[188:191], a[236:239]
    v_mfma_f32_16x16x32_bf16 a[240:243], v[144:147], v[188:191], a[240:243]
    v_mfma_f32_16x16x32_bf16 a[244:247], v[148:151], v[188:191], a[244:247]
    v_mfma_f32_16x16x32_bf16 a[248:251], v[152:155], v[188:191], a[248:251]
    v_mfma_f32_16x16x32_bf16 a[252:255], v[156:159], v[188:191], a[252:255]
    s_lshl_b32 s54, s61, 1
    s_and_b32 s55, s3, 1
    s_add_u32 s54, s54, s55
    s_lshl_b32 s52, s54, 19
    s_lshl_b32 s54, s60, 1
    s_lshr_b32 s55, s3, 1
    s_add_u32 s54, s54, s55
    s_lshl_b32 s54, s54, 15
    s_add_u32 s52, s52, s54
    s_add_u32 s52, s52, 35913728
    v_accvgpr_read_b32 v68, a0
    v_accvgpr_read_b32 v69, a1
    v_accvgpr_read_b32 v70, a2
    v_accvgpr_read_b32 v71, a3
    v_cvt_pk_bf16_f32 v64, v68, v69
    v_cvt_pk_bf16_f32 v65, v70, v71
    v_accvgpr_read_b32 v68, a36
    v_accvgpr_read_b32 v69, a37
    v_accvgpr_read_b32 v70, a38
    v_accvgpr_read_b32 v71, a39
    v_cvt_pk_bf16_f32 v66, v68, v69
    v_cvt_pk_bf16_f32 v67, v70, v71
    s_add_u32 s54, s52, 0
    buffer_store_dwordx4 v[64:67], v18, s[8:11], s54 offen sc1
    v_accvgpr_read_b32 v84, a32
    v_accvgpr_read_b32 v85, a33
    v_accvgpr_read_b32 v86, a34
    v_accvgpr_read_b32 v87, a35
    v_cvt_pk_bf16_f32 v80, v84, v85
    v_cvt_pk_bf16_f32 v81, v86, v87
    v_accvgpr_read_b32 v84, a4
    v_accvgpr_read_b32 v85, a5
    v_accvgpr_read_b32 v86, a6
    v_accvgpr_read_b32 v87, a7
    v_cvt_pk_bf16_f32 v82, v84, v85
    v_cvt_pk_bf16_f32 v83, v86, v87
    s_add_u32 s54, s52, 1024
    buffer_store_dwordx4 v[80:83], v18, s[8:11], s54 offen sc1
    v_accvgpr_read_b32 v100, a64
    v_accvgpr_read_b32 v101, a65
    v_accvgpr_read_b32 v102, a66
    v_accvgpr_read_b32 v103, a67
    v_cvt_pk_bf16_f32 v96, v100, v101
    v_cvt_pk_bf16_f32 v97, v102, v103
    v_accvgpr_read_b32 v100, a100
    v_accvgpr_read_b32 v101, a101
    v_accvgpr_read_b32 v102, a102
    v_accvgpr_read_b32 v103, a103
    v_cvt_pk_bf16_f32 v98, v100, v101
    v_cvt_pk_bf16_f32 v99, v102, v103
    s_add_u32 s54, s52, 2048
    buffer_store_dwordx4 v[96:99], v18, s[8:11], s54 offen sc1
    v_accvgpr_read_b32 v116, a96
    v_accvgpr_read_b32 v117, a97
    v_accvgpr_read_b32 v118, a98
    v_accvgpr_read_b32 v119, a99
    v_cvt_pk_bf16_f32 v112, v116, v117
    v_cvt_pk_bf16_f32 v113, v118, v119
    v_accvgpr_read_b32 v116, a68
    v_accvgpr_read_b32 v117, a69
    v_accvgpr_read_b32 v118, a70
    v_accvgpr_read_b32 v119, a71
    v_cvt_pk_bf16_f32 v114, v116, v117
    v_cvt_pk_bf16_f32 v115, v118, v119
    s_add_u32 s54, s52, 3072
    buffer_store_dwordx4 v[112:115], v18, s[8:11], s54 offen sc1
    v_accvgpr_read_b32 v68, a128
    v_accvgpr_read_b32 v69, a129
    v_accvgpr_read_b32 v70, a130
    v_accvgpr_read_b32 v71, a131
    v_cvt_pk_bf16_f32 v64, v68, v69
    v_cvt_pk_bf16_f32 v65, v70, v71
    v_accvgpr_read_b32 v68, a164
    v_accvgpr_read_b32 v69, a165
    v_accvgpr_read_b32 v70, a166
    v_accvgpr_read_b32 v71, a167
    v_cvt_pk_bf16_f32 v66, v68, v69
    v_cvt_pk_bf16_f32 v67, v70, v71
    s_add_u32 s54, s52, 4096
    buffer_store_dwordx4 v[64:67], v18, s[8:11], s54 offen sc1
    v_accvgpr_read_b32 v84, a160
    v_accvgpr_read_b32 v85, a161
    v_accvgpr_read_b32 v86, a162
    v_accvgpr_read_b32 v87, a163
    v_cvt_pk_bf16_f32 v80, v84, v85
    v_cvt_pk_bf16_f32 v81, v86, v87
    v_accvgpr_read_b32 v84, a132
    v_accvgpr_read_b32 v85, a133
    v_accvgpr_read_b32 v86, a134
    v_accvgpr_read_b32 v87, a135
    v_cvt_pk_bf16_f32 v82, v84, v85
    v_cvt_pk_bf16_f32 v83, v86, v87
    s_add_u32 s54, s52, 5120
    buffer_store_dwordx4 v[80:83], v18, s[8:11], s54 offen sc1
    v_accvgpr_read_b32 v100, a192
    v_accvgpr_read_b32 v101, a193
    v_accvgpr_read_b32 v102, a194
    v_accvgpr_read_b32 v103, a195
    v_cvt_pk_bf16_f32 v96, v100, v101
    v_cvt_pk_bf16_f32 v97, v102, v103
    v_accvgpr_read_b32 v100, a228
    v_accvgpr_read_b32 v101, a229
    v_accvgpr_read_b32 v102, a230
    v_accvgpr_read_b32 v103, a231
    v_cvt_pk_bf16_f32 v98, v100, v101
    v_cvt_pk_bf16_f32 v99, v102, v103
    s_add_u32 s54, s52, 6144
    buffer_store_dwordx4 v[96:99], v18, s[8:11], s54 offen sc1
    v_accvgpr_read_b32 v116, a224
    v_accvgpr_read_b32 v117, a225
    v_accvgpr_read_b32 v118, a226
    v_accvgpr_read_b32 v119, a227
    v_cvt_pk_bf16_f32 v112, v116, v117
    v_cvt_pk_bf16_f32 v113, v118, v119
    v_accvgpr_read_b32 v116, a196
    v_accvgpr_read_b32 v117, a197
    v_accvgpr_read_b32 v118, a198
    v_accvgpr_read_b32 v119, a199
    v_cvt_pk_bf16_f32 v114, v116, v117
    v_cvt_pk_bf16_f32 v115, v118, v119
    s_add_u32 s54, s52, 7168
    buffer_store_dwordx4 v[112:115], v18, s[8:11], s54 offen sc1
    v_accvgpr_read_b32 v68, a8
    v_accvgpr_read_b32 v69, a9
    v_accvgpr_read_b32 v70, a10
    v_accvgpr_read_b32 v71, a11
    v_cvt_pk_bf16_f32 v64, v68, v69
    v_cvt_pk_bf16_f32 v65, v70, v71
    v_accvgpr_read_b32 v68, a44
    v_accvgpr_read_b32 v69, a45
    v_accvgpr_read_b32 v70, a46
    v_accvgpr_read_b32 v71, a47
    v_cvt_pk_bf16_f32 v66, v68, v69
    v_cvt_pk_bf16_f32 v67, v70, v71
    s_add_u32 s54, s52, 8192
    buffer_store_dwordx4 v[64:67], v18, s[8:11], s54 offen sc1
    v_accvgpr_read_b32 v84, a40
    v_accvgpr_read_b32 v85, a41
    v_accvgpr_read_b32 v86, a42
    v_accvgpr_read_b32 v87, a43
    v_cvt_pk_bf16_f32 v80, v84, v85
    v_cvt_pk_bf16_f32 v81, v86, v87
    v_accvgpr_read_b32 v84, a12
    v_accvgpr_read_b32 v85, a13
    v_accvgpr_read_b32 v86, a14
    v_accvgpr_read_b32 v87, a15
    v_cvt_pk_bf16_f32 v82, v84, v85
    v_cvt_pk_bf16_f32 v83, v86, v87
    s_add_u32 s54, s52, 9216
    buffer_store_dwordx4 v[80:83], v18, s[8:11], s54 offen sc1
    v_accvgpr_read_b32 v100, a72
    v_accvgpr_read_b32 v101, a73
    v_accvgpr_read_b32 v102, a74
    v_accvgpr_read_b32 v103, a75
    v_cvt_pk_bf16_f32 v96, v100, v101
    v_cvt_pk_bf16_f32 v97, v102, v103
    v_accvgpr_read_b32 v100, a108
    v_accvgpr_read_b32 v101, a109
    v_accvgpr_read_b32 v102, a110
    v_accvgpr_read_b32 v103, a111
    v_cvt_pk_bf16_f32 v98, v100, v101
    v_cvt_pk_bf16_f32 v99, v102, v103
    s_add_u32 s54, s52, 10240
    buffer_store_dwordx4 v[96:99], v18, s[8:11], s54 offen sc1
    v_accvgpr_read_b32 v116, a104
    v_accvgpr_read_b32 v117, a105
    v_accvgpr_read_b32 v118, a106
    v_accvgpr_read_b32 v119, a107
    v_cvt_pk_bf16_f32 v112, v116, v117
    v_cvt_pk_bf16_f32 v113, v118, v119
    v_accvgpr_read_b32 v116, a76
    v_accvgpr_read_b32 v117, a77
    v_accvgpr_read_b32 v118, a78
    v_accvgpr_read_b32 v119, a79
    v_cvt_pk_bf16_f32 v114, v116, v117
    v_cvt_pk_bf16_f32 v115, v118, v119
    s_add_u32 s54, s52, 11264
    buffer_store_dwordx4 v[112:115], v18, s[8:11], s54 offen sc1
    v_accvgpr_read_b32 v68, a136
    v_accvgpr_read_b32 v69, a137
    v_accvgpr_read_b32 v70, a138
    v_accvgpr_read_b32 v71, a139
    v_cvt_pk_bf16_f32 v64, v68, v69
    v_cvt_pk_bf16_f32 v65, v70, v71
    v_accvgpr_read_b32 v68, a172
    v_accvgpr_read_b32 v69, a173
    v_accvgpr_read_b32 v70, a174
    v_accvgpr_read_b32 v71, a175
    v_cvt_pk_bf16_f32 v66, v68, v69
    v_cvt_pk_bf16_f32 v67, v70, v71
    s_add_u32 s54, s52, 12288
    buffer_store_dwordx4 v[64:67], v18, s[8:11], s54 offen sc1
    v_accvgpr_read_b32 v84, a168
    v_accvgpr_read_b32 v85, a169
    v_accvgpr_read_b32 v86, a170
    v_accvgpr_read_b32 v87, a171
    v_cvt_pk_bf16_f32 v80, v84, v85
    v_cvt_pk_bf16_f32 v81, v86, v87
    v_accvgpr_read_b32 v84, a140
    v_accvgpr_read_b32 v85, a141
    v_accvgpr_read_b32 v86, a142
    v_accvgpr_read_b32 v87, a143
    v_cvt_pk_bf16_f32 v82, v84, v85
    v_cvt_pk_bf16_f32 v83, v86, v87
    s_add_u32 s54, s52, 13312
    buffer_store_dwordx4 v[80:83], v18, s[8:11], s54 offen sc1
    v_accvgpr_read_b32 v100, a200
    v_accvgpr_read_b32 v101, a201
    v_accvgpr_read_b32 v102, a202
    v_accvgpr_read_b32 v103, a203
    v_cvt_pk_bf16_f32 v96, v100, v101
    v_cvt_pk_bf16_f32 v97, v102, v103
    v_accvgpr_read_b32 v100, a236
    v_accvgpr_read_b32 v101, a237
    v_accvgpr_read_b32 v102, a238
    v_accvgpr_read_b32 v103, a239
    v_cvt_pk_bf16_f32 v98, v100, v101
    v_cvt_pk_bf16_f32 v99, v102, v103
    s_add_u32 s54, s52, 14336
    buffer_store_dwordx4 v[96:99], v18, s[8:11], s54 offen sc1
    v_accvgpr_read_b32 v116, a232
    v_accvgpr_read_b32 v117, a233
    v_accvgpr_read_b32 v118, a234
    v_accvgpr_read_b32 v119, a235
    v_cvt_pk_bf16_f32 v112, v116, v117
    v_cvt_pk_bf16_f32 v113, v118, v119
    v_accvgpr_read_b32 v116, a204
    v_accvgpr_read_b32 v117, a205
    v_accvgpr_read_b32 v118, a206
    v_accvgpr_read_b32 v119, a207
    v_cvt_pk_bf16_f32 v114, v116, v117
    v_cvt_pk_bf16_f32 v115, v118, v119
    s_add_u32 s54, s52, 15360
    buffer_store_dwordx4 v[112:115], v18, s[8:11], s54 offen sc1
    v_accvgpr_read_b32 v68, a16
    v_accvgpr_read_b32 v69, a17
    v_accvgpr_read_b32 v70, a18
    v_accvgpr_read_b32 v71, a19
    v_cvt_pk_bf16_f32 v64, v68, v69
    v_cvt_pk_bf16_f32 v65, v70, v71
    v_accvgpr_read_b32 v68, a52
    v_accvgpr_read_b32 v69, a53
    v_accvgpr_read_b32 v70, a54
    v_accvgpr_read_b32 v71, a55
    v_cvt_pk_bf16_f32 v66, v68, v69
    v_cvt_pk_bf16_f32 v67, v70, v71
    s_add_u32 s54, s52, 16384
    buffer_store_dwordx4 v[64:67], v18, s[8:11], s54 offen sc1
    v_accvgpr_read_b32 v84, a48
    v_accvgpr_read_b32 v85, a49
    v_accvgpr_read_b32 v86, a50
    v_accvgpr_read_b32 v87, a51
    v_cvt_pk_bf16_f32 v80, v84, v85
    v_cvt_pk_bf16_f32 v81, v86, v87
    v_accvgpr_read_b32 v84, a20
    v_accvgpr_read_b32 v85, a21
    v_accvgpr_read_b32 v86, a22
    v_accvgpr_read_b32 v87, a23
    v_cvt_pk_bf16_f32 v82, v84, v85
    v_cvt_pk_bf16_f32 v83, v86, v87
    s_add_u32 s54, s52, 17408
    buffer_store_dwordx4 v[80:83], v18, s[8:11], s54 offen sc1
    v_accvgpr_read_b32 v100, a80
    v_accvgpr_read_b32 v101, a81
    v_accvgpr_read_b32 v102, a82
    v_accvgpr_read_b32 v103, a83
    v_cvt_pk_bf16_f32 v96, v100, v101
    v_cvt_pk_bf16_f32 v97, v102, v103
    v_accvgpr_read_b32 v100, a116
    v_accvgpr_read_b32 v101, a117
    v_accvgpr_read_b32 v102, a118
    v_accvgpr_read_b32 v103, a119
    v_cvt_pk_bf16_f32 v98, v100, v101
    v_cvt_pk_bf16_f32 v99, v102, v103
    s_add_u32 s54, s52, 18432
    buffer_store_dwordx4 v[96:99], v18, s[8:11], s54 offen sc1
    v_accvgpr_read_b32 v116, a112
    v_accvgpr_read_b32 v117, a113
    v_accvgpr_read_b32 v118, a114
    v_accvgpr_read_b32 v119, a115
    v_cvt_pk_bf16_f32 v112, v116, v117
    v_cvt_pk_bf16_f32 v113, v118, v119
    v_accvgpr_read_b32 v116, a84
    v_accvgpr_read_b32 v117, a85
    v_accvgpr_read_b32 v118, a86
    v_accvgpr_read_b32 v119, a87
    v_cvt_pk_bf16_f32 v114, v116, v117
    v_cvt_pk_bf16_f32 v115, v118, v119
    s_add_u32 s54, s52, 19456
    buffer_store_dwordx4 v[112:115], v18, s[8:11], s54 offen sc1
    v_accvgpr_read_b32 v68, a144
    v_accvgpr_read_b32 v69, a145
    v_accvgpr_read_b32 v70, a146
    v_accvgpr_read_b32 v71, a147
    v_cvt_pk_bf16_f32 v64, v68, v69
    v_cvt_pk_bf16_f32 v65, v70, v71
    v_accvgpr_read_b32 v68, a180
    v_accvgpr_read_b32 v69, a181
    v_accvgpr_read_b32 v70, a182
    v_accvgpr_read_b32 v71, a183
    v_cvt_pk_bf16_f32 v66, v68, v69
    v_cvt_pk_bf16_f32 v67, v70, v71
    s_add_u32 s54, s52, 20480
    buffer_store_dwordx4 v[64:67], v18, s[8:11], s54 offen sc1
    v_accvgpr_read_b32 v84, a176
    v_accvgpr_read_b32 v85, a177
    v_accvgpr_read_b32 v86, a178
    v_accvgpr_read_b32 v87, a179
    v_cvt_pk_bf16_f32 v80, v84, v85
    v_cvt_pk_bf16_f32 v81, v86, v87
    v_accvgpr_read_b32 v84, a148
    v_accvgpr_read_b32 v85, a149
    v_accvgpr_read_b32 v86, a150
    v_accvgpr_read_b32 v87, a151
    v_cvt_pk_bf16_f32 v82, v84, v85
    v_cvt_pk_bf16_f32 v83, v86, v87
    s_add_u32 s54, s52, 21504
    buffer_store_dwordx4 v[80:83], v18, s[8:11], s54 offen sc1
    v_accvgpr_read_b32 v100, a208
    v_accvgpr_read_b32 v101, a209
    v_accvgpr_read_b32 v102, a210
    v_accvgpr_read_b32 v103, a211
    v_cvt_pk_bf16_f32 v96, v100, v101
    v_cvt_pk_bf16_f32 v97, v102, v103
    v_accvgpr_read_b32 v100, a244
    v_accvgpr_read_b32 v101, a245
    v_accvgpr_read_b32 v102, a246
    v_accvgpr_read_b32 v103, a247
    v_cvt_pk_bf16_f32 v98, v100, v101
    v_cvt_pk_bf16_f32 v99, v102, v103
    s_add_u32 s54, s52, 22528
    buffer_store_dwordx4 v[96:99], v18, s[8:11], s54 offen sc1
    v_accvgpr_read_b32 v116, a240
    v_accvgpr_read_b32 v117, a241
    v_accvgpr_read_b32 v118, a242
    v_accvgpr_read_b32 v119, a243
    v_cvt_pk_bf16_f32 v112, v116, v117
    v_cvt_pk_bf16_f32 v113, v118, v119
    v_accvgpr_read_b32 v116, a212
    v_accvgpr_read_b32 v117, a213
    v_accvgpr_read_b32 v118, a214
    v_accvgpr_read_b32 v119, a215
    v_cvt_pk_bf16_f32 v114, v116, v117
    v_cvt_pk_bf16_f32 v115, v118, v119
    s_add_u32 s54, s52, 23552
    buffer_store_dwordx4 v[112:115], v18, s[8:11], s54 offen sc1
    v_accvgpr_read_b32 v68, a24
    v_accvgpr_read_b32 v69, a25
    v_accvgpr_read_b32 v70, a26
    v_accvgpr_read_b32 v71, a27
    v_cvt_pk_bf16_f32 v64, v68, v69
    v_cvt_pk_bf16_f32 v65, v70, v71
    v_accvgpr_read_b32 v68, a60
    v_accvgpr_read_b32 v69, a61
    v_accvgpr_read_b32 v70, a62
    v_accvgpr_read_b32 v71, a63
    v_cvt_pk_bf16_f32 v66, v68, v69
    v_cvt_pk_bf16_f32 v67, v70, v71
    s_add_u32 s54, s52, 24576
    buffer_store_dwordx4 v[64:67], v18, s[8:11], s54 offen sc1
    v_accvgpr_read_b32 v84, a56
    v_accvgpr_read_b32 v85, a57
    v_accvgpr_read_b32 v86, a58
    v_accvgpr_read_b32 v87, a59
    v_cvt_pk_bf16_f32 v80, v84, v85
    v_cvt_pk_bf16_f32 v81, v86, v87
    v_accvgpr_read_b32 v84, a28
    v_accvgpr_read_b32 v85, a29
    v_accvgpr_read_b32 v86, a30
    v_accvgpr_read_b32 v87, a31
    v_cvt_pk_bf16_f32 v82, v84, v85
    v_cvt_pk_bf16_f32 v83, v86, v87
    s_add_u32 s54, s52, 25600
    buffer_store_dwordx4 v[80:83], v18, s[8:11], s54 offen sc1
    v_accvgpr_read_b32 v100, a88
    v_accvgpr_read_b32 v101, a89
    v_accvgpr_read_b32 v102, a90
    v_accvgpr_read_b32 v103, a91
    v_cvt_pk_bf16_f32 v96, v100, v101
    v_cvt_pk_bf16_f32 v97, v102, v103
    v_accvgpr_read_b32 v100, a124
    v_accvgpr_read_b32 v101, a125
    v_accvgpr_read_b32 v102, a126
    v_accvgpr_read_b32 v103, a127
    v_cvt_pk_bf16_f32 v98, v100, v101
    v_cvt_pk_bf16_f32 v99, v102, v103
    s_add_u32 s54, s52, 26624
    buffer_store_dwordx4 v[96:99], v18, s[8:11], s54 offen sc1
    v_accvgpr_read_b32 v116, a120
    v_accvgpr_read_b32 v117, a121
    v_accvgpr_read_b32 v118, a122
    v_accvgpr_read_b32 v119, a123
    v_cvt_pk_bf16_f32 v112, v116, v117
    v_cvt_pk_bf16_f32 v113, v118, v119
    v_accvgpr_read_b32 v116, a92
    v_accvgpr_read_b32 v117, a93
    v_accvgpr_read_b32 v118, a94
    v_accvgpr_read_b32 v119, a95
    v_cvt_pk_bf16_f32 v114, v116, v117
    v_cvt_pk_bf16_f32 v115, v118, v119
    s_add_u32 s54, s52, 27648
    buffer_store_dwordx4 v[112:115], v18, s[8:11], s54 offen sc1
    v_accvgpr_read_b32 v68, a152
    v_accvgpr_read_b32 v69, a153
    v_accvgpr_read_b32 v70, a154
    v_accvgpr_read_b32 v71, a155
    v_cvt_pk_bf16_f32 v64, v68, v69
    v_cvt_pk_bf16_f32 v65, v70, v71
    v_accvgpr_read_b32 v68, a188
    v_accvgpr_read_b32 v69, a189
    v_accvgpr_read_b32 v70, a190
    v_accvgpr_read_b32 v71, a191
    v_cvt_pk_bf16_f32 v66, v68, v69
    v_cvt_pk_bf16_f32 v67, v70, v71
    s_add_u32 s54, s52, 28672
    buffer_store_dwordx4 v[64:67], v18, s[8:11], s54 offen sc1
    v_accvgpr_read_b32 v84, a184
    v_accvgpr_read_b32 v85, a185
    v_accvgpr_read_b32 v86, a186
    v_accvgpr_read_b32 v87, a187
    v_cvt_pk_bf16_f32 v80, v84, v85
    v_cvt_pk_bf16_f32 v81, v86, v87
    v_accvgpr_read_b32 v84, a156
    v_accvgpr_read_b32 v85, a157
    v_accvgpr_read_b32 v86, a158
    v_accvgpr_read_b32 v87, a159
    v_cvt_pk_bf16_f32 v82, v84, v85
    v_cvt_pk_bf16_f32 v83, v86, v87
    s_add_u32 s54, s52, 29696
    buffer_store_dwordx4 v[80:83], v18, s[8:11], s54 offen sc1
    v_accvgpr_read_b32 v100, a216
    v_accvgpr_read_b32 v101, a217
    v_accvgpr_read_b32 v102, a218
    v_accvgpr_read_b32 v103, a219
    v_cvt_pk_bf16_f32 v96, v100, v101
    v_cvt_pk_bf16_f32 v97, v102, v103
    v_accvgpr_read_b32 v100, a252
    v_accvgpr_read_b32 v101, a253
    v_accvgpr_read_b32 v102, a254
    v_accvgpr_read_b32 v103, a255
    v_cvt_pk_bf16_f32 v98, v100, v101
    v_cvt_pk_bf16_f32 v99, v102, v103
    s_add_u32 s54, s52, 30720
    buffer_store_dwordx4 v[96:99], v18, s[8:11], s54 offen sc1
    v_accvgpr_read_b32 v116, a248
    v_accvgpr_read_b32 v117, a249
    v_accvgpr_read_b32 v118, a250
    v_accvgpr_read_b32 v119, a251
    v_cvt_pk_bf16_f32 v112, v116, v117
    v_cvt_pk_bf16_f32 v113, v118, v119
    v_accvgpr_read_b32 v116, a220
    v_accvgpr_read_b32 v117, a221
    v_accvgpr_read_b32 v118, a222
    v_accvgpr_read_b32 v119, a223
    v_cvt_pk_bf16_f32 v114, v116, v117
    v_cvt_pk_bf16_f32 v115, v118, v119
    s_add_u32 s54, s52, 31744
    buffer_store_dwordx4 v[112:115], v18, s[8:11], s54 offen sc1
    s_branch W_DONE
W_tq:
    s_mov_b64 s[12:13], s[24:25]
    s_mov_b32 s14, 4718592
    s_mov_b32 s63, 8192
    v_and_b32 v1, 63, v0
    v_lshrrev_b32 v2, 4, v1
    v_lshlrev_b32 v18, 4, v1
    s_lshr_b32 s54, s3, 1
    s_lshl_b32 s54, s54, 13
    v_add_u32 v8, s54, v18
    v_bfe_u32 v3, v1, 2, 2
    v_and_b32 v4, 3, v1
    v_and_b32 v5, 1, v2
    v_lshl_add_u32 v5, v5, 2, v3
    v_lshlrev_b32 v6, 12, v2
    v_lshl_add_u32 v6, v3, 9, v6
    v_lshl_add_u32 v6, v4, 3, v6
    v_add_u32 v6, 16384, v6
    s_and_b32 s54, s3, 1
    s_mul_i32 s54, s54, 8
    s_add_u32 s55, s54, 0
    v_xor_b32 v7, s55, v5
    v_lshl_add_u32 v10, v7, 5, v6
    s_add_u32 s55, s54, 1
    v_xor_b32 v7, s55, v5
    v_lshl_add_u32 v11, v7, 5, v6
    s_add_u32 s55, s54, 2
    v_xor_b32 v7, s55, v5
    v_lshl_add_u32 v12, v7, 5, v6
    s_add_u32 s55, s54, 3
    v_xor_b32 v7, s55, v5
    v_lshl_add_u32 v13, v7, 5, v6
    s_add_u32 s55, s54, 4
    v_xor_b32 v7, s55, v5
    v_lshl_add_u32 v14, v7, 5, v6
    s_add_u32 s55, s54, 5
    v_xor_b32 v7, s55, v5
    v_lshl_add_u32 v15, v7, 5, v6
    s_add_u32 s55, s54, 6
    v_xor_b32 v7, s55, v5
    v_lshl_add_u32 v16, v7, 5, v6
    s_add_u32 s55, s54, 7
    v_xor_b32 v7, s55, v5
    v_lshl_add_u32 v17, v7, 5, v6
    s_and_b32 s54, s3, 1
    s_lshl_b32 s54, s54, 1
    s_lshr_b32 s55, s3, 1
    s_lshl_b32 s55, s55, 2
    s_or_b32 s54, s54, s55
    v_lshrrev_b32 v3, 5, v1
    v_or_b32 v4, s54, v3
    v_lshlrev_b32 v4, 1, v4
    v_and_b32 v5, 31, v1
    v_xor_b32 v4, v4, v5
    v_mul_lo_u32 v3, v3, s63
    v_lshl_add_u32 v19, v4, 4, v3
    s_mul_i32 s64, s60, 294912
    s_add_u32 s64, s64, 0
    s_lshl_b32 s65, s61, 9
    s_mul_i32 s54, s3, 73728
    s_add_u32 s54, s54, s64
    s_add_u32 s40, s54, 0
    s_add_u32 s41, s54, 18432
    s_add_u32 s42, s54, 36864
    s_add_u32 s43, s54, 55296
    s_and_b32 s54, s3, 1
    s_lshl_b32 s54, s54, 1
    s_lshr_b32 s55, s3, 1
    s_mul_i32 s55, s55, 8
    s_add_u32 s54, s54, s55
    s_add_u32 s55, s54, 0
    s_mul_i32 s55, s55, s63
    s_add_u32 s44, s55, s65
    s_add_u32 s55, s54, 4
    s_mul_i32 s55, s55, s63
    s_add_u32 s45, s55, s65
    s_add_u32 s55, s54, 16
    s_mul_i32 s55, s55, s63
    s_add_u32 s46, s55, s65
    s_add_u32 s55, s54, 20
    s_mul_i32 s55, s55, s63
    s_add_u32 s47, s55, s65
    s_lshl_b32 s50, s63, 5
    s_lshl_b32 s48, s3, 12
    s_and_b32 s54, s3, 1
    s_lshl_b32 s54, s54, 10
    s_lshr_b32 s55, s3, 1
    s_lshl_b32 s55, s55, 12
    s_add_u32 s49, s54, s55
    s_add_u32 s49, s49, 16384
    s_add_u32 m0, s48, 0
    s_nop 0
    buffer_load_dwordx4 v18, s[8:11], s40 offen  lds
    s_add_u32 s40, s40, 1024
    s_add_u32 m0, s48, 1024
    s_nop 0
    buffer_load_dwordx4 v18, s[8:11], s41 offen  lds
    s_add_u32 s41, s41, 1024
    s_add_u32 m0, s48, 2048
    s_nop 0
    buffer_load_dwordx4 v18, s[8:11], s42 offen  lds
    s_add_u32 s42, s42, 1024
    s_add_u32 m0, s48, 3072
    s_nop 0
    buffer_load_dwordx4 v18, s[8:11], s43 offen  lds
    s_add_u32 s43, s43, 1024
    s_add_u32 s48, s48, 32768
    s_and_b32 s48, s48, 0x1ffff
    s_add_u32 m0, s49, 0
    s_nop 0
    buffer_load_dwordx4 v19, s[12:15], s44 offen lds
    s_add_u32 s44, s44, s50
    s_add_u32 m0, s49, 2048
    s_nop 0
    buffer_load_dwordx4 v19, s[12:15], s45 offen lds
    s_add_u32 s45, s45, s50
    s_add_u32 m0, s49, 8192
    s_nop 0
    buffer_load_dwordx4 v19, s[12:15], s46 offen lds
    s_add_u32 s46, s46, s50
    s_add_u32 m0, s49, 10240
    s_nop 0
    buffer_load_dwordx4 v19, s[12:15], s47 offen lds
    s_add_u32 s47, s47, s50
    s_add_u32 s49, s49, 32768
    s_and_b32 s49, s49, 0x1ffff
    s_add_u32 m0, s48, 0
    s_nop 0
    buffer_load_dwordx4 v18, s[8:11], s40 offen  lds
    s_add_u32 s40, s40, 1024
    s_add_u32 m0, s48, 1024
    s_nop 0
    buffer_load_dwordx4 v18, s[8:11], s41 offen  lds
    s_add_u32 s41, s41, 1024
    s_add_u32 m0, s48, 2048
    s_nop 0
    buffer_load_dwordx4 v18, s[8:11], s42 offen  lds
    s_add_u32 s42, s42, 1024
    s_add_u32 m0, s48, 3072
    s_nop 0
    buffer_load_dwordx4 v18, s[8:11], s43 offen  lds
    s_add_u32 s43, s43, 1024
    s_add_u32 s48, s48, 32768
    s_and_b32 s48, s48, 0x1ffff
    s_add_u32 m0, s49, 0
    s_nop 0
    buffer_load_dwordx4 v19, s[12:15], s44 offen lds
    s_add_u32 s44, s44, s50
    s_add_u32 m0, s49, 2048
    s_nop 0
    buffer_load_dwordx4 v19, s[12:15], s45 offen lds
    s_add_u32 s45, s45, s50
    s_add_u32 m0, s49, 8192
    s_nop 0
    buffer_load_dwordx4 v19, s[12:15], s46 offen lds
    s_add_u32 s46, s46, s50
    s_add_u32 m0, s49, 10240
    s_nop 0
    buffer_load_dwordx4 v19, s[12:15], s47 offen lds
    s_add_u32 s47, s47, s50
    s_add_u32 s49, s49, 32768
    s_and_b32 s49, s49, 0x1ffff
    s_add_u32 m0, s48, 0
    s_nop 0
    buffer_load_dwordx4 v18, s[8:11], s40 offen  lds
    s_add_u32 s40, s40, 1024
    s_add_u32 m0, s48, 1024
    s_nop 0
    buffer_load_dwordx4 v18, s[8:11], s41 offen  lds
    s_add_u32 s41, s41, 1024
    s_add_u32 m0, s48, 2048
    s_nop 0
    buffer_load_dwordx4 v18, s[8:11], s42 offen  lds
    s_add_u32 s42, s42, 1024
    s_add_u32 m0, s48, 3072
    s_nop 0
    buffer_load_dwordx4 v18, s[8:11], s43 offen  lds
    s_add_u32 s43, s43, 1024
    s_add_u32 s48, s48, 32768
    s_and_b32 s48, s48, 0x1ffff
    s_add_u32 m0, s49, 0
    s_nop 0
    buffer_load_dwordx4 v19, s[12:15], s44 offen lds
    s_add_u32 s44, s44, s50
    s_add_u32 m0, s49, 2048
    s_nop 0
    buffer_load_dwordx4 v19, s[12:15], s45 offen lds
    s_add_u32 s45, s45, s50
    s_add_u32 m0, s49, 8192
    s_nop 0
    buffer_load_dwordx4 v19, s[12:15], s46 offen lds
    s_add_u32 s46, s46, s50
    s_add_u32 m0, s49, 10240
    s_nop 0
    buffer_load_dwordx4 v19, s[12:15], s47 offen lds
    s_add_u32 s47, s47, s50
    s_add_u32 s49, s49, 32768
    s_and_b32 s49, s49, 0x1ffff
    s_add_u32 m0, s48, 0
    s_nop 0
    buffer_load_dwordx4 v18, s[8:11], s40 offen  lds
    s_add_u32 s40, s40, 1024
    s_add_u32 m0, s48, 1024
    s_nop 0
    buffer_load_dwordx4 v18, s[8:11], s41 offen  lds
    s_add_u32 s41, s41, 1024
    s_add_u32 m0, s48, 2048
    s_nop 0
    buffer_load_dwordx4 v18, s[8:11], s42 offen  lds
    s_add_u32 s42, s42, 1024
    s_add_u32 m0, s48, 3072
    s_nop 0
    buffer_load_dwordx4 v18, s[8:11], s43 offen  lds
    s_add_u32 s43, s43, 1024
    s_add_u32 s48, s48, 32768
    s_and_b32 s48, s48, 0x1ffff
    s_add_u32 m0, s49, 0
    s_nop 0
    buffer_load_dwordx4 v19, s[12:15], s44 offen lds
    s_add_u32 s44, s44, s50
    s_add_u32 m0, s49, 2048
    s_nop 0
    buffer_load_dwordx4 v19, s[12:15], s45 offen lds
    s_add_u32 s45, s45, s50
    s_add_u32 m0, s49, 8192
    s_nop 0
    buffer_load_dwordx4 v19, s[12:15], s46 offen lds
    s_add_u32 s46, s46, s50
    s_add_u32 m0, s49, 10240
    s_nop 0
    buffer_load_dwordx4 v19, s[12:15], s47 offen lds
    s_add_u32 s47, s47, s50
    s_add_u32 s49, s49, 32768
    s_and_b32 s49, s49, 0x1ffff
    v_accvgpr_write_b32 a0, 0
    v_accvgpr_write_b32 a1, 0
    v_accvgpr_write_b32 a2, 0
    v_accvgpr_write_b32 a3, 0
    v_accvgpr_write_b32 a4, 0
    v_accvgpr_write_b32 a5, 0
    v_accvgpr_write_b32 a6, 0
    v_accvgpr_write_b32 a7, 0
    v_accvgpr_write_b32 a8, 0
    v_accvgpr_write_b32 a9, 0
    v_accvgpr_write_b32 a10, 0
    v_accvgpr_write_b32 a11, 0
    v_accvgpr_write_b32 a12, 0
    v_accvgpr_write_b32 a13, 0
    v_accvgpr_write_b32 a14, 0
    v_accvgpr_write_b32 a15, 0
    v_accvgpr_write_b32 a16, 0
    v_accvgpr_write_b32 a17, 0
    v_accvgpr_write_b32 a18, 0
    v_accvgpr_write_b32 a19, 0
    v_accvgpr_write_b32 a20, 0
    v_accvgpr_write_b32 a21, 0
    v_accvgpr_write_b32 a22, 0
    v_accvgpr_write_b32 a23, 0
    v_accvgpr_write_b32 a24, 0
    v_accvgpr_write_b32 a25, 0
    v_accvgpr_write_b32 a26, 0
    v_accvgpr_write_b32 a27, 0
    v_accvgpr_write_b32 a28, 0
    v_accvgpr_write_b32 a29, 0
    v_accvgpr_write_b32 a30, 0
    v_accvgpr_write_b32 a31, 0
    v_accvgpr_write_b32 a32, 0
    v_accvgpr_write_b32 a33, 0
    v_accvgpr_write_b32 a34, 0
    v_accvgpr_write_b32 a35, 0
    v_accvgpr_write_b32 a36, 0
    v_accvgpr_write_b32 a37, 0
    v_accvgpr_write_b32 a38, 0
    v_accvgpr_write_b32 a39, 0
    v_accvgpr_write_b32 a40, 0
    v_accvgpr_write_b32 a41, 0
    v_accvgpr_write_b32 a42, 0
    v_accvgpr_write_b32 a43, 0
    v_accvgpr_write_b32 a44, 0
    v_accvgpr_write_b32 a45, 0
    v_accvgpr_write_b32 a46, 0
    v_accvgpr_write_b32 a47, 0
    v_accvgpr_write_b32 a48, 0
    v_accvgpr_write_b32 a49, 0
    v_accvgpr_write_b32 a50, 0
    v_accvgpr_write_b32 a51, 0
    v_accvgpr_write_b32 a52, 0
    v_accvgpr_write_b32 a53, 0
    v_accvgpr_write_b32 a54, 0
    v_accvgpr_write_b32 a55, 0
    v_accvgpr_write_b32 a56, 0
    v_accvgpr_write_b32 a57, 0
    v_accvgpr_write_b32 a58, 0
    v_accvgpr_write_b32 a59, 0
    v_accvgpr_write_b32 a60, 0
    v_accvgpr_write_b32 a61, 0
    v_accvgpr_write_b32 a62, 0
    v_accvgpr_write_b32 a63, 0
    v_accvgpr_write_b32 a64, 0
    v_accvgpr_write_b32 a65, 0
    v_accvgpr_write_b32 a66, 0
    v_accvgpr_write_b32 a67, 0
    v_accvgpr_write_b32 a68, 0
    v_accvgpr_write_b32 a69, 0
    v_accvgpr_write_b32 a70, 0
    v_accvgpr_write_b32 a71, 0
    v_accvgpr_write_b32 a72, 0
    v_accvgpr_write_b32 a73, 0
    v_accvgpr_write_b32 a74, 0
    v_accvgpr_write_b32 a75, 0
    v_accvgpr_write_b32 a76, 0
    v_accvgpr_write_b32 a77, 0
    v_accvgpr_write_b32 a78, 0
    v_accvgpr_write_b32 a79, 0
    v_accvgpr_write_b32 a80, 0
    v_accvgpr_write_b32 a81, 0
    v_accvgpr_write_b32 a82, 0
    v_accvgpr_write_b32 a83, 0
    v_accvgpr_write_b32 a84, 0
    v_accvgpr_write_b32 a85, 0
    v_accvgpr_write_b32 a86, 0
    v_accvgpr_write_b32 a87, 0
    v_accvgpr_write_b32 a88, 0
    v_accvgpr_write_b32 a89, 0
    v_accvgpr_write_b32 a90, 0
    v_accvgpr_write_b32 a91, 0
    v_accvgpr_write_b32 a92, 0
    v_accvgpr_write_b32 a93, 0
    v_accvgpr_write_b32 a94, 0
    v_accvgpr_write_b32 a95, 0
    v_accvgpr_write_b32 a96, 0
    v_accvgpr_write_b32 a97, 0
    v_accvgpr_write_b32 a98, 0
    v_accvgpr_write_b32 a99, 0
    v_accvgpr_write_b32 a100, 0
    v_accvgpr_write_b32 a101, 0
    v_accvgpr_write_b32 a102, 0
    v_accvgpr_write_b32 a103, 0
    v_accvgpr_write_b32 a104, 0
    v_accvgpr_write_b32 a105, 0
    v_accvgpr_write_b32 a106, 0
    v_accvgpr_write_b32 a107, 0
    v_accvgpr_write_b32 a108, 0
    v_accvgpr_write_b32 a109, 0
    v_accvgpr_write_b32 a110, 0
    v_accvgpr_write_b32 a111, 0
    v_accvgpr_write_b32 a112, 0
    v_accvgpr_write_b32 a113, 0
    v_accvgpr_write_b32 a114, 0
    v_accvgpr_write_b32 a115, 0
    v_accvgpr_write_b32 a116, 0
    v_accvgpr_write_b32 a117, 0
    v_accvgpr_write_b32 a118, 0
    v_accvgpr_write_b32 a119, 0
    v_accvgpr_write_b32 a120, 0
    v_accvgpr_write_b32 a121, 0
    v_accvgpr_write_b32 a122, 0
    v_accvgpr_write_b32 a123, 0
    v_accvgpr_write_b32 a124, 0
    v_accvgpr_write_b32 a125, 0
    v_accvgpr_write_b32 a126, 0
    v_accvgpr_write_b32 a127, 0
    v_accvgpr_write_b32 a128, 0
    v_accvgpr_write_b32 a129, 0
    v_accvgpr_write_b32 a130, 0
    v_accvgpr_write_b32 a131, 0
    v_accvgpr_write_b32 a132, 0
    v_accvgpr_write_b32 a133, 0
    v_accvgpr_write_b32 a134, 0
    v_accvgpr_write_b32 a135, 0
    v_accvgpr_write_b32 a136, 0
    v_accvgpr_write_b32 a137, 0
    v_accvgpr_write_b32 a138, 0
    v_accvgpr_write_b32 a139, 0
    v_accvgpr_write_b32 a140, 0
    v_accvgpr_write_b32 a141, 0
    v_accvgpr_write_b32 a142, 0
    v_accvgpr_write_b32 a143, 0
    v_accvgpr_write_b32 a144, 0
    v_accvgpr_write_b32 a145, 0
    v_accvgpr_write_b32 a146, 0
    v_accvgpr_write_b32 a147, 0
    v_accvgpr_write_b32 a148, 0
    v_accvgpr_write_b32 a149, 0
    v_accvgpr_write_b32 a150, 0
    v_accvgpr_write_b32 a151, 0
    v_accvgpr_write_b32 a152, 0
    v_accvgpr_write_b32 a153, 0
    v_accvgpr_write_b32 a154, 0
    v_accvgpr_write_b32 a155, 0
    v_accvgpr_write_b32 a156, 0
    v_accvgpr_write_b32 a157, 0
    v_accvgpr_write_b32 a158, 0
    v_accvgpr_write_b32 a159, 0
    v_accvgpr_write_b32 a160, 0
    v_accvgpr_write_b32 a161, 0
    v_accvgpr_write_b32 a162, 0
    v_accvgpr_write_b32 a163, 0
    v_accvgpr_write_b32 a164, 0
    v_accvgpr_write_b32 a165, 0
    v_accvgpr_write_b32 a166, 0
    v_accvgpr_write_b32 a167, 0
    v_accvgpr_write_b32 a168, 0
    v_accvgpr_write_b32 a169, 0
    v_accvgpr_write_b32 a170, 0
    v_accvgpr_write_b32 a171, 0
    v_accvgpr_write_b32 a172, 0
    v_accvgpr_write_b32 a173, 0
    v_accvgpr_write_b32 a174, 0
    v_accvgpr_write_b32 a175, 0
    v_accvgpr_write_b32 a176, 0
    v_accvgpr_write_b32 a177, 0
    v_accvgpr_write_b32 a178, 0
    v_accvgpr_write_b32 a179, 0
    v_accvgpr_write_b32 a180, 0
    v_accvgpr_write_b32 a181, 0
    v_accvgpr_write_b32 a182, 0
    v_accvgpr_write_b32 a183, 0
    v_accvgpr_write_b32 a184, 0
    v_accvgpr_write_b32 a185, 0
    v_accvgpr_write_b32 a186, 0
    v_accvgpr_write_b32 a187, 0
    v_accvgpr_write_b32 a188, 0
    v_accvgpr_write_b32 a189, 0
    v_accvgpr_write_b32 a190, 0
    v_accvgpr_write_b32 a191, 0
    v_accvgpr_write_b32 a192, 0
    v_accvgpr_write_b32 a193, 0
    v_accvgpr_write_b32 a194, 0
    v_accvgpr_write_b32 a195, 0
    v_accvgpr_write_b32 a196, 0
    v_accvgpr_write_b32 a197, 0
    v_accvgpr_write_b32 a198, 0
    v_accvgpr_write_b32 a199, 0
    v_accvgpr_write_b32 a200, 0
    v_accvgpr_write_b32 a201, 0
    v_accvgpr_write_b32 a202, 0
    v_accvgpr_write_b32 a203, 0
    v_accvgpr_write_b32 a204, 0
    v_accvgpr_write_b32 a205, 0
    v_accvgpr_write_b32 a206, 0
    v_accvgpr_write_b32 a207, 0
    v_accvgpr_write_b32 a208, 0
    v_accvgpr_write_b32 a209, 0
    v_accvgpr_write_b32 a210, 0
    v_accvgpr_write_b32 a211, 0
    v_accvgpr_write_b32 a212, 0
    v_accvgpr_write_b32 a213, 0
    v_accvgpr_write_b32 a214, 0
    v_accvgpr_write_b32 a215, 0
    v_accvgpr_write_b32 a216, 0
    v_accvgpr_write_b32 a217, 0
    v_accvgpr_write_b32 a218, 0
    v_accvgpr_write_b32 a219, 0
    v_accvgpr_write_b32 a220, 0
    v_accvgpr_write_b32 a221, 0
    v_accvgpr_write_b32 a222, 0
    v_accvgpr_write_b32 a223, 0
    v_accvgpr_write_b32 a224, 0
    v_accvgpr_write_b32 a225, 0
    v_accvgpr_write_b32 a226, 0
    v_accvgpr_write_b32 a227, 0
    v_accvgpr_write_b32 a228, 0
    v_accvgpr_write_b32 a229, 0
    v_accvgpr_write_b32 a230, 0
    v_accvgpr_write_b32 a231, 0
    v_accvgpr_write_b32 a232, 0
    v_accvgpr_write_b32 a233, 0
    v_accvgpr_write_b32 a234, 0
    v_accvgpr_write_b32 a235, 0
    v_accvgpr_write_b32 a236, 0
    v_accvgpr_write_b32 a237, 0
    v_accvgpr_write_b32 a238, 0
    v_accvgpr_write_b32 a239, 0
    v_accvgpr_write_b32 a240, 0
    v_accvgpr_write_b32 a241, 0
    v_accvgpr_write_b32 a242, 0
    v_accvgpr_write_b32 a243, 0
    v_accvgpr_write_b32 a244, 0
    v_accvgpr_write_b32 a245, 0
    v_accvgpr_write_b32 a246, 0
    v_accvgpr_write_b32 a247, 0
    v_accvgpr_write_b32 a248, 0
    v_accvgpr_write_b32 a249, 0
    v_accvgpr_write_b32 a250, 0
    v_accvgpr_write_b32 a251, 0
    v_accvgpr_write_b32 a252, 0
    v_accvgpr_write_b32 a253, 0
    v_accvgpr_write_b32 a254, 0
    v_accvgpr_write_b32 a255, 0
    s_waitcnt vmcnt(24)
    s_barrier
    ds_read_b64_tr_b16 v[96:97], v10 offset:0
    ds_read_b64_tr_b16 v[98:99], v10 offset:2048
    ds_read_b128 v[64:67], v8 offset:0
    ds_read_b64_tr_b16 v[100:101], v11 offset:0
    ds_read_b64_tr_b16 v[102:103], v11 offset:2048
    ds_read_b128 v[68:71], v8 offset:1024
    ds_read_b64_tr_b16 v[104:105], v12 offset:0
    ds_read_b64_tr_b16 v[106:107], v12 offset:2048
    ds_read_b128 v[72:75], v8 offset:2048
    ds_read_b64_tr_b16 v[108:109], v13 offset:0
    ds_read_b64_tr_b16 v[110:111], v13 offset:2048
    ds_read_b128 v[76:79], v8 offset:3072
    ds_read_b64_tr_b16 v[112:113], v14 offset:0
    ds_read_b64_tr_b16 v[114:115], v14 offset:2048
    ds_read_b128 v[80:83], v8 offset:4096
    ds_read_b64_tr_b16 v[116:117], v15 offset:0
    ds_read_b64_tr_b16 v[118:119], v15 offset:2048
    ds_read_b128 v[84:87], v8 offset:5120
    ds_read_b64_tr_b16 v[120:121], v16 offset:0
    ds_read_b64_tr_b16 v[122:123], v16 offset:2048
    ds_read_b128 v[88:91], v8 offset:6144
    ds_read_b64_tr_b16 v[124:125], v17 offset:0
    ds_read_b64_tr_b16 v[126:127], v17 offset:2048
    ds_read_b128 v[92:95], v8 offset:7168
    s_mov_b32 s51, 7
Gq_loop:
    s_waitcnt vmcnt(16) lgkmcnt(0)
    s_barrier
    v_mfma_f32_16x16x32_bf16 a[0:3], v[96:99], v[64:67], a[0:3]
    ds_read_b64_tr_b16 v[160:161], v10 offset:32768
    v_mfma_f32_16x16x32_bf16 a[4:7], v[96:99], v[68:71], a[4:7]
    ds_read_b64_tr_b16 v[162:163], v10 offset:34816
    v_mfma_f32_16x16x32_bf16 a[8:11], v[96:99], v[72:75], a[8:11]
    ds_read_b128 v[128:131], v8 offset:32768
    s_add_u32 m0, s48, 0
    s_nop 0
    buffer_load_dwordx4 v18, s[8:11], s40 offen  lds
    s_add_u32 s40, s40, 1024
    v_mfma_f32_16x16x32_bf16 a[12:15], v[96:99], v[76:79], a[12:15]
    ds_read_b64_tr_b16 v[164:165], v11 offset:32768
    v_mfma_f32_16x16x32_bf16 a[16:19], v[96:99], v[80:83], a[16:19]
    ds_read_b64_tr_b16 v[166:167], v11 offset:34816
    v_mfma_f32_16x16x32_bf16 a[20:23], v[96:99], v[84:87], a[20:23]
    ds_read_b128 v[132:135], v8 offset:33792
    v_mfma_f32_16x16x32_bf16 a[24:27], v[96:99], v[88:91], a[24:27]
    ds_read_b64_tr_b16 v[168:169], v12 offset:32768
    v_mfma_f32_16x16x32_bf16 a[28:31], v[96:99], v[92:95], a[28:31]
    ds_read_b64_tr_b16 v[170:171], v12 offset:34816
    v_mfma_f32_16x16x32_bf16 a[32:35], v[100:103], v[64:67], a[32:35]
    ds_read_b128 v[136:139], v8 offset:34816
    v_mfma_f32_16x16x32_bf16 a[36:39], v[100:103], v[68:71], a[36:39]
    ds_read_b64_tr_b16 v[172:173], v13 offset:32768
    s_add_u32 m0, s48, 1024
    s_nop 0
    buffer_load_dwordx4 v18, s[8:11], s41 offen  lds
    s_add_u32 s41, s41, 1024
    v_mfma_f32_16x16x32_bf16 a[40:43], v[100:103], v[72:75], a[40:43]
    ds_read_b64_tr_b16 v[174:175], v13 offset:34816
    v_mfma_f32_16x16x32_bf16 a[44:47], v[100:103], v[76:79], a[44:47]
    ds_read_b128 v[140:143], v8 offset:35840
    v_mfma_f32_16x16x32_bf16 a[48:51], v[100:103], v[80:83], a[48:51]
    ds_read_b64_tr_b16 v[176:177], v14 offset:32768
    v_mfma_f32_16x16x32_bf16 a[52:55], v[100:103], v[84:87], a[52:55]
    ds_read_b64_tr_b16 v[178:179], v14 offset:34816
    v_mfma_f32_16x16x32_bf16 a[56:59], v[100:103], v[88:91], a[56:59]
    ds_read_b128 v[144:147], v8 offset:36864
    v_mfma_f32_16x16x32_bf16 a[60:63], v[100:103], v[92:95], a[60:63]
    ds_read_b64_tr_b16 v[180:181], v15 offset:32768
    v_mfma_f32_16x16x32_bf16 a[64:67], v[104:107], v[64:67], a[64:67]
    ds_read_b64_tr_b16 v[182:183], v15 offset:34816
    s_add_u32 m0, s48, 2048
    s_nop 0
    buffer_load_dwordx4 v18, s[8:11], s42 offen  lds
    s_add_u32 s42, s42, 1024
    v_mfma_f32_16x16x32_bf16 a[68:71], v[104:107], v[68:71], a[68:71]
    ds_read_b128 v[148:151], v8 offset:37888
    v_mfma_f32_16x16x32_bf16 a[72:75], v[104:107], v[72:75], a[72:75]
    ds_read_b64_tr_b16 v[184:185], v16 offset:32768
    v_mfma_f32_16x16x32_bf16 a[76:79], v[104:107], v[76:79], a[76:79]
    ds_read_b64_tr_b16 v[186:187], v16 offset:34816
    v_mfma_f32_16x16x32_bf16 a[80:83], v[104:107], v[80:83], a[80:83]
    ds_read_b128 v[152:155], v8 offset:38912
    v_mfma_f32_16x16x32_bf16 a[84:87], v[104:107], v[84:87], a[84:87]
    ds_read_b64_tr_b16 v[188:189], v17 offset:32768
    v_mfma_f32_16x16x32_bf16 a[88:91], v[104:107], v[88:91], a[88:91]
    ds_read_b64_tr_b16 v[190:191], v17 offset:34816
    v_mfma_f32_16x16x32_bf16 a[92:95], v[104:107], v[92:95], a[92:95]
    ds_read_b128 v[156:159], v8 offset:39936
    s_add_u32 m0, s48, 3072
    s_nop 0
    buffer_load_dwordx4 v18, s[8:11], s43 offen  lds
    s_add_u32 s43, s43, 1024
    s_add_u32 s48, s48, 32768
    s_and_b32 s48, s48, 0x1ffff
    v_mfma_f32_16x16x32_bf16 a[96:99], v[108:111], v[64:67], a[96:99]
    v_mfma_f32_16x16x32_bf16 a[100:103], v[108:111], v[68:71], a[100:103]
    v_mfma_f32_16x16x32_bf16 a[104:107], v[108:111], v[72:75], a[104:107]
    v_mfma_f32_16x16x32_bf16 a[108:111], v[108:111], v[76:79], a[108:111]
    v_mfma_f32_16x16x32_bf16 a[112:115], v[108:111], v[80:83], a[112:115]
    v_mfma_f32_16x16x32_bf16 a[116:119], v[108:111], v[84:87], a[116:119]
    v_mfma_f32_16x16x32_bf16 a[120:123], v[108:111], v[88:91], a[120:123]
    s_add_u32 m0, s49, 0
    s_nop 0
    buffer_load_dwordx4 v19, s[12:15], s44 offen lds
    s_add_u32 s44, s44, s50
    v_mfma_f32_16x16x32_bf16 a[124:127], v[108:111], v[92:95], a[124:127]
    v_mfma_f32_16x16x32_bf16 a[128:131], v[112:115], v[64:67], a[128:131]
    v_mfma_f32_16x16x32_bf16 a[132:135], v[112:115], v[68:71], a[132:135]
    v_mfma_f32_16x16x32_bf16 a[136:139], v[112:115], v[72:75], a[136:139]
    v_mfma_f32_16x16x32_bf16 a[140:143], v[112:115], v[76:79], a[140:143]
    v_mfma_f32_16x16x32_bf16 a[144:147], v[112:115], v[80:83], a[144:147]
    v_mfma_f32_16x16x32_bf16 a[148:151], v[112:115], v[84:87], a[148:151]
    s_add_u32 m0, s49, 2048
    s_nop 0
    buffer_load_dwordx4 v19, s[12:15], s45 offen lds
    s_add_u32 s45, s45, s50
    v_mfma_f32_16x16x32_bf16 a[152:155], v[112:115], v[88:91], a[152:155]
    v_mfma_f32_16x16x32_bf16 a[156:159], v[112:115], v[92:95], a[156:159]
    v_mfma_f32_16x16x32_bf16 a[160:163], v[116:119], v[64:67], a[160:163]
    v_mfma_f32_16x16x32_bf16 a[164:167], v[116:119], v[68:71], a[164:167]
    v_mfma_f32_16x16x32_bf16 a[168:171], v[116:119], v[72:75], a[168:171]
    v_mfma_f32_16x16x32_bf16 a[172:175], v[116:119], v[76:79], a[172:175]
    v_mfma_f32_16x16x32_bf16 a[176:179], v[116:119], v[80:83], a[176:179]
    s_add_u32 m0, s49, 8192
    s_nop 0
    buffer_load_dwordx4 v19, s[12:15], s46 offen lds
    s_add_u32 s46, s46, s50
    v_mfma_f32_16x16x32_bf16 a[180:183], v[116:119], v[84:87], a[180:183]
    v_mfma_f32_16x16x32_bf16 a[184:187], v[116:119], v[88:91], a[184:187]
    v_mfma_f32_16x16x32_bf16 a[188:191], v[116:119], v[92:95], a[188:191]
    v_mfma_f32_16x16x32_bf16 a[192:195], v[120:123], v[64:67], a[192:195]
    v_mfma_f32_16x16x32_bf16 a[196:199], v[120:123], v[68:71], a[196:199]
    v_mfma_f32_16x16x32_bf16 a[200:203], v[120:123], v[72:75], a[200:203]
    v_mfma_f32_16x16x32_bf16 a[204:207], v[120:123], v[76:79], a[204:207]
    s_add_u32 m0, s49, 10240
    s_nop 0
    buffer_load_dwordx4 v19, s[12:15], s47 offen lds
    s_add_u32 s47, s47, s50
    s_add_u32 s49, s49, 32768
    s_and_b32 s49, s49, 0x1ffff
    v_mfma_f32_16x16x32_bf16 a[208:211], v[120:123], v[80:83], a[208:211]
    v_mfma_f32_16x16x32_bf16 a[212:215], v[120:123], v[84:87], a[212:215]
    v_mfma_f32_16x16x32_bf16 a[216:219], v[120:123], v[88:91], a[216:219]
    v_mfma_f32_16x16x32_bf16 a[220:223], v[120:123], v[92:95], a[220:223]
    v_mfma_f32_16x16x32_bf16 a[224:227], v[124:127], v[64:67], a[224:227]
    v_mfma_f32_16x16x32_bf16 a[228:231], v[124:127], v[68:71], a[228:231]
    v_mfma_f32_16x16x32_bf16 a[232:235], v[124:127], v[72:75], a[232:235]
    v_mfma_f32_16x16x32_bf16 a[236:239], v[124:127], v[76:79], a[236:239]
    v_mfma_f32_16x16x32_bf16 a[240:243], v[124:127], v[80:83], a[240:243]
    v_mfma_f32_16x16x32_bf16 a[244:247], v[124:127], v[84:87], a[244:247]
    v_mfma_f32_16x16x32_bf16 a[248:251], v[124:127], v[88:91], a[248:251]
    v_mfma_f32_16x16x32_bf16 a[252:255], v[124:127], v[92:95], a[252:255]
    v_xor_b32 v8, 0x10000, v8
    v_xor_b32 v10, 0x10000, v10
    v_xor_b32 v11, 0x10000, v11
    v_xor_b32 v12, 0x10000, v12
    v_xor_b32 v13, 0x10000, v13
    v_xor_b32 v14, 0x10000, v14
    v_xor_b32 v15, 0x10000, v15
    v_xor_b32 v16, 0x10000, v16
    v_xor_b32 v17, 0x10000, v17
    s_waitcnt vmcnt(16) lgkmcnt(0)
    s_barrier
    v_mfma_f32_16x16x32_bf16 a[0:3], v[160:163], v[128:131], a[0:3]
    ds_read_b64_tr_b16 v[96:97], v10 offset:0
    v_mfma_f32_16x16x32_bf16 a[4:7], v[160:163], v[132:135], a[4:7]
    ds_read_b64_tr_b16 v[98:99], v10 offset:2048
    v_mfma_f32_16x16x32_bf16 a[8:11], v[160:163], v[136:139], a[8:11]
    ds_read_b128 v[64:67], v8 offset:0
    s_add_u32 m0, s48, 0
    s_nop 0
    buffer_load_dwordx4 v18, s[8:11], s40 offen  lds
    s_add_u32 s40, s40, 1024
    v_mfma_f32_16x16x32_bf16 a[12:15], v[160:163], v[140:143], a[12:15]
    ds_read_b64_tr_b16 v[100:101], v11 offset:0
    v_mfma_f32_16x16x32_bf16 a[16:19], v[160:163], v[144:147], a[16:19]
    ds_read_b64_tr_b16 v[102:103], v11 offset:2048
    v_mfma_f32_16x16x32_bf16 a[20:23], v[160:163], v[148:151], a[20:23]
    ds_read_b128 v[68:71], v8 offset:1024
    v_mfma_f32_16x16x32_bf16 a[24:27], v[160:163], v[152:155], a[24:27]
    ds_read_b64_tr_b16 v[104:105], v12 offset:0
    v_mfma_f32_16x16x32_bf16 a[28:31], v[160:163], v[156:159], a[28:31]
    ds_read_b64_tr_b16 v[106:107], v12 offset:2048
    v_mfma_f32_16x16x32_bf16 a[32:35], v[164:167], v[128:131], a[32:35]
    ds_read_b128 v[72:75], v8 offset:2048
    v_mfma_f32_16x16x32_bf16 a[36:39], v[164:167], v[132:135], a[36:39]
    ds_read_b64_tr_b16 v[108:109], v13 offset:0
    s_add_u32 m0, s48, 1024
    s_nop 0
    buffer_load_dwordx4 v18, s[8:11], s41 offen  lds
    s_add_u32 s41, s41, 1024
    v_mfma_f32_16x16x32_bf16 a[40:43], v[164:167], v[136:139], a[40:43]
    ds_read_b64_tr_b16 v[110:111], v13 offset:2048
    v_mfma_f32_16x16x32_bf16 a[44:47], v[164:167], v[140:143], a[44:47]
    ds_read_b128 v[76:79], v8 offset:3072
    v_mfma_f32_16x16x32_bf16 a[48:51], v[164:167], v[144:147], a[48:51]
    ds_read_b64_tr_b16 v[112:113], v14 offset:0
    v_mfma_f32_16x16x32_bf16 a[52:55], v[164:167], v[148:151], a[52:55]
    ds_read_b64_tr_b16 v[114:115], v14 offset:2048
    v_mfma_f32_16x16x32_bf16 a[56:59], v[164:167], v[152:155], a[56:59]
    ds_read_b128 v[80:83], v8 offset:4096
    v_mfma_f32_16x16x32_bf16 a[60:63], v[164:167], v[156:159], a[60:63]
    ds_read_b64_tr_b16 v[116:117], v15 offset:0
    v_mfma_f32_16x16x32_bf16 a[64:67], v[168:171], v[128:131], a[64:67]
    ds_read_b64_tr_b16 v[118:119], v15 offset:2048
    s_add_u32 m0, s48, 2048
    s_nop 0
    buffer_load_dwordx4 v18, s[8:11], s42 offen  lds
    s_add_u32 s42, s42, 1024
    v_mfma_f32_16x16x32_bf16 a[68:71], v[168:171], v[132:135], a[68:71]
    ds_read_b128 v[84:87], v8 offset:5120
    v_mfma_f32_16x16x32_bf16 a[72:75], v[168:171], v[136:139], a[72:75]
    ds_read_b64_tr_b16 v[120:121], v16 offset:0
    v_mfma_f32_16x16x32_bf16 a[76:79], v[168:171], v[140:143], a[76:79]
    ds_read_b64_tr_b16 v[122:123], v16 offset:2048
    v_mfma_f32_16x16x32_bf16 a[80:83], v[168:171], v[144:147], a[80:83]
    ds_read_b128 v[88:91], v8 offset:6144
    v_mfma_f32_16x16x32_bf16 a[84:87], v[168:171], v[148:151], a[84:87]
    ds_read_b64_tr_b16 v[124:125], v17 offset:0
    v_mfma_f32_16x16x32_bf16 a[88:91], v[168:171], v[152:155], a[88:91]
    ds_read_b64_tr_b16 v[126:127], v17 offset:2048
    v_mfma_f32_16x16x32_bf16 a[92:95], v[168:171], v[156:159], a[92:95]
    ds_read_b128 v[92:95], v8 offset:7168
    s_add_u32 m0, s48, 3072
    s_nop 0
    buffer_load_dwordx4 v18, s[8:11], s43 offen  lds
    s_add_u32 s43, s43, 1024
    s_add_u32 s48, s48, 32768
    s_and_b32 s48, s48, 0x1ffff
    v_mfma_f32_16x16x32_bf16 a[96:99], v[172:175], v[128:131], a[96:99]
    v_mfma_f32_16x16x32_bf16 a[100:103], v[172:175], v[132:135], a[100:103]
    v_mfma_f32_16x16x32_bf16 a[104:107], v[172:175], v[136:139], a[104:107]
    v_mfma_f32_16x16x32_bf16 a[108:111], v[172:175], v[140:143], a[108:111]
    v_mfma_f32_16x16x32_bf16 a[112:115], v[172:175], v[144:147], a[112:115]
    v_mfma_f32_16x16x32_bf16 a[116:119], v[172:175], v[148:151], a[116:119]
    v_mfma_f32_16x16x32_bf16 a[120:123], v[172:175], v[152:155], a[120:123]
    s_add_u32 m0, s49, 0
    s_nop 0
    buffer_load_dwordx4 v19, s[12:15], s44 offen lds
    s_add_u32 s44, s44, s50
    v_mfma_f32_16x16x32_bf16 a[124:127], v[172:175], v[156:159], a[124:127]
    v_mfma_f32_16x16x32_bf16 a[128:131], v[176:179], v[128:131], a[128:131]
    v_mfma_f32_16x16x32_bf16 a[132:135], v[176:179], v[132:135], a[132:135]
    v_mfma_f32_16x16x32_bf16 a[136:139], v[176:179], v[136:139], a[136:139]
    v_mfma_f32_16x16x32_bf16 a[140:143], v[176:179], v[140:143], a[140:143]
    v_mfma_f32_16x16x32_bf16 a[144:147], v[176:179], v[144:147], a[144:147]
    v_mfma_f32_16x16x32_bf16 a[148:151], v[176:179], v[148:151], a[148:151]
    s_add_u32 m0, s49, 2048
    s_nop 0
    buffer_load_dwordx4 v19, s[12:15], s45 offen lds
    s_add_u32 s45, s45, s50
    v_mfma_f32_16x16x32_bf16 a[152:155], v[176:179], v[152:155], a[152:155]
    v_mfma_f32_16x16x32_bf16 a[156:159], v[176:179], v[156:159], a[156:159]
    v_mfma_f32_16x16x32_bf16 a[160:163], v[180:183], v[128:131], a[160:163]
    v_mfma_f32_16x16x32_bf16 a[164:167], v[180:183], v[132:135], a[164:167]
    v_mfma_f32_16x16x32_bf16 a[168:171], v[180:183], v[136:139], a[168:171]
    v_mfma_f32_16x16x32_bf16 a[172:175], v[180:183], v[140:143], a[172:175]
    v_mfma_f32_16x16x32_bf16 a[176:179], v[180:183], v[144:147], a[176:179]
    s_add_u32 m0, s49, 8192
    s_nop 0
    buffer_load_dwordx4 v19, s[12:15], s46 offen lds
    s_add_u32 s46, s46, s50
    v_mfma_f32_16x16x32_bf16 a[180:183], v[180:183], v[148:151], a[180:183]
    v_mfma_f32_16x16x32_bf16 a[184:187], v[180:183], v[152:155], a[184:187]
    v_mfma_f32_16x16x32_bf16 a[188:191], v[180:183], v[156:159], a[188:191]
    v_mfma_f32_16x16x32_bf16 a[192:195], v[184:187], v[128:131], a[192:195]
    v_mfma_f32_16x16x32_bf16 a[196:199], v[184:187], v[132:135], a[196:199]
    v_mfma_f32_16x16x32_bf16 a[200:203], v[184:187], v[136:139], a[200:203]
    v_mfma_f32_16x16x32_bf16 a[204:207], v[184:187], v[140:143], a[204:207]
    s_add_u32 m0, s49, 10240
    s_nop 0
    buffer_load_dwordx4 v19, s[12:15], s47 offen lds
    s_add_u32 s47, s47, s50
    s_add_u32 s49, s49, 32768
    s_and_b32 s49, s49, 0x1ffff
    v_mfma_f32_16x16x32_bf16 a[208:211], v[184:187], v[144:147], a[208:211]
    v_mfma_f32_16x16x32_bf16 a[212:215], v[184:187], v[148:151], a[212:215]
    v_mfma_f32_16x16x32_bf16 a[216:219], v[184:187], v[152:155], a[216:219]
    v_mfma_f32_16x16x32_bf16 a[220:223], v[184:187], v[156:159], a[220:223]
    v_mfma_f32_16x16x32_bf16 a[224:227], v[188:191], v[128:131], a[224:227]
    v_mfma_f32_16x16x32_bf16 a[228:231], v[188:191], v[132:135], a[228:231]
    v_mfma_f32_16x16x32_bf16 a[232:235], v[188:191], v[136:139], a[232:235]
    v_mfma_f32_16x16x32_bf16 a[236:239], v[188:191], v[140:143], a[236:239]
    v_mfma_f32_16x16x32_bf16 a[240:243], v[188:191], v[144:147], a[240:243]
    v_mfma_f32_16x16x32_bf16 a[244:247], v[188:191], v[148:151], a[244:247]
    v_mfma_f32_16x16x32_bf16 a[248:251], v[188:191], v[152:155], a[248:251]
    v_mfma_f32_16x16x32_bf16 a[252:255], v[188:191], v[156:159], a[252:255]
    s_sub_u32 s51, s51, 1
    s_cmp_lg_u32 s51, 0
    s_cbranch_scc1 Gq_loop
    s_waitcnt vmcnt(16) lgkmcnt(0)
    s_barrier
    v_mfma_f32_16x16x32_bf16 a[0:3], v[96:99], v[64:67], a[0:3]
    ds_read_b64_tr_b16 v[160:161], v10 offset:32768
    v_mfma_f32_16x16x32_bf16 a[4:7], v[96:99], v[68:71], a[4:7]
    ds_read_b64_tr_b16 v[162:163], v10 offset:34816
    v_mfma_f32_16x16x32_bf16 a[8:11], v[96:99], v[72:75], a[8:11]
    ds_read_b128 v[128:131], v8 offset:32768
    v_mfma_f32_16x16x32_bf16 a[12:15], v[96:99], v[76:79], a[12:15]
    ds_read_b64_tr_b16 v[164:165], v11 offset:32768
    v_mfma_f32_16x16x32_bf16 a[16:19], v[96:99], v[80:83], a[16:19]
    ds_read_b64_tr_b16 v[166:167], v11 offset:34816
    v_mfma_f32_16x16x32_bf16 a[20:23], v[96:99], v[84:87], a[20:23]
    ds_read_b128 v[132:135], v8 offset:33792
    v_mfma_f32_16x16x32_bf16 a[24:27], v[96:99], v[88:91], a[24:27]
    ds_read_b64_tr_b16 v[168:169], v12 offset:32768
    v_mfma_f32_16x16x32_bf16 a[28:31], v[96:99], v[92:95], a[28:31]
    ds_read_b64_tr_b16 v[170:171], v12 offset:34816
    v_mfma_f32_16x16x32_bf16 a[32:35], v[100:103], v[64:67], a[32:35]
    ds_read_b128 v[136:139], v8 offset:34816
    v_mfma_f32_16x16x32_bf16 a[36:39], v[100:103], v[68:71], a[36:39]
    ds_read_b64_tr_b16 v[172:173], v13 offset:32768
    v_mfma_f32_16x16x32_bf16 a[40:43], v[100:103], v[72:75], a[40:43]
    ds_read_b64_tr_b16 v[174:175], v13 offset:34816
    v_mfma_f32_16x16x32_bf16 a[44:47], v[100:103], v[76:79], a[44:47]
    ds_read_b128 v[140:143], v8 offset:35840
    v_mfma_f32_16x16x32_bf16 a[48:51], v[100:103], v[80:83], a[48:51]
    ds_read_b64_tr_b16 v[176:177], v14 offset:32768
    v_mfma_f32_16x16x32_bf16 a[52:55], v[100:103], v[84:87], a[52:55]
    ds_read_b64_tr_b16 v[178:179], v14 offset:34816
    v_mfma_f32_16x16x32_bf16 a[56:59], v[100:103], v[88:91], a[56:59]
    ds_read_b128 v[144:147], v8 offset:36864
    v_mfma_f32_16x16x32_bf16 a[60:63], v[100:103], v[92:95], a[60:63]
    ds_read_b64_tr_b16 v[180:181], v15 offset:32768
    v_mfma_f32_16x16x32_bf16 a[64:67], v[104:107], v[64:67], a[64:67]
    ds_read_b64_tr_b16 v[182:183], v15 offset:34816
    v_mfma_f32_16x16x32_bf16 a[68:71], v[104:107], v[68:71], a[68:71]
    ds_read_b128 v[148:151], v8 offset:37888
    v_mfma_f32_16x16x32_bf16 a[72:75], v[104:107], v[72:75], a[72:75]
    ds_read_b64_tr_b16 v[184:185], v16 offset:32768
    v_mfma_f32_16x16x32_bf16 a[76:79], v[104:107], v[76:79], a[76:79]
    ds_read_b64_tr_b16 v[186:187], v16 offset:34816
    v_mfma_f32_16x16x32_bf16 a[80:83], v[104:107], v[80:83], a[80:83]
    ds_read_b128 v[152:155], v8 offset:38912
    v_mfma_f32_16x16x32_bf16 a[84:87], v[104:107], v[84:87], a[84:87]
    ds_read_b64_tr_b16 v[188:189], v17 offset:32768
    v_mfma_f32_16x16x32_bf16 a[88:91], v[104:107], v[88:91], a[88:91]
    ds_read_b64_tr_b16 v[190:191], v17 offset:34816
    v_mfma_f32_16x16x32_bf16 a[92:95], v[104:107], v[92:95], a[92:95]
    ds_read_b128 v[156:159], v8 offset:39936
    v_mfma_f32_16x16x32_bf16 a[96:99], v[108:111], v[64:67], a[96:99]
    v_mfma_f32_16x16x32_bf16 a[100:103], v[108:111], v[68:71], a[100:103]
    v_mfma_f32_16x16x32_bf16 a[104:107], v[108:111], v[72:75], a[104:107]
    v_mfma_f32_16x16x32_bf16 a[108:111], v[108:111], v[76:79], a[108:111]
    v_mfma_f32_16x16x32_bf16 a[112:115], v[108:111], v[80:83], a[112:115]
    v_mfma_f32_16x16x32_bf16 a[116:119], v[108:111], v[84:87], a[116:119]
    v_mfma_f32_16x16x32_bf16 a[120:123], v[108:111], v[88:91], a[120:123]
    v_mfma_f32_16x16x32_bf16 a[124:127], v[108:111], v[92:95], a[124:127]
    v_mfma_f32_16x16x32_bf16 a[128:131], v[112:115], v[64:67], a[128:131]
    v_mfma_f32_16x16x32_bf16 a[132:135], v[112:115], v[68:71], a[132:135]
    v_mfma_f32_16x16x32_bf16 a[136:139], v[112:115], v[72:75], a[136:139]
    v_mfma_f32_16x16x32_bf16 a[140:143], v[112:115], v[76:79], a[140:143]
    v_mfma_f32_16x16x32_bf16 a[144:147], v[112:115], v[80:83], a[144:147]
    v_mfma_f32_16x16x32_bf16 a[148:151], v[112:115], v[84:87], a[148:151]
    v_mfma_f32_16x16x32_bf16 a[152:155], v[112:115], v[88:91], a[152:155]
    v_mfma_f32_16x16x32_bf16 a[156:159], v[112:115], v[92:95], a[156:159]
    v_mfma_f32_16x16x32_bf16 a[160:163], v[116:119], v[64:67], a[160:163]
    v_mfma_f32_16x16x32_bf16 a[164:167], v[116:119], v[68:71], a[164:167]
    v_mfma_f32_16x16x32_bf16 a[168:171], v[116:119], v[72:75], a[168:171]
    v_mfma_f32_16x16x32_bf16 a[172:175], v[116:119], v[76:79], a[172:175]
    v_mfma_f32_16x16x32_bf16 a[176:179], v[116:119], v[80:83], a[176:179]
    v_mfma_f32_16x16x32_bf16 a[180:183], v[116:119], v[84:87], a[180:183]
    v_mfma_f32_16x16x32_bf16 a[184:187], v[116:119], v[88:91], a[184:187]
    v_mfma_f32_16x16x32_bf16 a[188:191], v[116:119], v[92:95], a[188:191]
    v_mfma_f32_16x16x32_bf16 a[192:195], v[120:123], v[64:67], a[192:195]
    v_mfma_f32_16x16x32_bf16 a[196:199], v[120:123], v[68:71], a[196:199]
    v_mfma_f32_16x16x32_bf16 a[200:203], v[120:123], v[72:75], a[200:203]
    v_mfma_f32_16x16x32_bf16 a[204:207], v[120:123], v[76:79], a[204:207]
    v_mfma_f32_16x16x32_bf16 a[208:211], v[120:123], v[80:83], a[208:211]
    v_mfma_f32_16x16x32_bf16 a[212:215], v[120:123], v[84:87], a[212:215]
    v_mfma_f32_16x16x32_bf16 a[216:219], v[120:123], v[88:91], a[216:219]
    v_mfma_f32_16x16x32_bf16 a[220:223], v[120:123], v[92:95], a[220:223]
    v_mfma_f32_16x16x32_bf16 a[224:227], v[124:127], v[64:67], a[224:227]
    v_mfma_f32_16x16x32_bf16 a[228:231], v[124:127], v[68:71], a[228:231]
    v_mfma_f32_16x16x32_bf16 a[232:235], v[124:127], v[72:75], a[232:235]
    v_mfma_f32_16x16x32_bf16 a[236:239], v[124:127], v[76:79], a[236:239]
    v_mfma_f32_16x16x32_bf16 a[240:243], v[124:127], v[80:83], a[240:243]
    v_mfma_f32_16x16x32_bf16 a[244:247], v[124:127], v[84:87], a[244:247]
    v_mfma_f32_16x16x32_bf16 a[248:251], v[124:127], v[88:91], a[248:251]
    v_mfma_f32_16x16x32_bf16 a[252:255], v[124:127], v[92:95], a[252:255]
    v_xor_b32 v8, 0x10000, v8
    v_xor_b32 v10, 0x10000, v10
    v_xor_b32 v11, 0x10000, v11
    v_xor_b32 v12, 0x10000, v12
    v_xor_b32 v13, 0x10000, v13
    v_xor_b32 v14, 0x10000, v14
    v_xor_b32 v15, 0x10000, v15
    v_xor_b32 v16, 0x10000, v16
    v_xor_b32 v17, 0x10000, v17
    s_waitcnt vmcnt(8) lgkmcnt(0)
    s_barrier
    v_mfma_f32_16x16x32_bf16 a[0:3], v[160:163], v[128:131], a[0:3]
    ds_read_b64_tr_b16 v[96:97], v10 offset:0
    v_mfma_f32_16x16x32_bf16 a[4:7], v[160:163], v[132:135], a[4:7]
    ds_read_b64_tr_b16 v[98:99], v10 offset:2048
    v_mfma_f32_16x16x32_bf16 a[8:11], v[160:163], v[136:139], a[8:11]
    ds_read_b128 v[64:67], v8 offset:0
    v_mfma_f32_16x16x32_bf16 a[12:15], v[160:163], v[140:143], a[12:15]
    ds_read_b64_tr_b16 v[100:101], v11 offset:0
    v_mfma_f32_16x16x32_bf16 a[16:19], v[160:163], v[144:147], a[16:19]
    ds_read_b64_tr_b16 v[102:103], v11 offset:2048
    v_mfma_f32_16x16x32_bf16 a[20:23], v[160:163], v[148:151], a[20:23]
    ds_read_b128 v[68:71], v8 offset:1024
    v_mfma_f32_16x16x32_bf16 a[24:27], v[160:163], v[152:155], a[24:27]
    ds_read_b64_tr_b16 v[104:105], v12 offset:0
    v_mfma_f32_16x16x32_bf16 a[28:31], v[160:163], v[156:159], a[28:31]
    ds_read_b64_tr_b16 v[106:107], v12 offset:2048
    v_mfma_f32_16x16x32_bf16 a[32:35], v[164:167], v[128:131], a[32:35]
    ds_read_b128 v[72:75], v8 offset:2048
    v_mfma_f32_16x16x32_bf16 a[36:39], v[164:167], v[132:135], a[36:39]
    ds_read_b64_tr_b16 v[108:109], v13 offset:0
    v_mfma_f32_16x16x32_bf16 a[40:43], v[164:167], v[136:139], a[40:43]
    ds_read_b64_tr_b16 v[110:111], v13 offset:2048
    v_mfma_f32_16x16x32_bf16 a[44:47], v[164:167], v[140:143], a[44:47]
    ds_read_b128 v[76:79], v8 offset:3072
    v_mfma_f32_16x16x32_bf16 a[48:51], v[164:167], v[144:147], a[48:51]
    ds_read_b64_tr_b16 v[112:113], v14 offset:0
    v_mfma_f32_16x16x32_bf16 a[52:55], v[164:167], v[148:151], a[52:55]
    ds_read_b64_tr_b16 v[114:115], v14 offset:2048
    v_mfma_f32_16x16x32_bf16 a[56:59], v[164:167], v[152:155], a[56:59]
    ds_read_b128 v[80:83], v8 offset:4096
    v_mfma_f32_16x16x32_bf16 a[60:63], v[164:167], v[156:159], a[60:63]
    ds_read_b64_tr_b16 v[116:117], v15 offset:0
    v_mfma_f32_16x16x32_bf16 a[64:67], v[168:171], v[128:131], a[64:67]
    ds_read_b64_tr_b16 v[118:119], v15 offset:2048
    v_mfma_f32_16x16x32_bf16 a[68:71], v[168:171], v[132:135], a[68:71]
    ds_read_b128 v[84:87], v8 offset:5120
    v_mfma_f32_16x16x32_bf16 a[72:75], v[168:171], v[136:139], a[72:75]
    ds_read_b64_tr_b16 v[120:121], v16 offset:0
    v_mfma_f32_16x16x32_bf16 a[76:79], v[168:171], v[140:143], a[76:79]
    ds_read_b64_tr_b16 v[122:123], v16 offset:2048
    v_mfma_f32_16x16x32_bf16 a[80:83], v[168:171], v[144:147], a[80:83]
    ds_read_b128 v[88:91], v8 offset:6144
    v_mfma_f32_16x16x32_bf16 a[84:87], v[168:171], v[148:151], a[84:87]
    ds_read_b64_tr_b16 v[124:125], v17 offset:0
    v_mfma_f32_16x16x32_bf16 a[88:91], v[168:171], v[152:155], a[88:91]
    ds_read_b64_tr_b16 v[126:127], v17 offset:2048
    v_mfma_f32_16x16x32_bf16 a[92:95], v[168:171], v[156:159], a[92:95]
    ds_read_b128 v[92:95], v8 offset:7168
    v_mfma_f32_16x16x32_bf16 a[96:99], v[172:175], v[128:131], a[96:99]
    v_mfma_f32_16x16x32_bf16 a[100:103], v[172:175], v[132:135], a[100:103]
    v_mfma_f32_16x16x32_bf16 a[104:107], v[172:175], v[136:139], a[104:107]
    v_mfma_f32_16x16x32_bf16 a[108:111], v[172:175], v[140:143], a[108:111]
    v_mfma_f32_16x16x32_bf16 a[112:115], v[172:175], v[144:147], a[112:115]
    v_mfma_f32_16x16x32_bf16 a[116:119], v[172:175], v[148:151], a[116:119]
    v_mfma_f32_16x16x32_bf16 a[120:123], v[172:175], v[152:155], a[120:123]
    v_mfma_f32_16x16x32_bf16 a[124:127], v[172:175], v[156:159], a[124:127]
    v_mfma_f32_16x16x32_bf16 a[128:131], v[176:179], v[128:131], a[128:131]
    v_mfma_f32_16x16x32_bf16 a[132:135], v[176:179], v[132:135], a[132:135]
    v_mfma_f32_16x16x32_bf16 a[136:139], v[176:179], v[136:139], a[136:139]
    v_mfma_f32_16x16x32_bf16 a[140:143], v[176:179], v[140:143], a[140:143]
    v_mfma_f32_16x16x32_bf16 a[144:147], v[176:179], v[144:147], a[144:147]
    v_mfma_f32_16x16x32_bf16 a[148:151], v[176:179], v[148:151], a[148:151]
    v_mfma_f32_16x16x32_bf16 a[152:155], v[176:179], v[152:155], a[152:155]
    v_mfma_f32_16x16x32_bf16 a[156:159], v[176:179], v[156:159], a[156:159]
    v_mfma_f32_16x16x32_bf16 a[160:163], v[180:183], v[128:131], a[160:163]
    v_mfma_f32_16x16x32_bf16 a[164:167], v[180:183], v[132:135], a[164:167]
    v_mfma_f32_16x16x32_bf16 a[168:171], v[180:183], v[136:139], a[168:171]
    v_mfma_f32_16x16x32_bf16 a[172:175], v[180:183], v[140:143], a[172:175]
    v_mfma_f32_16x16x32_bf16 a[176:179], v[180:183], v[144:147], a[176:179]
    v_mfma_f32_16x16x32_bf16 a[180:183], v[180:183], v[148:151], a[180:183]
    v_mfma_f32_16x16x32_bf16 a[184:187], v[180:183], v[152:155], a[184:187]
    v_mfma_f32_16x16x32_bf16 a[188:191], v[180:183], v[156:159], a[188:191]
    v_mfma_f32_16x16x32_bf16 a[192:195], v[184:187], v[128:131], a[192:195]
    v_mfma_f32_16x16x32_bf16 a[196:199], v[184:187], v[132:135], a[196:199]
    v_mfma_f32_16x16x32_bf16 a[200:203], v[184:187], v[136:139], a[200:203]
    v_mfma_f32_16x16x32_bf16 a[204:207], v[184:187], v[140:143], a[204:207]
    v_mfma_f32_16x16x32_bf16 a[208:211], v[184:187], v[144:147], a[208:211]
    v_mfma_f32_16x16x32_bf16 a[212:215], v[184:187], v[148:151], a[212:215]
    v_mfma_f32_16x16x32_bf16 a[216:219], v[184:187], v[152:155], a[216:219]
    v_mfma_f32_16x16x32_bf16 a[220:223], v[184:187], v[156:159], a[220:223]
    v_mfma_f32_16x16x32_bf16 a[224:227], v[188:191], v[128:131], a[224:227]
    v_mfma_f32_16x16x32_bf16 a[228:231], v[188:191], v[132:135], a[228:231]
    v_mfma_f32_16x16x32_bf16 a[232:235], v[188:191], v[136:139], a[232:235]
    v_mfma_f32_16x16x32_bf16 a[236:239], v[188:191], v[140:143], a[236:239]
    v_mfma_f32_16x16x32_bf16 a[240:243], v[188:191], v[144:147], a[240:243]
    v_mfma_f32_16x16x32_bf16 a[244:247], v[188:191], v[148:151], a[244:247]
    v_mfma_f32_16x16x32_bf16 a[248:251], v[188:191], v[152:155], a[248:251]
    v_mfma_f32_16x16x32_bf16 a[252:255], v[188:191], v[156:159], a[252:255]
    s_waitcnt vmcnt(0) lgkmcnt(0)
    s_barrier
    v_mfma_f32_16x16x32_bf16 a[0:3], v[96:99], v[64:67], a[0:3]
    ds_read_b64_tr_b16 v[160:161], v10 offset:32768
    v_mfma_f32_16x16x32_bf16 a[4:7], v[96:99], v[68:71], a[4:7]
    ds_read_b64_tr_b16 v[162:163], v10 offset:34816
    v_mfma_f32_16x16x32_bf16 a[8:11], v[96:99], v[72:75], a[8:11]
    ds_read_b128 v[128:131], v8 offset:32768
    v_mfma_f32_16x16x32_bf16 a[12:15], v[96:99], v[76:79], a[12:15]
    ds_read_b64_tr_b16 v[164:165], v11 offset:32768
    v_mfma_f32_16x16x32_bf16 a[16:19], v[96:99], v[80:83], a[16:19]
    ds_read_b64_tr_b16 v[166:167], v11 offset:34816
    v_mfma_f32_16x16x32_bf16 a[20:23], v[96:99], v[84:87], a[20:23]
    ds_read_b128 v[132:135], v8 offset:33792
    v_mfma_f32_16x16x32_bf16 a[24:27], v[96:99], v[88:91], a[24:27]
    ds_read_b64_tr_b16 v[168:169], v12 offset:32768
    v_mfma_f32_16x16x32_bf16 a[28:31], v[96:99], v[92:95], a[28:31]
    ds_read_b64_tr_b16 v[170:171], v12 offset:34816
    v_mfma_f32_16x16x32_bf16 a[32:35], v[100:103], v[64:67], a[32:35]
    ds_read_b128 v[136:139], v8 offset:34816
    v_mfma_f32_16x16x32_bf16 a[36:39], v[100:103], v[68:71], a[36:39]
    ds_read_b64_tr_b16 v[172:173], v13 offset:32768
    v_mfma_f32_16x16x32_bf16 a[40:43], v[100:103], v[72:75], a[40:43]
    ds_read_b64_tr_b16 v[174:175], v13 offset:34816
    v_mfma_f32_16x16x32_bf16 a[44:47], v[100:103], v[76:79], a[44:47]
    ds_read_b128 v[140:143], v8 offset:35840
    v_mfma_f32_16x16x32_bf16 a[48:51], v[100:103], v[80:83], a[48:51]
    ds_read_b64_tr_b16 v[176:177], v14 offset:32768
    v_mfma_f32_16x16x32_bf16 a[52:55], v[100:103], v[84:87], a[52:55]
    ds_read_b64_tr_b16 v[178:179], v14 offset:34816
    v_mfma_f32_16x16x32_bf16 a[56:59], v[100:103], v[88:91], a[56:59]
    ds_read_b128 v[144:147], v8 offset:36864
    v_mfma_f32_16x16x32_bf16 a[60:63], v[100:103], v[92:95], a[60:63]
    ds_read_b64_tr_b16 v[180:181], v15 offset:32768
    v_mfma_f32_16x16x32_bf16 a[64:67], v[104:107], v[64:67], a[64:67]
    ds_read_b64_tr_b16 v[182:183], v15 offset:34816
    v_mfma_f32_16x16x32_bf16 a[68:71], v[104:107], v[68:71], a[68:71]
    ds_read_b128 v[148:151], v8 offset:37888
    v_mfma_f32_16x16x32_bf16 a[72:75], v[104:107], v[72:75], a[72:75]
    ds_read_b64_tr_b16 v[184:185], v16 offset:32768
    v_mfma_f32_16x16x32_bf16 a[76:79], v[104:107], v[76:79], a[76:79]
    ds_read_b64_tr_b16 v[186:187], v16 offset:34816
    v_mfma_f32_16x16x32_bf16 a[80:83], v[104:107], v[80:83], a[80:83]
    ds_read_b128 v[152:155], v8 offset:38912
    v_mfma_f32_16x16x32_bf16 a[84:87], v[104:107], v[84:87], a[84:87]
    ds_read_b64_tr_b16 v[188:189], v17 offset:32768
    v_mfma_f32_16x16x32_bf16 a[88:91], v[104:107], v[88:91], a[88:91]
    ds_read_b64_tr_b16 v[190:191], v17 offset:34816
    v_mfma_f32_16x16x32_bf16 a[92:95], v[104:107], v[92:95], a[92:95]
    ds_read_b128 v[156:159], v8 offset:39936
    v_mfma_f32_16x16x32_bf16 a[96:99], v[108:111], v[64:67], a[96:99]
    v_mfma_f32_16x16x32_bf16 a[100:103], v[108:111], v[68:71], a[100:103]
    v_mfma_f32_16x16x32_bf16 a[104:107], v[108:111], v[72:75], a[104:107]
    v_mfma_f32_16x16x32_bf16 a[108:111], v[108:111], v[76:79], a[108:111]
    v_mfma_f32_16x16x32_bf16 a[112:115], v[108:111], v[80:83], a[112:115]
    v_mfma_f32_16x16x32_bf16 a[116:119], v[108:111], v[84:87], a[116:119]
    v_mfma_f32_16x16x32_bf16 a[120:123], v[108:111], v[88:91], a[120:123]
    v_mfma_f32_16x16x32_bf16 a[124:127], v[108:111], v[92:95], a[124:127]
    v_mfma_f32_16x16x32_bf16 a[128:131], v[112:115], v[64:67], a[128:131]
    v_mfma_f32_16x16x32_bf16 a[132:135], v[112:115], v[68:71], a[132:135]
    v_mfma_f32_16x16x32_bf16 a[136:139], v[112:115], v[72:75], a[136:139]
    v_mfma_f32_16x16x32_bf16 a[140:143], v[112:115], v[76:79], a[140:143]
    v_mfma_f32_16x16x32_bf16 a[144:147], v[112:115], v[80:83], a[144:147]
    v_mfma_f32_16x16x32_bf16 a[148:151], v[112:115], v[84:87], a[148:151]
    v_mfma_f32_16x16x32_bf16 a[152:155], v[112:115], v[88:91], a[152:155]
    v_mfma_f32_16x16x32_bf16 a[156:159], v[112:115], v[92:95], a[156:159]
    v_mfma_f32_16x16x32_bf16 a[160:163], v[116:119], v[64:67], a[160:163]
    v_mfma_f32_16x16x32_bf16 a[164:167], v[116:119], v[68:71], a[164:167]
    v_mfma_f32_16x16x32_bf16 a[168:171], v[116:119], v[72:75], a[168:171]
    v_mfma_f32_16x16x32_bf16 a[172:175], v[116:119], v[76:79], a[172:175]
    v_mfma_f32_16x16x32_bf16 a[176:179], v[116:119], v[80:83], a[176:179]
    v_mfma_f32_16x16x32_bf16 a[180:183], v[116:119], v[84:87], a[180:183]
    v_mfma_f32_16x16x32_bf16 a[184:187], v[116:119], v[88:91], a[184:187]
    v_mfma_f32_16x16x32_bf16 a[188:191], v[116:119], v[92:95], a[188:191]
    v_mfma_f32_16x16x32_bf16 a[192:195], v[120:123], v[64:67], a[192:195]
    v_mfma_f32_16x16x32_bf16 a[196:199], v[120:123], v[68:71], a[196:199]
    v_mfma_f32_16x16x32_bf16 a[200:203], v[120:123], v[72:75], a[200:203]
    v_mfma_f32_16x16x32_bf16 a[204:207], v[120:123], v[76:79], a[204:207]
    v_mfma_f32_16x16x32_bf16 a[208:211], v[120:123], v[80:83], a[208:211]
    v_mfma_f32_16x16x32_bf16 a[212:215], v[120:123], v[84:87], a[212:215]
    v_mfma_f32_16x16x32_bf16 a[216:219], v[120:123], v[88:91], a[216:219]
    v_mfma_f32_16x16x32_bf16 a[220:223], v[120:123], v[92:95], a[220:223]
    v_mfma_f32_16x16x32_bf16 a[224:227], v[124:127], v[64:67], a[224:227]
    v_mfma_f32_16x16x32_bf16 a[228:231], v[124:127], v[68:71], a[228:231]
    v_mfma_f32_16x16x32_bf16 a[232:235], v[124:127], v[72:75], a[232:235]
    v_mfma_f32_16x16x32_bf16 a[236:239], v[124:127], v[76:79], a[236:239]
    v_mfma_f32_16x16x32_bf16 a[240:243], v[124:127], v[80:83], a[240:243]
    v_mfma_f32_16x16x32_bf16 a[244:247], v[124:127], v[84:87], a[244:247]
    v_mfma_f32_16x16x32_bf16 a[248:251], v[124:127], v[88:91], a[248:251]
    v_mfma_f32_16x16x32_bf16 a[252:255], v[124:127], v[92:95], a[252:255]
    s_waitcnt lgkmcnt(0)
    s_barrier
    v_mfma_f32_16x16x32_bf16 a[0:3], v[160:163], v[128:131], a[0:3]
    v_mfma_f32_16x16x32_bf16 a[4:7], v[160:163], v[132:135], a[4:7]
    v_mfma_f32_16x16x32_bf16 a[8:11], v[160:163], v[136:139], a[8:11]
    v_mfma_f32_16x16x32_bf16 a[12:15], v[160:163], v[140:143], a[12:15]
    v_mfma_f32_16x16x32_bf16 a[16:19], v[160:163], v[144:147], a[16:19]
    v_mfma_f32_16x16x32_bf16 a[20:23], v[160:163], v[148:151], a[20:23]
    v_mfma_f32_16x16x32_bf16 a[24:27], v[160:163], v[152:155], a[24:27]
    v_mfma_f32_16x16x32_bf16 a[28:31], v[160:163], v[156:159], a[28:31]
    v_mfma_f32_16x16x32_bf16 a[32:35], v[164:167], v[128:131], a[32:35]
    v_mfma_f32_16x16x32_bf16 a[36:39], v[164:167], v[132:135], a[36:39]
    v_mfma_f32_16x16x32_bf16 a[40:43], v[164:167], v[136:139], a[40:43]
    v_mfma_f32_16x16x32_bf16 a[44:47], v[164:167], v[140:143], a[44:47]
    v_mfma_f32_16x16x32_bf16 a[48:51], v[164:167], v[144:147], a[48:51]
    v_mfma_f32_16x16x32_bf16 a[52:55], v[164:167], v[148:151], a[52:55]
    v_mfma_f32_16x16x32_bf16 a[56:59], v[164:167], v[152:155], a[56:59]
    v_mfma_f32_16x16x32_bf16 a[60:63], v[164:167], v[156:159], a[60:63]
    v_mfma_f32_16x16x32_bf16 a[64:67], v[168:171], v[128:131], a[64:67]
    v_mfma_f32_16x16x32_bf16 a[68:71], v[168:171], v[132:135], a[68:71]
    v_mfma_f32_16x16x32_bf16 a[72:75], v[168:171], v[136:139], a[72:75]
    v_mfma_f32_16x16x32_bf16 a[76:79], v[168:171], v[140:143], a[76:79]
    v_mfma_f32_16x16x32_bf16 a[80:83], v[168:171], v[144:147], a[80:83]
    v_mfma_f32_16x16x32_bf16 a[84:87], v[168:171], v[148:151], a[84:87]
    v_mfma_f32_16x16x32_bf16 a[88:91], v[168:171], v[152:155], a[88:91]
    v_mfma_f32_16x16x32_bf16 a[92:95], v[168:171], v[156:159], a[92:95]
    v_mfma_f32_16x16x32_bf16 a[96:99], v[172:175], v[128:131], a[96:99]
    v_mfma_f32_16x16x32_bf16 a[100:103], v[172:175], v[132:135], a[100:103]
    v_mfma_f32_16x16x32_bf16 a[104:107], v[172:175], v[136:139], a[104:107]
    v_mfma_f32_16x16x32_bf16 a[108:111], v[172:175], v[140:143], a[108:111]
    v_mfma_f32_16x16x32_bf16 a[112:115], v[172:175], v[144:147], a[112:115]
    v_mfma_f32_16x16x32_bf16 a[116:119], v[172:175], v[148:151], a[116:119]
    v_mfma_f32_16x16x32_bf16 a[120:123], v[172:175], v[152:155], a[120:123]
    v_mfma_f32_16x16x32_bf16 a[124:127], v[172:175], v[156:159], a[124:127]
    v_mfma_f32_16x16x32_bf16 a[128:131], v[176:179], v[128:131], a[128:131]
    v_mfma_f32_16x16x32_bf16 a[132:135], v[176:179], v[132:135], a[132:135]
    v_mfma_f32_16x16x32_bf16 a[136:139], v[176:179], v[136:139], a[136:139]
    v_mfma_f32_16x16x32_bf16 a[140:143], v[176:179], v[140:143], a[140:143]
    v_mfma_f32_16x16x32_bf16 a[144:147], v[176:179], v[144:147], a[144:147]
    v_mfma_f32_16x16x32_bf16 a[148:151], v[176:179], v[148:151], a[148:151]
    v_mfma_f32_16x16x32_bf16 a[152:155], v[176:179], v[152:155], a[152:155]
    v_mfma_f32_16x16x32_bf16 a[156:159], v[176:179], v[156:159], a[156:159]
    v_mfma_f32_16x16x32_bf16 a[160:163], v[180:183], v[128:131], a[160:163]
    v_mfma_f32_16x16x32_bf16 a[164:167], v[180:183], v[132:135], a[164:167]
    v_mfma_f32_16x16x32_bf16 a[168:171], v[180:183], v[136:139], a[168:171]
    v_mfma_f32_16x16x32_bf16 a[172:175], v[180:183], v[140:143], a[172:175]
    v_mfma_f32_16x16x32_bf16 a[176:179], v[180:183], v[144:147], a[176:179]
    v_mfma_f32_16x16x32_bf16 a[180:183], v[180:183], v[148:151], a[180:183]
    v_mfma_f32_16x16x32_bf16 a[184:187], v[180:183], v[152:155], a[184:187]
    v_mfma_f32_16x16x32_bf16 a[188:191], v[180:183], v[156:159], a[188:191]
    v_mfma_f32_16x16x32_bf16 a[192:195], v[184:187], v[128:131], a[192:195]
    v_mfma_f32_16x16x32_bf16 a[196:199], v[184:187], v[132:135], a[196:199]
    v_mfma_f32_16x16x32_bf16 a[200:203], v[184:187], v[136:139], a[200:203]
    v_mfma_f32_16x16x32_bf16 a[204:207], v[184:187], v[140:143], a[204:207]
    v_mfma_f32_16x16x32_bf16 a[208:211], v[184:187], v[144:147], a[208:211]
    v_mfma_f32_16x16x32_bf16 a[212:215], v[184:187], v[148:151], a[212:215]
    v_mfma_f32_16x16x32_bf16 a[216:219], v[184:187], v[152:155], a[216:219]
    v_mfma_f32_16x16x32_bf16 a[220:223], v[184:187], v[156:159], a[220:223]
    v_mfma_f32_16x16x32_bf16 a[224:227], v[188:191], v[128:131], a[224:227]
    v_mfma_f32_16x16x32_bf16 a[228:231], v[188:191], v[132:135], a[228:231]
    v_mfma_f32_16x16x32_bf16 a[232:235], v[188:191], v[136:139], a[232:235]
    v_mfma_f32_16x16x32_bf16 a[236:239], v[188:191], v[140:143], a[236:239]
    v_mfma_f32_16x16x32_bf16 a[240:243], v[188:191], v[144:147], a[240:243]
    v_mfma_f32_16x16x32_bf16 a[244:247], v[188:191], v[148:151], a[244:247]
    v_mfma_f32_16x16x32_bf16 a[248:251], v[188:191], v[152:155], a[248:251]
    v_mfma_f32_16x16x32_bf16 a[252:255], v[188:191], v[156:159], a[252:255]
    s_lshl_b32 s54, s61, 1
    s_and_b32 s55, s3, 1
    s_add_u32 s54, s54, s55
    s_lshl_b32 s52, s54, 19
    s_lshl_b32 s54, s60, 1
    s_lshr_b32 s55, s3, 1
    s_add_u32 s54, s54, s55
    s_lshl_b32 s54, s54, 15
    s_add_u32 s52, s52, s54
    s_add_u32 s52, s52, 2359296
    v_accvgpr_read_b32 v68, a0
    v_accvgpr_read_b32 v69, a1
    v_accvgpr_read_b32 v70, a2
    v_accvgpr_read_b32 v71, a3
    v_cvt_pk_bf16_f32 v64, v68, v69
    v_cvt_pk_bf16_f32 v65, v70, v71
    v_accvgpr_read_b32 v68, a32
    v_accvgpr_read_b32 v69, a33
    v_accvgpr_read_b32 v70, a34
    v_accvgpr_read_b32 v71, a35
    v_cvt_pk_bf16_f32 v66, v68, v69
    v_cvt_pk_bf16_f32 v67, v70, v71
    s_add_u32 s54, s52, 0
    buffer_store_dwordx4 v[64:67], v18, s[8:11], s54 offen sc1
    v_accvgpr_read_b32 v84, a64
    v_accvgpr_read_b32 v85, a65
    v_accvgpr_read_b32 v86, a66
    v_accvgpr_read_b32 v87, a67
    v_cvt_pk_bf16_f32 v80, v84, v85
    v_cvt_pk_bf16_f32 v81, v86, v87
    v_accvgpr_read_b32 v84, a96
    v_accvgpr_read_b32 v85, a97
    v_accvgpr_read_b32 v86, a98
    v_accvgpr_read_b32 v87, a99
    v_cvt_pk_bf16_f32 v82, v84, v85
    v_cvt_pk_bf16_f32 v83, v86, v87
    s_add_u32 s54, s52, 2048
    buffer_store_dwordx4 v[80:83], v18, s[8:11], s54 offen sc1
    v_accvgpr_read_b32 v100, a128
    v_accvgpr_read_b32 v101, a129
    v_accvgpr_read_b32 v102, a130
    v_accvgpr_read_b32 v103, a131
    v_cvt_pk_bf16_f32 v96, v100, v101
    v_cvt_pk_bf16_f32 v97, v102, v103
    v_accvgpr_read_b32 v100, a160
    v_accvgpr_read_b32 v101, a161
    v_accvgpr_read_b32 v102, a162
    v_accvgpr_read_b32 v103, a163
    v_cvt_pk_bf16_f32 v98, v100, v101
    v_cvt_pk_bf16_f32 v99, v102, v103
    s_add_u32 s54, s52, 4096
    buffer_store_dwordx4 v[96:99], v18, s[8:11], s54 offen sc1
    v_accvgpr_read_b32 v116, a192
    v_accvgpr_read_b32 v117, a193
    v_accvgpr_read_b32 v118, a194
    v_accvgpr_read_b32 v119, a195
    v_cvt_pk_bf16_f32 v112, v116, v117
    v_cvt_pk_bf16_f32 v113, v118, v119
    v_accvgpr_read_b32 v116, a224
    v_accvgpr_read_b32 v117, a225
    v_accvgpr_read_b32 v118, a226
    v_accvgpr_read_b32 v119, a227
    v_cvt_pk_bf16_f32 v114, v116, v117
    v_cvt_pk_bf16_f32 v115, v118, v119
    s_add_u32 s54, s52, 6144
    buffer_store_dwordx4 v[112:115], v18, s[8:11], s54 offen sc1
    v_accvgpr_read_b32 v68, a4
    v_accvgpr_read_b32 v69, a5
    v_accvgpr_read_b32 v70, a6
    v_accvgpr_read_b32 v71, a7
    v_cvt_pk_bf16_f32 v64, v68, v69
    v_cvt_pk_bf16_f32 v65, v70, v71
    v_accvgpr_read_b32 v68, a36
    v_accvgpr_read_b32 v69, a37
    v_accvgpr_read_b32 v70, a38
    v_accvgpr_read_b32 v71, a39
    v_cvt_pk_bf16_f32 v66, v68, v69
    v_cvt_pk_bf16_f32 v67, v70, v71
    s_add_u32 s54, s52, 1024
    buffer_store_dwordx4 v[64:67], v18, s[8:11], s54 offen sc1
    v_accvgpr_read_b32 v84, a68
    v_accvgpr_read_b32 v85, a69
    v_accvgpr_read_b32 v86, a70
    v_accvgpr_read_b32 v87, a71
    v_cvt_pk_bf16_f32 v80, v84, v85
    v_cvt_pk_bf16_f32 v81, v86, v87
    v_accvgpr_read_b32 v84, a100
    v_accvgpr_read_b32 v85, a101
    v_accvgpr_read_b32 v86, a102
    v_accvgpr_read_b32 v87, a103
    v_cvt_pk_bf16_f32 v82, v84, v85
    v_cvt_pk_bf16_f32 v83, v86, v87
    s_add_u32 s54, s52, 3072
    buffer_store_dwordx4 v[80:83], v18, s[8:11], s54 offen sc1
    v_accvgpr_read_b32 v100, a132
    v_accvgpr_read_b32 v101, a133
    v_accvgpr_read_b32 v102, a134
    v_accvgpr_read_b32 v103, a135
    v_cvt_pk_bf16_f32 v96, v100, v101
    v_cvt_pk_bf16_f32 v97, v102, v103
    v_accvgpr_read_b32 v100, a164
    v_accvgpr_read_b32 v101, a165
    v_accvgpr_read_b32 v102, a166
    v_accvgpr_read_b32 v103, a167
    v_cvt_pk_bf16_f32 v98, v100, v101
    v_cvt_pk_bf16_f32 v99, v102, v103
    s_add_u32 s54, s52, 5120
    buffer_store_dwordx4 v[96:99], v18, s[8:11], s54 offen sc1
    v_accvgpr_read_b32 v116, a196
    v_accvgpr_read_b32 v117, a197
    v_accvgpr_read_b32 v118, a198
    v_accvgpr_read_b32 v119, a199
    v_cvt_pk_bf16_f32 v112, v116, v117
    v_cvt_pk_bf16_f32 v113, v118, v119
    v_accvgpr_read_b32 v116, a228
    v_accvgpr_read_b32 v117, a229
    v_accvgpr_read_b32 v118, a230
    v_accvgpr_read_b32 v119, a231
    v_cvt_pk_bf16_f32 v114, v116, v117
    v_cvt_pk_bf16_f32 v115, v118, v119
    s_add_u32 s54, s52, 7168
    buffer_store_dwordx4 v[112:115], v18, s[8:11], s54 offen sc1
    v_accvgpr_read_b32 v68, a8
    v_accvgpr_read_b32 v69, a9
    v_accvgpr_read_b32 v70, a10
    v_accvgpr_read_b32 v71, a11
    v_cvt_pk_bf16_f32 v64, v68, v69
    v_cvt_pk_bf16_f32 v65, v70, v71
    v_accvgpr_read_b32 v68, a40
    v_accvgpr_read_b32 v69, a41
    v_accvgpr_read_b32 v70, a42
    v_accvgpr_read_b32 v71, a43
    v_cvt_pk_bf16_f32 v66, v68, v69
    v_cvt_pk_bf16_f32 v67, v70, v71
    s_add_u32 s54, s52, 8192
    buffer_store_dwordx4 v[64:67], v18, s[8:11], s54 offen sc1
    v_accvgpr_read_b32 v84, a72
    v_accvgpr_read_b32 v85, a73
    v_accvgpr_read_b32 v86, a74
    v_accvgpr_read_b32 v87, a75
    v_cvt_pk_bf16_f32 v80, v84, v85
    v_cvt_pk_bf16_f32 v81, v86, v87
    v_accvgpr_read_b32 v84, a104
    v_accvgpr_read_b32 v85, a105
    v_accvgpr_read_b32 v86, a106
    v_accvgpr_read_b32 v87, a107
    v_cvt_pk_bf16_f32 v82, v84, v85
    v_cvt_pk_bf16_f32 v83, v86, v87
    s_add_u32 s54, s52, 10240
    buffer_store_dwordx4 v[80:83], v18, s[8:11], s54 offen sc1
    v_accvgpr_read_b32 v100, a136
    v_accvgpr_read_b32 v101, a137
    v_accvgpr_read_b32 v102, a138
    v_accvgpr_read_b32 v103, a139
    v_cvt_pk_bf16_f32 v96, v100, v101
    v_cvt_pk_bf16_f32 v97, v102, v103
    v_accvgpr_read_b32 v100, a168
    v_accvgpr_read_b32 v101, a169
    v_accvgpr_read_b32 v102, a170
    v_accvgpr_read_b32 v103, a171
    v_cvt_pk_bf16_f32 v98, v100, v101
    v_cvt_pk_bf16_f32 v99, v102, v103
    s_add_u32 s54, s52, 12288
    buffer_store_dwordx4 v[96:99], v18, s[8:11], s54 offen sc1
    v_accvgpr_read_b32 v116, a200
    v_accvgpr_read_b32 v117, a201
    v_accvgpr_read_b32 v118, a202
    v_accvgpr_read_b32 v119, a203
    v_cvt_pk_bf16_f32 v112, v116, v117
    v_cvt_pk_bf16_f32 v113, v118, v119
    v_accvgpr_read_b32 v116, a232
    v_accvgpr_read_b32 v117, a233
    v_accvgpr_read_b32 v118, a234
    v_accvgpr_read_b32 v119, a235
    v_cvt_pk_bf16_f32 v114, v116, v117
    v_cvt_pk_bf16_f32 v115, v118, v119
    s_add_u32 s54, s52, 14336
    buffer_store_dwordx4 v[112:115], v18, s[8:11], s54 offen sc1
    v_accvgpr_read_b32 v68, a12
    v_accvgpr_read_b32 v69, a13
    v_accvgpr_read_b32 v70, a14
    v_accvgpr_read_b32 v71, a15
    v_cvt_pk_bf16_f32 v64, v68, v69
    v_cvt_pk_bf16_f32 v65, v70, v71
    v_accvgpr_read_b32 v68, a44
    v_accvgpr_read_b32 v69, a45
    v_accvgpr_read_b32 v70, a46
    v_accvgpr_read_b32 v71, a47
    v_cvt_pk_bf16_f32 v66, v68, v69
    v_cvt_pk_bf16_f32 v67, v70, v71
    s_add_u32 s54, s52, 9216
    buffer_store_dwordx4 v[64:67], v18, s[8:11], s54 offen sc1
    v_accvgpr_read_b32 v84, a76
    v_accvgpr_read_b32 v85, a77
    v_accvgpr_read_b32 v86, a78
    v_accvgpr_read_b32 v87, a79
    v_cvt_pk_bf16_f32 v80, v84, v85
    v_cvt_pk_bf16_f32 v81, v86, v87
    v_accvgpr_read_b32 v84, a108
    v_accvgpr_read_b32 v85, a109
    v_accvgpr_read_b32 v86, a110
    v_accvgpr_read_b32 v87, a111
    v_cvt_pk_bf16_f32 v82, v84, v85
    v_cvt_pk_bf16_f32 v83, v86, v87
    s_add_u32 s54, s52, 11264
    buffer_store_dwordx4 v[80:83], v18, s[8:11], s54 offen sc1
    v_accvgpr_read_b32 v100, a140
    v_accvgpr_read_b32 v101, a141
    v_accvgpr_read_b32 v102, a142
    v_accvgpr_read_b32 v103, a143
    v_cvt_pk_bf16_f32 v96, v100, v101
    v_cvt_pk_bf16_f32 v97, v102, v103
    v_accvgpr_read_b32 v100, a172
    v_accvgpr_read_b32 v101, a173
    v_accvgpr_read_b32 v102, a174
    v_accvgpr_read_b32 v103, a175
    v_cvt_pk_bf16_f32 v98, v100, v101
    v_cvt_pk_bf16_f32 v99, v102, v103
    s_add_u32 s54, s52, 13312
    buffer_store_dwordx4 v[96:99], v18, s[8:11], s54 offen sc1
    v_accvgpr_read_b32 v116, a204
    v_accvgpr_read_b32 v117, a205
    v_accvgpr_read_b32 v118, a206
    v_accvgpr_read_b32 v119, a207
    v_cvt_pk_bf16_f32 v112, v116, v117
    v_cvt_pk_bf16_f32 v113, v118, v119
    v_accvgpr_read_b32 v116, a236
    v_accvgpr_read_b32 v117, a237
    v_accvgpr_read_b32 v118, a238
    v_accvgpr_read_b32 v119, a239
    v_cvt_pk_bf16_f32 v114, v116, v117
    v_cvt_pk_bf16_f32 v115, v118, v119
    s_add_u32 s54, s52, 15360
    buffer_store_dwordx4 v[112:115], v18, s[8:11], s54 offen sc1
    v_accvgpr_read_b32 v68, a16
    v_accvgpr_read_b32 v69, a17
    v_accvgpr_read_b32 v70, a18
    v_accvgpr_read_b32 v71, a19
    v_cvt_pk_bf16_f32 v64, v68, v69
    v_cvt_pk_bf16_f32 v65, v70, v71
    v_accvgpr_read_b32 v68, a48
    v_accvgpr_read_b32 v69, a49
    v_accvgpr_read_b32 v70, a50
    v_accvgpr_read_b32 v71, a51
    v_cvt_pk_bf16_f32 v66, v68, v69
    v_cvt_pk_bf16_f32 v67, v70, v71
    s_add_u32 s54, s52, 16384
    buffer_store_dwordx4 v[64:67], v18, s[8:11], s54 offen sc1
    v_accvgpr_read_b32 v84, a80
    v_accvgpr_read_b32 v85, a81
    v_accvgpr_read_b32 v86, a82
    v_accvgpr_read_b32 v87, a83
    v_cvt_pk_bf16_f32 v80, v84, v85
    v_cvt_pk_bf16_f32 v81, v86, v87
    v_accvgpr_read_b32 v84, a112
    v_accvgpr_read_b32 v85, a113
    v_accvgpr_read_b32 v86, a114
    v_accvgpr_read_b32 v87, a115
    v_cvt_pk_bf16_f32 v82, v84, v85
    v_cvt_pk_bf16_f32 v83, v86, v87
    s_add_u32 s54, s52, 18432
    buffer_store_dwordx4 v[80:83], v18, s[8:11], s54 offen sc1
    v_accvgpr_read_b32 v100, a144
    v_accvgpr_read_b32 v101, a145
    v_accvgpr_read_b32 v102, a146
    v_accvgpr_read_b32 v103, a147
    v_cvt_pk_bf16_f32 v96, v100, v101
    v_cvt_pk_bf16_f32 v97, v102, v103
    v_accvgpr_read_b32 v100, a176
    v_accvgpr_read_b32 v101, a177
    v_accvgpr_read_b32 v102, a178
    v_accvgpr_read_b32 v103, a179
    v_cvt_pk_bf16_f32 v98, v100, v101
    v_cvt_pk_bf16_f32 v99, v102, v103
    s_add_u32 s54, s52, 20480
    buffer_store_dwordx4 v[96:99], v18, s[8:11], s54 offen sc1
    v_accvgpr_read_b32 v116, a208
    v_accvgpr_read_b32 v117, a209
    v_accvgpr_read_b32 v118, a210
    v_accvgpr_read_b32 v119, a211
    v_cvt_pk_bf16_f32 v112, v116, v117
    v_cvt_pk_bf16_f32 v113, v118, v119
    v_accvgpr_read_b32 v116, a240
    v_accvgpr_read_b32 v117, a241
    v_accvgpr_read_b32 v118, a242
    v_accvgpr_read_b32 v119, a243
    v_cvt_pk_bf16_f32 v114, v116, v117
    v_cvt_pk_bf16_f32 v115, v118, v119
    s_add_u32 s54, s52, 22528
    buffer_store_dwordx4 v[112:115], v18, s[8:11], s54 offen sc1
    v_accvgpr_read_b32 v68, a20
    v_accvgpr_read_b32 v69, a21
    v_accvgpr_read_b32 v70, a22
    v_accvgpr_read_b32 v71, a23
    v_cvt_pk_bf16_f32 v64, v68, v69
    v_cvt_pk_bf16_f32 v65, v70, v71
    v_accvgpr_read_b32 v68, a52
    v_accvgpr_read_b32 v69, a53
    v_accvgpr_read_b32 v70, a54
    v_accvgpr_read_b32 v71, a55
    v_cvt_pk_bf16_f32 v66, v68, v69
    v_cvt_pk_bf16_f32 v67, v70, v71
    s_add_u32 s54, s52, 17408
    buffer_store_dwordx4 v[64:67], v18, s[8:11], s54 offen sc1
    v_accvgpr_read_b32 v84, a84
    v_accvgpr_read_b32 v85, a85
    v_accvgpr_read_b32 v86, a86
    v_accvgpr_read_b32 v87, a87
    v_cvt_pk_bf16_f32 v80, v84, v85
    v_cvt_pk_bf16_f32 v81, v86, v87
    v_accvgpr_read_b32 v84, a116
    v_accvgpr_read_b32 v85, a117
    v_accvgpr_read_b32 v86, a118
    v_accvgpr_read_b32 v87, a119
    v_cvt_pk_bf16_f32 v82, v84, v85
    v_cvt_pk_bf16_f32 v83, v86, v87
    s_add_u32 s54, s52, 19456
    buffer_store_dwordx4 v[80:83], v18, s[8:11], s54 offen sc1
    v_accvgpr_read_b32 v100, a148
    v_accvgpr_read_b32 v101, a149
    v_accvgpr_read_b32 v102, a150
    v_accvgpr_read_b32 v103, a151
    v_cvt_pk_bf16_f32 v96, v100, v101
    v_cvt_pk_bf16_f32 v97, v102, v103
    v_accvgpr_read_b32 v100, a180
    v_accvgpr_read_b32 v101, a181
    v_accvgpr_read_b32 v102, a182
    v_accvgpr_read_b32 v103, a183
    v_cvt_pk_bf16_f32 v98, v100, v101
    v_cvt_pk_bf16_f32 v99, v102, v103
    s_add_u32 s54, s52, 21504
    buffer_store_dwordx4 v[96:99], v18, s[8:11], s54 offen sc1
    v_accvgpr_read_b32 v116, a212
    v_accvgpr_read_b32 v117, a213
    v_accvgpr_read_b32 v118, a214
    v_accvgpr_read_b32 v119, a215
    v_cvt_pk_bf16_f32 v112, v116, v117
    v_cvt_pk_bf16_f32 v113, v118, v119
    v_accvgpr_read_b32 v116, a244
    v_accvgpr_read_b32 v117, a245
    v_accvgpr_read_b32 v118, a246
    v_accvgpr_read_b32 v119, a247
    v_cvt_pk_bf16_f32 v114, v116, v117
    v_cvt_pk_bf16_f32 v115, v118, v119
    s_add_u32 s54, s52, 23552
    buffer_store_dwordx4 v[112:115], v18, s[8:11], s54 offen sc1
    v_accvgpr_read_b32 v68, a24
    v_accvgpr_read_b32 v69, a25
    v_accvgpr_read_b32 v70, a26
    v_accvgpr_read_b32 v71, a27
    v_cvt_pk_bf16_f32 v64, v68, v69
    v_cvt_pk_bf16_f32 v65, v70, v71
    v_accvgpr_read_b32 v68, a56
    v_accvgpr_read_b32 v69, a57
    v_accvgpr_read_b32 v70, a58
    v_accvgpr_read_b32 v71, a59
    v_cvt_pk_bf16_f32 v66, v68, v69
    v_cvt_pk_bf16_f32 v67, v70, v71
    s_add_u32 s54, s52, 24576
    buffer_store_dwordx4 v[64:67], v18, s[8:11], s54 offen sc1
    v_accvgpr_read_b32 v84, a88
    v_accvgpr_read_b32 v85, a89
    v_accvgpr_read_b32 v86, a90
    v_accvgpr_read_b32 v87, a91
    v_cvt_pk_bf16_f32 v80, v84, v85
    v_cvt_pk_bf16_f32 v81, v86, v87
    v_accvgpr_read_b32 v84, a120
    v_accvgpr_read_b32 v85, a121
    v_accvgpr_read_b32 v86, a122
    v_accvgpr_read_b32 v87, a123
    v_cvt_pk_bf16_f32 v82, v84, v85
    v_cvt_pk_bf16_f32 v83, v86, v87
    s_add_u32 s54, s52, 26624
    buffer_store_dwordx4 v[80:83], v18, s[8:11], s54 offen sc1
    v_accvgpr_read_b32 v100, a152
    v_accvgpr_read_b32 v101, a153
    v_accvgpr_read_b32 v102, a154
    v_accvgpr_read_b32 v103, a155
    v_cvt_pk_bf16_f32 v96, v100, v101
    v_cvt_pk_bf16_f32 v97, v102, v103
    v_accvgpr_read_b32 v100, a184
    v_accvgpr_read_b32 v101, a185
    v_accvgpr_read_b32 v102, a186
    v_accvgpr_read_b32 v103, a187
    v_cvt_pk_bf16_f32 v98, v100, v101
    v_cvt_pk_bf16_f32 v99, v102, v103
    s_add_u32 s54, s52, 28672
    buffer_store_dwordx4 v[96:99], v18, s[8:11], s54 offen sc1
    v_accvgpr_read_b32 v116, a216
    v_accvgpr_read_b32 v117, a217
    v_accvgpr_read_b32 v118, a218
    v_accvgpr_read_b32 v119, a219
    v_cvt_pk_bf16_f32 v112, v116, v117
    v_cvt_pk_bf16_f32 v113, v118, v119
    v_accvgpr_read_b32 v116, a248
    v_accvgpr_read_b32 v117, a249
    v_accvgpr_read_b32 v118, a250
    v_accvgpr_read_b32 v119, a251
    v_cvt_pk_bf16_f32 v114, v116, v117
    v_cvt_pk_bf16_f32 v115, v118, v119
    s_add_u32 s54, s52, 30720
    buffer_store_dwordx4 v[112:115], v18, s[8:11], s54 offen sc1
    v_accvgpr_read_b32 v68, a28
    v_accvgpr_read_b32 v69, a29
    v_accvgpr_read_b32 v70, a30
    v_accvgpr_read_b32 v71, a31
    v_cvt_pk_bf16_f32 v64, v68, v69
    v_cvt_pk_bf16_f32 v65, v70, v71
    v_accvgpr_read_b32 v68, a60
    v_accvgpr_read_b32 v69, a61
    v_accvgpr_read_b32 v70, a62
    v_accvgpr_read_b32 v71, a63
    v_cvt_pk_bf16_f32 v66, v68, v69
    v_cvt_pk_bf16_f32 v67, v70, v71
    s_add_u32 s54, s52, 25600
    buffer_store_dwordx4 v[64:67], v18, s[8:11], s54 offen sc1
    v_accvgpr_read_b32 v84, a92
    v_accvgpr_read_b32 v85, a93
    v_accvgpr_read_b32 v86, a94
    v_accvgpr_read_b32 v87, a95
    v_cvt_pk_bf16_f32 v80, v84, v85
    v_cvt_pk_bf16_f32 v81, v86, v87
    v_accvgpr_read_b32 v84, a124
    v_accvgpr_read_b32 v85, a125
    v_accvgpr_read_b32 v86, a126
    v_accvgpr_read_b32 v87, a127
    v_cvt_pk_bf16_f32 v82, v84, v85
    v_cvt_pk_bf16_f32 v83, v86, v87
    s_add_u32 s54, s52, 27648
    buffer_store_dwordx4 v[80:83], v18, s[8:11], s54 offen sc1
    v_accvgpr_read_b32 v100, a156
    v_accvgpr_read_b32 v101, a157
    v_accvgpr_read_b32 v102, a158
    v_accvgpr_read_b32 v103, a159
    v_cvt_pk_bf16_f32 v96, v100, v101
    v_cvt_pk_bf16_f32 v97, v102, v103
    v_accvgpr_read_b32 v100, a188
    v_accvgpr_read_b32 v101, a189
    v_accvgpr_read_b32 v102, a190
    v_accvgpr_read_b32 v103, a191
    v_cvt_pk_bf16_f32 v98, v100, v101
    v_cvt_pk_bf16_f32 v99, v102, v103
    s_add_u32 s54, s52, 29696
    buffer_store_dwordx4 v[96:99], v18, s[8:11], s54 offen sc1
    v_accvgpr_read_b32 v116, a220
    v_accvgpr_read_b32 v117, a221
    v_accvgpr_read_b32 v118, a222
    v_accvgpr_read_b32 v119, a223
    v_cvt_pk_bf16_f32 v112, v116, v117
    v_cvt_pk_bf16_f32 v113, v118, v119
    v_accvgpr_read_b32 v116, a252
    v_accvgpr_read_b32 v117, a253
    v_accvgpr_read_b32 v118, a254
    v_accvgpr_read_b32 v119, a255
    v_cvt_pk_bf16_f32 v114, v116, v117
    v_cvt_pk_bf16_f32 v115, v118, v119
    s_add_u32 s54, s52, 31744
    buffer_store_dwordx4 v[112:115], v18, s[8:11], s54 offen sc1
    s_branch W_DONE
W_th:
    s_mov_b64 s[12:13], s[30:31]
    s_mov_b32 s14, 5308416
    s_mov_b32 s63, 9216
    v_and_b32 v1, 63, v0
    v_lshrrev_b32 v2, 4, v1
    v_lshlrev_b32 v18, 4, v1
    s_lshr_b32 s54, s3, 1
    s_lshl_b32 s54, s54, 13
    v_add_u32 v8, s54, v18
    v_bfe_u32 v3, v1, 2, 2
    v_and_b32 v4, 3, v1
    v_and_b32 v5, 1, v2
    v_lshl_add_u32 v5, v5, 2, v3
    v_lshlrev_b32 v6, 12, v2
    v_lshl_add_u32 v6, v3, 9, v6
    v_lshl_add_u32 v6, v4, 3, v6
    v_add_u32 v6, 16384, v6
    s_and_b32 s54, s3, 1
    s_mul_i32 s54, s54, 8
    s_add_u32 s55, s54, 0
    v_xor_b32 v7, s55, v5
    v_lshl_add_u32 v10, v7, 5, v6
    s_add_u32 s55, s54, 1
    v_xor_b32 v7, s55, v5
    v_lshl_add_u32 v11, v7, 5, v6
    s_add_u32 s55, s54, 2
    v_xor_b32 v7, s55, v5
    v_lshl_add_u32 v12, v7, 5, v6
    s_add_u32 s55, s54, 3
    v_xor_b32 v7, s55, v5
    v_lshl_add_u32 v13, v7, 5, v6
    s_add_u32 s55, s54, 4
    v_xor_b32 v7, s55, v5
    v_lshl_add_u32 v14, v7, 5, v6
    s_add_u32 s55, s54, 5
    v_xor_b32 v7, s55, v5
    v_lshl_add_u32 v15, v7, 5, v6
    s_add_u32 s55, s54, 6
    v_xor_b32 v7, s55, v5
    v_lshl_add_u32 v16, v7, 5, v6
    s_add_u32 s55, s54, 7
    v_xor_b32 v7, s55, v5
    v_lshl_add_u32 v17, v7, 5, v6
    s_and_b32 s54, s3, 1
    s_lshl_b32 s54, s54, 1
    s_lshr_b32 s55, s3, 1
    s_lshl_b32 s55, s55, 2
    s_or_b32 s54, s54, s55
    v_lshrrev_b32 v3, 5, v1
    v_or_b32 v4, s54, v3
    v_lshlrev_b32 v4, 1, v4
    v_and_b32 v5, 31, v1
    v_xor_b32 v4, v4, v5
    v_mul_lo_u32 v3, v3, s63
    v_lshl_add_u32 v19, v4, 4, v3
    s_mul_i32 s64, s60, 294912
    s_add_u32 s64, s64, 0
    s_lshl_b32 s65, s61, 9
    s_mul_i32 s54, s3, 73728
    s_add_u32 s54, s54, s64
    s_add_u32 s40, s54, 0
    s_add_u32 s41, s54, 18432
    s_add_u32 s42, s54, 36864
    s_add_u32 s43, s54, 55296
    s_and_b32 s54, s3, 1
    s_lshl_b32 s54, s54, 1
    s_lshr_b32 s55, s3, 1
    s_mul_i32 s55, s55, 8
    s_add_u32 s54, s54, s55
    s_add_u32 s55, s54, 0
    s_mul_i32 s55, s55, s63
    s_add_u32 s44, s55, s65
    s_add_u32 s55, s54, 4
    s_mul_i32 s55, s55, s63
    s_add_u32 s45, s55, s65
    s_add_u32 s55, s54, 16
    s_mul_i32 s55, s55, s63
    s_add_u32 s46, s55, s65
    s_add_u32 s55, s54, 20
    s_mul_i32 s55, s55, s63
    s_add_u32 s47, s55, s65
    s_lshl_b32 s50, s63, 5
    s_lshl_b32 s48, s3, 12
    s_and_b32 s54, s3, 1
    s_lshl_b32 s54, s54, 10
    s_lshr_b32 s55, s3, 1
    s_lshl_b32 s55, s55, 12
    s_add_u32 s49, s54, s55
    s_add_u32 s49, s49, 16384
    s_add_u32 m0, s48, 0
    s_nop 0
    buffer_load_dwordx4 v18, s[8:11], s40 offen  lds
    s_add_u32 s40, s40, 1024
    s_add_u32 m0, s48, 1024
    s_nop 0
    buffer_load_dwordx4 v18, s[8:11], s41 offen  lds
    s_add_u32 s41, s41, 1024
    s_add_u32 m0, s48, 2048
    s_nop 0
    buffer_load_dwordx4 v18, s[8:11], s42 offen  lds
    s_add_u32 s42, s42, 1024
    s_add_u32 m0, s48, 3072
    s_nop 0
    buffer_load_dwordx4 v18, s[8:11], s43 offen  lds
    s_add_u32 s43, s43, 1024
    s_add_u32 s48, s48, 32768
    s_and_b32 s48, s48, 0x1ffff
    s_add_u32 m0, s49, 0
    s_nop 0
    buffer_load_dwordx4 v19, s[12:15], s44 offen lds
    s_add_u32 s44, s44, s50
    s_add_u32 m0, s49, 2048
    s_nop 0
    buffer_load_dwordx4 v19, s[12:15], s45 offen lds
    s_add_u32 s45, s45, s50
    s_add_u32 m0, s49, 8192
    s_nop 0
    buffer_load_dwordx4 v19, s[12:15], s46 offen lds
    s_add_u32 s46, s46, s50
    s_add_u32 m0, s49, 10240
    s_nop 0
    buffer_load_dwordx4 v19, s[12:15], s47 offen lds
    s_add_u32 s47, s47, s50
    s_add_u32 s49, s49, 32768
    s_and_b32 s49, s49, 0x1ffff
    s_add_u32 m0, s48, 0
    s_nop 0
    buffer_load_dwordx4 v18, s[8:11], s40 offen  lds
    s_add_u32 s40, s40, 1024
    s_add_u32 m0, s48, 1024
    s_nop 0
    buffer_load_dwordx4 v18, s[8:11], s41 offen  lds
    s_add_u32 s41, s41, 1024
    s_add_u32 m0, s48, 2048
    s_nop 0
    buffer_load_dwordx4 v18, s[8:11], s42 offen  lds
    s_add_u32 s42, s42, 1024
    s_add_u32 m0, s48, 3072
    s_nop 0
    buffer_load_dwordx4 v18, s[8:11], s43 offen  lds
    s_add_u32 s43, s43, 1024
    s_add_u32 s48, s48, 32768
    s_and_b32 s48, s48, 0x1ffff
    s_add_u32 m0, s49, 0
    s_nop 0
    buffer_load_dwordx4 v19, s[12:15], s44 offen lds
    s_add_u32 s44, s44, s50
    s_add_u32 m0, s49, 2048
    s_nop 0
    buffer_load_dwordx4 v19, s[12:15], s45 offen lds
    s_add_u32 s45, s45, s50
    s_add_u32 m0, s49, 8192
    s_nop 0
    buffer_load_dwordx4 v19, s[12:15], s46 offen lds
    s_add_u32 s46, s46, s50
    s_add_u32 m0, s49, 10240
    s_nop 0
    buffer_load_dwordx4 v19, s[12:15], s47 offen lds
    s_add_u32 s47, s47, s50
    s_add_u32 s49, s49, 32768
    s_and_b32 s49, s49, 0x1ffff
    s_add_u32 m0, s48, 0
    s_nop 0
    buffer_load_dwordx4 v18, s[8:11], s40 offen  lds
    s_add_u32 s40, s40, 1024
    s_add_u32 m0, s48, 1024
    s_nop 0
    buffer_load_dwordx4 v18, s[8:11], s41 offen  lds
    s_add_u32 s41, s41, 1024
    s_add_u32 m0, s48, 2048
    s_nop 0
    buffer_load_dwordx4 v18, s[8:11], s42 offen  lds
    s_add_u32 s42, s42, 1024
    s_add_u32 m0, s48, 3072
    s_nop 0
    buffer_load_dwordx4 v18, s[8:11], s43 offen  lds
    s_add_u32 s43, s43, 1024
    s_add_u32 s48, s48, 32768
    s_and_b32 s48, s48, 0x1ffff
    s_add_u32 m0, s49, 0
    s_nop 0
    buffer_load_dwordx4 v19, s[12:15], s44 offen lds
    s_add_u32 s44, s44, s50
    s_add_u32 m0, s49, 2048
    s_nop 0
    buffer_load_dwordx4 v19, s[12:15], s45 offen lds
    s_add_u32 s45, s45, s50
    s_add_u32 m0, s49, 8192
    s_nop 0
    buffer_load_dwordx4 v19, s[12:15], s46 offen lds
    s_add_u32 s46, s46, s50
    s_add_u32 m0, s49, 10240
    s_nop 0
    buffer_load_dwordx4 v19, s[12:15], s47 offen lds
    s_add_u32 s47, s47, s50
    s_add_u32 s49, s49, 32768
    s_and_b32 s49, s49, 0x1ffff
    s_add_u32 m0, s48, 0
    s_nop 0
    buffer_load_dwordx4 v18, s[8:11], s40 offen  lds
    s_add_u32 s40, s40, 1024
    s_add_u32 m0, s48, 1024
    s_nop 0
    buffer_load_dwordx4 v18, s[8:11], s41 offen  lds
    s_add_u32 s41, s41, 1024
    s_add_u32 m0, s48, 2048
    s_nop 0
    buffer_load_dwordx4 v18, s[8:11], s42 offen  lds
    s_add_u32 s42, s42, 1024
    s_add_u32 m0, s48, 3072
    s_nop 0
    buffer_load_dwordx4 v18, s[8:11], s43 offen  lds
    s_add_u32 s43, s43, 1024
    s_add_u32 s48, s48, 32768
    s_and_b32 s48, s48, 0x1ffff
    s_add_u32 m0, s49, 0
    s_nop 0
    buffer_load_dwordx4 v19, s[12:15], s44 offen lds
    s_add_u32 s44, s44, s50
    s_add_u32 m0, s49, 2048
    s_nop 0
    buffer_load_dwordx4 v19, s[12:15], s45 offen lds
    s_add_u32 s45, s45, s50
    s_add_u32 m0, s49, 8192
    s_nop 0
    buffer_load_dwordx4 v19, s[12:15], s46 offen lds
    s_add_u32 s46, s46, s50
    s_add_u32 m0, s49, 10240
    s_nop 0
    buffer_load_dwordx4 v19, s[12:15], s47 offen lds
    s_add_u32 s47, s47, s50
    s_add_u32 s49, s49, 32768
    s_and_b32 s49, s49, 0x1ffff
    v_accvgpr_write_b32 a0, 0
    v_accvgpr_write_b32 a1, 0
    v_accvgpr_write_b32 a2, 0
    v_accvgpr_write_b32 a3, 0
    v_accvgpr_write_b32 a4, 0
    v_accvgpr_write_b32 a5, 0
    v_accvgpr_write_b32 a6, 0
    v_accvgpr_write_b32 a7, 0
    v_accvgpr_write_b32 a8, 0
    v_accvgpr_write_b32 a9, 0
    v_accvgpr_write_b32 a10, 0
    v_accvgpr_write_b32 a11, 0
    v_accvgpr_write_b32 a12, 0
    v_accvgpr_write_b32 a13, 0
    v_accvgpr_write_b32 a14, 0
    v_accvgpr_write_b32 a15, 0
    v_accvgpr_write_b32 a16, 0
    v_accvgpr_write_b32 a17, 0
    v_accvgpr_write_b32 a18, 0
    v_accvgpr_write_b32 a19, 0
    v_accvgpr_write_b32 a20, 0
    v_accvgpr_write_b32 a21, 0
    v_accvgpr_write_b32 a22, 0
    v_accvgpr_write_b32 a23, 0
    v_accvgpr_write_b32 a24, 0
    v_accvgpr_write_b32 a25, 0
    v_accvgpr_write_b32 a26, 0
    v_accvgpr_write_b32 a27, 0
    v_accvgpr_write_b32 a28, 0
    v_accvgpr_write_b32 a29, 0
    v_accvgpr_write_b32 a30, 0
    v_accvgpr_write_b32 a31, 0
    v_accvgpr_write_b32 a32, 0
    v_accvgpr_write_b32 a33, 0
    v_accvgpr_write_b32 a34, 0
    v_accvgpr_write_b32 a35, 0
    v_accvgpr_write_b32 a36, 0
    v_accvgpr_write_b32 a37, 0
    v_accvgpr_write_b32 a38, 0
    v_accvgpr_write_b32 a39, 0
    v_accvgpr_write_b32 a40, 0
    v_accvgpr_write_b32 a41, 0
    v_accvgpr_write_b32 a42, 0
    v_accvgpr_write_b32 a43, 0
    v_accvgpr_write_b32 a44, 0
    v_accvgpr_write_b32 a45, 0
    v_accvgpr_write_b32 a46, 0
    v_accvgpr_write_b32 a47, 0
    v_accvgpr_write_b32 a48, 0
    v_accvgpr_write_b32 a49, 0
    v_accvgpr_write_b32 a50, 0
    v_accvgpr_write_b32 a51, 0
    v_accvgpr_write_b32 a52, 0
    v_accvgpr_write_b32 a53, 0
    v_accvgpr_write_b32 a54, 0
    v_accvgpr_write_b32 a55, 0
    v_accvgpr_write_b32 a56, 0
    v_accvgpr_write_b32 a57, 0
    v_accvgpr_write_b32 a58, 0
    v_accvgpr_write_b32 a59, 0
    v_accvgpr_write_b32 a60, 0
    v_accvgpr_write_b32 a61, 0
    v_accvgpr_write_b32 a62, 0
    v_accvgpr_write_b32 a63, 0
    v_accvgpr_write_b32 a64, 0
    v_accvgpr_write_b32 a65, 0
    v_accvgpr_write_b32 a66, 0
    v_accvgpr_write_b32 a67, 0
    v_accvgpr_write_b32 a68, 0
    v_accvgpr_write_b32 a69, 0
    v_accvgpr_write_b32 a70, 0
    v_accvgpr_write_b32 a71, 0
    v_accvgpr_write_b32 a72, 0
    v_accvgpr_write_b32 a73, 0
    v_accvgpr_write_b32 a74, 0
    v_accvgpr_write_b32 a75, 0
    v_accvgpr_write_b32 a76, 0
    v_accvgpr_write_b32 a77, 0
    v_accvgpr_write_b32 a78, 0
    v_accvgpr_write_b32 a79, 0
    v_accvgpr_write_b32 a80, 0
    v_accvgpr_write_b32 a81, 0
    v_accvgpr_write_b32 a82, 0
    v_accvgpr_write_b32 a83, 0
    v_accvgpr_write_b32 a84, 0
    v_accvgpr_write_b32 a85, 0
    v_accvgpr_write_b32 a86, 0
    v_accvgpr_write_b32 a87, 0
    v_accvgpr_write_b32 a88, 0
    v_accvgpr_write_b32 a89, 0
    v_accvgpr_write_b32 a90, 0
    v_accvgpr_write_b32 a91, 0
    v_accvgpr_write_b32 a92, 0
    v_accvgpr_write_b32 a93, 0
    v_accvgpr_write_b32 a94, 0
    v_accvgpr_write_b32 a95, 0
    v_accvgpr_write_b32 a96, 0
    v_accvgpr_write_b32 a97, 0
    v_accvgpr_write_b32 a98, 0
    v_accvgpr_write_b32 a99, 0
    v_accvgpr_write_b32 a100, 0
    v_accvgpr_write_b32 a101, 0
    v_accvgpr_write_b32 a102, 0
    v_accvgpr_write_b32 a103, 0
    v_accvgpr_write_b32 a104, 0
    v_accvgpr_write_b32 a105, 0
    v_accvgpr_write_b32 a106, 0
    v_accvgpr_write_b32 a107, 0
    v_accvgpr_write_b32 a108, 0
    v_accvgpr_write_b32 a109, 0
    v_accvgpr_write_b32 a110, 0
    v_accvgpr_write_b32 a111, 0
    v_accvgpr_write_b32 a112, 0
    v_accvgpr_write_b32 a113, 0
    v_accvgpr_write_b32 a114, 0
    v_accvgpr_write_b32 a115, 0
    v_accvgpr_write_b32 a116, 0
    v_accvgpr_write_b32 a117, 0
    v_accvgpr_write_b32 a118, 0
    v_accvgpr_write_b32 a119, 0
    v_accvgpr_write_b32 a120, 0
    v_accvgpr_write_b32 a121, 0
    v_accvgpr_write_b32 a122, 0
    v_accvgpr_write_b32 a123, 0
    v_accvgpr_write_b32 a124, 0
    v_accvgpr_write_b32 a125, 0
    v_accvgpr_write_b32 a126, 0
    v_accvgpr_write_b32 a127, 0
    v_accvgpr_write_b32 a128, 0
    v_accvgpr_write_b32 a129, 0
    v_accvgpr_write_b32 a130, 0
    v_accvgpr_write_b32 a131, 0
    v_accvgpr_write_b32 a132, 0
    v_accvgpr_write_b32 a133, 0
    v_accvgpr_write_b32 a134, 0
    v_accvgpr_write_b32 a135, 0
    v_accvgpr_write_b32 a136, 0
    v_accvgpr_write_b32 a137, 0
    v_accvgpr_write_b32 a138, 0
    v_accvgpr_write_b32 a139, 0
    v_accvgpr_write_b32 a140, 0
    v_accvgpr_write_b32 a141, 0
    v_accvgpr_write_b32 a142, 0
    v_accvgpr_write_b32 a143, 0
    v_accvgpr_write_b32 a144, 0
    v_accvgpr_write_b32 a145, 0
    v_accvgpr_write_b32 a146, 0
    v_accvgpr_write_b32 a147, 0
    v_accvgpr_write_b32 a148, 0
    v_accvgpr_write_b32 a149, 0
    v_accvgpr_write_b32 a150, 0
    v_accvgpr_write_b32 a151, 0
    v_accvgpr_write_b32 a152, 0
    v_accvgpr_write_b32 a153, 0
    v_accvgpr_write_b32 a154, 0
    v_accvgpr_write_b32 a155, 0
    v_accvgpr_write_b32 a156, 0
    v_accvgpr_write_b32 a157, 0
    v_accvgpr_write_b32 a158, 0
    v_accvgpr_write_b32 a159, 0
    v_accvgpr_write_b32 a160, 0
    v_accvgpr_write_b32 a161, 0
    v_accvgpr_write_b32 a162, 0
    v_accvgpr_write_b32 a163, 0
    v_accvgpr_write_b32 a164, 0
    v_accvgpr_write_b32 a165, 0
    v_accvgpr_write_b32 a166, 0
    v_accvgpr_write_b32 a167, 0
    v_accvgpr_write_b32 a168, 0
    v_accvgpr_write_b32 a169, 0
    v_accvgpr_write_b32 a170, 0
    v_accvgpr_write_b32 a171, 0
    v_accvgpr_write_b32 a172, 0
    v_accvgpr_write_b32 a173, 0
    v_accvgpr_write_b32 a174, 0
    v_accvgpr_write_b32 a175, 0
    v_accvgpr_write_b32 a176, 0
    v_accvgpr_write_b32 a177, 0
    v_accvgpr_write_b32 a178, 0
    v_accvgpr_write_b32 a179, 0
    v_accvgpr_write_b32 a180, 0
    v_accvgpr_write_b32 a181, 0
    v_accvgpr_write_b32 a182, 0
    v_accvgpr_write_b32 a183, 0
    v_accvgpr_write_b32 a184, 0
    v_accvgpr_write_b32 a185, 0
    v_accvgpr_write_b32 a186, 0
    v_accvgpr_write_b32 a187, 0
    v_accvgpr_write_b32 a188, 0
    v_accvgpr_write_b32 a189, 0
    v_accvgpr_write_b32 a190, 0
    v_accvgpr_write_b32 a191, 0
    v_accvgpr_write_b32 a192, 0
    v_accvgpr_write_b32 a193, 0
    v_accvgpr_write_b32 a194, 0
    v_accvgpr_write_b32 a195, 0
    v_accvgpr_write_b32 a196, 0
    v_accvgpr_write_b32 a197, 0
    v_accvgpr_write_b32 a198, 0
    v_accvgpr_write_b32 a199, 0
    v_accvgpr_write_b32 a200, 0
    v_accvgpr_write_b32 a201, 0
    v_accvgpr_write_b32 a202, 0
    v_accvgpr_write_b32 a203, 0
    v_accvgpr_write_b32 a204, 0
    v_accvgpr_write_b32 a205, 0
    v_accvgpr_write_b32 a206, 0
    v_accvgpr_write_b32 a207, 0
    v_accvgpr_write_b32 a208, 0
    v_accvgpr_write_b32 a209, 0
    v_accvgpr_write_b32 a210, 0
    v_accvgpr_write_b32 a211, 0
    v_accvgpr_write_b32 a212, 0
    v_accvgpr_write_b32 a213, 0
    v_accvgpr_write_b32 a214, 0
    v_accvgpr_write_b32 a215, 0
    v_accvgpr_write_b32 a216, 0
    v_accvgpr_write_b32 a217, 0
    v_accvgpr_write_b32 a218, 0
    v_accvgpr_write_b32 a219, 0
    v_accvgpr_write_b32 a220, 0
    v_accvgpr_write_b32 a221, 0
    v_accvgpr_write_b32 a222, 0
    v_accvgpr_write_b32 a223, 0
    v_accvgpr_write_b32 a224, 0
    v_accvgpr_write_b32 a225, 0
    v_accvgpr_write_b32 a226, 0
    v_accvgpr_write_b32 a227, 0
    v_accvgpr_write_b32 a228, 0
    v_accvgpr_write_b32 a229, 0
    v_accvgpr_write_b32 a230, 0
    v_accvgpr_write_b32 a231, 0
    v_accvgpr_write_b32 a232, 0
    v_accvgpr_write_b32 a233, 0
    v_accvgpr_write_b32 a234, 0
    v_accvgpr_write_b32 a235, 0
    v_accvgpr_write_b32 a236, 0
    v_accvgpr_write_b32 a237, 0
    v_accvgpr_write_b32 a238, 0
    v_accvgpr_write_b32 a239, 0
    v_accvgpr_write_b32 a240, 0
    v_accvgpr_write_b32 a241, 0
    v_accvgpr_write_b32 a242, 0
    v_accvgpr_write_b32 a243, 0
    v_accvgpr_write_b32 a244, 0
    v_accvgpr_write_b32 a245, 0
    v_accvgpr_write_b32 a246, 0
    v_accvgpr_write_b32 a247, 0
    v_accvgpr_write_b32 a248, 0
    v_accvgpr_write_b32 a249, 0
    v_accvgpr_write_b32 a250, 0
    v_accvgpr_write_b32 a251, 0
    v_accvgpr_write_b32 a252, 0
    v_accvgpr_write_b32 a253, 0
    v_accvgpr_write_b32 a254, 0
    v_accvgpr_write_b32 a255, 0
    s_waitcnt vmcnt(24)
    s_barrier
    ds_read_b64_tr_b16 v[96:97], v10 offset:0
    ds_read_b64_tr_b16 v[98:99], v10 offset:2048
    ds_read_b128 v[64:67], v8 offset:0
    ds_read_b64_tr_b16 v[100:101], v11 offset:0
    ds_read_b64_tr_b16 v[102:103], v11 offset:2048
    ds_read_b128 v[68:71], v8 offset:1024
    ds_read_b64_tr_b16 v[104:105], v12 offset:0
    ds_read_b64_tr_b16 v[106:107], v12 offset:2048
    ds_read_b128 v[72:75], v8 offset:2048
    ds_read_b64_tr_b16 v[108:109], v13 offset:0
    ds_read_b64_tr_b16 v[110:111], v13 offset:2048
    ds_read_b128 v[76:79], v8 offset:3072
    ds_read_b64_tr_b16 v[112:113], v14 offset:0
    ds_read_b64_tr_b16 v[114:115], v14 offset:2048
    ds_read_b128 v[80:83], v8 offset:4096
    ds_read_b64_tr_b16 v[116:117], v15 offset:0
    ds_read_b64_tr_b16 v[118:119], v15 offset:2048
    ds_read_b128 v[84:87], v8 offset:5120
    ds_read_b64_tr_b16 v[120:121], v16 offset:0
    ds_read_b64_tr_b16 v[122:123], v16 offset:2048
    ds_read_b128 v[88:91], v8 offset:6144
    ds_read_b64_tr_b16 v[124:125], v17 offset:0
    ds_read_b64_tr_b16 v[126:127], v17 offset:2048
    ds_read_b128 v[92:95], v8 offset:7168
    s_mov_b32 s51, 7
Gh_loop:
    s_waitcnt vmcnt(16) lgkmcnt(0)
    s_barrier
    v_mfma_f32_16x16x32_bf16 a[0:3], v[96:99], v[64:67], a[0:3]
    ds_read_b64_tr_b16 v[160:161], v10 offset:32768
    v_mfma_f32_16x16x32_bf16 a[4:7], v[96:99], v[68:71], a[4:7]
    ds_read_b64_tr_b16 v[162:163], v10 offset:34816
    v_mfma_f32_16x16x32_bf16 a[8:11], v[96:99], v[72:75], a[8:11]
    ds_read_b128 v[128:131], v8 offset:32768
    s_add_u32 m0, s48, 0
    s_nop 0
    buffer_load_dwordx4 v18, s[8:11], s40 offen  lds
    s_add_u32 s40, s40, 1024
    v_mfma_f32_16x16x32_bf16 a[12:15], v[96:99], v[76:79], a[12:15]
    ds_read_b64_tr_b16 v[164:165], v11 offset:32768
    v_mfma_f32_16x16x32_bf16 a[16:19], v[96:99], v[80:83], a[16:19]
    ds_read_b64_tr_b16 v[166:167], v11 offset:34816
    v_mfma_f32_16x16x32_bf16 a[20:23], v[96:99], v[84:87], a[20:23]
    ds_read_b128 v[132:135], v8 offset:33792
    v_mfma_f32_16x16x32_bf16 a[24:27], v[96:99], v[88:91], a[24:27]
    ds_read_b64_tr_b16 v[168:169], v12 offset:32768
    v_mfma_f32_16x16x32_bf16 a[28:31], v[96:99], v[92:95], a[28:31]
    ds_read_b64_tr_b16 v[170:171], v12 offset:34816
    v_mfma_f32_16x16x32_bf16 a[32:35], v[100:103], v[64:67], a[32:35]
    ds_read_b128 v[136:139], v8 offset:34816
    v_mfma_f32_16x16x32_bf16 a[36:39], v[100:103], v[68:71], a[36:39]
    ds_read_b64_tr_b16 v[172:173], v13 offset:32768
    s_add_u32 m0, s48, 1024
    s_nop 0
    buffer_load_dwordx4 v18, s[8:11], s41 offen  lds
    s_add_u32 s41, s41, 1024
    v_mfma_f32_16x16x32_bf16 a[40:43], v[100:103], v[72:75], a[40:43]
    ds_read_b64_tr_b16 v[174:175], v13 offset:34816
    v_mfma_f32_16x16x32_bf16 a[44:47], v[100:103], v[76:79], a[44:47]
    ds_read_b128 v[140:143], v8 offset:35840
    v_mfma_f32_16x16x32_bf16 a[48:51], v[100:103], v[80:83], a[48:51]
    ds_read_b64_tr_b16 v[176:177], v14 offset:32768
    v_mfma_f32_16x16x32_bf16 a[52:55], v[100:103], v[84:87], a[52:55]
    ds_read_b64_tr_b16 v[178:179], v14 offset:34816
    v_mfma_f32_16x16x32_bf16 a[56:59], v[100:103], v[88:91], a[56:59]
    ds_read_b128 v[144:147], v8 offset:36864
    v_mfma_f32_16x16x32_bf16 a[60:63], v[100:103], v[92:95], a[60:63]
    ds_read_b64_tr_b16 v[180:181], v15 offset:32768
    v_mfma_f32_16x16x32_bf16 a[64:67], v[104:107], v[64:67], a[64:67]
    ds_read_b64_tr_b16 v[182:183], v15 offset:34816
    s_add_u32 m0, s48, 2048
    s_nop 0
    buffer_load_dwordx4 v18, s[8:11], s42 offen  lds
    s_add_u32 s42, s42, 1024
    v_mfma_f32_16x16x32_bf16 a[68:71], v[104:107], v[68:71], a[68:71]
    ds_read_b128 v[148:151], v8 offset:37888
    v_mfma_f32_16x16x32_bf16 a[72:75], v[104:107], v[72:75], a[72:75]
    ds_read_b64_tr_b16 v[184:185], v16 offset:32768
    v_mfma_f32_16x16x32_bf16 a[76:79], v[104:107], v[76:79], a[76:79]
    ds_read_b64_tr_b16 v[186:187], v16 offset:34816
    v_mfma_f32_16x16x32_bf16 a[80:83], v[104:107], v[80:83], a[80:83]
    ds_read_b128 v[152:155], v8 offset:38912
    v_mfma_f32_16x16x32_bf16 a[84:87], v[104:107], v[84:87], a[84:87]
    ds_read_b64_tr_b16 v[188:189], v17 offset:32768
    v_mfma_f32_16x16x32_bf16 a[88:91], v[104:107], v[88:91], a[88:91]
    ds_read_b64_tr_b16 v[190:191], v17 offset:34816
    v_mfma_f32_16x16x32_bf16 a[92:95], v[104:107], v[92:95], a[92:95]
    ds_read_b128 v[156:159], v8 offset:39936
    s_add_u32 m0, s48, 3072
    s_nop 0
    buffer_load_dwordx4 v18, s[8:11], s43 offen  lds
    s_add_u32 s43, s43, 1024
    s_add_u32 s48, s48, 32768
    s_and_b32 s48, s48, 0x1ffff
    v_mfma_f32_16x16x32_bf16 a[96:99], v[108:111], v[64:67], a[96:99]
    v_mfma_f32_16x16x32_bf16 a[100:103], v[108:111], v[68:71], a[100:103]
    v_mfma_f32_16x16x32_bf16 a[104:107], v[108:111], v[72:75], a[104:107]
    v_mfma_f32_16x16x32_bf16 a[108:111], v[108:111], v[76:79], a[108:111]
    v_mfma_f32_16x16x32_bf16 a[112:115], v[108:111], v[80:83], a[112:115]
    v_mfma_f32_16x16x32_bf16 a[116:119], v[108:111], v[84:87], a[116:119]
    v_mfma_f32_16x16x32_bf16 a[120:123], v[108:111], v[88:91], a[120:123]
    s_add_u32 m0, s49, 0
    s_nop 0
    buffer_load_dwordx4 v19, s[12:15], s44 offen lds
    s_add_u32 s44, s44, s50
    v_mfma_f32_16x16x32_bf16 a[124:127], v[108:111], v[92:95], a[124:127]
    v_mfma_f32_16x16x32_bf16 a[128:131], v[112:115], v[64:67], a[128:131]
    v_mfma_f32_16x16x32_bf16 a[132:135], v[112:115], v[68:71], a[132:135]
    v_mfma_f32_16x16x32_bf16 a[136:139], v[112:115], v[72:75], a[136:139]
    v_mfma_f32_16x16x32_bf16 a[140:143], v[112:115], v[76:79], a[140:143]
    v_mfma_f32_16x16x32_bf16 a[144:147], v[112:115], v[80:83], a[144:147]
    v_mfma_f32_16x16x32_bf16 a[148:151], v[112:115], v[84:87], a[148:151]
    s_add_u32 m0, s49, 2048
    s_nop 0
    buffer_load_dwordx4 v19, s[12:15], s45 offen lds
    s_add_u32 s45, s45, s50
    v_mfma_f32_16x16x32_bf16 a[152:155], v[112:115], v[88:91], a[152:155]
    v_mfma_f32_16x16x32_bf16 a[156:159], v[112:115], v[92:95], a[156:159]
    v_mfma_f32_16x16x32_bf16 a[160:163], v[116:119], v[64:67], a[160:163]
    v_mfma_f32_16x16x32_bf16 a[164:167], v[116:119], v[68:71], a[164:167]
    v_mfma_f32_16x16x32_bf16 a[168:171], v[116:119], v[72:75], a[168:171]
    v_mfma_f32_16x16x32_bf16 a[172:175], v[116:119], v[76:79], a[172:175]
    v_mfma_f32_16x16x32_bf16 a[176:179], v[116:119], v[80:83], a[176:179]
    s_add_u32 m0, s49, 8192
    s_nop 0
    buffer_load_dwordx4 v19, s[12:15], s46 offen lds
    s_add_u32 s46, s46, s50
    v_mfma_f32_16x16x32_bf16 a[180:183], v[116:119], v[84:87], a[180:183]
    v_mfma_f32_16x16x32_bf16 a[184:187], v[116:119], v[88:91], a[184:187]
    v_mfma_f32_16x16x32_bf16 a[188:191], v[116:119], v[92:95], a[188:191]
    v_mfma_f32_16x16x32_bf16 a[192:195], v[120:123], v[64:67], a[192:195]
    v_mfma_f32_16x16x32_bf16 a[196:199], v[120:123], v[68:71], a[196:199]
    v_mfma_f32_16x16x32_bf16 a[200:203], v[120:123], v[72:75], a[200:203]
    v_mfma_f32_16x16x32_bf16 a[204:207], v[120:123], v[76:79], a[204:207]
    s_add_u32 m0, s49, 10240
    s_nop 0
    buffer_load_dwordx4 v19, s[12:15], s47 offen lds
    s_add_u32 s47, s47, s50
    s_add_u32 s49, s49, 32768
    s_and_b32 s49, s49, 0x1ffff
    v_mfma_f32_16x16x32_bf16 a[208:211], v[120:123], v[80:83], a[208:211]
    v_mfma_f32_16x16x32_bf16 a[212:215], v[120:123], v[84:87], a[212:215]
    v_mfma_f32_16x16x32_bf16 a[216:219], v[120:123], v[88:91], a[216:219]
    v_mfma_f32_16x16x32_bf16 a[220:223], v[120:123], v[92:95], a[220:223]
    v_mfma_f32_16x16x32_bf16 a[224:227], v[124:127], v[64:67], a[224:227]
    v_mfma_f32_16x16x32_bf16 a[228:231], v[124:127], v[68:71], a[228:231]
    v_mfma_f32_16x16x32_bf16 a[232:235], v[124:127], v[72:75], a[232:235]
    v_mfma_f32_16x16x32_bf16 a[236:239], v[124:127], v[76:79], a[236:239]
    v_mfma_f32_16x16x32_bf16 a[240:243], v[124:127], v[80:83], a[240:243]
    v_mfma_f32_16x16x32_bf16 a[244:247], v[124:127], v[84:87], a[244:247]
    v_mfma_f32_16x16x32_bf16 a[248:251], v[124:127], v[88:91], a[248:251]
    v_mfma_f32_16x16x32_bf16 a[252:255], v[124:127], v[92:95], a[252:255]
    v_xor_b32 v8, 0x10000, v8
    v_xor_b32 v10, 0x10000, v10
    v_xor_b32 v11, 0x10000, v11
    v_xor_b32 v12, 0x10000, v12
    v_xor_b32 v13, 0x10000, v13
    v_xor_b32 v14, 0x10000, v14
    v_xor_b32 v15, 0x10000, v15
    v_xor_b32 v16, 0x10000, v16
    v_xor_b32 v17, 0x10000, v17
    s_waitcnt vmcnt(16) lgkmcnt(0)
    s_barrier
    v_mfma_f32_16x16x32_bf16 a[0:3], v[160:163], v[128:131], a[0:3]
    ds_read_b64_tr_b16 v[96:97], v10 offset:0
    v_mfma_f32_16x16x32_bf16 a[4:7], v[160:163], v[132:135], a[4:7]
    ds_read_b64_tr_b16 v[98:99], v10 offset:2048
    v_mfma_f32_16x16x32_bf16 a[8:11], v[160:163], v[136:139], a[8:11]
    ds_read_b128 v[64:67], v8 offset:0
    s_add_u32 m0, s48, 0
    s_nop 0
    buffer_load_dwordx4 v18, s[8:11], s40 offen  lds
    s_add_u32 s40, s40, 1024
    v_mfma_f32_16x16x32_bf16 a[12:15], v[160:163], v[140:143], a[12:15]
    ds_read_b64_tr_b16 v[100:101], v11 offset:0
    v_mfma_f32_16x16x32_bf16 a[16:19], v[160:163], v[144:147], a[16:19]
    ds_read_b64_tr_b16 v[102:103], v11 offset:2048
    v_mfma_f32_16x16x32_bf16 a[20:23], v[160:163], v[148:151], a[20:23]
    ds_read_b128 v[68:71], v8 offset:1024
    v_mfma_f32_16x16x32_bf16 a[24:27], v[160:163], v[152:155], a[24:27]
    ds_read_b64_tr_b16 v[104:105], v12 offset:0
    v_mfma_f32_16x16x32_bf16 a[28:31], v[160:163], v[156:159], a[28:31]
    ds_read_b64_tr_b16 v[106:107], v12 offset:2048
    v_mfma_f32_16x16x32_bf16 a[32:35], v[164:167], v[128:131], a[32:35]
    ds_read_b128 v[72:75], v8 offset:2048
    v_mfma_f32_16x16x32_bf16 a[36:39], v[164:167], v[132:135], a[36:39]
    ds_read_b64_tr_b16 v[108:109], v13 offset:0
    s_add_u32 m0, s48, 1024
    s_nop 0
    buffer_load_dwordx4 v18, s[8:11], s41 offen  lds
    s_add_u32 s41, s41, 1024
    v_mfma_f32_16x16x32_bf16 a[40:43], v[164:167], v[136:139], a[40:43]
    ds_read_b64_tr_b16 v[110:111], v13 offset:2048
    v_mfma_f32_16x16x32_bf16 a[44:47], v[164:167], v[140:143], a[44:47]
    ds_read_b128 v[76:79], v8 offset:3072
    v_mfma_f32_16x16x32_bf16 a[48:51], v[164:167], v[144:147], a[48:51]
    ds_read_b64_tr_b16 v[112:113], v14 offset:0
    v_mfma_f32_16x16x32_bf16 a[52:55], v[164:167], v[148:151], a[52:55]
    ds_read_b64_tr_b16 v[114:115], v14 offset:2048
    v_mfma_f32_16x16x32_bf16 a[56:59], v[164:167], v[152:155], a[56:59]
    ds_read_b128 v[80:83], v8 offset:4096
    v_mfma_f32_16x16x32_bf16 a[60:63], v[164:167], v[156:159], a[60:63]
    ds_read_b64_tr_b16 v[116:117], v15 offset:0
    v_mfma_f32_16x16x32_bf16 a[64:67], v[168:171], v[128:131], a[64:67]
    ds_read_b64_tr_b16 v[118:119], v15 offset:2048
    s_add_u32 m0, s48, 2048
    s_nop 0
    buffer_load_dwordx4 v18, s[8:11], s42 offen  lds
    s_add_u32 s42, s42, 1024
    v_mfma_f32_16x16x32_bf16 a[68:71], v[168:171], v[132:135], a[68:71]
    ds_read_b128 v[84:87], v8 offset:5120
    v_mfma_f32_16x16x32_bf16 a[72:75], v[168:171], v[136:139], a[72:75]
    ds_read_b64_tr_b16 v[120:121], v16 offset:0
    v_mfma_f32_16x16x32_bf16 a[76:79], v[168:171], v[140:143], a[76:79]
    ds_read_b64_tr_b16 v[122:123], v16 offset:2048
    v_mfma_f32_16x16x32_bf16 a[80:83], v[168:171], v[144:147], a[80:83]
    ds_read_b128 v[88:91], v8 offset:6144
    v_mfma_f32_16x16x32_bf16 a[84:87], v[168:171], v[148:151], a[84:87]
    ds_read_b64_tr_b16 v[124:125], v17 offset:0
    v_mfma_f32_16x16x32_bf16 a[88:91], v[168:171], v[152:155], a[88:91]
    ds_read_b64_tr_b16 v[126:127], v17 offset:2048
    v_mfma_f32_16x16x32_bf16 a[92:95], v[168:171], v[156:159], a[92:95]
    ds_read_b128 v[92:95], v8 offset:7168
    s_add_u32 m0, s48, 3072
    s_nop 0
    buffer_load_dwordx4 v18, s[8:11], s43 offen  lds
    s_add_u32 s43, s43, 1024
    s_add_u32 s48, s48, 32768
    s_and_b32 s48, s48, 0x1ffff
    v_mfma_f32_16x16x32_bf16 a[96:99], v[172:175], v[128:131], a[96:99]
    v_mfma_f32_16x16x32_bf16 a[100:103], v[172:175], v[132:135], a[100:103]
    v_mfma_f32_16x16x32_bf16 a[104:107], v[172:175], v[136:139], a[104:107]
    v_mfma_f32_16x16x32_bf16 a[108:111], v[172:175], v[140:143], a[108:111]
    v_mfma_f32_16x16x32_bf16 a[112:115], v[172:175], v[144:147], a[112:115]
    v_mfma_f32_16x16x32_bf16 a[116:119], v[172:175], v[148:151], a[116:119]
    v_mfma_f32_16x16x32_bf16 a[120:123], v[172:175], v[152:155], a[120:123]
    s_add_u32 m0, s49, 0
    s_nop 0
    buffer_load_dwordx4 v19, s[12:15], s44 offen lds
    s_add_u32 s44, s44, s50
    v_mfma_f32_16x16x32_bf16 a[124:127], v[172:175], v[156:159], a[124:127]
    v_mfma_f32_16x16x32_bf16 a[128:131], v[176:179], v[128:131], a[128:131]
    v_mfma_f32_16x16x32_bf16 a[132:135], v[176:179], v[132:135], a[132:135]
    v_mfma_f32_16x16x32_bf16 a[136:139], v[176:179], v[136:139], a[136:139]
    v_mfma_f32_16x16x32_bf16 a[140:143], v[176:179], v[140:143], a[140:143]
    v_mfma_f32_16x16x32_bf16 a[144:147], v[176:179], v[144:147], a[144:147]
    v_mfma_f32_16x16x32_bf16 a[148:151], v[176:179], v[148:151], a[148:151]
    s_add_u32 m0, s49, 2048
    s_nop 0
    buffer_load_dwordx4 v19, s[12:15], s45 offen lds
    s_add_u32 s45, s45, s50
    v_mfma_f32_16x16x32_bf16 a[152:155], v[176:179], v[152:155], a[152:155]
    v_mfma_f32_16x16x32_bf16 a[156:159], v[176:179], v[156:159], a[156:159]
    v_mfma_f32_16x16x32_bf16 a[160:163], v[180:183], v[128:131], a[160:163]
    v_mfma_f32_16x16x32_bf16 a[164:167], v[180:183], v[132:135], a[164:167]
    v_mfma_f32_16x16x32_bf16 a[168:171], v[180:183], v[136:139], a[168:171]
    v_mfma_f32_16x16x32_bf16 a[172:175], v[180:183], v[140:143], a[172:175]
    v_mfma_f32_16x16x32_bf16 a[176:179], v[180:183], v[144:147], a[176:179]
    s_add_u32 m0, s49, 8192
    s_nop 0
    buffer_load_dwordx4 v19, s[12:15], s46 offen lds
    s_add_u32 s46, s46, s50
    v_mfma_f32_16x16x32_bf16 a[180:183], v[180:183], v[148:151], a[180:183]
    v_mfma_f32_16x16x32_bf16 a[184:187], v[180:183], v[152:155], a[184:187]
    v_mfma_f32_16x16x32_bf16 a[188:191], v[180:183], v[156:159], a[188:191]
    v_mfma_f32_16x16x32_bf16 a[192:195], v[184:187], v[128:131], a[192:195]
    v_mfma_f32_16x16x32_bf16 a[196:199], v[184:187], v[132:135], a[196:199]
    v_mfma_f32_16x16x32_bf16 a[200:203], v[184:187], v[136:139], a[200:203]
    v_mfma_f32_16x16x32_bf16 a[204:207], v[184:187], v[140:143], a[204:207]
    s_add_u32 m0, s49, 10240
    s_nop 0
    buffer_load_dwordx4 v19, s[12:15], s47 offen lds
    s_add_u32 s47, s47, s50
    s_add_u32 s49, s49, 32768
    s_and_b32 s49, s49, 0x1ffff
    v_mfma_f32_16x16x32_bf16 a[208:211], v[184:187], v[144:147], a[208:211]
    v_mfma_f32_16x16x32_bf16 a[212:215], v[184:187], v[148:151], a[212:215]
    v_mfma_f32_16x16x32_bf16 a[216:219], v[184:187], v[152:155], a[216:219]
    v_mfma_f32_16x16x32_bf16 a[220:223], v[184:187], v[156:159], a[220:223]
    v_mfma_f32_16x16x32_bf16 a[224:227], v[188:191], v[128:131], a[224:227]
    v_mfma_f32_16x16x32_bf16 a[228:231], v[188:191], v[132:135], a[228:231]
    v_mfma_f32_16x16x32_bf16 a[232:235], v[188:191], v[136:139], a[232:235]
    v_mfma_f32_16x16x32_bf16 a[236:239], v[188:191], v[140:143], a[236:239]
    v_mfma_f32_16x16x32_bf16 a[240:243], v[188:191], v[144:147], a[240:243]
    v_mfma_f32_16x16x32_bf16 a[244:247], v[188:191], v[148:151], a[244:247]
    v_mfma_f32_16x16x32_bf16 a[248:251], v[188:191], v[152:155], a[248:251]
    v_mfma_f32_16x16x32_bf16 a[252:255], v[188:191], v[156:159], a[252:255]
    s_sub_u32 s51, s51, 1
    s_cmp_lg_u32 s51, 0
    s_cbranch_scc1 Gh_loop
    s_waitcnt vmcnt(16) lgkmcnt(0)
    s_barrier
    v_mfma_f32_16x16x32_bf16 a[0:3], v[96:99], v[64:67], a[0:3]
    ds_read_b64_tr_b16 v[160:161], v10 offset:32768
    v_mfma_f32_16x16x32_bf16 a[4:7], v[96:99], v[68:71], a[4:7]
    ds_read_b64_tr_b16 v[162:163], v10 offset:34816
    v_mfma_f32_16x16x32_bf16 a[8:11], v[96:99], v[72:75], a[8:11]
    ds_read_b128 v[128:131], v8 offset:32768
    v_mfma_f32_16x16x32_bf16 a[12:15], v[96:99], v[76:79], a[12:15]
    ds_read_b64_tr_b16 v[164:165], v11 offset:32768
    v_mfma_f32_16x16x32_bf16 a[16:19], v[96:99], v[80:83], a[16:19]
    ds_read_b64_tr_b16 v[166:167], v11 offset:34816
    v_mfma_f32_16x16x32_bf16 a[20:23], v[96:99], v[84:87], a[20:23]
    ds_read_b128 v[132:135], v8 offset:33792
    v_mfma_f32_16x16x32_bf16 a[24:27], v[96:99], v[88:91], a[24:27]
    ds_read_b64_tr_b16 v[168:169], v12 offset:32768
    v_mfma_f32_16x16x32_bf16 a[28:31], v[96:99], v[92:95], a[28:31]
    ds_read_b64_tr_b16 v[170:171], v12 offset:34816
    v_mfma_f32_16x16x32_bf16 a[32:35], v[100:103], v[64:67], a[32:35]
    ds_read_b128 v[136:139], v8 offset:34816
    v_mfma_f32_16x16x32_bf16 a[36:39], v[100:103], v[68:71], a[36:39]
    ds_read_b64_tr_b16 v[172:173], v13 offset:32768
    v_mfma_f32_16x16x32_bf16 a[40:43], v[100:103], v[72:75], a[40:43]
    ds_read_b64_tr_b16 v[174:175], v13 offset:34816
    v_mfma_f32_16x16x32_bf16 a[44:47], v[100:103], v[76:79], a[44:47]
    ds_read_b128 v[140:143], v8 offset:35840
    v_mfma_f32_16x16x32_bf16 a[48:51], v[100:103], v[80:83], a[48:51]
    ds_read_b64_tr_b16 v[176:177], v14 offset:32768
    v_mfma_f32_16x16x32_bf16 a[52:55], v[100:103], v[84:87], a[52:55]
    ds_read_b64_tr_b16 v[178:179], v14 offset:34816
    v_mfma_f32_16x16x32_bf16 a[56:59], v[100:103], v[88:91], a[56:59]
    ds_read_b128 v[144:147], v8 offset:36864
    v_mfma_f32_16x16x32_bf16 a[60:63], v[100:103], v[92:95], a[60:63]
    ds_read_b64_tr_b16 v[180:181], v15 offset:32768
    v_mfma_f32_16x16x32_bf16 a[64:67], v[104:107], v[64:67], a[64:67]
    ds_read_b64_tr_b16 v[182:183], v15 offset:34816
    v_mfma_f32_16x16x32_bf16 a[68:71], v[104:107], v[68:71], a[68:71]
    ds_read_b128 v[148:151], v8 offset:37888
    v_mfma_f32_16x16x32_bf16 a[72:75], v[104:107], v[72:75], a[72:75]
    ds_read_b64_tr_b16 v[184:185], v16 offset:32768
    v_mfma_f32_16x16x32_bf16 a[76:79], v[104:107], v[76:79], a[76:79]
    ds_read_b64_tr_b16 v[186:187], v16 offset:34816
    v_mfma_f32_16x16x32_bf16 a[80:83], v[104:107], v[80:83], a[80:83]
    ds_read_b128 v[152:155], v8 offset:38912
    v_mfma_f32_16x16x32_bf16 a[84:87], v[104:107], v[84:87], a[84:87]
    ds_read_b64_tr_b16 v[188:189], v17 offset:32768
    v_mfma_f32_16x16x32_bf16 a[88:91], v[104:107], v[88:91], a[88:91]
    ds_read_b64_tr_b16 v[190:191], v17 offset:34816
    v_mfma_f32_16x16x32_bf16 a[92:95], v[104:107], v[92:95], a[92:95]
    ds_read_b128 v[156:159], v8 offset:39936
    v_mfma_f32_16x16x32_bf16 a[96:99], v[108:111], v[64:67], a[96:99]
    v_mfma_f32_16x16x32_bf16 a[100:103], v[108:111], v[68:71], a[100:103]
    v_mfma_f32_16x16x32_bf16 a[104:107], v[108:111], v[72:75], a[104:107]
    v_mfma_f32_16x16x32_bf16 a[108:111], v[108:111], v[76:79], a[108:111]
    v_mfma_f32_16x16x32_bf16 a[112:115], v[108:111], v[80:83], a[112:115]
    v_mfma_f32_16x16x32_bf16 a[116:119], v[108:111], v[84:87], a[116:119]
    v_mfma_f32_16x16x32_bf16 a[120:123], v[108:111], v[88:91], a[120:123]
    v_mfma_f32_16x16x32_bf16 a[124:127], v[108:111], v[92:95], a[124:127]
    v_mfma_f32_16x16x32_bf16 a[128:131], v[112:115], v[64:67], a[128:131]
    v_mfma_f32_16x16x32_bf16 a[132:135], v[112:115], v[68:71], a[132:135]
    v_mfma_f32_16x16x32_bf16 a[136:139], v[112:115], v[72:75], a[136:139]
    v_mfma_f32_16x16x32_bf16 a[140:143], v[112:115], v[76:79], a[140:143]
    v_mfma_f32_16x16x32_bf16 a[144:147], v[112:115], v[80:83], a[144:147]
    v_mfma_f32_16x16x32_bf16 a[148:151], v[112:115], v[84:87], a[148:151]
    v_mfma_f32_16x16x32_bf16 a[152:155], v[112:115], v[88:91], a[152:155]
    v_mfma_f32_16x16x32_bf16 a[156:159], v[112:115], v[92:95], a[156:159]
    v_mfma_f32_16x16x32_bf16 a[160:163], v[116:119], v[64:67], a[160:163]
    v_mfma_f32_16x16x32_bf16 a[164:167], v[116:119], v[68:71], a[164:167]
    v_mfma_f32_16x16x32_bf16 a[168:171], v[116:119], v[72:75], a[168:171]
    v_mfma_f32_16x16x32_bf16 a[172:175], v[116:119], v[76:79], a[172:175]
    v_mfma_f32_16x16x32_bf16 a[176:179], v[116:119], v[80:83], a[176:179]
    v_mfma_f32_16x16x32_bf16 a[180:183], v[116:119], v[84:87], a[180:183]
    v_mfma_f32_16x16x32_bf16 a[184:187], v[116:119], v[88:91], a[184:187]
    v_mfma_f32_16x16x32_bf16 a[188:191], v[116:119], v[92:95], a[188:191]
    v_mfma_f32_16x16x32_bf16 a[192:195], v[120:123], v[64:67], a[192:195]
    v_mfma_f32_16x16x32_bf16 a[196:199], v[120:123], v[68:71], a[196:199]
    v_mfma_f32_16x16x32_bf16 a[200:203], v[120:123], v[72:75], a[200:203]
    v_mfma_f32_16x16x32_bf16 a[204:207], v[120:123], v[76:79], a[204:207]
    v_mfma_f32_16x16x32_bf16 a[208:211], v[120:123], v[80:83], a[208:211]
    v_mfma_f32_16x16x32_bf16 a[212:215], v[120:123], v[84:87], a[212:215]
    v_mfma_f32_16x16x32_bf16 a[216:219], v[120:123], v[88:91], a[216:219]
    v_mfma_f32_16x16x32_bf16 a[220:223], v[120:123], v[92:95], a[220:223]
    v_mfma_f32_16x16x32_bf16 a[224:227], v[124:127], v[64:67], a[224:227]
    v_mfma_f32_16x16x32_bf16 a[228:231], v[124:127], v[68:71], a[228:231]
    v_mfma_f32_16x16x32_bf16 a[232:235], v[124:127], v[72:75], a[232:235]
    v_mfma_f32_16x16x32_bf16 a[236:239], v[124:127], v[76:79], a[236:239]
    v_mfma_f32_16x16x32_bf16 a[240:243], v[124:127], v[80:83], a[240:243]
    v_mfma_f32_16x16x32_bf16 a[244:247], v[124:127], v[84:87], a[244:247]
    v_mfma_f32_16x16x32_bf16 a[248:251], v[124:127], v[88:91], a[248:251]
    v_mfma_f32_16x16x32_bf16 a[252:255], v[124:127], v[92:95], a[252:255]
    v_xor_b32 v8, 0x10000, v8
    v_xor_b32 v10, 0x10000, v10
    v_xor_b32 v11, 0x10000, v11
    v_xor_b32 v12, 0x10000, v12
    v_xor_b32 v13, 0x10000, v13
    v_xor_b32 v14, 0x10000, v14
    v_xor_b32 v15, 0x10000, v15
    v_xor_b32 v16, 0x10000, v16
    v_xor_b32 v17, 0x10000, v17
    s_waitcnt vmcnt(8) lgkmcnt(0)
    s_barrier
    v_mfma_f32_16x16x32_bf16 a[0:3], v[160:163], v[128:131], a[0:3]
    ds_read_b64_tr_b16 v[96:97], v10 offset:0
    v_mfma_f32_16x16x32_bf16 a[4:7], v[160:163], v[132:135], a[4:7]
    ds_read_b64_tr_b16 v[98:99], v10 offset:2048
    v_mfma_f32_16x16x32_bf16 a[8:11], v[160:163], v[136:139], a[8:11]
    ds_read_b128 v[64:67], v8 offset:0
    v_mfma_f32_16x16x32_bf16 a[12:15], v[160:163], v[140:143], a[12:15]
    ds_read_b64_tr_b16 v[100:101], v11 offset:0
    v_mfma_f32_16x16x32_bf16 a[16:19], v[160:163], v[144:147], a[16:19]
    ds_read_b64_tr_b16 v[102:103], v11 offset:2048
    v_mfma_f32_16x16x32_bf16 a[20:23], v[160:163], v[148:151], a[20:23]
    ds_read_b128 v[68:71], v8 offset:1024
    v_mfma_f32_16x16x32_bf16 a[24:27], v[160:163], v[152:155], a[24:27]
    ds_read_b64_tr_b16 v[104:105], v12 offset:0
    v_mfma_f32_16x16x32_bf16 a[28:31], v[160:163], v[156:159], a[28:31]
    ds_read_b64_tr_b16 v[106:107], v12 offset:2048
    v_mfma_f32_16x16x32_bf16 a[32:35], v[164:167], v[128:131], a[32:35]
    ds_read_b128 v[72:75], v8 offset:2048
    v_mfma_f32_16x16x32_bf16 a[36:39], v[164:167], v[132:135], a[36:39]
    ds_read_b64_tr_b16 v[108:109], v13 offset:0
    v_mfma_f32_16x16x32_bf16 a[40:43], v[164:167], v[136:139], a[40:43]
    ds_read_b64_tr_b16 v[110:111], v13 offset:2048
    v_mfma_f32_16x16x32_bf16 a[44:47], v[164:167], v[140:143], a[44:47]
    ds_read_b128 v[76:79], v8 offset:3072
    v_mfma_f32_16x16x32_bf16 a[48:51], v[164:167], v[144:147], a[48:51]
    ds_read_b64_tr_b16 v[112:113], v14 offset:0
    v_mfma_f32_16x16x32_bf16 a[52:55], v[164:167], v[148:151], a[52:55]
    ds_read_b64_tr_b16 v[114:115], v14 offset:2048
    v_mfma_f32_16x16x32_bf16 a[56:59], v[164:167], v[152:155], a[56:59]
    ds_read_b128 v[80:83], v8 offset:4096
    v_mfma_f32_16x16x32_bf16 a[60:63], v[164:167], v[156:159], a[60:63]
    ds_read_b64_tr_b16 v[116:117], v15 offset:0
    v_mfma_f32_16x16x32_bf16 a[64:67], v[168:171], v[128:131], a[64:67]
    ds_read_b64_tr_b16 v[118:119], v15 offset:2048
    v_mfma_f32_16x16x32_bf16 a[68:71], v[168:171], v[132:135], a[68:71]
    ds_read_b128 v[84:87], v8 offset:5120
    v_mfma_f32_16x16x32_bf16 a[72:75], v[168:171], v[136:139], a[72:75]
    ds_read_b64_tr_b16 v[120:121], v16 offset:0
    v_mfma_f32_16x16x32_bf16 a[76:79], v[168:171], v[140:143], a[76:79]
    ds_read_b64_tr_b16 v[122:123], v16 offset:2048
    v_mfma_f32_16x16x32_bf16 a[80:83], v[168:171], v[144:147], a[80:83]
    ds_read_b128 v[88:91], v8 offset:6144
    v_mfma_f32_16x16x32_bf16 a[84:87], v[168:171], v[148:151], a[84:87]
    ds_read_b64_tr_b16 v[124:125], v17 offset:0
    v_mfma_f32_16x16x32_bf16 a[88:91], v[168:171], v[152:155], a[88:91]
    ds_read_b64_tr_b16 v[126:127], v17 offset:2048
    v_mfma_f32_16x16x32_bf16 a[92:95], v[168:171], v[156:159], a[92:95]
    ds_read_b128 v[92:95], v8 offset:7168
    v_mfma_f32_16x16x32_bf16 a[96:99], v[172:175], v[128:131], a[96:99]
    v_mfma_f32_16x16x32_bf16 a[100:103], v[172:175], v[132:135], a[100:103]
    v_mfma_f32_16x16x32_bf16 a[104:107], v[172:175], v[136:139], a[104:107]
    v_mfma_f32_16x16x32_bf16 a[108:111], v[172:175], v[140:143], a[108:111]
    v_mfma_f32_16x16x32_bf16 a[112:115], v[172:175], v[144:147], a[112:115]
    v_mfma_f32_16x16x32_bf16 a[116:119], v[172:175], v[148:151], a[116:119]
    v_mfma_f32_16x16x32_bf16 a[120:123], v[172:175], v[152:155], a[120:123]
    v_mfma_f32_16x16x32_bf16 a[124:127], v[172:175], v[156:159], a[124:127]
    v_mfma_f32_16x16x32_bf16 a[128:131], v[176:179], v[128:131], a[128:131]
    v_mfma_f32_16x16x32_bf16 a[132:135], v[176:179], v[132:135], a[132:135]
    v_mfma_f32_16x16x32_bf16 a[136:139], v[176:179], v[136:139], a[136:139]
    v_mfma_f32_16x16x32_bf16 a[140:143], v[176:179], v[140:143], a[140:143]
    v_mfma_f32_16x16x32_bf16 a[144:147], v[176:179], v[144:147], a[144:147]
    v_mfma_f32_16x16x32_bf16 a[148:151], v[176:179], v[148:151], a[148:151]
    v_mfma_f32_16x16x32_bf16 a[152:155], v[176:179], v[152:155], a[152:155]
    v_mfma_f32_16x16x32_bf16 a[156:159], v[176:179], v[156:159], a[156:159]
    v_mfma_f32_16x16x32_bf16 a[160:163], v[180:183], v[128:131], a[160:163]
    v_mfma_f32_16x16x32_bf16 a[164:167], v[180:183], v[132:135], a[164:167]
    v_mfma_f32_16x16x32_bf16 a[168:171], v[180:183], v[136:139], a[168:171]
    v_mfma_f32_16x16x32_bf16 a[172:175], v[180:183], v[140:143], a[172:175]
    v_mfma_f32_16x16x32_bf16 a[176:179], v[180:183], v[144:147], a[176:179]
    v_mfma_f32_16x16x32_bf16 a[180:183], v[180:183], v[148:151], a[180:183]
    v_mfma_f32_16x16x32_bf16 a[184:187], v[180:183], v[152:155], a[184:187]
    v_mfma_f32_16x16x32_bf16 a[188:191], v[180:183], v[156:159], a[188:191]
    v_mfma_f32_16x16x32_bf16 a[192:195], v[184:187], v[128:131], a[192:195]
    v_mfma_f32_16x16x32_bf16 a[196:199], v[184:187], v[132:135], a[196:199]
    v_mfma_f32_16x16x32_bf16 a[200:203], v[184:187], v[136:139], a[200:203]
    v_mfma_f32_16x16x32_bf16 a[204:207], v[184:187], v[140:143], a[204:207]
    v_mfma_f32_16x16x32_bf16 a[208:211], v[184:187], v[144:147], a[208:211]
    v_mfma_f32_16x16x32_bf16 a[212:215], v[184:187], v[148:151], a[212:215]
    v_mfma_f32_16x16x32_bf16 a[216:219], v[184:187], v[152:155], a[216:219]
    v_mfma_f32_16x16x32_bf16 a[220:223], v[184:187], v[156:159], a[220:223]
    v_mfma_f32_16x16x32_bf16 a[224:227], v[188:191], v[128:131], a[224:227]
    v_mfma_f32_16x16x32_bf16 a[228:231], v[188:191], v[132:135], a[228:231]
    v_mfma_f32_16x16x32_bf16 a[232:235], v[188:191], v[136:139], a[232:235]
    v_mfma_f32_16x16x32_bf16 a[236:239], v[188:191], v[140:143], a[236:239]
    v_mfma_f32_16x16x32_bf16 a[240:243], v[188:191], v[144:147], a[240:243]
    v_mfma_f32_16x16x32_bf16 a[244:247], v[188:191], v[148:151], a[244:247]
    v_mfma_f32_16x16x32_bf16 a[248:251], v[188:191], v[152:155], a[248:251]
    v_mfma_f32_16x16x32_bf16 a[252:255], v[188:191], v[156:159], a[252:255]
    s_waitcnt vmcnt(0) lgkmcnt(0)
    s_barrier
    v_mfma_f32_16x16x32_bf16 a[0:3], v[96:99], v[64:67], a[0:3]
    ds_read_b64_tr_b16 v[160:161], v10 offset:32768
    v_mfma_f32_16x16x32_bf16 a[4:7], v[96:99], v[68:71], a[4:7]
    ds_read_b64_tr_b16 v[162:163], v10 offset:34816
    v_mfma_f32_16x16x32_bf16 a[8:11], v[96:99], v[72:75], a[8:11]
    ds_read_b128 v[128:131], v8 offset:32768
    v_mfma_f32_16x16x32_bf16 a[12:15], v[96:99], v[76:79], a[12:15]
    ds_read_b64_tr_b16 v[164:165], v11 offset:32768
    v_mfma_f32_16x16x32_bf16 a[16:19], v[96:99], v[80:83], a[16:19]
    ds_read_b64_tr_b16 v[166:167], v11 offset:34816
    v_mfma_f32_16x16x32_bf16 a[20:23], v[96:99], v[84:87], a[20:23]
    ds_read_b128 v[132:135], v8 offset:33792
    v_mfma_f32_16x16x32_bf16 a[24:27], v[96:99], v[88:91], a[24:27]
    ds_read_b64_tr_b16 v[168:169], v12 offset:32768
    v_mfma_f32_16x16x32_bf16 a[28:31], v[96:99], v[92:95], a[28:31]
    ds_read_b64_tr_b16 v[170:171], v12 offset:34816
    v_mfma_f32_16x16x32_bf16 a[32:35], v[100:103], v[64:67], a[32:35]
    ds_read_b128 v[136:139], v8 offset:34816
    v_mfma_f32_16x16x32_bf16 a[36:39], v[100:103], v[68:71], a[36:39]
    ds_read_b64_tr_b16 v[172:173], v13 offset:32768
    v_mfma_f32_16x16x32_bf16 a[40:43], v[100:103], v[72:75], a[40:43]
    ds_read_b64_tr_b16 v[174:175], v13 offset:34816
    v_mfma_f32_16x16x32_bf16 a[44:47], v[100:103], v[76:79], a[44:47]
    ds_read_b128 v[140:143], v8 offset:35840
    v_mfma_f32_16x16x32_bf16 a[48:51], v[100:103], v[80:83], a[48:51]
    ds_read_b64_tr_b16 v[176:177], v14 offset:32768
    v_mfma_f32_16x16x32_bf16 a[52:55], v[100:103], v[84:87], a[52:55]
    ds_read_b64_tr_b16 v[178:179], v14 offset:34816
    v_mfma_f32_16x16x32_bf16 a[56:59], v[100:103], v[88:91], a[56:59]
    ds_read_b128 v[144:147], v8 offset:36864
    v_mfma_f32_16x16x32_bf16 a[60:63], v[100:103], v[92:95], a[60:63]
    ds_read_b64_tr_b16 v[180:181], v15 offset:32768
    v_mfma_f32_16x16x32_bf16 a[64:67], v[104:107], v[64:67], a[64:67]
    ds_read_b64_tr_b16 v[182:183], v15 offset:34816
    v_mfma_f32_16x16x32_bf16 a[68:71], v[104:107], v[68:71], a[68:71]
    ds_read_b128 v[148:151], v8 offset:37888
    v_mfma_f32_16x16x32_bf16 a[72:75], v[104:107], v[72:75], a[72:75]
    ds_read_b64_tr_b16 v[184:185], v16 offset:32768
    v_mfma_f32_16x16x32_bf16 a[76:79], v[104:107], v[76:79], a[76:79]
    ds_read_b64_tr_b16 v[186:187], v16 offset:34816
    v_mfma_f32_16x16x32_bf16 a[80:83], v[104:107], v[80:83], a[80:83]
    ds_read_b128 v[152:155], v8 offset:38912
    v_mfma_f32_16x16x32_bf16 a[84:87], v[104:107], v[84:87], a[84:87]
    ds_read_b64_tr_b16 v[188:189], v17 offset:32768
    v_mfma_f32_16x16x32_bf16 a[88:91], v[104:107], v[88:91], a[88:91]
    ds_read_b64_tr_b16 v[190:191], v17 offset:34816
    v_mfma_f32_16x16x32_bf16 a[92:95], v[104:107], v[92:95], a[92:95]
    ds_read_b128 v[156:159], v8 offset:39936
    v_mfma_f32_16x16x32_bf16 a[96:99], v[108:111], v[64:67], a[96:99]
    v_mfma_f32_16x16x32_bf16 a[100:103], v[108:111], v[68:71], a[100:103]
    v_mfma_f32_16x16x32_bf16 a[104:107], v[108:111], v[72:75], a[104:107]
    v_mfma_f32_16x16x32_bf16 a[108:111], v[108:111], v[76:79], a[108:111]
    v_mfma_f32_16x16x32_bf16 a[112:115], v[108:111], v[80:83], a[112:115]
    v_mfma_f32_16x16x32_bf16 a[116:119], v[108:111], v[84:87], a[116:119]
    v_mfma_f32_16x16x32_bf16 a[120:123], v[108:111], v[88:91], a[120:123]
    v_mfma_f32_16x16x32_bf16 a[124:127], v[108:111], v[92:95], a[124:127]
    v_mfma_f32_16x16x32_bf16 a[128:131], v[112:115], v[64:67], a[128:131]
    v_mfma_f32_16x16x32_bf16 a[132:135], v[112:115], v[68:71], a[132:135]
    v_mfma_f32_16x16x32_bf16 a[136:139], v[112:115], v[72:75], a[136:139]
    v_mfma_f32_16x16x32_bf16 a[140:143], v[112:115], v[76:79], a[140:143]
    v_mfma_f32_16x16x32_bf16 a[144:147], v[112:115], v[80:83], a[144:147]
    v_mfma_f32_16x16x32_bf16 a[148:151], v[112:115], v[84:87], a[148:151]
    v_mfma_f32_16x16x32_bf16 a[152:155], v[112:115], v[88:91], a[152:155]
    v_mfma_f32_16x16x32_bf16 a[156:159], v[112:115], v[92:95], a[156:159]
    v_mfma_f32_16x16x32_bf16 a[160:163], v[116:119], v[64:67], a[160:163]
    v_mfma_f32_16x16x32_bf16 a[164:167], v[116:119], v[68:71], a[164:167]
    v_mfma_f32_16x16x32_bf16 a[168:171], v[116:119], v[72:75], a[168:171]
    v_mfma_f32_16x16x32_bf16 a[172:175], v[116:119], v[76:79], a[172:175]
    v_mfma_f32_16x16x32_bf16 a[176:179], v[116:119], v[80:83], a[176:179]
    v_mfma_f32_16x16x32_bf16 a[180:183], v[116:119], v[84:87], a[180:183]
    v_mfma_f32_16x16x32_bf16 a[184:187], v[116:119], v[88:91], a[184:187]
    v_mfma_f32_16x16x32_bf16 a[188:191], v[116:119], v[92:95], a[188:191]
    v_mfma_f32_16x16x32_bf16 a[192:195], v[120:123], v[64:67], a[192:195]
    v_mfma_f32_16x16x32_bf16 a[196:199], v[120:123], v[68:71], a[196:199]
    v_mfma_f32_16x16x32_bf16 a[200:203], v[120:123], v[72:75], a[200:203]
    v_mfma_f32_16x16x32_bf16 a[204:207], v[120:123], v[76:79], a[204:207]
    v_mfma_f32_16x16x32_bf16 a[208:211], v[120:123], v[80:83], a[208:211]
    v_mfma_f32_16x16x32_bf16 a[212:215], v[120:123], v[84:87], a[212:215]
    v_mfma_f32_16x16x32_bf16 a[216:219], v[120:123], v[88:91], a[216:219]
    v_mfma_f32_16x16x32_bf16 a[220:223], v[120:123], v[92:95], a[220:223]
    v_mfma_f32_16x16x32_bf16 a[224:227], v[124:127], v[64:67], a[224:227]
    v_mfma_f32_16x16x32_bf16 a[228:231], v[124:127], v[68:71], a[228:231]
    v_mfma_f32_16x16x32_bf16 a[232:235], v[124:127], v[72:75], a[232:235]
    v_mfma_f32_16x16x32_bf16 a[236:239], v[124:127], v[76:79], a[236:239]
    v_mfma_f32_16x16x32_bf16 a[240:243], v[124:127], v[80:83], a[240:243]
    v_mfma_f32_16x16x32_bf16 a[244:247], v[124:127], v[84:87], a[244:247]
    v_mfma_f32_16x16x32_bf16 a[248:251], v[124:127], v[88:91], a[248:251]
    v_mfma_f32_16x16x32_bf16 a[252:255], v[124:127], v[92:95], a[252:255]
    s_waitcnt lgkmcnt(0)
    s_barrier
    v_mfma_f32_16x16x32_bf16 a[0:3], v[160:163], v[128:131], a[0:3]
    v_mfma_f32_16x16x32_bf16 a[4:7], v[160:163], v[132:135], a[4:7]
    v_mfma_f32_16x16x32_bf16 a[8:11], v[160:163], v[136:139], a[8:11]
    v_mfma_f32_16x16x32_bf16 a[12:15], v[160:163], v[140:143], a[12:15]
    v_mfma_f32_16x16x32_bf16 a[16:19], v[160:163], v[144:147], a[16:19]
    v_mfma_f32_16x16x32_bf16 a[20:23], v[160:163], v[148:151], a[20:23]
    v_mfma_f32_16x16x32_bf16 a[24:27], v[160:163], v[152:155], a[24:27]
    v_mfma_f32_16x16x32_bf16 a[28:31], v[160:163], v[156:159], a[28:31]
    v_mfma_f32_16x16x32_bf16 a[32:35], v[164:167], v[128:131], a[32:35]
    v_mfma_f32_16x16x32_bf16 a[36:39], v[164:167], v[132:135], a[36:39]
    v_mfma_f32_16x16x32_bf16 a[40:43], v[164:167], v[136:139], a[40:43]
    v_mfma_f32_16x16x32_bf16 a[44:47], v[164:167], v[140:143], a[44:47]
    v_mfma_f32_16x16x32_bf16 a[48:51], v[164:167], v[144:147], a[48:51]
    v_mfma_f32_16x16x32_bf16 a[52:55], v[164:167], v[148:151], a[52:55]
    v_mfma_f32_16x16x32_bf16 a[56:59], v[164:167], v[152:155], a[56:59]
    v_mfma_f32_16x16x32_bf16 a[60:63], v[164:167], v[156:159], a[60:63]
    v_mfma_f32_16x16x32_bf16 a[64:67], v[168:171], v[128:131], a[64:67]
    v_mfma_f32_16x16x32_bf16 a[68:71], v[168:171], v[132:135], a[68:71]
    v_mfma_f32_16x16x32_bf16 a[72:75], v[168:171], v[136:139], a[72:75]
    v_mfma_f32_16x16x32_bf16 a[76:79], v[168:171], v[140:143], a[76:79]
    v_mfma_f32_16x16x32_bf16 a[80:83], v[168:171], v[144:147], a[80:83]
    v_mfma_f32_16x16x32_bf16 a[84:87], v[168:171], v[148:151], a[84:87]
    v_mfma_f32_16x16x32_bf16 a[88:91], v[168:171], v[152:155], a[88:91]
    v_mfma_f32_16x16x32_bf16 a[92:95], v[168:171], v[156:159], a[92:95]
    v_mfma_f32_16x16x32_bf16 a[96:99], v[172:175], v[128:131], a[96:99]
    v_mfma_f32_16x16x32_bf16 a[100:103], v[172:175], v[132:135], a[100:103]
    v_mfma_f32_16x16x32_bf16 a[104:107], v[172:175], v[136:139], a[104:107]
    v_mfma_f32_16x16x32_bf16 a[108:111], v[172:175], v[140:143], a[108:111]
    v_mfma_f32_16x16x32_bf16 a[112:115], v[172:175], v[144:147], a[112:115]
    v_mfma_f32_16x16x32_bf16 a[116:119], v[172:175], v[148:151], a[116:119]
    v_mfma_f32_16x16x32_bf16 a[120:123], v[172:175], v[152:155], a[120:123]
    v_mfma_f32_16x16x32_bf16 a[124:127], v[172:175], v[156:159], a[124:127]
    v_mfma_f32_16x16x32_bf16 a[128:131], v[176:179], v[128:131], a[128:131]
    v_mfma_f32_16x16x32_bf16 a[132:135], v[176:179], v[132:135], a[132:135]
    v_mfma_f32_16x16x32_bf16 a[136:139], v[176:179], v[136:139], a[136:139]
    v_mfma_f32_16x16x32_bf16 a[140:143], v[176:179], v[140:143], a[140:143]
    v_mfma_f32_16x16x32_bf16 a[144:147], v[176:179], v[144:147], a[144:147]
    v_mfma_f32_16x16x32_bf16 a[148:151], v[176:179], v[148:151], a[148:151]
    v_mfma_f32_16x16x32_bf16 a[152:155], v[176:179], v[152:155], a[152:155]
    v_mfma_f32_16x16x32_bf16 a[156:159], v[176:179], v[156:159], a[156:159]
    v_mfma_f32_16x16x32_bf16 a[160:163], v[180:183], v[128:131], a[160:163]
    v_mfma_f32_16x16x32_bf16 a[164:167], v[180:183], v[132:135], a[164:167]
    v_mfma_f32_16x16x32_bf16 a[168:171], v[180:183], v[136:139], a[168:171]
    v_mfma_f32_16x16x32_bf16 a[172:175], v[180:183], v[140:143], a[172:175]
    v_mfma_f32_16x16x32_bf16 a[176:179], v[180:183], v[144:147], a[176:179]
    v_mfma_f32_16x16x32_bf16 a[180:183], v[180:183], v[148:151], a[180:183]
    v_mfma_f32_16x16x32_bf16 a[184:187], v[180:183], v[152:155], a[184:187]
    v_mfma_f32_16x16x32_bf16 a[188:191], v[180:183], v[156:159], a[188:191]
    v_mfma_f32_16x16x32_bf16 a[192:195], v[184:187], v[128:131], a[192:195]
    v_mfma_f32_16x16x32_bf16 a[196:199], v[184:187], v[132:135], a[196:199]
    v_mfma_f32_16x16x32_bf16 a[200:203], v[184:187], v[136:139], a[200:203]
    v_mfma_f32_16x16x32_bf16 a[204:207], v[184:187], v[140:143], a[204:207]
    v_mfma_f32_16x16x32_bf16 a[208:211], v[184:187], v[144:147], a[208:211]
    v_mfma_f32_16x16x32_bf16 a[212:215], v[184:187], v[148:151], a[212:215]
    v_mfma_f32_16x16x32_bf16 a[216:219], v[184:187], v[152:155], a[216:219]
    v_mfma_f32_16x16x32_bf16 a[220:223], v[184:187], v[156:159], a[220:223]
    v_mfma_f32_16x16x32_bf16 a[224:227], v[188:191], v[128:131], a[224:227]
    v_mfma_f32_16x16x32_bf16 a[228:231], v[188:191], v[132:135], a[228:231]
    v_mfma_f32_16x16x32_bf16 a[232:235], v[188:191], v[136:139], a[232:235]
    v_mfma_f32_16x16x32_bf16 a[236:239], v[188:191], v[140:143], a[236:239]
    v_mfma_f32_16x16x32_bf16 a[240:243], v[188:191], v[144:147], a[240:243]
    v_mfma_f32_16x16x32_bf16 a[244:247], v[188:191], v[148:151], a[244:247]
    v_mfma_f32_16x16x32_bf16 a[248:251], v[188:191], v[152:155], a[248:251]
    v_mfma_f32_16x16x32_bf16 a[252:255], v[188:191], v[156:159], a[252:255]
    s_lshl_b32 s54, s60, 1
    s_lshr_b32 s55, s3, 1
    s_add_u32 s54, s54, s55
    s_mul_i32 s52, s54, 1179648
    s_lshl_b32 s54, s61, 1
    s_and_b32 s55, s3, 1
    s_add_u32 s54, s54, s55
    s_lshl_b32 s54, s54, 12
    s_add_u32 s52, s52, s54
    s_add_u32 s52, s52, 52690944
    v_accvgpr_read_b32 v68, a0
    v_accvgpr_read_b32 v69, a1
    v_accvgpr_read_b32 v70, a2
    v_accvgpr_read_b32 v71, a3
    v_cvt_pk_bf16_f32 v64, v68, v69
    v_cvt_pk_bf16_f32 v65, v70, v71
    v_accvgpr_read_b32 v68, a32
    v_accvgpr_read_b32 v69, a33
    v_accvgpr_read_b32 v70, a34
    v_accvgpr_read_b32 v71, a35
    v_cvt_pk_bf16_f32 v66, v68, v69
    v_cvt_pk_bf16_f32 v67, v70, v71
    v_pk_max_i16 v64, v64, 0
    v_pk_max_i16 v65, v65, 0
    v_pk_max_i16 v66, v66, 0
    v_pk_max_i16 v67, v67, 0
    s_add_u32 s54, s52, 0
    buffer_store_dwordx4 v[64:67], v18, s[8:11], s54 offen sc1
    v_accvgpr_read_b32 v84, a64
    v_accvgpr_read_b32 v85, a65
    v_accvgpr_read_b32 v86, a66
    v_accvgpr_read_b32 v87, a67
    v_cvt_pk_bf16_f32 v80, v84, v85
    v_cvt_pk_bf16_f32 v81, v86, v87
    v_accvgpr_read_b32 v84, a96
    v_accvgpr_read_b32 v85, a97
    v_accvgpr_read_b32 v86, a98
    v_accvgpr_read_b32 v87, a99
    v_cvt_pk_bf16_f32 v82, v84, v85
    v_cvt_pk_bf16_f32 v83, v86, v87
    v_pk_max_i16 v80, v80, 0
    v_pk_max_i16 v81, v81, 0
    v_pk_max_i16 v82, v82, 0
    v_pk_max_i16 v83, v83, 0
    s_add_u32 s54, s52, 1024
    buffer_store_dwordx4 v[80:83], v18, s[8:11], s54 offen sc1
    v_accvgpr_read_b32 v100, a128
    v_accvgpr_read_b32 v101, a129
    v_accvgpr_read_b32 v102, a130
    v_accvgpr_read_b32 v103, a131
    v_cvt_pk_bf16_f32 v96, v100, v101
    v_cvt_pk_bf16_f32 v97, v102, v103
    v_accvgpr_read_b32 v100, a160
    v_accvgpr_read_b32 v101, a161
    v_accvgpr_read_b32 v102, a162
    v_accvgpr_read_b32 v103, a163
    v_cvt_pk_bf16_f32 v98, v100, v101
    v_cvt_pk_bf16_f32 v99, v102, v103
    v_pk_max_i16 v96, v96, 0
    v_pk_max_i16 v97, v97, 0
    v_pk_max_i16 v98, v98, 0
    v_pk_max_i16 v99, v99, 0
    s_add_u32 s54, s52, 2048
    buffer_store_dwordx4 v[96:99], v18, s[8:11], s54 offen sc1
    v_accvgpr_read_b32 v116, a192
    v_accvgpr_read_b32 v117, a193
    v_accvgpr_read_b32 v118, a194
    v_accvgpr_read_b32 v119, a195
    v_cvt_pk_bf16_f32 v112, v116, v117
    v_cvt_pk_bf16_f32 v113, v118, v119
    v_accvgpr_read_b32 v116, a224
    v_accvgpr_read_b32 v117, a225
    v_accvgpr_read_b32 v118, a226
    v_accvgpr_read_b32 v119, a227
    v_cvt_pk_bf16_f32 v114, v116, v117
    v_cvt_pk_bf16_f32 v115, v118, v119
    v_pk_max_i16 v112, v112, 0
    v_pk_max_i16 v113, v113, 0
    v_pk_max_i16 v114, v114, 0
    v_pk_max_i16 v115, v115, 0
    s_add_u32 s54, s52, 3072
    buffer_store_dwordx4 v[112:115], v18, s[8:11], s54 offen sc1
    v_accvgpr_read_b32 v68, a4
    v_accvgpr_read_b32 v69, a5
    v_accvgpr_read_b32 v70, a6
    v_accvgpr_read_b32 v71, a7
    v_cvt_pk_bf16_f32 v64, v68, v69
    v_cvt_pk_bf16_f32 v65, v70, v71
    v_accvgpr_read_b32 v68, a36
    v_accvgpr_read_b32 v69, a37
    v_accvgpr_read_b32 v70, a38
    v_accvgpr_read_b32 v71, a39
    v_cvt_pk_bf16_f32 v66, v68, v69
    v_cvt_pk_bf16_f32 v67, v70, v71
    v_pk_max_i16 v64, v64, 0
    v_pk_max_i16 v65, v65, 0
    v_pk_max_i16 v66, v66, 0
    v_pk_max_i16 v67, v67, 0
    s_add_u32 s54, s52, 147456
    buffer_store_dwordx4 v[64:67], v18, s[8:11], s54 offen sc1
    v_accvgpr_read_b32 v84, a68
    v_accvgpr_read_b32 v85, a69
    v_accvgpr_read_b32 v86, a70
    v_accvgpr_read_b32 v87, a71
    v_cvt_pk_bf16_f32 v80, v84, v85
    v_cvt_pk_bf16_f32 v81, v86, v87
    v_accvgpr_read_b32 v84, a100
    v_accvgpr_read_b32 v85, a101
    v_accvgpr_read_b32 v86, a102
    v_accvgpr_read_b32 v87, a103
    v_cvt_pk_bf16_f32 v82, v84, v85
    v_cvt_pk_bf16_f32 v83, v86, v87
    v_pk_max_i16 v80, v80, 0
    v_pk_max_i16 v81, v81, 0
    v_pk_max_i16 v82, v82, 0
    v_pk_max_i16 v83, v83, 0
    s_add_u32 s54, s52, 148480
    buffer_store_dwordx4 v[80:83], v18, s[8:11], s54 offen sc1
    v_accvgpr_read_b32 v100, a132
    v_accvgpr_read_b32 v101, a133
    v_accvgpr_read_b32 v102, a134
    v_accvgpr_read_b32 v103, a135
    v_cvt_pk_bf16_f32 v96, v100, v101
    v_cvt_pk_bf16_f32 v97, v102, v103
    v_accvgpr_read_b32 v100, a164
    v_accvgpr_read_b32 v101, a165
    v_accvgpr_read_b32 v102, a166
    v_accvgpr_read_b32 v103, a167
    v_cvt_pk_bf16_f32 v98, v100, v101
    v_cvt_pk_bf16_f32 v99, v102, v103
    v_pk_max_i16 v96, v96, 0
    v_pk_max_i16 v97, v97, 0
    v_pk_max_i16 v98, v98, 0
    v_pk_max_i16 v99, v99, 0
    s_add_u32 s54, s52, 149504
    buffer_store_dwordx4 v[96:99], v18, s[8:11], s54 offen sc1
    v_accvgpr_read_b32 v116, a196
    v_accvgpr_read_b32 v117, a197
    v_accvgpr_read_b32 v118, a198
    v_accvgpr_read_b32 v119, a199
    v_cvt_pk_bf16_f32 v112, v116, v117
    v_cvt_pk_bf16_f32 v113, v118, v119
    v_accvgpr_read_b32 v116, a228
    v_accvgpr_read_b32 v117, a229
    v_accvgpr_read_b32 v118, a230
    v_accvgpr_read_b32 v119, a231
    v_cvt_pk_bf16_f32 v114, v116, v117
    v_cvt_pk_bf16_f32 v115, v118, v119
    v_pk_max_i16 v112, v112, 0
    v_pk_max_i16 v113, v113, 0
    v_pk_max_i16 v114, v114, 0
    v_pk_max_i16 v115, v115, 0
    s_add_u32 s54, s52, 150528
    buffer_store_dwordx4 v[112:115], v18, s[8:11], s54 offen sc1
    v_accvgpr_read_b32 v68, a8
    v_accvgpr_read_b32 v69, a9
    v_accvgpr_read_b32 v70, a10
    v_accvgpr_read_b32 v71, a11
    v_cvt_pk_bf16_f32 v64, v68, v69
    v_cvt_pk_bf16_f32 v65, v70, v71
    v_accvgpr_read_b32 v68, a40
    v_accvgpr_read_b32 v69, a41
    v_accvgpr_read_b32 v70, a42
    v_accvgpr_read_b32 v71, a43
    v_cvt_pk_bf16_f32 v66, v68, v69
    v_cvt_pk_bf16_f32 v67, v70, v71
    v_pk_max_i16 v64, v64, 0
    v_pk_max_i16 v65, v65, 0
    v_pk_max_i16 v66, v66, 0
    v_pk_max_i16 v67, v67, 0
    s_add_u32 s54, s52, 294912
    buffer_store_dwordx4 v[64:67], v18, s[8:11], s54 offen sc1
    v_accvgpr_read_b32 v84, a72
    v_accvgpr_read_b32 v85, a73
    v_accvgpr_read_b32 v86, a74
    v_accvgpr_read_b32 v87, a75
    v_cvt_pk_bf16_f32 v80, v84, v85
    v_cvt_pk_bf16_f32 v81, v86, v87
    v_accvgpr_read_b32 v84, a104
    v_accvgpr_read_b32 v85, a105
    v_accvgpr_read_b32 v86, a106
    v_accvgpr_read_b32 v87, a107
    v_cvt_pk_bf16_f32 v82, v84, v85
    v_cvt_pk_bf16_f32 v83, v86, v87
    v_pk_max_i16 v80, v80, 0
    v_pk_max_i16 v81, v81, 0
    v_pk_max_i16 v82, v82, 0
    v_pk_max_i16 v83, v83, 0
    s_add_u32 s54, s52, 295936
    buffer_store_dwordx4 v[80:83], v18, s[8:11], s54 offen sc1
    v_accvgpr_read_b32 v100, a136
    v_accvgpr_read_b32 v101, a137
    v_accvgpr_read_b32 v102, a138
    v_accvgpr_read_b32 v103, a139
    v_cvt_pk_bf16_f32 v96, v100, v101
    v_cvt_pk_bf16_f32 v97, v102, v103
    v_accvgpr_read_b32 v100, a168
    v_accvgpr_read_b32 v101, a169
    v_accvgpr_read_b32 v102, a170
    v_accvgpr_read_b32 v103, a171
    v_cvt_pk_bf16_f32 v98, v100, v101
    v_cvt_pk_bf16_f32 v99, v102, v103
    v_pk_max_i16 v96, v96, 0
    v_pk_max_i16 v97, v97, 0
    v_pk_max_i16 v98, v98, 0
    v_pk_max_i16 v99, v99, 0
    s_add_u32 s54, s52, 296960
    buffer_store_dwordx4 v[96:99], v18, s[8:11], s54 offen sc1
    v_accvgpr_read_b32 v116, a200
    v_accvgpr_read_b32 v117, a201
    v_accvgpr_read_b32 v118, a202
    v_accvgpr_read_b32 v119, a203
    v_cvt_pk_bf16_f32 v112, v116, v117
    v_cvt_pk_bf16_f32 v113, v118, v119
    v_accvgpr_read_b32 v116, a232
    v_accvgpr_read_b32 v117, a233
    v_accvgpr_read_b32 v118, a234
    v_accvgpr_read_b32 v119, a235
    v_cvt_pk_bf16_f32 v114, v116, v117
    v_cvt_pk_bf16_f32 v115, v118, v119
    v_pk_max_i16 v112, v112, 0
    v_pk_max_i16 v113, v113, 0
    v_pk_max_i16 v114, v114, 0
    v_pk_max_i16 v115, v115, 0
    s_add_u32 s54, s52, 297984
    buffer_store_dwordx4 v[112:115], v18, s[8:11], s54 offen sc1
    v_accvgpr_read_b32 v68, a12
    v_accvgpr_read_b32 v69, a13
    v_accvgpr_read_b32 v70, a14
    v_accvgpr_read_b32 v71, a15
    v_cvt_pk_bf16_f32 v64, v68, v69
    v_cvt_pk_bf16_f32 v65, v70, v71
    v_accvgpr_read_b32 v68, a44
    v_accvgpr_read_b32 v69, a45
    v_accvgpr_read_b32 v70, a46
    v_accvgpr_read_b32 v71, a47
    v_cvt_pk_bf16_f32 v66, v68, v69
    v_cvt_pk_bf16_f32 v67, v70, v71
    v_pk_max_i16 v64, v64, 0
    v_pk_max_i16 v65, v65, 0
    v_pk_max_i16 v66, v66, 0
    v_pk_max_i16 v67, v67, 0
    s_add_u32 s54, s52, 442368
    buffer_store_dwordx4 v[64:67], v18, s[8:11], s54 offen sc1
    v_accvgpr_read_b32 v84, a76
    v_accvgpr_read_b32 v85, a77
    v_accvgpr_read_b32 v86, a78
    v_accvgpr_read_b32 v87, a79
    v_cvt_pk_bf16_f32 v80, v84, v85
    v_cvt_pk_bf16_f32 v81, v86, v87
    v_accvgpr_read_b32 v84, a108
    v_accvgpr_read_b32 v85, a109
    v_accvgpr_read_b32 v86, a110
    v_accvgpr_read_b32 v87, a111
    v_cvt_pk_bf16_f32 v82, v84, v85
    v_cvt_pk_bf16_f32 v83, v86, v87
    v_pk_max_i16 v80, v80, 0
    v_pk_max_i16 v81, v81, 0
    v_pk_max_i16 v82, v82, 0
    v_pk_max_i16 v83, v83, 0
    s_add_u32 s54, s52, 443392
    buffer_store_dwordx4 v[80:83], v18, s[8:11], s54 offen sc1
    v_accvgpr_read_b32 v100, a140
    v_accvgpr_read_b32 v101, a141
    v_accvgpr_read_b32 v102, a142
    v_accvgpr_read_b32 v103, a143
    v_cvt_pk_bf16_f32 v96, v100, v101
    v_cvt_pk_bf16_f32 v97, v102, v103
    v_accvgpr_read_b32 v100, a172
    v_accvgpr_read_b32 v101, a173
    v_accvgpr_read_b32 v102, a174
    v_accvgpr_read_b32 v103, a175
    v_cvt_pk_bf16_f32 v98, v100, v101
    v_cvt_pk_bf16_f32 v99, v102, v103
    v_pk_max_i16 v96, v96, 0
    v_pk_max_i16 v97, v97, 0
    v_pk_max_i16 v98, v98, 0
    v_pk_max_i16 v99, v99, 0
    s_add_u32 s54, s52, 444416
    buffer_store_dwordx4 v[96:99], v18, s[8:11], s54 offen sc1
    v_accvgpr_read_b32 v116, a204
    v_accvgpr_read_b32 v117, a205
    v_accvgpr_read_b32 v118, a206
    v_accvgpr_read_b32 v119, a207
    v_cvt_pk_bf16_f32 v112, v116, v117
    v_cvt_pk_bf16_f32 v113, v118, v119
    v_accvgpr_read_b32 v116, a236
    v_accvgpr_read_b32 v117, a237
    v_accvgpr_read_b32 v118, a238
    v_accvgpr_read_b32 v119, a239
    v_cvt_pk_bf16_f32 v114, v116, v117
    v_cvt_pk_bf16_f32 v115, v118, v119
    v_pk_max_i16 v112, v112, 0
    v_pk_max_i16 v113, v113, 0
    v_pk_max_i16 v114, v114, 0
    v_pk_max_i16 v115, v115, 0
    s_add_u32 s54, s52, 445440
    buffer_store_dwordx4 v[112:115], v18, s[8:11], s54 offen sc1
    v_accvgpr_read_b32 v68, a16
    v_accvgpr_read_b32 v69, a17
    v_accvgpr_read_b32 v70, a18
    v_accvgpr_read_b32 v71, a19
    v_cvt_pk_bf16_f32 v64, v68, v69
    v_cvt_pk_bf16_f32 v65, v70, v71
    v_accvgpr_read_b32 v68, a48
    v_accvgpr_read_b32 v69, a49
    v_accvgpr_read_b32 v70, a50
    v_accvgpr_read_b32 v71, a51
    v_cvt_pk_bf16_f32 v66, v68, v69
    v_cvt_pk_bf16_f32 v67, v70, v71
    v_pk_max_i16 v64, v64, 0
    v_pk_max_i16 v65, v65, 0
    v_pk_max_i16 v66, v66, 0
    v_pk_max_i16 v67, v67, 0
    s_add_u32 s54, s52, 589824
    buffer_store_dwordx4 v[64:67], v18, s[8:11], s54 offen sc1
    v_accvgpr_read_b32 v84, a80
    v_accvgpr_read_b32 v85, a81
    v_accvgpr_read_b32 v86, a82
    v_accvgpr_read_b32 v87, a83
    v_cvt_pk_bf16_f32 v80, v84, v85
    v_cvt_pk_bf16_f32 v81, v86, v87
    v_accvgpr_read_b32 v84, a112
    v_accvgpr_read_b32 v85, a113
    v_accvgpr_read_b32 v86, a114
    v_accvgpr_read_b32 v87, a115
    v_cvt_pk_bf16_f32 v82, v84, v85
    v_cvt_pk_bf16_f32 v83, v86, v87
    v_pk_max_i16 v80, v80, 0
    v_pk_max_i16 v81, v81, 0
    v_pk_max_i16 v82, v82, 0
    v_pk_max_i16 v83, v83, 0
    s_add_u32 s54, s52, 590848
    buffer_store_dwordx4 v[80:83], v18, s[8:11], s54 offen sc1
    v_accvgpr_read_b32 v100, a144
    v_accvgpr_read_b32 v101, a145
    v_accvgpr_read_b32 v102, a146
    v_accvgpr_read_b32 v103, a147
    v_cvt_pk_bf16_f32 v96, v100, v101
    v_cvt_pk_bf16_f32 v97, v102, v103
    v_accvgpr_read_b32 v100, a176
    v_accvgpr_read_b32 v101, a177
    v_accvgpr_read_b32 v102, a178
    v_accvgpr_read_b32 v103, a179
    v_cvt_pk_bf16_f32 v98, v100, v101
    v_cvt_pk_bf16_f32 v99, v102, v103
    v_pk_max_i16 v96, v96, 0
    v_pk_max_i16 v97, v97, 0
    v_pk_max_i16 v98, v98, 0
    v_pk_max_i16 v99, v99, 0
    s_add_u32 s54, s52, 591872
    buffer_store_dwordx4 v[96:99], v18, s[8:11], s54 offen sc1
    v_accvgpr_read_b32 v116, a208
    v_accvgpr_read_b32 v117, a209
    v_accvgpr_read_b32 v118, a210
    v_accvgpr_read_b32 v119, a211
    v_cvt_pk_bf16_f32 v112, v116, v117
    v_cvt_pk_bf16_f32 v113, v118, v119
    v_accvgpr_read_b32 v116, a240
    v_accvgpr_read_b32 v117, a241
    v_accvgpr_read_b32 v118, a242
    v_accvgpr_read_b32 v119, a243
    v_cvt_pk_bf16_f32 v114, v116, v117
    v_cvt_pk_bf16_f32 v115, v118, v119
    v_pk_max_i16 v112, v112, 0
    v_pk_max_i16 v113, v113, 0
    v_pk_max_i16 v114, v114, 0
    v_pk_max_i16 v115, v115, 0
    s_add_u32 s54, s52, 592896
    buffer_store_dwordx4 v[112:115], v18, s[8:11], s54 offen sc1
    v_accvgpr_read_b32 v68, a20
    v_accvgpr_read_b32 v69, a21
    v_accvgpr_read_b32 v70, a22
    v_accvgpr_read_b32 v71, a23
    v_cvt_pk_bf16_f32 v64, v68, v69
    v_cvt_pk_bf16_f32 v65, v70, v71
    v_accvgpr_read_b32 v68, a52
    v_accvgpr_read_b32 v69, a53
    v_accvgpr_read_b32 v70, a54
    v_accvgpr_read_b32 v71, a55
    v_cvt_pk_bf16_f32 v66, v68, v69
    v_cvt_pk_bf16_f32 v67, v70, v71
    v_pk_max_i16 v64, v64, 0
    v_pk_max_i16 v65, v65, 0
    v_pk_max_i16 v66, v66, 0
    v_pk_max_i16 v67, v67, 0
    s_add_u32 s54, s52, 737280
    buffer_store_dwordx4 v[64:67], v18, s[8:11], s54 offen sc1
    v_accvgpr_read_b32 v84, a84
    v_accvgpr_read_b32 v85, a85
    v_accvgpr_read_b32 v86, a86
    v_accvgpr_read_b32 v87, a87
    v_cvt_pk_bf16_f32 v80, v84, v85
    v_cvt_pk_bf16_f32 v81, v86, v87
    v_accvgpr_read_b32 v84, a116
    v_accvgpr_read_b32 v85, a117
    v_accvgpr_read_b32 v86, a118
    v_accvgpr_read_b32 v87, a119
    v_cvt_pk_bf16_f32 v82, v84, v85
    v_cvt_pk_bf16_f32 v83, v86, v87
    v_pk_max_i16 v80, v80, 0
    v_pk_max_i16 v81, v81, 0
    v_pk_max_i16 v82, v82, 0
    v_pk_max_i16 v83, v83, 0
    s_add_u32 s54, s52, 738304
    buffer_store_dwordx4 v[80:83], v18, s[8:11], s54 offen sc1
    v_accvgpr_read_b32 v100, a148
    v_accvgpr_read_b32 v101, a149
    v_accvgpr_read_b32 v102, a150
    v_accvgpr_read_b32 v103, a151
    v_cvt_pk_bf16_f32 v96, v100, v101
    v_cvt_pk_bf16_f32 v97, v102, v103
    v_accvgpr_read_b32 v100, a180
    v_accvgpr_read_b32 v101, a181
    v_accvgpr_read_b32 v102, a182
    v_accvgpr_read_b32 v103, a183
    v_cvt_pk_bf16_f32 v98, v100, v101
    v_cvt_pk_bf16_f32 v99, v102, v103
    v_pk_max_i16 v96, v96, 0
    v_pk_max_i16 v97, v97, 0
    v_pk_max_i16 v98, v98, 0
    v_pk_max_i16 v99, v99, 0
    s_add_u32 s54, s52, 739328
    buffer_store_dwordx4 v[96:99], v18, s[8:11], s54 offen sc1
    v_accvgpr_read_b32 v116, a212
    v_accvgpr_read_b32 v117, a213
    v_accvgpr_read_b32 v118, a214
    v_accvgpr_read_b32 v119, a215
    v_cvt_pk_bf16_f32 v112, v116, v117
    v_cvt_pk_bf16_f32 v113, v118, v119
    v_accvgpr_read_b32 v116, a244
    v_accvgpr_read_b32 v117, a245
    v_accvgpr_read_b32 v118, a246
    v_accvgpr_read_b32 v119, a247
    v_cvt_pk_bf16_f32 v114, v116, v117
    v_cvt_pk_bf16_f32 v115, v118, v119
    v_pk_max_i16 v112, v112, 0
    v_pk_max_i16 v113, v113, 0
    v_pk_max_i16 v114, v114, 0
    v_pk_max_i16 v115, v115, 0
    s_add_u32 s54, s52, 740352
    buffer_store_dwordx4 v[112:115], v18, s[8:11], s54 offen sc1
    v_accvgpr_read_b32 v68, a24
    v_accvgpr_read_b32 v69, a25
    v_accvgpr_read_b32 v70, a26
    v_accvgpr_read_b32 v71, a27
    v_cvt_pk_bf16_f32 v64, v68, v69
    v_cvt_pk_bf16_f32 v65, v70, v71
    v_accvgpr_read_b32 v68, a56
    v_accvgpr_read_b32 v69, a57
    v_accvgpr_read_b32 v70, a58
    v_accvgpr_read_b32 v71, a59
    v_cvt_pk_bf16_f32 v66, v68, v69
    v_cvt_pk_bf16_f32 v67, v70, v71
    v_pk_max_i16 v64, v64, 0
    v_pk_max_i16 v65, v65, 0
    v_pk_max_i16 v66, v66, 0
    v_pk_max_i16 v67, v67, 0
    s_add_u32 s54, s52, 884736
    buffer_store_dwordx4 v[64:67], v18, s[8:11], s54 offen sc1
    v_accvgpr_read_b32 v84, a88
    v_accvgpr_read_b32 v85, a89
    v_accvgpr_read_b32 v86, a90
    v_accvgpr_read_b32 v87, a91
    v_cvt_pk_bf16_f32 v80, v84, v85
    v_cvt_pk_bf16_f32 v81, v86, v87
    v_accvgpr_read_b32 v84, a120
    v_accvgpr_read_b32 v85, a121
    v_accvgpr_read_b32 v86, a122
    v_accvgpr_read_b32 v87, a123
    v_cvt_pk_bf16_f32 v82, v84, v85
    v_cvt_pk_bf16_f32 v83, v86, v87
    v_pk_max_i16 v80, v80, 0
    v_pk_max_i16 v81, v81, 0
    v_pk_max_i16 v82, v82, 0
    v_pk_max_i16 v83, v83, 0
    s_add_u32 s54, s52, 885760
    buffer_store_dwordx4 v[80:83], v18, s[8:11], s54 offen sc1
    v_accvgpr_read_b32 v100, a152
    v_accvgpr_read_b32 v101, a153
    v_accvgpr_read_b32 v102, a154
    v_accvgpr_read_b32 v103, a155
    v_cvt_pk_bf16_f32 v96, v100, v101
    v_cvt_pk_bf16_f32 v97, v102, v103
    v_accvgpr_read_b32 v100, a184
    v_accvgpr_read_b32 v101, a185
    v_accvgpr_read_b32 v102, a186
    v_accvgpr_read_b32 v103, a187
    v_cvt_pk_bf16_f32 v98, v100, v101
    v_cvt_pk_bf16_f32 v99, v102, v103
    v_pk_max_i16 v96, v96, 0
    v_pk_max_i16 v97, v97, 0
    v_pk_max_i16 v98, v98, 0
    v_pk_max_i16 v99, v99, 0
    s_add_u32 s54, s52, 886784
    buffer_store_dwordx4 v[96:99], v18, s[8:11], s54 offen sc1
    v_accvgpr_read_b32 v116, a216
    v_accvgpr_read_b32 v117, a217
    v_accvgpr_read_b32 v118, a218
    v_accvgpr_read_b32 v119, a219
    v_cvt_pk_bf16_f32 v112, v116, v117
    v_cvt_pk_bf16_f32 v113, v118, v119
    v_accvgpr_read_b32 v116, a248
    v_accvgpr_read_b32 v117, a249
    v_accvgpr_read_b32 v118, a250
    v_accvgpr_read_b32 v119, a251
    v_cvt_pk_bf16_f32 v114, v116, v117
    v_cvt_pk_bf16_f32 v115, v118, v119
    v_pk_max_i16 v112, v112, 0
    v_pk_max_i16 v113, v113, 0
    v_pk_max_i16 v114, v114, 0
    v_pk_max_i16 v115, v115, 0
    s_add_u32 s54, s52, 887808
    buffer_store_dwordx4 v[112:115], v18, s[8:11], s54 offen sc1
    v_accvgpr_read_b32 v68, a28
    v_accvgpr_read_b32 v69, a29
    v_accvgpr_read_b32 v70, a30
    v_accvgpr_read_b32 v71, a31
    v_cvt_pk_bf16_f32 v64, v68, v69
    v_cvt_pk_bf16_f32 v65, v70, v71
    v_accvgpr_read_b32 v68, a60
    v_accvgpr_read_b32 v69, a61
    v_accvgpr_read_b32 v70, a62
    v_accvgpr_read_b32 v71, a63
    v_cvt_pk_bf16_f32 v66, v68, v69
    v_cvt_pk_bf16_f32 v67, v70, v71
    v_pk_max_i16 v64, v64, 0
    v_pk_max_i16 v65, v65, 0
    v_pk_max_i16 v66, v66, 0
    v_pk_max_i16 v67, v67, 0
    s_add_u32 s54, s52, 1032192
    buffer_store_dwordx4 v[64:67], v18, s[8:11], s54 offen sc1
    v_accvgpr_read_b32 v84, a92
    v_accvgpr_read_b32 v85, a93
    v_accvgpr_read_b32 v86, a94
    v_accvgpr_read_b32 v87, a95
    v_cvt_pk_bf16_f32 v80, v84, v85
    v_cvt_pk_bf16_f32 v81, v86, v87
    v_accvgpr_read_b32 v84, a124
    v_accvgpr_read_b32 v85, a125
    v_accvgpr_read_b32 v86, a126
    v_accvgpr_read_b32 v87, a127
    v_cvt_pk_bf16_f32 v82, v84, v85
    v_cvt_pk_bf16_f32 v83, v86, v87
    v_pk_max_i16 v80, v80, 0
    v_pk_max_i16 v81, v81, 0
    v_pk_max_i16 v82, v82, 0
    v_pk_max_i16 v83, v83, 0
    s_add_u32 s54, s52, 1033216
    buffer_store_dwordx4 v[80:83], v18, s[8:11], s54 offen sc1
    v_accvgpr_read_b32 v100, a156
    v_accvgpr_read_b32 v101, a157
    v_accvgpr_read_b32 v102, a158
    v_accvgpr_read_b32 v103, a159
    v_cvt_pk_bf16_f32 v96, v100, v101
    v_cvt_pk_bf16_f32 v97, v102, v103
    v_accvgpr_read_b32 v100, a188
    v_accvgpr_read_b32 v101, a189
    v_accvgpr_read_b32 v102, a190
    v_accvgpr_read_b32 v103, a191
    v_cvt_pk_bf16_f32 v98, v100, v101
    v_cvt_pk_bf16_f32 v99, v102, v103
    v_pk_max_i16 v96, v96, 0
    v_pk_max_i16 v97, v97, 0
    v_pk_max_i16 v98, v98, 0
    v_pk_max_i16 v99, v99, 0
    s_add_u32 s54, s52, 1034240
    buffer_store_dwordx4 v[96:99], v18, s[8:11], s54 offen sc1
    v_accvgpr_read_b32 v116, a220
    v_accvgpr_read_b32 v117, a221
    v_accvgpr_read_b32 v118, a222
    v_accvgpr_read_b32 v119, a223
    v_cvt_pk_bf16_f32 v112, v116, v117
    v_cvt_pk_bf16_f32 v113, v118, v119
    v_accvgpr_read_b32 v116, a252
    v_accvgpr_read_b32 v117, a253
    v_accvgpr_read_b32 v118, a254
    v_accvgpr_read_b32 v119, a255
    v_cvt_pk_bf16_f32 v114, v116, v117
    v_cvt_pk_bf16_f32 v115, v118, v119
    v_pk_max_i16 v112, v112, 0
    v_pk_max_i16 v113, v113, 0
    v_pk_max_i16 v114, v114, 0
    v_pk_max_i16 v115, v115, 0
    s_add_u32 s54, s52, 1035264
    buffer_store_dwordx4 v[112:115], v18, s[8:11], s54 offen sc1
W_DONE:
    s_cmp_eq_u32 s94, 0
    s_cbranch_scc0 W_npz
    s_cmp_eq_u32 s60, 7
    s_cbranch_scc0 W_npz
    s_waitcnt vmcnt(0)
    v_mov_b32 v4, -1
    v_mov_b32 v5, -1
    v_mov_b32 v6, -1
    v_mov_b32 v7, -1
    v_lshlrev_b32 v8, 4, v0
    s_lshl_b32 s40, s61, 13
    s_add_u32 s40, s40, 108003328
    s_add_u32 s41, s40, 0
    buffer_store_dwordx4 v[4:7], v8, s[8:11], s41 offen sc1
    s_add_u32 s41, s40, 4096
    buffer_store_dwordx4 v[4:7], v8, s[8:11], s41 offen sc1
    s_add_u32 s41, s40, 131072
    buffer_store_dwordx4 v[4:7], v8, s[8:11], s41 offen sc1
    s_add_u32 s41, s40, 135168
    buffer_store_dwordx4 v[4:7], v8, s[8:11], s41 offen sc1
W_npz:
    s_waitcnt vmcnt(0)
    s_barrier
    s_add_u32 s82, s82, 1
    s_cmp_lg_u32 s3, 0
    s_cbranch_scc1 W_d2
    s_cmp_eq_u32 s95, 0
    s_cbranch_scc0 W_dh
    v_mov_b32 v3, 2
    s_mov_b64 exec, 1
    buffer_store_dword v3, off, s[8:11], s93 sc1
    s_mov_b64 exec, -1
    s_branch W_d3
W_dh:
    v_mov_b32 v3, 1
    s_mov_b64 exec, 1
    buffer_atomic_add v3, off, s[8:11], s93 sc1
    s_cmp_eq_u32 s60, 0
    s_cbranch_scc0 W_d4
    s_lshl_b32 s40, s61, 2
    s_add_u32 s40, s40, 160
    s_lshl_b32 s41, s62, 3
    s_lshl_b32 s41, 1, s41
    v_mov_b32 v4, s41
    buffer_atomic_add v4, off, s[84:87], s40 sc1
W_d4:
    s_mov_b64 exec, -1
W_d3:
W_d2:
    s_branch W_NEXT
W_TAIL:
    s_sub_u32 s60, s80, 1
    s_lshr_b32 s61, s81, 2
    s_and_b32 s62, s81, 3
    v_and_b32 v1, 63, v0
    v_lshrrev_b32 v2, 4, v1
    v_and_b32 v3, 15, v1
    v_lshlrev_b32 v8, 4, v1
    v_and_b32 v4, 6, v3
    v_lshlrev_b32 v4, 1, v4
    v_and_b32 v5, 1, v3
    v_add_u32 v4, v4, v5
    v_lshl_add_u32 v4, v2, 4, v4
    v_lshlrev_b32 v9, 4, v4
    v_and_b32 v4, 1, v2
    v_lshl_add_u32 v5, v4, 5, v3
    v_lshlrev_b32 v5, 4, v5
    v_add_u32 v10, 8, v5
    v_add_u32 v11, 264, v5
    v_lshl_add_u32 v4, v2, 2, 0
    v_cmp_le_u32 s[64:65], v4, v3
    v_lshl_add_u32 v4, v2, 2, 1
    v_cmp_le_u32 s[66:67], v4, v3
    v_lshl_add_u32 v4, v2, 2, 2
    v_cmp_le_u32 s[68:69], v4, v3
    v_lshl_add_u32 v4, v2, 2, 3
    v_cmp_le_u32 s[70:71], v4, v3
    v_cmp_gt_u32 s[72:73], 2, v2
    s_mov_b32 s74, 0x3e0293ee
    s_mov_b64 s[12:13], s[34:35]
    s_mov_b32 s14, 4718592
    v_lshrrev_b32 v4, 5, v1
    v_and_b32 v5, 31, v1
    v_mul_u32_u24 v6, 1152, v4
    v_or_b32 v7, 0, v4
    v_lshlrev_b32 v7, 1, v7
    v_xor_b32 v7, v7, v5
    v_lshl_add_u32 v12, v7, 4, v6
    v_or_b32 v7, 2, v4
    v_lshlrev_b32 v7, 1, v7
    v_xor_b32 v7, v7, v5
    v_lshl_add_u32 v13, v7, 4, v6
    v_or_b32 v7, 4, v4
    v_lshlrev_b32 v7, 1, v7
    v_xor_b32 v7, v7, v5
    v_lshl_add_u32 v14, v7, 4, v6
    v_or_b32 v7, 6, v4
    v_lshlrev_b32 v7, 1, v7
    v_xor_b32 v7, v7, v5
    v_lshl_add_u32 v15, v7, 4, v6
    v_bfe_u32 v4, v1, 2, 2
    v_and_b32 v5, 3, v1
    v_and_b32 v6, 1, v2
    v_lshl_add_u32 v6, v6, 2, v4
    v_lshlrev_b32 v7, 12, v2
    v_lshl_add_u32 v7, v4, 9, v7
    v_lshl_add_u32 v7, v5, 3, v7
    s_lshl_b32 s75, s3, 15
    v_add_u32 v7, s75, v7
    v_xor_b32 v4, 0, v6
    v_lshl_add_u32 v20, v4, 5, v7
    v_xor_b32 v4, 1, v6
    v_lshl_add_u32 v21, v4, 5, v7
    v_xor_b32 v4, 2, v6
    v_lshl_add_u32 v22, v4, 5, v7
    v_xor_b32 v4, 3, v6
    v_lshl_add_u32 v23, v4, 5, v7
    v_xor_b32 v4, 4, v6
    v_lshl_add_u32 v24, v4, 5, v7
    v_xor_b32 v4, 5, v6
    v_lshl_add_u32 v25, v4, 5, v7
    v_xor_b32 v4, 6, v6
    v_lshl_add_u32 v26, v4, 5, v7
    v_xor_b32 v4, 7, v6
    v_lshl_add_u32 v27, v4, 5, v7
    v_xor_b32 v4, 8, v6
    v_lshl_add_u32 v28, v4, 5, v7
    s_lshl_b32 s76, s61, 2
    s_add_u32 s76, s76, s3
    s_mul_i32 s76, s76, 147456
    s_mul_i32 s77, s62, 288
    s_add_u32 s76, s76, s77
    s_add_u32 m0, s75, 0
    s_add_u32 s77, s76, 0
    buffer_load_dwordx4 v12, s[12:15], s77 offen lds
    s_add_u32 m0, s75, 1024
    s_add_u32 s77, s76, 2304
    buffer_load_dwordx4 v13, s[12:15], s77 offen lds
    s_add_u32 m0, s75, 2048
    s_add_u32 s77, s76, 18432
    buffer_load_dwordx4 v12, s[12:15], s77 offen lds
    s_add_u32 m0, s75, 3072
    s_add_u32 s77, s76, 20736
    buffer_load_dwordx4 v13, s[12:15], s77 offen lds
    s_add_u32 m0, s75, 4096
    s_add_u32 s77, s76, 4608
    buffer_load_dwordx4 v14, s[12:15], s77 offen lds
    s_add_u32 m0, s75, 5120
    s_add_u32 s77, s76, 6912
    buffer_load_dwordx4 v15, s[12:15], s77 offen lds
    s_add_u32 m0, s75, 6144
    s_add_u32 s77, s76, 23040
    buffer_load_dwordx4 v14, s[12:15], s77 offen lds
    s_add_u32 m0, s75, 7168
    s_add_u32 s77, s76, 25344
    buffer_load_dwordx4 v15, s[12:15], s77 offen lds
    s_add_u32 m0, s75, 8192
    s_add_u32 s77, s76, 9216
    buffer_load_dwordx4 v12, s[12:15], s77 offen lds
    s_add_u32 m0, s75, 9216
    s_add_u32 s77, s76, 11520
    buffer_load_dwordx4 v13, s[12:15], s77 offen lds
    s_add_u32 m0, s75, 10240
    s_add_u32 s77, s76, 27648
    buffer_load_dwordx4 v12, s[12:15], s77 offen lds
    s_add_u32 m0, s75, 11264
    s_add_u32 s77, s76, 29952
    buffer_load_dwordx4 v13, s[12:15], s77 offen lds
    s_add_u32 m0, s75, 12288
    s_add_u32 s77, s76, 13824
    buffer_load_dwordx4 v14, s[12:15], s77 offen lds
    s_add_u32 m0, s75, 13312
    s_add_u32 s77, s76, 16128
    buffer_load_dwordx4 v15, s[12:15], s77 offen lds
    s_add_u32 m0, s75, 14336
    s_add_u32 s77, s76, 32256
    buffer_load_dwordx4 v14, s[12:15], s77 offen lds
    s_add_u32 m0, s75, 15360
    s_add_u32 s77, s76, 34560
    buffer_load_dwordx4 v15, s[12:15], s77 offen lds
    s_add_u32 m0, s75, 16384
    s_add_u32 s77, s76, 36864
    buffer_load_dwordx4 v12, s[12:15], s77 offen lds
    s_add_u32 m0, s75, 17408
    s_add_u32 s77, s76, 39168
    buffer_load_dwordx4 v13, s[12:15], s77 offen lds
    s_add_u32 m0, s75, 18432
    s_add_u32 s77, s76, 55296
    buffer_load_dwordx4 v12, s[12:15], s77 offen lds
    s_add_u32 m0, s75, 19456
    s_add_u32 s77, s76, 57600
    buffer_load_dwordx4 v13, s[12:15], s77 offen lds
    s_add_u32 m0, s75, 20480
    s_add_u32 s77, s76, 41472
    buffer_load_dwordx4 v14, s[12:15], s77 offen lds
    s_add_u32 m0, s75, 21504
    s_add_u32 s77, s76, 43776
    buffer_load_dwordx4 v15, s[12:15], s77 offen lds
    s_add_u32 m0, s75, 22528
    s_add_u32 s77, s76, 59904
    buffer_load_dwordx4 v14, s[12:15], s77 offen lds
    s_add_u32 m0, s75, 23552
    s_add_u32 s77, s76, 62208
    buffer_load_dwordx4 v15, s[12:15], s77 offen lds
    s_add_u32 m0, s75, 24576
    s_add_u32 s77, s76, 46080
    buffer_load_dwordx4 v12, s[12:15], s77 offen lds
    s_add_u32 m0, s75, 25600
    s_add_u32 s77, s76, 48384
    buffer_load_dwordx4 v13, s[12:15], s77 offen lds
    s_add_u32 m0, s75, 26624
    s_add_u32 s77, s76, 64512
    buffer_load_dwordx4 v12, s[12:15], s77 offen lds
    s_add_u32 m0, s75, 27648
    s_add_u32 s77, s76, 66816
    buffer_load_dwordx4 v13, s[12:15], s77 offen lds
    s_add_u32 m0, s75, 28672
    s_add_u32 s77, s76, 50688
    buffer_load_dwordx4 v14, s[12:15], s77 offen lds
    s_add_u32 m0, s75, 29696
    s_add_u32 s77, s76, 52992
    buffer_load_dwordx4 v15, s[12:15], s77 offen lds
    s_add_u32 m0, s75, 30720
    s_add_u32 s77, s76, 69120
    buffer_load_dwordx4 v14, s[12:15], s77 offen lds
    s_add_u32 m0, s75, 31744
    s_add_u32 s77, s76, 71424
    buffer_load_dwordx4 v15, s[12:15], s77 offen lds
    s_waitcnt vmcnt(16)
    ds_read_b64_tr_b16 a[0:1], v20 offset:0
    ds_read_b64_tr_b16 a[2:3], v20 offset:2048
    ds_read_b64_tr_b16 a[16:17], v21 offset:0
    ds_read_b64_tr_b16 a[18:19], v21 offset:2048
    ds_read_b64_tr_b16 a[32:33], v22 offset:0
    ds_read_b64_tr_b16 a[34:35], v22 offset:2048
    ds_read_b64_tr_b16 a[48:49], v23 offset:0
    ds_read_b64_tr_b16 a[50:51], v23 offset:2048
    ds_read_b64_tr_b16 a[64:65], v24 offset:0
    ds_read_b64_tr_b16 a[66:67], v24 offset:2048
    ds_read_b64_tr_b16 a[80:81], v25 offset:0
    ds_read_b64_tr_b16 a[82:83], v25 offset:2048
    ds_read_b64_tr_b16 a[96:97], v26 offset:0
    ds_read_b64_tr_b16 a[98:99], v26 offset:2048
    ds_read_b64_tr_b16 a[112:113], v27 offset:0
    ds_read_b64_tr_b16 a[114:115], v27 offset:2048
    ds_read_b64_tr_b16 a[128:129], v28 offset:0
    ds_read_b64_tr_b16 a[130:131], v28 offset:2048
    s_waitcnt lgkmcnt(0)
    s_add_u32 m0, s75, 0
    s_add_u32 s77, s76, 73728
    buffer_load_dwordx4 v12, s[12:15], s77 offen lds
    s_add_u32 m0, s75, 1024
    s_add_u32 s77, s76, 76032
    buffer_load_dwordx4 v13, s[12:15], s77 offen lds
    s_add_u32 m0, s75, 2048
    s_add_u32 s77, s76, 92160
    buffer_load_dwordx4 v12, s[12:15], s77 offen lds
    s_add_u32 m0, s75, 3072
    s_add_u32 s77, s76, 94464
    buffer_load_dwordx4 v13, s[12:15], s77 offen lds
    s_add_u32 m0, s75, 4096
    s_add_u32 s77, s76, 78336
    buffer_load_dwordx4 v14, s[12:15], s77 offen lds
    s_add_u32 m0, s75, 5120
    s_add_u32 s77, s76, 80640
    buffer_load_dwordx4 v15, s[12:15], s77 offen lds
    s_add_u32 m0, s75, 6144
    s_add_u32 s77, s76, 96768
    buffer_load_dwordx4 v14, s[12:15], s77 offen lds
    s_add_u32 m0, s75, 7168
    s_add_u32 s77, s76, 99072
    buffer_load_dwordx4 v15, s[12:15], s77 offen lds
    s_add_u32 m0, s75, 8192
    s_add_u32 s77, s76, 82944
    buffer_load_dwordx4 v12, s[12:15], s77 offen lds
    s_add_u32 m0, s75, 9216
    s_add_u32 s77, s76, 85248
    buffer_load_dwordx4 v13, s[12:15], s77 offen lds
    s_add_u32 m0, s75, 10240
    s_add_u32 s77, s76, 101376
    buffer_load_dwordx4 v12, s[12:15], s77 offen lds
    s_add_u32 m0, s75, 11264
    s_add_u32 s77, s76, 103680
    buffer_load_dwordx4 v13, s[12:15], s77 offen lds
    s_add_u32 m0, s75, 12288
    s_add_u32 s77, s76, 87552
    buffer_load_dwordx4 v14, s[12:15], s77 offen lds
    s_add_u32 m0, s75, 13312
    s_add_u32 s77, s76, 89856
    buffer_load_dwordx4 v15, s[12:15], s77 offen lds
    s_add_u32 m0, s75, 14336
    s_add_u32 s77, s76, 105984
    buffer_load_dwordx4 v14, s[12:15], s77 offen lds
    s_add_u32 m0, s75, 15360
    s_add_u32 s77, s76, 108288
    buffer_load_dwordx4 v15, s[12:15], s77 offen lds
    s_waitcnt vmcnt(16)
    ds_read_b64_tr_b16 a[4:5], v20 offset:16384
    ds_read_b64_tr_b16 a[6:7], v20 offset:18432
    ds_read_b64_tr_b16 a[20:21], v21 offset:16384
    ds_read_b64_tr_b16 a[22:23], v21 offset:18432
    ds_read_b64_tr_b16 a[36:37], v22 offset:16384
    ds_read_b64_tr_b16 a[38:39], v22 offset:18432
    ds_read_b64_tr_b16 a[52:53], v23 offset:16384
    ds_read_b64_tr_b16 a[54:55], v23 offset:18432
    ds_read_b64_tr_b16 a[68:69], v24 offset:16384
    ds_read_b64_tr_b16 a[70:71], v24 offset:18432
    ds_read_b64_tr_b16 a[84:85], v25 offset:16384
    ds_read_b64_tr_b16 a[86:87], v25 offset:18432
    ds_read_b64_tr_b16 a[100:101], v26 offset:16384
    ds_read_b64_tr_b16 a[102:103], v26 offset:18432
    ds_read_b64_tr_b16 a[116:117], v27 offset:16384
    ds_read_b64_tr_b16 a[118:119], v27 offset:18432
    ds_read_b64_tr_b16 a[132:133], v28 offset:16384
    ds_read_b64_tr_b16 a[134:135], v28 offset:18432
    s_waitcnt lgkmcnt(0)
    s_add_u32 m0, s75, 16384
    s_add_u32 s77, s76, 110592
    buffer_load_dwordx4 v12, s[12:15], s77 offen lds
    s_add_u32 m0, s75, 17408
    s_add_u32 s77, s76, 112896
    buffer_load_dwordx4 v13, s[12:15], s77 offen lds
    s_add_u32 m0, s75, 18432
    s_add_u32 s77, s76, 129024
    buffer_load_dwordx4 v12, s[12:15], s77 offen lds
    s_add_u32 m0, s75, 19456
    s_add_u32 s77, s76, 131328
    buffer_load_dwordx4 v13, s[12:15], s77 offen lds
    s_add_u32 m0, s75, 20480
    s_add_u32 s77, s76, 115200
    buffer_load_dwordx4 v14, s[12:15], s77 offen lds
    s_add_u32 m0, s75, 21504
    s_add_u32 s77, s76, 117504
    buffer_load_dwordx4 v15, s[12:15], s77 offen lds
    s_add_u32 m0, s75, 22528
    s_add_u32 s77, s76, 133632
    buffer_load_dwordx4 v14, s[12:15], s77 offen lds
    s_add_u32 m0, s75, 23552
    s_add_u32 s77, s76, 135936
    buffer_load_dwordx4 v15, s[12:15], s77 offen lds
    s_add_u32 m0, s75, 24576
    s_add_u32 s77, s76, 119808
    buffer_load_dwordx4 v12, s[12:15], s77 offen lds
    s_add_u32 m0, s75, 25600
    s_add_u32 s77, s76, 122112
    buffer_load_dwordx4 v13, s[12:15], s77 offen lds
    s_add_u32 m0, s75, 26624
    s_add_u32 s77, s76, 138240
    buffer_load_dwordx4 v12, s[12:15], s77 offen lds
    s_add_u32 m0, s75, 27648
    s_add_u32 s77, s76, 140544
    buffer_load_dwordx4 v13, s[12:15], s77 offen lds
    s_add_u32 m0, s75, 28672
    s_add_u32 s77, s76, 124416
    buffer_load_dwordx4 v14, s[12:15], s77 offen lds
    s_add_u32 m0, s75, 29696
    s_add_u32 s77, s76, 126720
    buffer_load_dwordx4 v15, s[12:15], s77 offen lds
    s_add_u32 m0, s75, 30720
    s_add_u32 s77, s76, 142848
    buffer_load_dwordx4 v14, s[12:15], s77 offen lds
    s_add_u32 m0, s75, 31744
    s_add_u32 s77, s76, 145152
    buffer_load_dwordx4 v15, s[12:15], s77 offen lds
    s_waitcnt vmcnt(16)
    ds_read_b64_tr_b16 a[8:9], v20 offset:0
    ds_read_b64_tr_b16 a[10:11], v20 offset:2048
    ds_read_b64_tr_b16 a[24:25], v21 offset:0
    ds_read_b64_tr_b16 a[26:27], v21 offset:2048
    ds_read_b64_tr_b16 a[40:41], v22 offset:0
    ds_read_b64_tr_b16 a[42:43], v22 offset:2048
    ds_read_b64_tr_b16 a[56:57], v23 offset:0
    ds_read_b64_tr_b16 a[58:59], v23 offset:2048
    ds_read_b64_tr_b16 a[72:73], v24 offset:0
    ds_read_b64_tr_b16 a[74:75], v24 offset:2048
    ds_read_b64_tr_b16 a[88:89], v25 offset:0
    ds_read_b64_tr_b16 a[90:91], v25 offset:2048
    ds_read_b64_tr_b16 a[104:105], v26 offset:0
    ds_read_b64_tr_b16 a[106:107], v26 offset:2048
    ds_read_b64_tr_b16 a[120:121], v27 offset:0
    ds_read_b64_tr_b16 a[122:123], v27 offset:2048
    ds_read_b64_tr_b16 a[136:137], v28 offset:0
    ds_read_b64_tr_b16 a[138:139], v28 offset:2048
    s_waitcnt lgkmcnt(0)
    s_waitcnt vmcnt(0)
    ds_read_b64_tr_b16 a[12:13], v20 offset:16384
    ds_read_b64_tr_b16 a[14:15], v20 offset:18432
    ds_read_b64_tr_b16 a[28:29], v21 offset:16384
    ds_read_b64_tr_b16 a[30:31], v21 offset:18432
    ds_read_b64_tr_b16 a[44:45], v22 offset:16384
    ds_read_b64_tr_b16 a[46:47], v22 offset:18432
    ds_read_b64_tr_b16 a[60:61], v23 offset:16384
    ds_read_b64_tr_b16 a[62:63], v23 offset:18432
    ds_read_b64_tr_b16 a[76:77], v24 offset:16384
    ds_read_b64_tr_b16 a[78:79], v24 offset:18432
    ds_read_b64_tr_b16 a[92:93], v25 offset:16384
    ds_read_b64_tr_b16 a[94:95], v25 offset:18432
    ds_read_b64_tr_b16 a[108:109], v26 offset:16384
    ds_read_b64_tr_b16 a[110:111], v26 offset:18432
    ds_read_b64_tr_b16 a[124:125], v27 offset:16384
    ds_read_b64_tr_b16 a[126:127], v27 offset:18432
    ds_read_b64_tr_b16 a[140:141], v28 offset:16384
    ds_read_b64_tr_b16 a[142:143], v28 offset:18432
    s_waitcnt lgkmcnt(0)
    v_and_b32 v4, 63, v0
    v_lshrrev_b32 v5, 4, v4
    v_and_b32 v4, 15, v4
    v_mul_u32_u24 v4, 1152, v4
    v_lshl_add_u32 v14, v5, 3, v4
    s_add_u32 s75, s60, 56
    s_cmp_eq_u32 s60, 0
    s_cselect_b32 s75, 63, s75
    s_lshl_b32 s75, s75, 3
    s_add_u32 s75, s75, s61
    s_mul_i32 s75, s75, 73728
    s_mul_i32 s76, s62, 9216
    s_add_u32 s75, s75, s76
    s_add_u32 s75, s75, 121532416
    v_mov_b64 v[4:5], -1
    v_mov_b64 v[6:7], -1
    s_add_u32 s76, s3, 0
    s_cmp_ge_u32 s76, 9
    s_cselect_b32 s77, 27648, 0
    s_lshl_b32 s76, s76, 10
    s_add_u32 s76, s76, s77
    s_add_u32 s76, s76, s75
    buffer_store_dwordx4 v[4:7], v8, s[8:11], s76 offen sc1
    s_add_u32 s76, s3, 4
    s_cmp_ge_u32 s76, 9
    s_cselect_b32 s77, 27648, 0
    s_lshl_b32 s76, s76, 10
    s_add_u32 s76, s76, s77
    s_add_u32 s76, s76, s75
    buffer_store_dwordx4 v[4:7], v8, s[8:11], s76 offen sc1
    s_add_u32 s76, s3, 8
    s_cmp_ge_u32 s76, 9
    s_cselect_b32 s77, 27648, 0
    s_lshl_b32 s76, s76, 10
    s_add_u32 s76, s76, s77
    s_add_u32 s76, s76, s75
    buffer_store_dwordx4 v[4:7], v8, s[8:11], s76 offen sc1
    s_add_u32 s76, s3, 12
    s_cmp_ge_u32 s76, 9
    s_cselect_b32 s77, 27648, 0
    s_lshl_b32 s76, s76, 10
    s_add_u32 s76, s76, s77
    s_add_u32 s76, s76, s75
    buffer_store_dwordx4 v[4:7], v8, s[8:11], s76 offen sc1
    s_cmp_ge_u32 s3, 2
    s_cbranch_scc1 TL_PZ_7
    s_add_u32 s76, s3, 16
    s_cmp_ge_u32 s76, 9
    s_cselect_b32 s77, 27648, 0
    s_lshl_b32 s76, s76, 10
    s_add_u32 s76, s76, s77
    s_add_u32 s76, s76, s75
    buffer_store_dwordx4 v[4:7], v8, s[8:11], s76 offen sc1
TL_PZ_7:
    s_nop 1
    v_and_b32 v4, 63, v0
    s_lshl_b32 s40, s61, 8
    s_add_u32 s40, s40, 117273600
    v_lshlrev_b32 v5, 2, v4
    v_add_u32 v6, 116, v5
    v_cmp_gt_u32 vcc, 3, v4
    s_nop 1
    v_cndmask_b32 v5, v6, v5, vcc
    v_add_u32 v5, s40, v5
    v_lshlrev_b32 v6, 2, v4
    v_add_u32 v6, 117296096, v6
    v_cmp_gt_u32 vcc, 8, v4
    s_nop 1
    v_cndmask_b32 v12, v6, v5, vcc
    v_mov_b32 v5, 128
    v_mov_b32 v6, 2048
    v_cndmask_b32 v13, v5, v6, vcc
TL_loop:
    s_cmp_lg_u32 s3, 0
    s_cbranch_scc1 TL_w1
    s_lshr_b32 s40, s60, 3
    v_mad_u32_u24 v2, v13, s40, v12
    s_mov_b32 exec_lo, 0x3ffff3f
    s_mov_b32 exec_hi, 0
TL_p1:
    buffer_load_dword v3, v2, s[8:11], 0 offen sc1
    s_waitcnt vmcnt(0)
    v_cmp_gt_u32 vcc, 2, v3
    s_cbranch_vccz TL_p1_ok
    s_sub_u32 s83, s83, 1
    s_cbranch_scc0 TL_p1
    s_mov_b32 s83, 0
TL_p1_ok:
    s_mov_b64 exec, -1
TL_w1:
    s_barrier
    s_lshl_b32 s40, s3, 3
    s_add_u32 s40, s40, s61
    s_cmp_ge_u32 s40, 18
    s_cbranch_scc1 TL_nf0
    s_cmp_ge_u32 s40, 9
    s_cselect_b32 s41, 27, 0
    s_add_u32 s40, s40, s41
    s_mul_i32 s41, s62, 9
    s_add_u32 s63, s40, s41
    s_lshl_b32 s76, s63, 10
    s_mul_i32 s75, s60, 73728
    s_add_u32 s75, s75, s76
    s_add_u32 s75, s75, 71565312
    buffer_load_dwordx4 v[208:211], v8, s[8:11], s75 offen
    s_add_u32 s75, s75, 4718592
    buffer_load_dwordx4 v[212:215], v8, s[8:11], s75 offen
    s_add_u32 s75, s75, 4718592
    buffer_load_dwordx4 v[216:219], v8, s[8:11], s75 offen
    s_add_u32 s75, s75, 4718592
    buffer_load_dwordx4 v[220:223], v8, s[8:11], s75 offen
    s_add_u32 s75, s75, 4718592
    buffer_load_dwordx4 v[224:227], v8, s[8:11], s75 offen
    s_add_u32 s75, s75, 4718592
    buffer_load_dwordx4 v[228:231], v8, s[8:11], s75 offen
    s_cmp_ge_u32 s63, 36
    s_cselect_b32 s76, 16, 0
    s_cselect_b32 s77, 36, 0
    s_sub_u32 s77, s63, s77
    s_lshl_b32 s75, s60, 5
    s_add_u32 s75, s75, s76
    s_mul_i32 s75, s75, 1152
    s_lshl_b32 s77, s77, 5
    s_add_u32 s75, s75, s77
    buffer_load_dwordx2 v[240:241], v14, s[16:19], s75 offen
TL_nf0:
    s_lshl_b32 s75, s61, 2
    s_add_u32 s75, s75, s3
    s_lshl_b32 s75, s75, 19
    s_lshl_b32 s76, s60, 13
    s_add_u32 s75, s75, s76
    s_add_u32 s76, s75, 2359296
    s_add_u32 s77, s75, 19136512
    s_add_u32 s78, s75, 35913728
    buffer_load_dwordx4 v[16:19], v8, s[8:11], s76 offen offset:0
    buffer_load_dwordx4 v[48:51], v8, s[8:11], s77 offen offset:0
    buffer_load_dwordx2 v[80:81], v8, s[8:11], s78 offen offset:0
    buffer_load_dwordx2 v[86:87], v8, s[8:11], s78 offen offset:8
    buffer_load_dwordx4 v[20:23], v8, s[8:11], s76 offen offset:1024
    buffer_load_dwordx2 v[54:55], v8, s[8:11], s77 offen offset:1024
    buffer_load_dwordx2 v[52:53], v8, s[8:11], s77 offen offset:1032
    buffer_load_dwordx2 v[84:85], v8, s[8:11], s78 offen offset:1024
    buffer_load_dwordx2 v[82:83], v8, s[8:11], s78 offen offset:1032
    buffer_load_dwordx4 v[24:27], v8, s[8:11], s76 offen offset:2048
    buffer_load_dwordx4 v[56:59], v8, s[8:11], s77 offen offset:2048
    buffer_load_dwordx2 v[88:89], v8, s[8:11], s78 offen offset:2048
    buffer_load_dwordx2 v[94:95], v8, s[8:11], s78 offen offset:2056
    buffer_load_dwordx4 v[28:31], v8, s[8:11], s76 offen offset:3072
    buffer_load_dwordx2 v[62:63], v8, s[8:11], s77 offen offset:3072
    buffer_load_dwordx2 v[60:61], v8, s[8:11], s77 offen offset:3080
    buffer_load_dwordx2 v[92:93], v8, s[8:11], s78 offen offset:3072
    buffer_load_dwordx2 v[90:91], v8, s[8:11], s78 offen offset:3080
    s_add_u32 s76, s76, 4096
    s_add_u32 s77, s77, 4096
    s_add_u32 s78, s78, 4096
    buffer_load_dwordx4 v[32:35], v8, s[8:11], s76 offen offset:0
    buffer_load_dwordx4 v[64:67], v8, s[8:11], s77 offen offset:0
    buffer_load_dwordx2 v[96:97], v8, s[8:11], s78 offen offset:0
    buffer_load_dwordx2 v[102:103], v8, s[8:11], s78 offen offset:8
    buffer_load_dwordx4 v[36:39], v8, s[8:11], s76 offen offset:1024
    buffer_load_dwordx2 v[70:71], v8, s[8:11], s77 offen offset:1024
    buffer_load_dwordx2 v[68:69], v8, s[8:11], s77 offen offset:1032
    buffer_load_dwordx2 v[100:101], v8, s[8:11], s78 offen offset:1024
    buffer_load_dwordx2 v[98:99], v8, s[8:11], s78 offen offset:1032
    buffer_load_dwordx4 v[40:43], v8, s[8:11], s76 offen offset:2048
    buffer_load_dwordx4 v[72:75], v8, s[8:11], s77 offen offset:2048
    buffer_load_dwordx2 v[104:105], v8, s[8:11], s78 offen offset:2048
    buffer_load_dwordx2 v[110:111], v8, s[8:11], s78 offen offset:2056
    buffer_load_dwordx4 v[44:47], v8, s[8:11], s76 offen offset:3072
    buffer_load_dwordx2 v[78:79], v8, s[8:11], s77 offen offset:3072
    buffer_load_dwordx2 v[76:77], v8, s[8:11], s77 offen offset:3080
    buffer_load_dwordx2 v[108:109], v8, s[8:11], s78 offen offset:3072
    buffer_load_dwordx2 v[106:107], v8, s[8:11], s78 offen offset:3080
    s_waitcnt vmcnt(0)
    v_mfma_f32_16x16x32_bf16 v[144:147], v[48:51], v[16:19], 0
    v_mfma_f32_16x16x32_bf16 v[144:147], v[56:59], v[24:27], v[144:147]
    v_mfma_f32_16x16x32_bf16 v[144:147], v[64:67], v[32:35], v[144:147]
    v_mfma_f32_16x16x32_bf16 v[144:147], v[72:75], v[40:43], v[144:147]
    v_mfma_f32_16x16x32_bf16 v[148:151], v[48:51], v[20:23], 0
    v_mfma_f32_16x16x32_bf16 v[148:151], v[56:59], v[28:31], v[148:151]
    v_mfma_f32_16x16x32_bf16 v[148:151], v[64:67], v[36:39], v[148:151]
    v_mfma_f32_16x16x32_bf16 v[148:151], v[72:75], v[44:47], v[148:151]
    v_mfma_f32_16x16x32_bf16 v[152:155], v[52:55], v[20:23], 0
    v_mfma_f32_16x16x32_bf16 v[152:155], v[60:63], v[28:31], v[152:155]
    v_mfma_f32_16x16x32_bf16 v[152:155], v[68:71], v[36:39], v[152:155]
    v_mfma_f32_16x16x32_bf16 v[152:155], v[76:79], v[44:47], v[152:155]
    v_pk_add_f32 v[208:209], v[208:209], v[212:213]
    v_pk_add_f32 v[210:211], v[210:211], v[214:215]
    v_pk_add_f32 v[216:217], v[216:217], v[220:221]
    v_pk_add_f32 v[218:219], v[218:219], v[222:223]
    v_pk_add_f32 v[224:225], v[224:225], v[228:229]
    v_pk_add_f32 v[226:227], v[226:227], v[230:231]
    v_pk_add_f32 v[208:209], v[208:209], v[216:217]
    v_pk_add_f32 v[210:211], v[210:211], v[218:219]
    v_pk_add_f32 v[208:209], v[208:209], v[224:225]
    v_pk_add_f32 v[210:211], v[210:211], v[226:227]
    v_cvt_pk_bf16_f32 v242, v208, v209
    v_cvt_pk_bf16_f32 v243, v210, v211
    v_mov_b32 v5, 0xf149f2ca
    v_cndmask_b32 v144, v5, v144, s[64:65]
    v_cndmask_b32 v152, v5, v152, s[64:65]
    v_cndmask_b32 v145, v5, v145, s[66:67]
    v_cndmask_b32 v153, v5, v153, s[66:67]
    v_cndmask_b32 v146, v5, v146, s[68:69]
    v_cndmask_b32 v154, v5, v154, s[68:69]
    v_cndmask_b32 v147, v5, v147, s[70:71]
    v_cndmask_b32 v155, v5, v155, s[70:71]
    v_max3_f32 v244, v144, v145, v146
    v_max_f32 v244, v244, v147
    v_mov_b32 v7, v244
    s_nop 1
    v_permlane16_swap_b32 v244, v7
    v_max_f32 v244, v244, v7
    v_mov_b32 v7, v244
    s_nop 1
    v_permlane32_swap_b32 v244, v7
    v_max_f32 v244, v244, v7
    v_mul_f32 v244, s74, v244
    v_fma_f32 v144, v144, s74, -v244
    v_fma_f32 v145, v145, s74, -v244
    v_fma_f32 v146, v146, s74, -v244
    v_fma_f32 v147, v147, s74, -v244
    v_exp_f32 v144, v144
    v_exp_f32 v145, v145
    v_exp_f32 v146, v146
    v_exp_f32 v147, v147
    v_add_f32 v246, v144, v145
    v_add_f32 v246, v246, v146
    v_add_f32 v246, v246, v147
    v_mov_b32 v7, v246
    s_nop 1
    v_permlane16_swap_b32 v246, v7
    v_add_f32 v246, v246, v7
    v_mov_b32 v7, v246
    s_nop 1
    v_permlane32_swap_b32 v246, v7
    v_add_f32 v246, v246, v7
    v_cvt_pk_bf16_f32 v164, v144, v145
    v_cvt_pk_bf16_f32 v165, v146, v147
    v_mov_b32 v166, 0
    v_mov_b32 v167, 0
    v_max3_f32 v245, v148, v149, v150
    v_max3_f32 v245, v245, v151, v152
    v_max3_f32 v245, v245, v153, v154
    v_max_f32 v245, v245, v155
    v_mov_b32 v7, v245
    s_nop 1
    v_permlane16_swap_b32 v245, v7
    v_max_f32 v245, v245, v7
    v_mov_b32 v7, v245
    s_nop 1
    v_permlane32_swap_b32 v245, v7
    v_max_f32 v245, v245, v7
    v_mul_f32 v245, s74, v245
    v_fma_f32 v148, v148, s74, -v245
    v_fma_f32 v149, v149, s74, -v245
    v_fma_f32 v150, v150, s74, -v245
    v_fma_f32 v151, v151, s74, -v245
    v_fma_f32 v152, v152, s74, -v245
    v_fma_f32 v153, v153, s74, -v245
    v_fma_f32 v154, v154, s74, -v245
    v_fma_f32 v155, v155, s74, -v245
    v_exp_f32 v148, v148
    v_exp_f32 v149, v149
    v_exp_f32 v150, v150
    v_exp_f32 v151, v151
    v_exp_f32 v152, v152
    v_exp_f32 v153, v153
    v_exp_f32 v154, v154
    v_exp_f32 v155, v155
    v_add_f32 v247, v148, v149
    v_add_f32 v247, v247, v150
    v_add_f32 v247, v247, v151
    v_add_f32 v247, v247, v152
    v_add_f32 v247, v247, v153
    v_add_f32 v247, v247, v154
    v_add_f32 v247, v247, v155
    v_mov_b32 v7, v247
    s_nop 1
    v_permlane16_swap_b32 v247, v7
    v_add_f32 v247, v247, v7
    v_mov_b32 v7, v247
    s_nop 1
    v_permlane32_swap_b32 v247, v7
    v_add_f32 v247, v247, v7
    v_cvt_pk_bf16_f32 v168, v148, v149
    v_cvt_pk_bf16_f32 v169, v150, v151
    v_cvt_pk_bf16_f32 v170, v152, v153
    v_cvt_pk_bf16_f32 v171, v154, v155
    v_mfma_f32_16x16x32_bf16 v[48:51], v[80:83], v[164:167], 0
    v_mfma_f32_16x16x32_bf16 v[56:59], v[84:87], v[164:167], 0
    v_mfma_f32_16x16x32_bf16 v[64:67], v[88:91], v[164:167], 0
    v_mfma_f32_16x16x32_bf16 v[72:75], v[92:95], v[164:167], 0
    v_mfma_f32_16x16x32_bf16 v[208:211], v[96:99], v[164:167], 0
    v_mfma_f32_16x16x32_bf16 v[216:219], v[100:103], v[164:167], 0
    v_mfma_f32_16x16x32_bf16 v[224:227], v[104:107], v[164:167], 0
    v_mfma_f32_16x16x32_bf16 v[232:235], v[108:111], v[164:167], 0
    v_mfma_f32_16x16x32_bf16 v[52:55], v[80:83], v[168:171], 0
    v_mfma_f32_16x16x32_bf16 v[60:63], v[84:87], v[168:171], 0
    v_mfma_f32_16x16x32_bf16 v[68:71], v[88:91], v[168:171], 0
    v_mfma_f32_16x16x32_bf16 v[76:79], v[92:95], v[168:171], 0
    v_mfma_f32_16x16x32_bf16 v[212:215], v[96:99], v[168:171], 0
    v_mfma_f32_16x16x32_bf16 v[220:223], v[100:103], v[168:171], 0
    v_mfma_f32_16x16x32_bf16 v[228:231], v[104:107], v[168:171], 0
    v_mfma_f32_16x16x32_bf16 v[236:239], v[108:111], v[168:171], 0
    s_cmp_lg_u32 s3, 0
    s_cbranch_scc1 TL_w2
    s_lshl_b32 s40, s80, 7
    s_add_u32 s40, s40, 117297152
    s_add_u32 s41, s60, 2
    s_cmp_ge_u32 s60, 62
    s_cselect_b32 s41, s60, s41
    s_mov_b64 exec, 1
TL_p2:
    buffer_load_dword v3, off, s[8:11], s40 sc1
    s_waitcnt vmcnt(0)
    v_cmp_gt_u32 vcc, s41, v3
    s_cbranch_vccz TL_p2_ok
    s_sub_u32 s83, s83, 1
    s_cbranch_scc0 TL_p2
    s_mov_b32 s83, 0
TL_p2_ok:
    s_mov_b64 exec, -1
TL_w2:
    s_barrier
    s_cmp_ge_u32 s60, 62
    s_cbranch_scc0 TL_kml
TL_kmp:
    s_lshl_b32 s75, s60, 17
    s_lshl_b32 s76, s61, 14
    s_add_u32 s75, s75, s76
    s_lshl_b32 s76, s3, 12
    s_add_u32 s75, s75, s76
    s_add_u32 s75, s75, 99876864
    buffer_load_dwordx2 v[112:113], v9, s[8:11], s75 offen offset:0 sc1
    buffer_load_dwordx2 v[114:115], v9, s[8:11], s75 offen offset:32 sc1
    buffer_load_dwordx2 v[116:117], v9, s[8:11], s75 offen offset:1024 sc1
    buffer_load_dwordx2 v[118:119], v9, s[8:11], s75 offen offset:1056 sc1
    buffer_load_dwordx2 v[120:121], v9, s[8:11], s75 offen offset:2048 sc1
    buffer_load_dwordx2 v[122:123], v9, s[8:11], s75 offen offset:2080 sc1
    buffer_load_dwordx2 v[124:125], v9, s[8:11], s75 offen offset:3072 sc1
    buffer_load_dwordx2 v[126:127], v9, s[8:11], s75 offen offset:3104 sc1
    buffer_load_dwordx2 v[180:181], v10, s[8:11], s75 offen offset:0 sc1
    buffer_load_dwordx2 v[182:183], v11, s[8:11], s75 offen offset:0 sc1
    buffer_load_dwordx2 v[184:185], v10, s[8:11], s75 offen offset:1024 sc1
    buffer_load_dwordx2 v[186:187], v11, s[8:11], s75 offen offset:1024 sc1
    buffer_load_dwordx2 v[188:189], v10, s[8:11], s75 offen offset:2048 sc1
    buffer_load_dwordx2 v[190:191], v11, s[8:11], s75 offen offset:2048 sc1
    buffer_load_dwordx2 v[192:193], v10, s[8:11], s75 offen offset:3072 sc1
    buffer_load_dwordx2 v[194:195], v11, s[8:11], s75 offen offset:3072 sc1
    s_waitcnt vmcnt(8)
    v_max3_u32 v4, v112, v114, v116
    v_max3_u32 v4, v4, v118, v120
    v_max3_u32 v4, v4, v122, v124
    v_max_u32 v4, v4, v126
    s_waitcnt vmcnt(0)
    v_max3_u32 v4, v4, v180, v182
    v_max3_u32 v4, v4, v184, v186
    v_max3_u32 v4, v4, v188, v190
    v_max3_u32 v4, v4, v192, v194
    v_cmp_eq_u32 vcc, -1, v4
    s_cbranch_vccz TL_kmok
    s_sub_u32 s83, s83, 1
    s_cbranch_scc0 TL_kmp
    s_mov_b32 s83, 0
    s_branch TL_kmok
TL_kml:
    s_lshl_b32 s75, s60, 17
    s_lshl_b32 s76, s61, 14
    s_add_u32 s75, s75, s76
    s_lshl_b32 s76, s3, 12
    s_add_u32 s75, s75, s76
    s_add_u32 s75, s75, 99876864
    buffer_load_dwordx2 v[112:113], v9, s[8:11], s75 offen offset:0
    buffer_load_dwordx2 v[114:115], v9, s[8:11], s75 offen offset:32
    buffer_load_dwordx2 v[116:117], v9, s[8:11], s75 offen offset:1024
    buffer_load_dwordx2 v[118:119], v9, s[8:11], s75 offen offset:1056
    buffer_load_dwordx2 v[120:121], v9, s[8:11], s75 offen offset:2048
    buffer_load_dwordx2 v[122:123], v9, s[8:11], s75 offen offset:2080
    buffer_load_dwordx2 v[124:125], v9, s[8:11], s75 offen offset:3072
    buffer_load_dwordx2 v[126:127], v9, s[8:11], s75 offen offset:3104
    buffer_load_dwordx2 v[180:181], v10, s[8:11], s75 offen offset:0
    buffer_load_dwordx2 v[182:183], v11, s[8:11], s75 offen offset:0
    buffer_load_dwordx2 v[184:185], v10, s[8:11], s75 offen offset:1024
    buffer_load_dwordx2 v[186:187], v11, s[8:11], s75 offen offset:1024
    buffer_load_dwordx2 v[188:189], v10, s[8:11], s75 offen offset:2048
    buffer_load_dwordx2 v[190:191], v11, s[8:11], s75 offen offset:2048
    buffer_load_dwordx2 v[192:193], v10, s[8:11], s75 offen offset:3072
    buffer_load_dwordx2 v[194:195], v11, s[8:11], s75 offen offset:3072
TL_kmok:
    s_waitcnt vmcnt(8)
    v_mfma_f32_16x16x32_bf16 v[156:159], v[112:115], v[16:19], 0
    v_mfma_f32_16x16x32_bf16 v[160:163], v[112:115], v[20:23], 0
    v_mfma_f32_16x16x32_bf16 v[156:159], v[116:119], v[24:27], v[156:159]
    v_mfma_f32_16x16x32_bf16 v[160:163], v[116:119], v[28:31], v[160:163]
    v_mfma_f32_16x16x32_bf16 v[156:159], v[120:123], v[32:35], v[156:159]
    v_mfma_f32_16x16x32_bf16 v[160:163], v[120:123], v[36:39], v[160:163]
    v_mfma_f32_16x16x32_bf16 v[156:159], v[124:127], v[40:43], v[156:159]
    v_mfma_f32_16x16x32_bf16 v[160:163], v[124:127], v[44:47], v[160:163]
    s_lshl_b32 s75, s60, 3
    s_add_u32 s75, s75, s61
    s_mul_i32 s75, s75, 73728
    s_mul_i32 s76, s62, 9216
    s_add_u32 s75, s75, s76
    s_add_u32 s75, s75, 121532416
    s_waitcnt vmcnt(0)
    v_mov_b32 v4, 0xffff
    v_mov_b32 v5, 0xf149f2ca
    v_bfi_b32 v128, v4, v180, v181
    v_bfi_b32 v129, v4, v182, v183
    v_bfi_b32 v130, v4, v181, v180
    v_bfi_b32 v131, v4, v183, v182
    v_bfi_b32 v132, v4, v184, v185
    v_bfi_b32 v133, v4, v186, v187
    v_bfi_b32 v134, v4, v185, v184
    v_bfi_b32 v135, v4, v187, v186
    v_bfi_b32 v136, v4, v188, v189
    v_bfi_b32 v137, v4, v190, v191
    v_bfi_b32 v138, v4, v189, v188
    v_bfi_b32 v139, v4, v191, v190
    v_bfi_b32 v140, v4, v192, v193
    v_bfi_b32 v141, v4, v194, v195
    v_bfi_b32 v142, v4, v193, v192
    v_bfi_b32 v143, v4, v195, v194
    v_cndmask_b32 v156, v5, v156, s[72:73]
    v_cndmask_b32 v160, v5, v160, s[72:73]
    v_cndmask_b32 v157, v5, v157, s[72:73]
    v_cndmask_b32 v161, v5, v161, s[72:73]
    v_cndmask_b32 v158, v5, v158, s[72:73]
    v_cndmask_b32 v162, v5, v162, s[72:73]
    v_cndmask_b32 v159, v5, v159, s[72:73]
    v_cndmask_b32 v163, v5, v163, s[72:73]
    v_max3_f32 v144, v156, v157, v158
    v_max3_f32 v145, v160, v161, v162
    v_max_f32 v144, v144, v159
    v_max_f32 v145, v145, v163
    v_mov_b32 v146, v144
    v_mov_b32 v147, v145
    s_nop 0
    v_permlane16_swap_b32 v144, v146
    v_permlane16_swap_b32 v145, v147
    v_max_f32 v144, v144, v146
    v_max_f32 v145, v145, v147
    v_mov_b32 v146, v144
    v_mov_b32 v147, v145
    s_nop 0
    v_permlane32_swap_b32 v144, v146
    v_permlane32_swap_b32 v145, v147
    v_max_f32 v144, v144, v146
    v_max_f32 v145, v145, v147
    v_mul_f32 v144, s74, v144
    v_mul_f32 v145, s74, v145
    v_max_f32 v144, v144, v244
    v_max_f32 v145, v145, v245
    v_sub_f32 v148, v244, v144
    v_sub_f32 v149, v245, v145
    v_fma_f32 v156, v156, s74, -v144
    v_fma_f32 v160, v160, s74, -v145
    v_fma_f32 v157, v157, s74, -v144
    v_fma_f32 v161, v161, s74, -v145
    v_fma_f32 v158, v158, s74, -v144
    v_fma_f32 v162, v162, s74, -v145
    v_fma_f32 v159, v159, s74, -v144
    v_fma_f32 v163, v163, s74, -v145
    v_exp_f32 v148, v148
    v_exp_f32 v149, v149
    v_exp_f32 v156, v156
    v_exp_f32 v160, v160
    v_exp_f32 v157, v157
    v_exp_f32 v161, v161
    v_exp_f32 v158, v158
    v_exp_f32 v162, v162
    v_exp_f32 v159, v159
    v_exp_f32 v163, v163
    v_add_f32 v144, v156, v157
    v_add_f32 v145, v160, v161
    v_add_f32 v150, v158, v159
    v_add_f32 v152, v162, v163
    v_add_f32 v144, v144, v150
    v_add_f32 v145, v145, v152
    v_mov_b32 v146, v144
    v_mov_b32 v147, v145
    s_nop 0
    v_permlane16_swap_b32 v144, v146
    v_permlane16_swap_b32 v145, v147
    v_add_f32 v144, v144, v146
    v_add_f32 v145, v145, v147
    v_mov_b32 v146, v144
    v_mov_b32 v147, v145
    s_nop 0
    v_permlane32_swap_b32 v144, v146
    v_permlane32_swap_b32 v145, v147
    v_add_f32 v144, v144, v146
    v_add_f32 v145, v145, v147
    v_fma_f32 v144, v148, v246, v144
    v_fma_f32 v145, v149, v247, v145
    v_rcp_f32 v144, v144
    v_rcp_f32 v145, v145
    v_mul_f32 v150, v148, v144
    v_mul_f32 v152, v149, v145
    v_mul_f32 v156, v156, v144
    v_mul_f32 v160, v160, v145
    v_mul_f32 v157, v157, v144
    v_mul_f32 v161, v161, v145
    v_mul_f32 v158, v158, v144
    v_mul_f32 v162, v162, v145
    v_mul_f32 v159, v159, v144
    v_mul_f32 v163, v163, v145
    v_cvt_pk_bf16_f32 v172, v156, v157
    v_cvt_pk_bf16_f32 v173, v158, v159
    v_cvt_pk_bf16_f32 v174, v160, v161
    v_cvt_pk_bf16_f32 v175, v162, v163
    v_pk_mul_f32 v[48:49], v[48:49], v[150:151] op_sel_hi:[1,0]
    v_pk_mul_f32 v[50:51], v[50:51], v[150:151] op_sel_hi:[1,0]
    v_pk_mul_f32 v[52:53], v[52:53], v[152:153] op_sel_hi:[1,0]
    v_pk_mul_f32 v[54:55], v[54:55], v[152:153] op_sel_hi:[1,0]
    v_pk_mul_f32 v[56:57], v[56:57], v[150:151] op_sel_hi:[1,0]
    v_pk_mul_f32 v[58:59], v[58:59], v[150:151] op_sel_hi:[1,0]
    v_pk_mul_f32 v[60:61], v[60:61], v[152:153] op_sel_hi:[1,0]
    v_pk_mul_f32 v[62:63], v[62:63], v[152:153] op_sel_hi:[1,0]
    v_mfma_f32_16x16x16_bf16 v[48:51], v[128:129], v[172:173], v[48:51]
    v_mfma_f32_16x16x16_bf16 v[52:55], v[128:129], v[174:175], v[52:55]
    v_pk_mul_f32 v[64:65], v[64:65], v[150:151] op_sel_hi:[1,0]
    v_pk_mul_f32 v[66:67], v[66:67], v[150:151] op_sel_hi:[1,0]
    v_pk_mul_f32 v[68:69], v[68:69], v[152:153] op_sel_hi:[1,0]
    v_pk_mul_f32 v[70:71], v[70:71], v[152:153] op_sel_hi:[1,0]
    v_mfma_f32_16x16x16_bf16 v[56:59], v[130:131], v[172:173], v[56:59]
    v_mfma_f32_16x16x16_bf16 v[60:63], v[130:131], v[174:175], v[60:63]
    v_pk_mul_f32 v[72:73], v[72:73], v[150:151] op_sel_hi:[1,0]
    v_pk_mul_f32 v[74:75], v[74:75], v[150:151] op_sel_hi:[1,0]
    v_pk_mul_f32 v[76:77], v[76:77], v[152:153] op_sel_hi:[1,0]
    v_pk_mul_f32 v[78:79], v[78:79], v[152:153] op_sel_hi:[1,0]
    v_mfma_f32_16x16x16_bf16 v[64:67], v[132:133], v[172:173], v[64:67]
    v_mfma_f32_16x16x16_bf16 v[68:71], v[132:133], v[174:175], v[68:71]
    v_pk_mul_f32 v[208:209], v[208:209], v[150:151] op_sel_hi:[1,0]
    v_pk_mul_f32 v[210:211], v[210:211], v[150:151] op_sel_hi:[1,0]
    v_pk_mul_f32 v[212:213], v[212:213], v[152:153] op_sel_hi:[1,0]
    v_pk_mul_f32 v[214:215], v[214:215], v[152:153] op_sel_hi:[1,0]
    v_cvt_pk_bf16_f32 v176, v48, v49
    v_cvt_pk_bf16_f32 v177, v50, v51
    v_cvt_pk_bf16_f32 v180, v52, v53
    v_cvt_pk_bf16_f32 v181, v54, v55
    v_mfma_f32_16x16x16_bf16 v[72:75], v[134:135], v[172:173], v[72:75]
    v_mfma_f32_16x16x16_bf16 v[76:79], v[134:135], v[174:175], v[76:79]
    v_pk_mul_f32 v[216:217], v[216:217], v[150:151] op_sel_hi:[1,0]
    v_pk_mul_f32 v[218:219], v[218:219], v[150:151] op_sel_hi:[1,0]
    v_pk_mul_f32 v[220:221], v[220:221], v[152:153] op_sel_hi:[1,0]
    v_pk_mul_f32 v[222:223], v[222:223], v[152:153] op_sel_hi:[1,0]
    v_cvt_pk_bf16_f32 v178, v56, v57
    v_cvt_pk_bf16_f32 v179, v58, v59
    v_cvt_pk_bf16_f32 v182, v60, v61
    v_cvt_pk_bf16_f32 v183, v62, v63
    v_mfma_f32_16x16x16_bf16 v[208:211], v[136:137], v[172:173], v[208:211]
    v_mfma_f32_16x16x16_bf16 v[212:215], v[136:137], v[174:175], v[212:215]
    v_pk_mul_f32 v[224:225], v[224:225], v[150:151] op_sel_hi:[1,0]
    v_pk_mul_f32 v[226:227], v[226:227], v[150:151] op_sel_hi:[1,0]
    v_pk_mul_f32 v[228:229], v[228:229], v[152:153] op_sel_hi:[1,0]
    v_pk_mul_f32 v[230:231], v[230:231], v[152:153] op_sel_hi:[1,0]
    v_cvt_pk_bf16_f32 v184, v64, v65
    v_cvt_pk_bf16_f32 v185, v66, v67
    v_cvt_pk_bf16_f32 v188, v68, v69
    v_cvt_pk_bf16_f32 v189, v70, v71
    v_mfma_f32_16x16x16_bf16 v[216:219], v[138:139], v[172:173], v[216:219]
    v_mfma_f32_16x16x16_bf16 v[220:223], v[138:139], v[174:175], v[220:223]
    v_pk_mul_f32 v[232:233], v[232:233], v[150:151] op_sel_hi:[1,0]
    v_pk_mul_f32 v[234:235], v[234:235], v[150:151] op_sel_hi:[1,0]
    v_pk_mul_f32 v[236:237], v[236:237], v[152:153] op_sel_hi:[1,0]
    v_pk_mul_f32 v[238:239], v[238:239], v[152:153] op_sel_hi:[1,0]
    v_cvt_pk_bf16_f32 v186, v72, v73
    v_cvt_pk_bf16_f32 v187, v74, v75
    v_cvt_pk_bf16_f32 v190, v76, v77
    v_cvt_pk_bf16_f32 v191, v78, v79
    v_mfma_f32_16x16x16_bf16 v[224:227], v[140:141], v[172:173], v[224:227]
    v_mfma_f32_16x16x16_bf16 v[228:231], v[140:141], v[174:175], v[228:231]
    v_cvt_pk_bf16_f32 v192, v208, v209
    v_cvt_pk_bf16_f32 v193, v210, v211
    v_cvt_pk_bf16_f32 v196, v212, v213
    v_cvt_pk_bf16_f32 v197, v214, v215
    v_mfma_f32_16x16x16_bf16 v[232:235], v[142:143], v[172:173], v[232:235]
    v_mfma_f32_16x16x16_bf16 v[236:239], v[142:143], v[174:175], v[236:239]
    v_cvt_pk_bf16_f32 v194, v216, v217
    v_cvt_pk_bf16_f32 v195, v218, v219
    v_cvt_pk_bf16_f32 v198, v220, v221
    v_cvt_pk_bf16_f32 v199, v222, v223
    v_cvt_pk_bf16_f32 v200, v224, v225
    v_cvt_pk_bf16_f32 v201, v226, v227
    v_cvt_pk_bf16_f32 v204, v228, v229
    v_cvt_pk_bf16_f32 v205, v230, v231
    v_cvt_pk_bf16_f32 v202, v232, v233
    v_cvt_pk_bf16_f32 v203, v234, v235
    v_cvt_pk_bf16_f32 v206, v236, v237
    v_cvt_pk_bf16_f32 v207, v238, v239
    s_mul_i32 s76, s3, 18432
    v_add_u32 v4, s76, v8
    v_mfma_f32_16x16x32_bf16 v[16:19], a[0:3], v[176:179], 0
    v_mfma_f32_16x16x32_bf16 v[52:55], a[0:3], v[180:183], 0
    v_mfma_f32_16x16x32_bf16 v[16:19], a[4:7], v[184:187], v[16:19]
    v_mfma_f32_16x16x32_bf16 v[52:55], a[4:7], v[188:191], v[52:55]
    v_mfma_f32_16x16x32_bf16 v[16:19], a[8:11], v[192:195], v[16:19]
    v_mfma_f32_16x16x32_bf16 v[52:55], a[8:11], v[196:199], v[52:55]
    v_mfma_f32_16x16x32_bf16 v[16:19], a[12:15], v[200:203], v[16:19]
    v_mfma_f32_16x16x32_bf16 v[52:55], a[12:15], v[204:207], v[52:55]
    v_mfma_f32_16x16x32_bf16 v[20:23], a[16:19], v[176:179], 0
    v_mfma_f32_16x16x32_bf16 v[56:59], a[16:19], v[180:183], 0
    v_mfma_f32_16x16x32_bf16 v[20:23], a[20:23], v[184:187], v[20:23]
    v_mfma_f32_16x16x32_bf16 v[56:59], a[20:23], v[188:191], v[56:59]
    ds_write_b128 v4, v[16:19] offset:0
    v_mfma_f32_16x16x32_bf16 v[20:23], a[24:27], v[192:195], v[20:23]
    v_mfma_f32_16x16x32_bf16 v[56:59], a[24:27], v[196:199], v[56:59]
    v_mfma_f32_16x16x32_bf16 v[20:23], a[28:31], v[200:203], v[20:23]
    ds_write_b128 v4, v[52:55] offset:9216
    v_mfma_f32_16x16x32_bf16 v[56:59], a[28:31], v[204:207], v[56:59]
    v_mfma_f32_16x16x32_bf16 v[24:27], a[32:35], v[176:179], 0
    v_mfma_f32_16x16x32_bf16 v[60:63], a[32:35], v[180:183], 0
    v_mfma_f32_16x16x32_bf16 v[24:27], a[36:39], v[184:187], v[24:27]
    v_mfma_f32_16x16x32_bf16 v[60:63], a[36:39], v[188:191], v[60:63]
    ds_write_b128 v4, v[20:23] offset:1024
    v_mfma_f32_16x16x32_bf16 v[24:27], a[40:43], v[192:195], v[24:27]
    v_mfma_f32_16x16x32_bf16 v[60:63], a[40:43], v[196:199], v[60:63]
    v_mfma_f32_16x16x32_bf16 v[24:27], a[44:47], v[200:203], v[24:27]
    ds_write_b128 v4, v[56:59] offset:10240
    v_mfma_f32_16x16x32_bf16 v[60:63], a[44:47], v[204:207], v[60:63]
    v_mfma_f32_16x16x32_bf16 v[28:31], a[48:51], v[176:179], 0
    v_mfma_f32_16x16x32_bf16 v[64:67], a[48:51], v[180:183], 0
    v_mfma_f32_16x16x32_bf16 v[28:31], a[52:55], v[184:187], v[28:31]
    v_mfma_f32_16x16x32_bf16 v[64:67], a[52:55], v[188:191], v[64:67]
    ds_write_b128 v4, v[24:27] offset:2048
    v_mfma_f32_16x16x32_bf16 v[28:31], a[56:59], v[192:195], v[28:31]
    v_mfma_f32_16x16x32_bf16 v[64:67], a[56:59], v[196:199], v[64:67]
    v_mfma_f32_16x16x32_bf16 v[28:31], a[60:63], v[200:203], v[28:31]
    ds_write_b128 v4, v[60:63] offset:11264
    v_mfma_f32_16x16x32_bf16 v[64:67], a[60:63], v[204:207], v[64:67]
    v_mfma_f32_16x16x32_bf16 v[32:35], a[64:67], v[176:179], 0
    v_mfma_f32_16x16x32_bf16 v[68:71], a[64:67], v[180:183], 0
    v_mfma_f32_16x16x32_bf16 v[32:35], a[68:71], v[184:187], v[32:35]
    v_mfma_f32_16x16x32_bf16 v[68:71], a[68:71], v[188:191], v[68:71]
    ds_write_b128 v4, v[28:31] offset:3072
    v_mfma_f32_16x16x32_bf16 v[32:35], a[72:75], v[192:195], v[32:35]
    v_mfma_f32_16x16x32_bf16 v[68:71], a[72:75], v[196:199], v[68:71]
    v_mfma_f32_16x16x32_bf16 v[32:35], a[76:79], v[200:203], v[32:35]
    ds_write_b128 v4, v[64:67] offset:12288
    v_mfma_f32_16x16x32_bf16 v[68:71], a[76:79], v[204:207], v[68:71]
    v_mfma_f32_16x16x32_bf16 v[36:39], a[80:83], v[176:179], 0
    v_mfma_f32_16x16x32_bf16 v[72:75], a[80:83], v[180:183], 0
    v_mfma_f32_16x16x32_bf16 v[36:39], a[84:87], v[184:187], v[36:39]
    v_mfma_f32_16x16x32_bf16 v[72:75], a[84:87], v[188:191], v[72:75]
    ds_write_b128 v4, v[32:35] offset:4096
    v_mfma_f32_16x16x32_bf16 v[36:39], a[88:91], v[192:195], v[36:39]
    v_mfma_f32_16x16x32_bf16 v[72:75], a[88:91], v[196:199], v[72:75]
    v_mfma_f32_16x16x32_bf16 v[36:39], a[92:95], v[200:203], v[36:39]
    ds_write_b128 v4, v[68:71] offset:13312
    v_mfma_f32_16x16x32_bf16 v[72:75], a[92:95], v[204:207], v[72:75]
    v_mfma_f32_16x16x32_bf16 v[40:43], a[96:99], v[176:179], 0
    v_mfma_f32_16x16x32_bf16 v[76:79], a[96:99], v[180:183], 0
    v_mfma_f32_16x16x32_bf16 v[40:43], a[100:103], v[184:187], v[40:43]
    v_mfma_f32_16x16x32_bf16 v[76:79], a[100:103], v[188:191], v[76:79]
    ds_write_b128 v4, v[36:39] offset:5120
    v_mfma_f32_16x16x32_bf16 v[40:43], a[104:107], v[192:195], v[40:43]
    v_mfma_f32_16x16x32_bf16 v[76:79], a[104:107], v[196:199], v[76:79]
    v_mfma_f32_16x16x32_bf16 v[40:43], a[108:111], v[200:203], v[40:43]
    ds_write_b128 v4, v[72:75] offset:14336
    v_mfma_f32_16x16x32_bf16 v[76:79], a[108:111], v[204:207], v[76:79]
    v_mfma_f32_16x16x32_bf16 v[44:47], a[112:115], v[176:179], 0
    v_mfma_f32_16x16x32_bf16 v[80:83], a[112:115], v[180:183], 0
    v_mfma_f32_16x16x32_bf16 v[44:47], a[116:119], v[184:187], v[44:47]
    v_mfma_f32_16x16x32_bf16 v[80:83], a[116:119], v[188:191], v[80:83]
    ds_write_b128 v4, v[40:43] offset:6144
    v_mfma_f32_16x16x32_bf16 v[44:47], a[120:123], v[192:195], v[44:47]
    v_mfma_f32_16x16x32_bf16 v[80:83], a[120:123], v[196:199], v[80:83]
    v_mfma_f32_16x16x32_bf16 v[44:47], a[124:127], v[200:203], v[44:47]
    ds_write_b128 v4, v[76:79] offset:15360
    v_mfma_f32_16x16x32_bf16 v[80:83], a[124:127], v[204:207], v[80:83]
    v_mfma_f32_16x16x32_bf16 v[48:51], a[128:131], v[176:179], 0
    v_mfma_f32_16x16x32_bf16 v[84:87], a[128:131], v[180:183], 0
    v_mfma_f32_16x16x32_bf16 v[48:51], a[132:135], v[184:187], v[48:51]
    v_mfma_f32_16x16x32_bf16 v[84:87], a[132:135], v[188:191], v[84:87]
    ds_write_b128 v4, v[44:47] offset:7168
    v_mfma_f32_16x16x32_bf16 v[48:51], a[136:139], v[192:195], v[48:51]
    v_mfma_f32_16x16x32_bf16 v[84:87], a[136:139], v[196:199], v[84:87]
    v_mfma_f32_16x16x32_bf16 v[48:51], a[140:143], v[200:203], v[48:51]
    ds_write_b128 v4, v[80:83] offset:16384
    v_mfma_f32_16x16x32_bf16 v[84:87], a[140:143], v[204:207], v[84:87]
    s_lshl_b32 s76, s3, 10
    v_add_u32 v6, s76, v8
    v_add_u32 v5, 36864, v6
    s_nop 0
    ds_write_b128 v4, v[48:51] offset:8192
    s_nop 2
    ds_write_b128 v4, v[84:87] offset:17408
    s_waitcnt lgkmcnt(0)
    s_barrier
    ds_read_b128 v[16:19], v6 offset:0
    ds_read_b128 v[20:23], v6 offset:18432
    ds_read_b128 v[24:27], v5 offset:0
    ds_read_b128 v[28:31], v5 offset:18432
    ds_read_b128 v[32:35], v6 offset:4096
    ds_read_b128 v[36:39], v6 offset:22528
    ds_read_b128 v[40:43], v5 offset:4096
    ds_read_b128 v[44:47], v5 offset:22528
    ds_read_b128 v[48:51], v6 offset:8192
    ds_read_b128 v[52:55], v6 offset:26624
    ds_read_b128 v[56:59], v5 offset:8192
    ds_read_b128 v[60:63], v5 offset:26624
    ds_read_b128 v[64:67], v6 offset:12288
    ds_read_b128 v[68:71], v6 offset:30720
    ds_read_b128 v[72:75], v5 offset:12288
    ds_read_b128 v[76:79], v5 offset:30720
    s_cmp_ge_u32 s3, 2
    s_cbranch_scc1 TL_R_8a
    ds_read_b128 v[80:83], v6 offset:16384
    ds_read_b128 v[84:87], v6 offset:34816
    ds_read_b128 v[88:91], v5 offset:16384
    ds_read_b128 v[92:95], v5 offset:34816
TL_R_8a:
    s_waitcnt lgkmcnt(12)
    s_add_u32 s76, s3, 0
    s_cmp_ge_u32 s76, 9
    s_cselect_b32 s77, 27648, 0
    s_lshl_b32 s76, s76, 10
    s_add_u32 s76, s76, s77
    s_add_u32 s76, s76, s75
    v_pk_add_f32 v[16:17], v[16:17], v[20:21]
    v_pk_add_f32 v[24:25], v[24:25], v[28:29]
    v_pk_add_f32 v[18:19], v[18:19], v[22:23]
    v_pk_add_f32 v[26:27], v[26:27], v[30:31]
    v_pk_add_f32 v[16:17], v[16:17], v[24:25]
    v_pk_add_f32 v[18:19], v[18:19], v[26:27]
    buffer_store_dwordx4 v[16:19], v8, s[8:11], s76 offen sc1
    s_waitcnt lgkmcnt(8)
    s_add_u32 s76, s3, 4
    s_cmp_ge_u32 s76, 9
    s_cselect_b32 s77, 27648, 0
    s_lshl_b32 s76, s76, 10
    s_add_u32 s76, s76, s77
    s_add_u32 s76, s76, s75
    v_pk_add_f32 v[32:33], v[32:33], v[36:37]
    v_pk_add_f32 v[40:41], v[40:41], v[44:45]
    v_pk_add_f32 v[34:35], v[34:35], v[38:39]
    v_pk_add_f32 v[42:43], v[42:43], v[46:47]
    v_pk_add_f32 v[32:33], v[32:33], v[40:41]
    v_pk_add_f32 v[34:35], v[34:35], v[42:43]
    buffer_store_dwordx4 v[32:35], v8, s[8:11], s76 offen sc1
    s_waitcnt lgkmcnt(4)
    s_add_u32 s76, s3, 8
    s_cmp_ge_u32 s76, 9
    s_cselect_b32 s77, 27648, 0
    s_lshl_b32 s76, s76, 10
    s_add_u32 s76, s76, s77
    s_add_u32 s76, s76, s75
    v_pk_add_f32 v[48:49], v[48:49], v[52:53]
    v_pk_add_f32 v[56:57], v[56:57], v[60:61]
    v_pk_add_f32 v[50:51], v[50:51], v[54:55]
    v_pk_add_f32 v[58:59], v[58:59], v[62:63]
    v_pk_add_f32 v[48:49], v[48:49], v[56:57]
    v_pk_add_f32 v[50:51], v[50:51], v[58:59]
    buffer_store_dwordx4 v[48:51], v8, s[8:11], s76 offen sc1
    s_waitcnt lgkmcnt(0)
    s_add_u32 s76, s3, 12
    s_cmp_ge_u32 s76, 9
    s_cselect_b32 s77, 27648, 0
    s_lshl_b32 s76, s76, 10
    s_add_u32 s76, s76, s77
    s_add_u32 s76, s76, s75
    v_pk_add_f32 v[64:65], v[64:65], v[68:69]
    v_pk_add_f32 v[72:73], v[72:73], v[76:77]
    v_pk_add_f32 v[66:67], v[66:67], v[70:71]
    v_pk_add_f32 v[74:75], v[74:75], v[78:79]
    v_pk_add_f32 v[64:65], v[64:65], v[72:73]
    v_pk_add_f32 v[66:67], v[66:67], v[74:75]
    buffer_store_dwordx4 v[64:67], v8, s[8:11], s76 offen sc1
    s_cmp_ge_u32 s3, 2
    s_cbranch_scc1 TL_R_8
    s_add_u32 s76, s3, 16
    s_cmp_ge_u32 s76, 9
    s_cselect_b32 s77, 27648, 0
    s_lshl_b32 s76, s76, 10
    s_add_u32 s76, s76, s77
    s_add_u32 s76, s76, s75
    v_pk_add_f32 v[80:81], v[80:81], v[84:85]
    v_pk_add_f32 v[88:89], v[88:89], v[92:93]
    v_pk_add_f32 v[82:83], v[82:83], v[86:87]
    v_pk_add_f32 v[90:91], v[90:91], v[94:95]
    v_pk_add_f32 v[80:81], v[80:81], v[88:89]
    v_pk_add_f32 v[82:83], v[82:83], v[90:91]
    buffer_store_dwordx4 v[80:83], v8, s[8:11], s76 offen sc1
TL_R_8:
    s_cmp_ge_u32 s60, 57
    s_cbranch_scc0 TL_nl
    s_lshl_b32 s40, s3, 3
    s_add_u32 s40, s40, s61
    s_cmp_ge_u32 s40, 18
    s_cbranch_scc1 TL_end
    s_waitcnt vmcnt(0)
TL_fp:
    s_mul_i32 s75, s60, 589824
    s_lshl_b32 s76, s63, 10
    s_add_u32 s75, s75, s76
    s_add_u32 s75, s75, 121532416
    buffer_load_dwordx4 v[16:19], v8, s[8:11], s75 offen sc1
    s_add_u32 s75, s75, 73728
    buffer_load_dwordx4 v[20:23], v8, s[8:11], s75 offen sc1
    s_add_u32 s75, s75, 73728
    buffer_load_dwordx4 v[24:27], v8, s[8:11], s75 offen sc1
    s_add_u32 s75, s75, 73728
    buffer_load_dwordx4 v[28:31], v8, s[8:11], s75 offen sc1
    s_add_u32 s75, s75, 73728
    buffer_load_dwordx4 v[32:35], v8, s[8:11], s75 offen sc1
    s_add_u32 s75, s75, 73728
    buffer_load_dwordx4 v[36:39], v8, s[8:11], s75 offen sc1
    s_add_u32 s75, s75, 73728
    buffer_load_dwordx4 v[40:43], v8, s[8:11], s75 offen sc1
    s_add_u32 s75, s75, 73728
    buffer_load_dwordx4 v[44:47], v8, s[8:11], s75 offen sc1
    s_waitcnt vmcnt(4)
    v_max3_u32 v4, v16, v20, v24
    v_max_u32 v4, v4, v28
    s_waitcnt vmcnt(0)
    v_max3_u32 v4, v4, v32, v36
    v_max3_u32 v4, v4, v40, v44
    v_cmp_eq_u32 vcc, -1, v4
    s_cbranch_vccz TL_fp_ok
    s_sub_u32 s83, s83, 1
    s_cbranch_scc0 TL_fp
    s_mov_b32 s83, 0
TL_fp_ok:
    s_cmp_ge_u32 s63, 36
    s_cselect_b32 s76, 16, 0
    s_cselect_b32 s77, 36, 0
    s_sub_u32 s77, s63, s77
    s_lshl_b32 s75, s60, 5
    s_add_u32 s75, s75, s76
    s_mul_i32 s75, s75, 1152
    s_lshl_b32 s77, s77, 5
    s_add_u32 s75, s75, s77
    s_waitcnt vmcnt(6)
    v_pk_add_f32 v[16:17], v[16:17], v[20:21]
    v_pk_add_f32 v[18:19], v[18:19], v[22:23]
    s_waitcnt vmcnt(4)
    v_pk_add_f32 v[24:25], v[24:25], v[28:29]
    v_pk_add_f32 v[26:27], v[26:27], v[30:31]
    s_waitcnt vmcnt(2)
    v_pk_add_f32 v[32:33], v[32:33], v[36:37]
    v_pk_add_f32 v[34:35], v[34:35], v[38:39]
    s_waitcnt vmcnt(0)
    v_pk_add_f32 v[40:41], v[40:41], v[44:45]
    v_pk_add_f32 v[42:43], v[42:43], v[46:47]
    v_pk_add_f32 v[16:17], v[16:17], v[24:25]
    v_pk_add_f32 v[18:19], v[18:19], v[26:27]
    v_pk_add_f32 v[32:33], v[32:33], v[40:41]
    v_pk_add_f32 v[34:35], v[34:35], v[42:43]
    v_pk_add_f32 v[16:17], v[16:17], v[32:33]
    v_pk_add_f32 v[18:19], v[18:19], v[34:35]
    v_cvt_pk_bf16_f32 v16, v16, v17
    v_cvt_pk_bf16_f32 v17, v18, v19
    v_lshlrev_b32 v102, 16, v240
    v_and_b32 v103, 0xffff0000, v240
    v_lshlrev_b32 v104, 16, v16
    v_and_b32 v105, 0xffff0000, v16
    v_add_f32 v102, v102, v104
    v_add_f32 v103, v103, v105
    v_cvt_pk_bf16_f32 v102, v102, v103
    v_and_b32 v103, 0xffff0000, v102
    v_lshlrev_b32 v102, 16, v102
    v_lshlrev_b32 v104, 16, v242
    v_and_b32 v105, 0xffff0000, v242
    v_add_f32 v102, v102, v104
    v_add_f32 v103, v103, v105
    v_cvt_pk_bf16_f32 v106, v102, v103
    v_lshlrev_b32 v102, 16, v241
    v_and_b32 v103, 0xffff0000, v241
    v_lshlrev_b32 v104, 16, v17
    v_and_b32 v105, 0xffff0000, v17
    v_add_f32 v102, v102, v104
    v_add_f32 v103, v103, v105
    v_cvt_pk_bf16_f32 v102, v102, v103
    v_and_b32 v103, 0xffff0000, v102
    v_lshlrev_b32 v102, 16, v102
    v_lshlrev_b32 v104, 16, v243
    v_and_b32 v105, 0xffff0000, v243
    v_add_f32 v102, v102, v104
    v_add_f32 v103, v103, v105
    v_cvt_pk_bf16_f32 v107, v102, v103
    buffer_store_dwordx2 v[106:107], v14, s[20:23], s75 offen
    s_branch TL_end
TL_nl:
    s_waitcnt vmcnt(0)
    s_barrier
    s_cmp_lg_u32 s3, 0
    s_cbranch_scc1 TL_w3
    s_lshl_b32 s40, s60, 2
    s_add_u32 s40, s40, s62
    s_lshl_b32 s40, s40, 7
    s_add_u32 s40, s40, 117298176
    s_lshl_b32 s41, s61, 2
    s_add_u32 s41, s41, s40
    v_mov_b32 v3, 2
    s_mov_b64 exec, 1
    buffer_store_dword v3, off, s[8:11], s41 sc1
    s_mov_b64 exec, -1
    v_lshlrev_b32 v2, 2, v0
    s_mov_b64 exec, 0xff
TL_p4:
    buffer_load_dword v3, v2, s[8:11], s40 offen sc1
    s_waitcnt vmcnt(0)
    v_cmp_eq_u32 vcc, 0, v3
    s_cbranch_vccz TL_p4_ok
    s_sub_u32 s83, s83, 1
    s_cbranch_scc0 TL_p4
    s_mov_b32 s83, 0
TL_p4_ok:
    s_mov_b64 exec, -1
TL_w3:
    s_barrier
    s_lshl_b32 s40, s3, 3
    s_add_u32 s40, s40, s61
    s_cmp_ge_u32 s40, 18
    s_cbranch_scc1 TL_nf
    s_cmp_ge_u32 s40, 9
    s_cselect_b32 s41, 27, 0
    s_add_u32 s40, s40, s41
    s_mul_i32 s41, s62, 9
    s_add_u32 s63, s40, s41
    s_mul_i32 s75, s60, 589824
    s_lshl_b32 s76, s63, 10
    s_add_u32 s75, s75, s76
    s_add_u32 s75, s75, 121532416
    buffer_load_dwordx4 v[16:19], v8, s[8:11], s75 offen
    s_add_u32 s75, s75, 73728
    buffer_load_dwordx4 v[20:23], v8, s[8:11], s75 offen
    s_add_u32 s75, s75, 73728
    buffer_load_dwordx4 v[24:27], v8, s[8:11], s75 offen
    s_add_u32 s75, s75, 73728
    buffer_load_dwordx4 v[28:31], v8, s[8:11], s75 offen
    s_add_u32 s75, s75, 73728
    buffer_load_dwordx4 v[32:35], v8, s[8:11], s75 offen
    s_add_u32 s75, s75, 73728
    buffer_load_dwordx4 v[36:39], v8, s[8:11], s75 offen
    s_add_u32 s75, s75, 73728
    buffer_load_dwordx4 v[40:43], v8, s[8:11], s75 offen
    s_add_u32 s75, s75, 73728
    buffer_load_dwordx4 v[44:47], v8, s[8:11], s75 offen
    s_cmp_ge_u32 s63, 36
    s_cselect_b32 s76, 16, 0
    s_cselect_b32 s77, 36, 0
    s_sub_u32 s77, s63, s77
    s_lshl_b32 s75, s60, 5
    s_add_u32 s75, s75, s76
    s_mul_i32 s75, s75, 1152
    s_lshl_b32 s77, s77, 5
    s_add_u32 s75, s75, s77
    s_waitcnt vmcnt(6)
    v_pk_add_f32 v[16:17], v[16:17], v[20:21]
    v_pk_add_f32 v[18:19], v[18:19], v[22:23]
    s_waitcnt vmcnt(4)
    v_pk_add_f32 v[24:25], v[24:25], v[28:29]
    v_pk_add_f32 v[26:27], v[26:27], v[30:31]
    s_waitcnt vmcnt(2)
    v_pk_add_f32 v[32:33], v[32:33], v[36:37]
    v_pk_add_f32 v[34:35], v[34:35], v[38:39]
    s_waitcnt vmcnt(0)
    v_pk_add_f32 v[40:41], v[40:41], v[44:45]
    v_pk_add_f32 v[42:43], v[42:43], v[46:47]
    v_pk_add_f32 v[16:17], v[16:17], v[24:25]
    v_pk_add_f32 v[18:19], v[18:19], v[26:27]
    v_pk_add_f32 v[32:33], v[32:33], v[40:41]
    v_pk_add_f32 v[34:35], v[34:35], v[42:43]
    v_pk_add_f32 v[16:17], v[16:17], v[32:33]
    v_pk_add_f32 v[18:19], v[18:19], v[34:35]
    v_cvt_pk_bf16_f32 v16, v16, v17
    v_cvt_pk_bf16_f32 v17, v18, v19
    v_lshlrev_b32 v102, 16, v240
    v_and_b32 v103, 0xffff0000, v240
    v_lshlrev_b32 v104, 16, v16
    v_and_b32 v105, 0xffff0000, v16
    v_add_f32 v102, v102, v104
    v_add_f32 v103, v103, v105
    v_cvt_pk_bf16_f32 v102, v102, v103
    v_and_b32 v103, 0xffff0000, v102
    v_lshlrev_b32 v102, 16, v102
    v_lshlrev_b32 v104, 16, v242
    v_and_b32 v105, 0xffff0000, v242
    v_add_f32 v102, v102, v104
    v_add_f32 v103, v103, v105
    v_cvt_pk_bf16_f32 v106, v102, v103
    v_lshlrev_b32 v102, 16, v241
    v_and_b32 v103, 0xffff0000, v241
    v_lshlrev_b32 v104, 16, v17
    v_and_b32 v105, 0xffff0000, v17
    v_add_f32 v102, v102, v104
    v_add_f32 v103, v103, v105
    v_cvt_pk_bf16_f32 v102, v102, v103
    v_and_b32 v103, 0xffff0000, v102
    v_lshlrev_b32 v102, 16, v102
    v_lshlrev_b32 v104, 16, v243
    v_and_b32 v105, 0xffff0000, v243
    v_add_f32 v102, v102, v104
    v_add_f32 v103, v103, v105
    v_cvt_pk_bf16_f32 v107, v102, v103
    buffer_store_dwordx2 v[106:107], v14, s[20:23], s75 offen
TL_nf:
    s_add_u32 s82, s82, 1
    s_add_u32 s60, s60, 7
    s_cmp_lt_u32 s60, 64
    s_cbranch_scc1 TL_loop
    s_branch W_fin
TL_end:
W_fin:
W_X:
    s_endpgm

.section .rodata,"a"
.p2align 6
.amdhsa_kernel parallel_sum__memory_aug_recurrent_mem_tr__dense_activation_relu__prompt_kernel
  .amdhsa_next_free_vgpr 512
  .amdhsa_next_free_sgpr 102
  .amdhsa_accum_offset 256
  .amdhsa_group_segment_fixed_size 0
  .amdhsa_kernarg_size 104
  .amdhsa_user_sgpr_count 2
  .amdhsa_user_sgpr_kernarg_segment_ptr 1
  .amdhsa_system_sgpr_workgroup_id_x 1
.end_amdhsa_kernel
```
